```python
import torch

def _softmax(x, axis=-1):
    return torch.softmax(x, dim=axis)

def _gelu(x):
    return torch.nn.functional.gelu(x, approximate='tanh')

def _silu(x):
    return torch.nn.functional.silu(x)

def _sigmoid(x):
    return torch.sigmoid(x)

def _layernorm(x, axis=-1, eps=1e-05):
    m = x.mean(dim=axis, keepdim=True)
    v = x.var(dim=axis, keepdim=True, unbiased=False)
    return (x - m) / torch.sqrt(v + eps)

def _scatter_add(tgt, idx, src, axis=0):
    return tgt.clone().index_add_(axis, idx, src)

def _segment_sum(src, seg, n):
    out = torch.zeros((n,) + src.shape[1:], dtype=src.dtype)
    return out.index_add_(0, seg, src)

def _pad(x, pw):
    flat = tuple((v for pair in reversed(pw) for v in pair))
    return torch.nn.functional.pad(x, flat)
kernel_name = 'adaLN_cond__gqa_block_cached__glu_gated_bilinear__decode'

def setup_inputs():

    _w = lambda a: (lambda t: t.to(torch.bfloat16) if t.is_floating_point() else t)(torch.as_tensor(a))

    def _A_setup():
        B, Sq, D = (4, 1, 512)
        Hq, Hkv, Sk, Dh = (32, 8, 8192, 128)
        assert Hq % Hkv == 0, (Hq, Hkv)
        return {'x': _w((lambda *s: torch.randn(*s, dtype=torch.bfloat16) * 0.1)(B, Sq, D)), 'k_cache': _w((lambda *s: torch.randn(*s, dtype=torch.bfloat16) * 0.8)(B, Hkv, Sk, Dh)), 'v_cache': _w((lambda *s: torch.randn(*s, dtype=torch.bfloat16) * 3.2)(B, Hkv, Sk, Dh)), 'wq': _w((lambda *s: torch.randn(*s, dtype=torch.bfloat16) * 0.8)(D, Hq * Dh) * D ** (-0.5)), 'wo': _w((lambda *s: torch.randn(*s, dtype=torch.bfloat16) * 3.2)(Hq * Dh, D) * (Hq * Dh) ** (-0.5))}
    _A_in = _A_setup()

    def _B_setup():
        B, S, D, F = (4, 1, 512, 1792)
        return {'x': _w((lambda *s: torch.randn(*s, dtype=torch.bfloat16) * 0.1)(B, S, D)), 'w_gate': _w((lambda *s: torch.randn(*s, dtype=torch.bfloat16) * 3.2)(D, F) * D ** (-0.5)), 'w_up': _w((lambda *s: torch.randn(*s, dtype=torch.bfloat16) * 3.2)(D, F) * D ** (-0.5)), 'w_down': _w((lambda *s: torch.randn(*s, dtype=torch.bfloat16) * 3.2)(F, D) * F ** (-0.5))}
    _B_in = _B_setup()
    return {'A_x': _A_in['x'], 'A_k_cache': _A_in['k_cache'], 'A_v_cache': _A_in['v_cache'], 'A_wq': _A_in['wq'], 'A_wo': _A_in['wo'], 'B_x': _B_in['x'], 'B_w_gate': _B_in['w_gate'], 'B_w_up': _B_in['w_up'], 'B_w_down': _B_in['w_down'], 'c': _w((lambda *s: torch.randn(*s, dtype=torch.bfloat16) * 0.4)(4, 512) * 8.0), 'w_mod': _w((lambda *s: torch.randn(*s, dtype=torch.bfloat16) * 0.4)(512, 6 * 512) * 512 ** (-0.5) * 8.0)}

def reference(A_x, A_k_cache, A_v_cache, A_wq, A_wo, B_x, B_w_gate, B_w_up, B_w_down, c, w_mod):

    def _A_ref(x, k_cache, v_cache, wq, wo):
        B, Sq, D = x.shape
        Hq, Dh = (32, 128)
        Hkv = k_cache.shape[1]
        rep = Hq // Hkv
        q = (lambda x, *d: x.permute(*d))((x @ wq).reshape(B, Sq, Hq, Dh), 0, 2, 1, 3)
        k = (lambda x, n, axis: torch.repeat_interleave(x, n, dim=axis))(k_cache, rep, axis=1)
        v = (lambda x, n, axis: torch.repeat_interleave(x, n, dim=axis))(v_cache, rep, axis=1)
        scores = torch.einsum('bhqd,bhkd->bhqk', q, k) * Dh ** (-0.5)
        p = _softmax(scores, axis=-1)
        o = torch.einsum('bhqk,bhkd->bhqd', p, v)
        return (lambda x, *d: x.permute(*d))(o, 0, 2, 1, 3).reshape(B, Sq, Hq * Dh) @ wo

    def _B_ref(x, w_gate, w_up, w_down):
        g = torch.einsum('bsd,df->bsf', x, w_gate)
        u = torch.einsum('bsd,df->bsf', x, w_up)
        h = g * u
        return torch.einsum('bsf,fd->bsd', h, w_down)
    x = A_x
    mod = (_silu(c) @ w_mod).reshape(c.shape[0], 6, 1, -1)
    sa, ca, ga, sb, cb, gb = (mod[:, 0].clone(), mod[:, 1].clone(), mod[:, 2].clone(), mod[:, 3].clone(), mod[:, 4].clone(), mod[:, 5].clone())
    h = _layernorm(x, axis=-1) * (1 + ca) + sa
    x = x + ga * _A_ref(h, A_k_cache, A_v_cache, A_wq, A_wo)
    h = _layernorm(x, axis=-1) * (1 + cb) + sb
    x = x + gb * _B_ref(h, B_w_gate, B_w_up, B_w_down)
    return x
```

```asm
; @launch grid=(256,1,1) block=(256,1,1) lds=27200
.amdgcn_target "amdgcn-amd-amdhsa--gfx950"
.text
.globl adaLN_cond__gqa_block_cached__glu_gated_bilinear__decode_kernel
.p2align 8
.type adaLN_cond__gqa_block_cached__glu_gated_bilinear__decode_kernel,@function
adaLN_cond__gqa_block_cached__glu_gated_bilinear__decode_kernel:
    s_cmp_ge_u32 s2, 256
    s_cbranch_scc1 L_exit
    s_load_dwordx16 s[32:47], s[0:1], 0
    s_load_dwordx8 s[48:55], s[0:1], 64
    s_load_dwordx2 s[56:57], s[0:1], 104
    v_lshrrev_b32 v10, 6, v0
    v_and_b32 v1, 63, v0
    v_readfirstlane_b32 s3, v10
    v_bfe_u32 v2, v1, 1, 1
    v_lshlrev_b32 v2, 13, v2
    v_bfe_u32 v10, v1, 2, 2
    v_lshl_add_u32 v2, v10, 8, v2
    v_and_b32 v10, 1, v1
    v_lshl_add_u32 v2, v10, 6, v2
    v_lshrrev_b32 v10, 4, v1
    v_lshl_add_u32 v2, v10, 4, v2
    v_lshlrev_b32 v3, 4, v1
    s_lshl_b32 s59, s2, 18
    s_lshl_b32 s61, s3, 16
    s_add_u32 s59, s59, s61
    s_lshr_b32 s61, s2, 4
    s_xor_b32 s61, s61, s2
    s_lshr_b32 s64, s61, 2
    s_xor_b32 s61, s61, s64
    s_xor_b32 s61, s61, s3
    s_and_b32 s61, s61, 3
    s_lshl_b32 s61, s61, 14
    s_add_u32 s59, s59, s61
    s_mov_b32 s60, s59
    v_lshrrev_b32 v5, 2, v1
    v_lshlrev_b32 v5, 4, v5
    s_lshl_b32 s61, s3, 9
    v_add_u32 v5, s61, v5
    s_mov_b32 s65, 0xff
    s_mov_b32 s66, 0xffff0000
    s_mov_b32 s67, 0x5040100
    s_mov_b32 s68, 0x7060302
    s_mov_b32 s69, 0x3fb8aa3b
    s_mov_b32 s70, 0x3db504f3
    s_mov_b32 s71, 0x3727c5ac
    s_mov_b32 s76, 0x3f80
    s_mov_b32 s77, 0x3f800000
    s_mov_b32 s78, 0x3f803f80
    s_mov_b32 s72, 0xff00ff
    s_mov_b32 s73, 0xff00ff
    s_mov_b32 s74, 0xff00ff00
    s_mov_b32 s75, 0xff00ff00
    s_waitcnt lgkmcnt(0)
    s_load_dword s58, s[56:57], 0
    s_mov_b32 s4, s34
    s_mov_b32 s5, s35
    s_mov_b32 s6, 0x4000000
    s_mov_b32 s7, 0x20000
    s_mov_b32 s8, s36
    s_mov_b32 s9, s37
    s_mov_b32 s10, 0x4000000
    s_mov_b32 s11, 0x20000
    s_mov_b32 s12, s56
    s_mov_b32 s13, s57
    s_mov_b32 s14, 0x600000
    s_mov_b32 s15, 0x20000
    s_mov_b32 s24, s32
    s_mov_b32 s25, s33
    s_mov_b32 s26, 0x1000
    s_mov_b32 s27, 0x20000
    s_cmp_lt_u32 s2, 48
    s_cbranch_scc1 CLS_X
    s_cmp_lt_u32 s2, 104
    s_cbranch_scc1 CLS_G
    s_cmp_lt_u32 s2, 112
    s_cbranch_scc1 CLS_Q
    s_cmp_lt_u32 s2, 176
    s_cbranch_scc1 CLS_W
    s_cmp_lt_u32 s2, 232
    s_cbranch_scc1 CLS_F
    s_cmp_lt_u32 s2, 248
    s_cbranch_scc1 CLS_Y
    s_branch CLS_N
L_exit:
    s_endpgm
.p2align 6
CLS_X:
    s_mov_b32 s16, s52
    s_mov_b32 s17, s53
    s_mov_b32 s18, 0x300000
    s_mov_b32 s19, 0x20000
    s_mov_b32 s28, s50
    s_mov_b32 s29, s51
    s_mov_b32 s30, 0x1000
    s_mov_b32 s31, 0x20000
    s_and_b32 s63, s2, 7
    s_mul_i32 s63, s63, 6
    s_lshr_b32 s64, s2, 3
    s_add_u32 s63, s63, s64
    s_lshl_b32 s64, s63, 7
    v_lshrrev_b32 v10, 4, v1
    v_lshlrev_b32 v10, 5, v10
    s_lshl_b32 s61, s3, 7
    v_add_u32 v10, s61, v10
    s_movk_i32 s61, 6144
    v_mul_lo_u32 v10, v10, s61
    v_and_b32 v11, 3, v1
    v_lshl_add_u32 v10, v11, 4, v10
    v_bfe_u32 v11, v1, 2, 1
    v_lshl_add_u32 v10, v11, 3, v10
    v_bfe_u32 v11, v1, 3, 1
    v_lshl_add_u32 v10, v11, 6, v10
    v_add_u32 v6, s64, v10
    v_and_b32 v10, 3, v1
    v_lshlrev_b32 v10, 10, v10
    v_lshrrev_b32 v11, 4, v1
    v_lshl_add_u32 v10, v11, 6, v10
    v_bfe_u32 v11, v1, 2, 2
    v_lshl_add_u32 v10, v11, 2, v10
    s_lshl_b32 s61, s3, 8
    v_add_u32 v7, s61, v10
    buffer_load_dword v244, v7, s[28:31], 0 offen offset:0
    buffer_load_dword v245, v7, s[28:31], 0 offen offset:16
    buffer_load_dword v246, v7, s[28:31], 0 offen offset:32
    buffer_load_dword v247, v7, s[28:31], 0 offen offset:48
    buffer_load_dwordx2 v[64:65], v6, s[16:19], 0 offen offset:0 nt
    s_mov_b32 s61, 0x1000
    buffer_load_dwordx2 v[66:67], v6, s[16:19], s61 offen offset:2048 nt
    s_mov_b32 s61, 0x3000
    buffer_load_dwordx2 v[80:81], v6, s[16:19], s61 offen offset:0 nt
    s_mov_b32 s61, 0x4000
    buffer_load_dwordx2 v[82:83], v6, s[16:19], s61 offen offset:2048 nt
    s_mov_b32 s61, 0x6000
    buffer_load_dwordx2 v[96:97], v6, s[16:19], s61 offen offset:0 nt
    s_mov_b32 s61, 0x7000
    buffer_load_dwordx2 v[98:99], v6, s[16:19], s61 offen offset:2048 nt
    s_mov_b32 s61, 0x9000
    buffer_load_dwordx2 v[112:113], v6, s[16:19], s61 offen offset:0 nt
    s_mov_b32 s61, 0xa000
    buffer_load_dwordx2 v[114:115], v6, s[16:19], s61 offen offset:2048 nt
    s_mov_b32 s61, 0xc000
    buffer_load_dwordx2 v[68:69], v6, s[16:19], s61 offen offset:0 nt
    s_mov_b32 s61, 0xd000
    buffer_load_dwordx2 v[70:71], v6, s[16:19], s61 offen offset:2048 nt
    s_mov_b32 s61, 0xf000
    buffer_load_dwordx2 v[84:85], v6, s[16:19], s61 offen offset:0 nt
    s_mov_b32 s61, 0x10000
    buffer_load_dwordx2 v[86:87], v6, s[16:19], s61 offen offset:2048 nt
    s_mov_b32 s61, 0x12000
    buffer_load_dwordx2 v[100:101], v6, s[16:19], s61 offen offset:0 nt
    s_mov_b32 s61, 0x13000
    buffer_load_dwordx2 v[102:103], v6, s[16:19], s61 offen offset:2048 nt
    s_mov_b32 s61, 0x15000
    buffer_load_dwordx2 v[116:117], v6, s[16:19], s61 offen offset:0 nt
    s_mov_b32 s61, 0x16000
    buffer_load_dwordx2 v[118:119], v6, s[16:19], s61 offen offset:2048 nt
    s_mov_b32 s61, 0x18000
    buffer_load_dwordx2 v[72:73], v6, s[16:19], s61 offen offset:0 nt
    s_mov_b32 s61, 0x19000
    buffer_load_dwordx2 v[74:75], v6, s[16:19], s61 offen offset:2048 nt
    s_mov_b32 s61, 0x1b000
    buffer_load_dwordx2 v[88:89], v6, s[16:19], s61 offen offset:0 nt
    s_mov_b32 s61, 0x1c000
    buffer_load_dwordx2 v[90:91], v6, s[16:19], s61 offen offset:2048 nt
    s_mov_b32 s61, 0x1e000
    buffer_load_dwordx2 v[104:105], v6, s[16:19], s61 offen offset:0 nt
    s_mov_b32 s61, 0x1f000
    buffer_load_dwordx2 v[106:107], v6, s[16:19], s61 offen offset:2048 nt
    s_mov_b32 s61, 0x21000
    buffer_load_dwordx2 v[120:121], v6, s[16:19], s61 offen offset:0 nt
    s_mov_b32 s61, 0x22000
    buffer_load_dwordx2 v[122:123], v6, s[16:19], s61 offen offset:2048 nt
    s_mov_b32 s61, 0x24000
    buffer_load_dwordx2 v[76:77], v6, s[16:19], s61 offen offset:0 nt
    s_mov_b32 s61, 0x25000
    buffer_load_dwordx2 v[78:79], v6, s[16:19], s61 offen offset:2048 nt
    s_mov_b32 s61, 0x27000
    buffer_load_dwordx2 v[92:93], v6, s[16:19], s61 offen offset:0 nt
    s_mov_b32 s61, 0x28000
    buffer_load_dwordx2 v[94:95], v6, s[16:19], s61 offen offset:2048 nt
    s_mov_b32 s61, 0x2a000
    buffer_load_dwordx2 v[108:109], v6, s[16:19], s61 offen offset:0 nt
    s_mov_b32 s61, 0x2b000
    buffer_load_dwordx2 v[110:111], v6, s[16:19], s61 offen offset:2048 nt
    s_mov_b32 s61, 0x2d000
    buffer_load_dwordx2 v[124:125], v6, s[16:19], s61 offen offset:0 nt
    s_mov_b32 s61, 0x2e000
    buffer_load_dwordx2 v[126:127], v6, s[16:19], s61 offen offset:2048 nt
    s_waitcnt vmcnt(32)
    v_lshlrev_b32 v192, 16, v244
    v_and_b32 v196, s66, v244
    v_lshlrev_b32 v193, 16, v245
    v_and_b32 v197, s66, v245
    v_lshlrev_b32 v194, 16, v246
    v_and_b32 v198, s66, v246
    v_lshlrev_b32 v195, 16, v247
    v_and_b32 v199, s66, v247
    s_mov_b32 s64, 0x32a57060
    s_mov_b32 s62, 0x3f317218
    v_mul_f32 v200, s69, v192
    v_mul_f32 v201, s69, v193
    v_mul_f32 v202, s69, v194
    v_mul_f32 v203, s69, v195
    v_mul_f32 v204, s69, v196
    v_mul_f32 v205, s69, v197
    v_mul_f32 v206, s69, v198
    v_mul_f32 v207, s69, v199
    v_fma_f32 v32, v192, s69, -v200
    v_fma_f32 v33, v193, s69, -v201
    v_fma_f32 v34, v194, s69, -v202
    v_fma_f32 v35, v195, s69, -v203
    v_fma_f32 v36, v196, s69, -v204
    v_fma_f32 v37, v197, s69, -v205
    v_fma_f32 v38, v198, s69, -v206
    v_fma_f32 v39, v199, s69, -v207
    v_fma_f32 v32, v192, s64, v32
    v_fma_f32 v33, v193, s64, v33
    v_fma_f32 v34, v194, s64, v34
    v_fma_f32 v35, v195, s64, v35
    v_fma_f32 v36, v196, s64, v36
    v_fma_f32 v37, v197, s64, v37
    v_fma_f32 v38, v198, s64, v38
    v_fma_f32 v39, v199, s64, v39
    v_max_f32 v200, 0xc2fc0000, v200
    v_max_f32 v201, 0xc2fc0000, v201
    v_max_f32 v202, 0xc2fc0000, v202
    v_max_f32 v203, 0xc2fc0000, v203
    v_max_f32 v204, 0xc2fc0000, v204
    v_max_f32 v205, 0xc2fc0000, v205
    v_max_f32 v206, 0xc2fc0000, v206
    v_max_f32 v207, 0xc2fc0000, v207
    v_exp_f32 v200, -v200
    v_exp_f32 v201, -v201
    v_exp_f32 v202, -v202
    v_exp_f32 v203, -v203
    v_exp_f32 v204, -v204
    v_exp_f32 v205, -v205
    v_exp_f32 v206, -v206
    v_exp_f32 v207, -v207
    v_mul_f32 v32, s62, v32
    v_mul_f32 v33, s62, v33
    v_mul_f32 v34, s62, v34
    v_mul_f32 v35, s62, v35
    v_mul_f32 v36, s62, v36
    v_mul_f32 v37, s62, v37
    v_mul_f32 v38, s62, v38
    v_mul_f32 v39, s62, v39
    v_fma_f32 v200, -v200, v32, v200
    v_fma_f32 v201, -v201, v33, v201
    v_fma_f32 v202, -v202, v34, v202
    v_fma_f32 v203, -v203, v35, v203
    v_fma_f32 v204, -v204, v36, v204
    v_fma_f32 v205, -v205, v37, v205
    v_fma_f32 v206, -v206, v38, v206
    v_fma_f32 v207, -v207, v39, v207
    v_add_f32 v200, 1.0, v200
    v_add_f32 v201, 1.0, v201
    v_add_f32 v202, 1.0, v202
    v_add_f32 v203, 1.0, v203
    v_add_f32 v204, 1.0, v204
    v_add_f32 v205, 1.0, v205
    v_add_f32 v206, 1.0, v206
    v_add_f32 v207, 1.0, v207
    v_rcp_f32 v32, v200
    v_rcp_f32 v33, v201
    v_rcp_f32 v34, v202
    v_rcp_f32 v35, v203
    v_rcp_f32 v36, v204
    v_rcp_f32 v37, v205
    v_rcp_f32 v38, v206
    v_rcp_f32 v39, v207
    v_mul_f32 v40, v192, v32
    v_mul_f32 v41, v193, v33
    v_mul_f32 v42, v194, v34
    v_mul_f32 v43, v195, v35
    v_mul_f32 v44, v196, v36
    v_mul_f32 v45, v197, v37
    v_mul_f32 v46, v198, v38
    v_mul_f32 v47, v199, v39
    v_fma_f32 v192, -v40, v200, v192
    v_fma_f32 v193, -v41, v201, v193
    v_fma_f32 v194, -v42, v202, v194
    v_fma_f32 v195, -v43, v203, v195
    v_fma_f32 v196, -v44, v204, v196
    v_fma_f32 v197, -v45, v205, v197
    v_fma_f32 v198, -v46, v206, v198
    v_fma_f32 v199, -v47, v207, v199
    v_fma_f32 v192, v192, v32, v40
    v_fma_f32 v193, v193, v33, v41
    v_fma_f32 v194, v194, v34, v42
    v_fma_f32 v195, v195, v35, v43
    v_fma_f32 v196, v196, v36, v44
    v_fma_f32 v197, v197, v37, v45
    v_fma_f32 v198, v198, v38, v46
    v_fma_f32 v199, v199, v39, v47
    v_cvt_pk_bf16_f32 v240, v192, v196
    v_cvt_pk_bf16_f32 v241, v193, v197
    v_cvt_pk_bf16_f32 v242, v194, v198
    v_cvt_pk_bf16_f32 v243, v195, v199
    buffer_load_dwordx4 a[0:3], v2, s[4:7], s59 offen offset:0 nt
    buffer_load_dwordx4 a[4:7], v2, s[4:7], s59 offen offset:128 nt
    buffer_load_dwordx4 a[8:11], v2, s[4:7], s59 offen offset:1024 nt
    buffer_load_dwordx4 a[12:15], v2, s[4:7], s59 offen offset:1152 nt
    buffer_load_dwordx4 a[16:19], v2, s[4:7], s59 offen offset:2048 nt
    buffer_load_dwordx4 a[20:23], v2, s[4:7], s59 offen offset:2176 nt
    buffer_load_dwordx4 a[24:27], v2, s[4:7], s59 offen offset:3072 nt
    buffer_load_dwordx4 a[28:31], v2, s[4:7], s59 offen offset:3200 nt
    s_add_u32 s79, s59, 4096
    s_pack_lh_b32_b16 s59, s79, s59
    v_mov_b32 v48, 0
    v_mov_b32 v49, 0
    v_mov_b32 v50, 0
    v_mov_b32 v51, 0
    v_mov_b32 v52, 0
    v_mov_b32 v53, 0
    v_mov_b32 v54, 0
    v_mov_b32 v55, 0
    v_mov_b32 v56, 0
    v_mov_b32 v57, 0
    v_mov_b32 v58, 0
    v_mov_b32 v59, 0
    v_mov_b32 v60, 0
    v_mov_b32 v61, 0
    v_mov_b32 v62, 0
    v_mov_b32 v63, 0
    v_lshrrev_b32 v10, 4, v1
    v_add_u32 v10, v10, v1
    v_and_b32 v10, 3, v10
    v_and_b32 v11, 60, v1
    v_or_b32 v10, v10, v11
    v_lshlrev_b32 v10, 4, v10
    s_lshl_b32 s61, s3, 10
    v_add_u32 v8, s61, v10
    v_lshrrev_b32 v10, 4, v1
    v_bfe_u32 v11, v1, 2, 2
    v_add_u32 v10, v10, v11
    v_and_b32 v10, 3, v10
    v_and_b32 v11, 15, v1
    v_lshl_or_b32 v10, v11, 2, v10
    v_lshlrev_b32 v14, 4, v10
    s_lshr_b32 s61, s63, 1
    s_lshl_b32 s61, s61, 9
    s_mov_b32 s64, s61
    s_and_b32 s61, s63, 1
    s_lshl_b32 s61, s61, 7
    s_add_u32 s64, s64, s61
    v_lshrrev_b32 v10, 4, v1
    v_mul_u32_u24 v10, 0x3000, v10
    v_and_b32 v11, 1, v1
    v_lshl_add_u32 v10, v11, 8, v10
    v_bfe_u32 v11, v1, 1, 3
    v_lshl_add_u32 v10, v11, 4, v10
    v_add_u32 v15, s64, v10
    s_add_u32 s58, s58, 0x9e3779b9
    v_mov_b32 v4, s58
    s_waitcnt vmcnt(8)
    v_perm_b32 v128, v66, v64, s67
    v_perm_b32 v129, v70, v68, s67
    v_perm_b32 v130, v74, v72, s67
    v_perm_b32 v131, v78, v76, s67
    v_perm_b32 v132, v66, v64, s68
    v_perm_b32 v133, v70, v68, s68
    v_perm_b32 v134, v74, v72, s68
    v_perm_b32 v135, v78, v76, s68
    v_perm_b32 v136, v67, v65, s67
    v_perm_b32 v137, v71, v69, s67
    v_perm_b32 v138, v75, v73, s67
    v_perm_b32 v139, v79, v77, s67
    v_perm_b32 v140, v67, v65, s68
    v_perm_b32 v141, v71, v69, s68
    v_perm_b32 v142, v75, v73, s68
    v_perm_b32 v143, v79, v77, s68
    v_perm_b32 v144, v82, v80, s67
    v_perm_b32 v145, v86, v84, s67
    v_perm_b32 v146, v90, v88, s67
    v_perm_b32 v147, v94, v92, s67
    v_perm_b32 v148, v82, v80, s68
    v_perm_b32 v149, v86, v84, s68
    v_perm_b32 v150, v90, v88, s68
    v_perm_b32 v151, v94, v92, s68
    v_perm_b32 v152, v83, v81, s67
    v_perm_b32 v153, v87, v85, s67
    v_perm_b32 v154, v91, v89, s67
    v_perm_b32 v155, v95, v93, s67
    v_perm_b32 v156, v83, v81, s68
    v_perm_b32 v157, v87, v85, s68
    v_perm_b32 v158, v91, v89, s68
    v_perm_b32 v159, v95, v93, s68
    v_perm_b32 v160, v98, v96, s67
    v_perm_b32 v161, v102, v100, s67
    v_perm_b32 v162, v106, v104, s67
    v_perm_b32 v163, v110, v108, s67
    v_perm_b32 v164, v98, v96, s68
    v_perm_b32 v165, v102, v100, s68
    v_perm_b32 v166, v106, v104, s68
    v_perm_b32 v167, v110, v108, s68
    v_perm_b32 v168, v99, v97, s67
    v_perm_b32 v169, v103, v101, s67
    v_perm_b32 v170, v107, v105, s67
    v_perm_b32 v171, v111, v109, s67
    v_perm_b32 v172, v99, v97, s68
    v_perm_b32 v173, v103, v101, s68
    v_perm_b32 v174, v107, v105, s68
    v_perm_b32 v175, v111, v109, s68
    v_perm_b32 v176, v114, v112, s67
    v_perm_b32 v177, v118, v116, s67
    v_perm_b32 v178, v122, v120, s67
    v_perm_b32 v179, v126, v124, s67
    v_perm_b32 v180, v114, v112, s68
    v_perm_b32 v181, v118, v116, s68
    v_perm_b32 v182, v122, v120, s68
    v_perm_b32 v183, v126, v124, s68
    v_perm_b32 v184, v115, v113, s67
    v_perm_b32 v185, v119, v117, s67
    v_perm_b32 v186, v123, v121, s67
    v_perm_b32 v187, v127, v125, s67
    v_perm_b32 v188, v115, v113, s68
    v_perm_b32 v189, v119, v117, s68
    v_perm_b32 v190, v123, v121, s68
    v_perm_b32 v191, v127, v125, s68
    v_mov_b32_dpp v48, v240 quad_perm:[0,1,2,3] row_mask:0xf bank_mask:0x1
    v_mov_b32_dpp v49, v241 quad_perm:[0,1,2,3] row_mask:0xf bank_mask:0x1
    v_mov_b32_dpp v50, v242 quad_perm:[0,1,2,3] row_mask:0xf bank_mask:0x1
    v_mov_b32_dpp v51, v243 quad_perm:[0,1,2,3] row_mask:0xf bank_mask:0x1
    s_nop 1
    v_mfma_f32_16x16x32_bf16 v[64:67], v[128:131], v[48:51], 0
    v_mov_b32_dpp v52, v240 quad_perm:[0,1,2,3] row_mask:0xf bank_mask:0x2
    v_mov_b32_dpp v53, v241 quad_perm:[0,1,2,3] row_mask:0xf bank_mask:0x2
    v_mfma_f32_16x16x32_bf16 v[68:71], v[132:135], v[48:51], 0
    v_mov_b32_dpp v54, v242 quad_perm:[0,1,2,3] row_mask:0xf bank_mask:0x2
    v_mov_b32_dpp v55, v243 quad_perm:[0,1,2,3] row_mask:0xf bank_mask:0x2
    s_nop 1
    v_mfma_f32_16x16x32_bf16 v[64:67], v[144:147], v[52:55], v[64:67]
    v_mov_b32_dpp v56, v240 quad_perm:[0,1,2,3] row_mask:0xf bank_mask:0x4
    v_mov_b32_dpp v57, v241 quad_perm:[0,1,2,3] row_mask:0xf bank_mask:0x4
    v_mfma_f32_16x16x32_bf16 v[68:71], v[148:151], v[52:55], v[68:71]
    v_mov_b32_dpp v58, v242 quad_perm:[0,1,2,3] row_mask:0xf bank_mask:0x4
    v_mov_b32_dpp v59, v243 quad_perm:[0,1,2,3] row_mask:0xf bank_mask:0x4
    s_nop 1
    v_mfma_f32_16x16x32_bf16 v[64:67], v[160:163], v[56:59], v[64:67]
    v_mov_b32_dpp v60, v240 quad_perm:[0,1,2,3] row_mask:0xf bank_mask:0x8
    v_mov_b32_dpp v61, v241 quad_perm:[0,1,2,3] row_mask:0xf bank_mask:0x8
    v_mfma_f32_16x16x32_bf16 v[68:71], v[164:167], v[56:59], v[68:71]
    v_mov_b32_dpp v62, v242 quad_perm:[0,1,2,3] row_mask:0xf bank_mask:0x8
    v_mov_b32_dpp v63, v243 quad_perm:[0,1,2,3] row_mask:0xf bank_mask:0x8
    s_nop 1
    v_mfma_f32_16x16x32_bf16 v[64:67], v[176:179], v[60:63], v[64:67]
    v_mfma_f32_16x16x32_bf16 v[68:71], v[180:183], v[60:63], v[68:71]
    v_mfma_f32_16x16x32_bf16 v[72:75], v[136:139], v[48:51], 0
    v_mfma_f32_16x16x32_bf16 v[76:79], v[140:143], v[48:51], 0
    v_mfma_f32_16x16x32_bf16 v[72:75], v[152:155], v[52:55], v[72:75]
    v_mfma_f32_16x16x32_bf16 v[76:79], v[156:159], v[52:55], v[76:79]
    s_nop 2
    v_add_f32_dpp v80, v64, v64 row_shl:4 row_mask:0xf bank_mask:0x5
    v_add_f32_dpp v82, v65, v65 row_shl:4 row_mask:0xf bank_mask:0x5
    v_mfma_f32_16x16x32_bf16 v[72:75], v[168:171], v[56:59], v[72:75]
    v_add_f32_dpp v84, v66, v66 row_shl:4 row_mask:0xf bank_mask:0x5
    v_add_f32_dpp v86, v67, v67 row_shl:4 row_mask:0xf bank_mask:0x5
    v_mfma_f32_16x16x32_bf16 v[76:79], v[172:175], v[56:59], v[76:79]
    v_add_f32_dpp v80, v68, v68 row_shr:4 row_mask:0xf bank_mask:0xa
    v_add_f32_dpp v82, v69, v69 row_shr:4 row_mask:0xf bank_mask:0xa
    v_mfma_f32_16x16x32_bf16 v[72:75], v[184:187], v[60:63], v[72:75]
    v_add_f32_dpp v84, v70, v70 row_shr:4 row_mask:0xf bank_mask:0xa
    v_add_f32_dpp v86, v71, v71 row_shr:4 row_mask:0xf bank_mask:0xa
    v_mfma_f32_16x16x32_bf16 v[76:79], v[188:191], v[60:63], v[76:79]
    s_nop 4
    v_add_f32_dpp v81, v72, v72 row_shl:4 row_mask:0xf bank_mask:0x5
    v_add_f32_dpp v83, v73, v73 row_shl:4 row_mask:0xf bank_mask:0x5
    v_add_f32_dpp v85, v74, v74 row_shl:4 row_mask:0xf bank_mask:0x5
    v_add_f32_dpp v87, v75, v75 row_shl:4 row_mask:0xf bank_mask:0x5
    v_add_f32_dpp v81, v76, v76 row_shr:4 row_mask:0xf bank_mask:0xa
    v_add_f32_dpp v83, v77, v77 row_shr:4 row_mask:0xf bank_mask:0xa
    v_add_f32_dpp v85, v78, v78 row_shr:4 row_mask:0xf bank_mask:0xa
    v_add_f32_dpp v87, v79, v79 row_shr:4 row_mask:0xf bank_mask:0xa
    v_add_f32_dpp v88, v80, v80 row_shl:8 row_mask:0xf bank_mask:0x3
    v_add_f32_dpp v89, v82, v82 row_shl:8 row_mask:0xf bank_mask:0x3
    v_add_f32_dpp v90, v84, v84 row_shl:8 row_mask:0xf bank_mask:0x3
    v_add_f32_dpp v91, v86, v86 row_shl:8 row_mask:0xf bank_mask:0x3
    v_add_f32_dpp v88, v81, v81 row_shr:8 row_mask:0xf bank_mask:0xc
    v_add_f32_dpp v89, v83, v83 row_shr:8 row_mask:0xf bank_mask:0xc
    v_add_f32_dpp v90, v85, v85 row_shr:8 row_mask:0xf bank_mask:0xc
    v_add_f32_dpp v91, v87, v87 row_shr:8 row_mask:0xf bank_mask:0xc
    ds_write_b128 v8, v[88:91] offset:0
    s_waitcnt lgkmcnt(0)
    s_barrier
    s_cmp_lg_u32 s3, 0
    s_cbranch_scc1 HS_X
    ds_read_b128 v[192:195], v14 offset:0
    ds_read_b128 v[196:199], v14 offset:1024
    ds_read_b128 v[200:203], v14 offset:2048
    ds_read_b128 v[204:207], v14 offset:3072
    s_waitcnt lgkmcnt(2)
    v_pk_add_f32 v[192:193], v[192:193], v[196:197]
    v_pk_add_f32 v[194:195], v[194:195], v[198:199]
    s_waitcnt lgkmcnt(0)
    v_pk_add_f32 v[200:201], v[200:201], v[204:205]
    v_pk_add_f32 v[202:203], v[202:203], v[206:207]
    v_pk_add_f32 v[192:193], v[192:193], v[200:201]
    v_pk_add_f32 v[194:195], v[194:195], v[202:203]
    v_cvt_pk_bf16_f32 v196, v192, v193
    v_cvt_pk_bf16_f32 v197, v194, v195
    v_perm_b32 v192, v196, v4, s67
    v_bfi_b32 v193, s66, v196, v4
    v_perm_b32 v194, v197, v4, s67
    v_bfi_b32 v195, s66, v197, v4
    s_mov_b32 s61, 0x1000
    buffer_store_dwordx4 v[192:195], v15, s[12:15], s61 offen offset:0 sc1
HS_X:
    buffer_load_dwordx4 a[32:35], v2, s[4:7], s59 offen offset:0 nt
    buffer_load_dwordx4 a[36:39], v2, s[4:7], s59 offen offset:128 nt
    buffer_load_dwordx4 a[40:43], v2, s[4:7], s59 offen offset:1024 nt
    buffer_load_dwordx4 a[44:47], v2, s[4:7], s59 offen offset:1152 nt
    buffer_load_dwordx4 a[48:51], v2, s[4:7], s59 offen offset:2048 nt
    buffer_load_dwordx4 a[52:55], v2, s[4:7], s59 offen offset:2176 nt
    buffer_load_dwordx4 a[56:59], v2, s[4:7], s59 offen offset:3072 nt
    buffer_load_dwordx4 a[60:63], v2, s[4:7], s59 offen offset:3200 nt
    s_add_u32 s79, s59, 12288
    s_pack_lh_b32_b16 s59, s79, s59
    buffer_load_dwordx4 a[64:67], v2, s[4:7], s59 offen offset:0 nt
    buffer_load_dwordx4 a[68:71], v2, s[4:7], s59 offen offset:128 nt
    buffer_load_dwordx4 a[72:75], v2, s[4:7], s59 offen offset:1024 nt
    buffer_load_dwordx4 a[76:79], v2, s[4:7], s59 offen offset:1152 nt
    buffer_load_dwordx4 a[80:83], v2, s[4:7], s59 offen offset:2048 nt
    buffer_load_dwordx4 a[84:87], v2, s[4:7], s59 offen offset:2176 nt
    buffer_load_dwordx4 a[88:91], v2, s[4:7], s59 offen offset:3072 nt
    buffer_load_dwordx4 a[92:95], v2, s[4:7], s59 offen offset:3200 nt
    s_add_u32 s79, s59, 4096
    s_pack_lh_b32_b16 s59, s79, s59
    buffer_load_dwordx4 a[96:99], v2, s[4:7], s59 offen offset:0 nt
    buffer_load_dwordx4 a[100:103], v2, s[4:7], s59 offen offset:128 nt
    buffer_load_dwordx4 a[104:107], v2, s[4:7], s59 offen offset:1024 nt
    buffer_load_dwordx4 a[108:111], v2, s[4:7], s59 offen offset:1152 nt
    buffer_load_dwordx4 a[112:115], v2, s[4:7], s59 offen offset:2048 nt
    buffer_load_dwordx4 a[116:119], v2, s[4:7], s59 offen offset:2176 nt
    buffer_load_dwordx4 a[120:123], v2, s[4:7], s59 offen offset:3072 nt
    buffer_load_dwordx4 a[124:127], v2, s[4:7], s59 offen offset:3200 nt
    s_add_u32 s79, s59, 12288
    s_pack_lh_b32_b16 s59, s79, s59
    buffer_load_dwordx4 a[128:131], v2, s[4:7], s59 offen offset:0 nt
    buffer_load_dwordx4 a[132:135], v2, s[4:7], s59 offen offset:128 nt
    buffer_load_dwordx4 a[136:139], v2, s[4:7], s59 offen offset:1024 nt
    buffer_load_dwordx4 a[140:143], v2, s[4:7], s59 offen offset:1152 nt
    buffer_load_dwordx4 a[144:147], v2, s[4:7], s59 offen offset:2048 nt
    buffer_load_dwordx4 a[148:151], v2, s[4:7], s59 offen offset:2176 nt
    buffer_load_dwordx4 a[152:155], v2, s[4:7], s59 offen offset:3072 nt
    buffer_load_dwordx4 a[156:159], v2, s[4:7], s59 offen offset:3200 nt
    s_add_u32 s79, s59, 4096
    s_pack_lh_b32_b16 s59, s79, s59
    buffer_load_dwordx4 a[160:163], v2, s[4:7], s59 offen offset:0 nt
    buffer_load_dwordx4 a[164:167], v2, s[4:7], s59 offen offset:128 nt
    buffer_load_dwordx4 a[168:171], v2, s[4:7], s59 offen offset:1024 nt
    buffer_load_dwordx4 a[172:175], v2, s[4:7], s59 offen offset:1152 nt
    buffer_load_dwordx4 a[176:179], v2, s[4:7], s59 offen offset:2048 nt
    buffer_load_dwordx4 a[180:183], v2, s[4:7], s59 offen offset:2176 nt
    buffer_load_dwordx4 a[184:187], v2, s[4:7], s59 offen offset:3072 nt
    buffer_load_dwordx4 a[188:191], v2, s[4:7], s59 offen offset:3200 nt
    s_add_u32 s79, s59, 12288
    s_pack_lh_b32_b16 s59, s79, s59
    buffer_load_dwordx4 a[192:195], v2, s[4:7], s59 offen offset:0 nt
    buffer_load_dwordx4 a[196:199], v2, s[4:7], s59 offen offset:128 nt
    buffer_load_dwordx4 a[200:203], v2, s[4:7], s59 offen offset:1024 nt
    buffer_load_dwordx4 a[204:207], v2, s[4:7], s59 offen offset:1152 nt
    buffer_load_dwordx4 a[208:211], v2, s[4:7], s59 offen offset:2048 nt
    buffer_load_dwordx4 a[212:215], v2, s[4:7], s59 offen offset:2176 nt
    buffer_load_dwordx4 a[216:219], v2, s[4:7], s59 offen offset:3072 nt
    buffer_load_dwordx4 a[220:223], v2, s[4:7], s59 offen offset:3200 nt
    s_add_u32 s79, s59, 4096
    s_pack_lh_b32_b16 s59, s79, s59
    buffer_load_dwordx4 a[224:227], v2, s[4:7], s59 offen offset:0 nt
    buffer_load_dwordx4 a[228:231], v2, s[4:7], s59 offen offset:128 nt
    buffer_load_dwordx4 a[232:235], v2, s[4:7], s59 offen offset:1024 nt
    buffer_load_dwordx4 a[236:239], v2, s[4:7], s59 offen offset:1152 nt
    buffer_load_dwordx4 a[240:243], v2, s[4:7], s59 offen offset:2048 nt
    buffer_load_dwordx4 a[244:247], v2, s[4:7], s59 offen offset:2176 nt
    buffer_load_dwordx4 a[248:251], v2, s[4:7], s59 offen offset:3072 nt
    buffer_load_dwordx4 a[252:255], v2, s[4:7], s59 offen offset:3200 nt
    s_add_u32 s79, s59, 12288
    s_pack_lh_b32_b16 s59, s79, s59
    v_and_b32 v10, 3, v1
    v_lshlrev_b32 v10, 9, v10
    v_lshrrev_b32 v11, 4, v1
    v_lshl_add_u32 v10, v11, 5, v10
    v_bfe_u32 v11, v1, 2, 1
    v_lshl_add_u32 v10, v11, 7, v10
    s_lshr_b32 s61, s2, 3
    s_lshl_b32 s61, s61, 11
    v_add_u32 v6, s61, v10
    s_mov_b32 s61, 0x10000
    buffer_load_dwordx4 v[224:227], v6, s[12:15], s61 offen offset:0 sc1
    s_mov_b32 s61, 0x10000
    buffer_load_dwordx4 v[228:231], v6, s[12:15], s61 offen offset:16 sc1
    s_mov_b32 s61, 0x10000
    buffer_load_dwordx4 v[232:235], v6, s[12:15], s61 offen offset:256 sc1
    s_mov_b32 s61, 0x10000
    buffer_load_dwordx4 v[236:239], v6, s[12:15], s61 offen offset:272 sc1
    buffer_load_dwordx4 v[64:67], v3, s[8:11], s60 offen offset:0 nt
    buffer_load_dwordx4 v[68:71], v3, s[8:11], s60 offen offset:1024 nt
    buffer_load_dwordx4 v[72:75], v3, s[8:11], s60 offen offset:2048 nt
    buffer_load_dwordx4 v[76:79], v3, s[8:11], s60 offen offset:3072 nt
    s_add_u32 s79, s60, 4096
    s_pack_lh_b32_b16 s60, s79, s60
    buffer_load_dwordx4 v[80:83], v3, s[8:11], s60 offen offset:0 nt
    buffer_load_dwordx4 v[84:87], v3, s[8:11], s60 offen offset:1024 nt
    buffer_load_dwordx4 v[88:91], v3, s[8:11], s60 offen offset:2048 nt
    buffer_load_dwordx4 v[92:95], v3, s[8:11], s60 offen offset:3072 nt
    s_add_u32 s79, s60, 4096
    s_pack_lh_b32_b16 s60, s79, s60
    s_mov_b32 s61, 0x10000
    buffer_load_dwordx4 v[224:227], v6, s[12:15], s61 offen offset:0 sc1
    s_mov_b32 s61, 0x10000
    buffer_load_dwordx4 v[228:231], v6, s[12:15], s61 offen offset:16 sc1
    s_mov_b32 s61, 0x10000
    buffer_load_dwordx4 v[232:235], v6, s[12:15], s61 offen offset:256 sc1
    s_mov_b32 s61, 0x10000
    buffer_load_dwordx4 v[236:239], v6, s[12:15], s61 offen offset:272 sc1
    buffer_load_dwordx4 v[96:99], v3, s[8:11], s60 offen offset:0 nt
    buffer_load_dwordx4 v[100:103], v3, s[8:11], s60 offen offset:1024 nt
    buffer_load_dwordx4 v[104:107], v3, s[8:11], s60 offen offset:2048 nt
    buffer_load_dwordx4 v[108:111], v3, s[8:11], s60 offen offset:3072 nt
    s_add_u32 s79, s60, 4096
    s_pack_lh_b32_b16 s60, s79, s60
    buffer_load_dwordx4 v[112:115], v3, s[8:11], s60 offen offset:0 nt
    buffer_load_dwordx4 v[116:119], v3, s[8:11], s60 offen offset:1024 nt
    buffer_load_dwordx4 v[120:123], v3, s[8:11], s60 offen offset:2048 nt
    buffer_load_dwordx4 v[124:127], v3, s[8:11], s60 offen offset:3072 nt
    s_add_u32 s79, s60, 4096
    s_pack_lh_b32_b16 s60, s79, s60
    s_mov_b32 s61, 0x10000
    buffer_load_dwordx4 v[224:227], v6, s[12:15], s61 offen offset:0 sc1
    s_mov_b32 s61, 0x10000
    buffer_load_dwordx4 v[228:231], v6, s[12:15], s61 offen offset:16 sc1
    s_mov_b32 s61, 0x10000
    buffer_load_dwordx4 v[232:235], v6, s[12:15], s61 offen offset:256 sc1
    s_mov_b32 s61, 0x10000
    buffer_load_dwordx4 v[236:239], v6, s[12:15], s61 offen offset:272 sc1
    buffer_load_dwordx4 v[128:131], v3, s[8:11], s60 offen offset:0 nt
    buffer_load_dwordx4 v[132:135], v3, s[8:11], s60 offen offset:1024 nt
    buffer_load_dwordx4 v[136:139], v3, s[8:11], s60 offen offset:2048 nt
    buffer_load_dwordx4 v[140:143], v3, s[8:11], s60 offen offset:3072 nt
    s_add_u32 s79, s60, 4096
    s_pack_lh_b32_b16 s60, s79, s60
    buffer_load_dwordx4 v[144:147], v3, s[8:11], s60 offen offset:0 nt
    buffer_load_dwordx4 v[148:151], v3, s[8:11], s60 offen offset:1024 nt
    buffer_load_dwordx4 v[152:155], v3, s[8:11], s60 offen offset:2048 nt
    buffer_load_dwordx4 v[156:159], v3, s[8:11], s60 offen offset:3072 nt
    s_add_u32 s79, s60, 4096
    s_pack_lh_b32_b16 s60, s79, s60
    s_waitcnt vmcnt(32)
    v_mov_b32 v48, v224
    v_mov_b32 v49, v225
    v_mov_b32 v50, v226
    v_mov_b32 v51, v227
    v_mov_b32 v52, v228
    v_mov_b32 v53, v229
    v_mov_b32 v54, v230
    v_mov_b32 v55, v231
    v_mov_b32 v56, v232
    v_mov_b32 v57, v233
    v_mov_b32 v58, v234
    v_mov_b32 v59, v235
    v_mov_b32 v60, v236
    v_mov_b32 v61, v237
    v_mov_b32 v62, v238
    v_mov_b32 v63, v239
    v_xor_b32 v10, s58, v48
    v_bitop3_b32 v10, v49, s58, v10 bitop3:0xbe
    v_bitop3_b32 v10, v50, s58, v10 bitop3:0xbe
    v_bitop3_b32 v10, v51, s58, v10 bitop3:0xbe
    v_bitop3_b32 v10, v52, s58, v10 bitop3:0xbe
    v_bitop3_b32 v10, v53, s58, v10 bitop3:0xbe
    v_bitop3_b32 v10, v54, s58, v10 bitop3:0xbe
    v_bitop3_b32 v10, v55, s58, v10 bitop3:0xbe
    v_bitop3_b32 v10, v56, s58, v10 bitop3:0xbe
    v_bitop3_b32 v10, v57, s58, v10 bitop3:0xbe
    v_bitop3_b32 v10, v58, s58, v10 bitop3:0xbe
    v_bitop3_b32 v10, v59, s58, v10 bitop3:0xbe
    v_bitop3_b32 v10, v60, s58, v10 bitop3:0xbe
    v_bitop3_b32 v10, v61, s58, v10 bitop3:0xbe
    v_bitop3_b32 v10, v62, s58, v10 bitop3:0xbe
    v_bitop3_b32 v10, v63, s58, v10 bitop3:0xbe
    v_and_b32 v10, 0xff, v10
    v_cmp_ne_u32 vcc, 0, v10
    s_cbranch_vccz QGO_X
    s_waitcnt vmcnt(20)
    v_mov_b32 v48, v224
    v_mov_b32 v49, v225
    v_mov_b32 v50, v226
    v_mov_b32 v51, v227
    v_mov_b32 v52, v228
    v_mov_b32 v53, v229
    v_mov_b32 v54, v230
    v_mov_b32 v55, v231
    v_mov_b32 v56, v232
    v_mov_b32 v57, v233
    v_mov_b32 v58, v234
    v_mov_b32 v59, v235
    v_mov_b32 v60, v236
    v_mov_b32 v61, v237
    v_mov_b32 v62, v238
    v_mov_b32 v63, v239
    v_xor_b32 v10, s58, v48
    v_bitop3_b32 v10, v49, s58, v10 bitop3:0xbe
    v_bitop3_b32 v10, v50, s58, v10 bitop3:0xbe
    v_bitop3_b32 v10, v51, s58, v10 bitop3:0xbe
    v_bitop3_b32 v10, v52, s58, v10 bitop3:0xbe
    v_bitop3_b32 v10, v53, s58, v10 bitop3:0xbe
    v_bitop3_b32 v10, v54, s58, v10 bitop3:0xbe
    v_bitop3_b32 v10, v55, s58, v10 bitop3:0xbe
    v_bitop3_b32 v10, v56, s58, v10 bitop3:0xbe
    v_bitop3_b32 v10, v57, s58, v10 bitop3:0xbe
    v_bitop3_b32 v10, v58, s58, v10 bitop3:0xbe
    v_bitop3_b32 v10, v59, s58, v10 bitop3:0xbe
    v_bitop3_b32 v10, v60, s58, v10 bitop3:0xbe
    v_bitop3_b32 v10, v61, s58, v10 bitop3:0xbe
    v_bitop3_b32 v10, v62, s58, v10 bitop3:0xbe
    v_bitop3_b32 v10, v63, s58, v10 bitop3:0xbe
    v_and_b32 v10, 0xff, v10
    v_cmp_ne_u32 vcc, 0, v10
    s_cbranch_vccz QGO_X
    s_waitcnt vmcnt(8)
    v_mov_b32 v48, v224
    v_mov_b32 v49, v225
    v_mov_b32 v50, v226
    v_mov_b32 v51, v227
    v_mov_b32 v52, v228
    v_mov_b32 v53, v229
    v_mov_b32 v54, v230
    v_mov_b32 v55, v231
    v_mov_b32 v56, v232
    v_mov_b32 v57, v233
    v_mov_b32 v58, v234
    v_mov_b32 v59, v235
    v_mov_b32 v60, v236
    v_mov_b32 v61, v237
    v_mov_b32 v62, v238
    v_mov_b32 v63, v239
    v_xor_b32 v10, s58, v48
    v_bitop3_b32 v10, v49, s58, v10 bitop3:0xbe
    v_bitop3_b32 v10, v50, s58, v10 bitop3:0xbe
    v_bitop3_b32 v10, v51, s58, v10 bitop3:0xbe
    v_bitop3_b32 v10, v52, s58, v10 bitop3:0xbe
    v_bitop3_b32 v10, v53, s58, v10 bitop3:0xbe
    v_bitop3_b32 v10, v54, s58, v10 bitop3:0xbe
    v_bitop3_b32 v10, v55, s58, v10 bitop3:0xbe
    v_bitop3_b32 v10, v56, s58, v10 bitop3:0xbe
    v_bitop3_b32 v10, v57, s58, v10 bitop3:0xbe
    v_bitop3_b32 v10, v58, s58, v10 bitop3:0xbe
    v_bitop3_b32 v10, v59, s58, v10 bitop3:0xbe
    v_bitop3_b32 v10, v60, s58, v10 bitop3:0xbe
    v_bitop3_b32 v10, v61, s58, v10 bitop3:0xbe
    v_bitop3_b32 v10, v62, s58, v10 bitop3:0xbe
    v_bitop3_b32 v10, v63, s58, v10 bitop3:0xbe
    v_and_b32 v10, 0xff, v10
    v_cmp_ne_u32 vcc, 0, v10
    s_cbranch_vccz QGO_X
    s_mov_b32 s62, 0x40000
QRX_X:
    s_mov_b32 s61, 0x10000
    buffer_load_dwordx4 v[224:227], v6, s[12:15], s61 offen offset:0 sc1
    s_mov_b32 s61, 0x10000
    buffer_load_dwordx4 v[228:231], v6, s[12:15], s61 offen offset:16 sc1
    s_mov_b32 s61, 0x10000
    buffer_load_dwordx4 v[232:235], v6, s[12:15], s61 offen offset:256 sc1
    s_mov_b32 s61, 0x10000
    buffer_load_dwordx4 v[236:239], v6, s[12:15], s61 offen offset:272 sc1
    s_waitcnt vmcnt(0)
    v_mov_b32 v48, v224
    v_mov_b32 v49, v225
    v_mov_b32 v50, v226
    v_mov_b32 v51, v227
    v_mov_b32 v52, v228
    v_mov_b32 v53, v229
    v_mov_b32 v54, v230
    v_mov_b32 v55, v231
    v_mov_b32 v56, v232
    v_mov_b32 v57, v233
    v_mov_b32 v58, v234
    v_mov_b32 v59, v235
    v_mov_b32 v60, v236
    v_mov_b32 v61, v237
    v_mov_b32 v62, v238
    v_mov_b32 v63, v239
    v_xor_b32 v10, s58, v48
    v_bitop3_b32 v10, v49, s58, v10 bitop3:0xbe
    v_bitop3_b32 v10, v50, s58, v10 bitop3:0xbe
    v_bitop3_b32 v10, v51, s58, v10 bitop3:0xbe
    v_bitop3_b32 v10, v52, s58, v10 bitop3:0xbe
    v_bitop3_b32 v10, v53, s58, v10 bitop3:0xbe
    v_bitop3_b32 v10, v54, s58, v10 bitop3:0xbe
    v_bitop3_b32 v10, v55, s58, v10 bitop3:0xbe
    v_bitop3_b32 v10, v56, s58, v10 bitop3:0xbe
    v_bitop3_b32 v10, v57, s58, v10 bitop3:0xbe
    v_bitop3_b32 v10, v58, s58, v10 bitop3:0xbe
    v_bitop3_b32 v10, v59, s58, v10 bitop3:0xbe
    v_bitop3_b32 v10, v60, s58, v10 bitop3:0xbe
    v_bitop3_b32 v10, v61, s58, v10 bitop3:0xbe
    v_bitop3_b32 v10, v62, s58, v10 bitop3:0xbe
    v_bitop3_b32 v10, v63, s58, v10 bitop3:0xbe
    v_and_b32 v10, 0xff, v10
    v_cmp_ne_u32 vcc, 0, v10
    s_cbranch_vccz QGO_X
    s_sub_u32 s62, s62, 1
    s_cbranch_scc0 QRX_X
QGO_X:
    buffer_load_dwordx4 v[224:227], v3, s[8:11], s60 offen offset:0 nt
    v_perm_b32 v16, v49, v48, s68
    v_perm_b32 v17, v51, v50, s68
    v_perm_b32 v18, v53, v52, s68
    v_perm_b32 v19, v55, v54, s68
    v_perm_b32 v20, v57, v56, s68
    v_perm_b32 v21, v59, v58, s68
    v_perm_b32 v22, v61, v60, s68
    buffer_load_dwordx4 v[228:231], v3, s[8:11], s60 offen offset:1024 nt
    v_perm_b32 v23, v63, v62, s68
    v_cndmask_b32 v32, 0, v16, s[72:73]
    v_cndmask_b32 v33, 0, v17, s[72:73]
    v_cndmask_b32 v34, 0, v18, s[72:73]
    v_cndmask_b32 v35, 0, v19, s[72:73]
    v_cndmask_b32 v36, 0, v20, s[72:73]
    v_cndmask_b32 v37, 0, v21, s[72:73]
    v_cndmask_b32 v38, 0, v22, s[72:73]
    buffer_load_dwordx4 v[232:235], v3, s[8:11], s60 offen offset:2048 nt
    v_cndmask_b32 v39, 0, v23, s[72:73]
    v_cndmask_b32 v40, 0, v16, s[74:75]
    v_cndmask_b32 v41, 0, v17, s[74:75]
    v_cndmask_b32 v42, 0, v18, s[74:75]
    v_cndmask_b32 v43, 0, v19, s[74:75]
    v_cndmask_b32 v44, 0, v20, s[74:75]
    v_cndmask_b32 v45, 0, v21, s[74:75]
    buffer_load_dwordx4 v[236:239], v3, s[8:11], s60 offen offset:3072 nt
    v_cndmask_b32 v46, 0, v22, s[74:75]
    v_cndmask_b32 v47, 0, v23, s[74:75]
    v_mfma_f32_16x16x32_bf16 v[160:163], a[0:3], v[32:35], 0
    v_mfma_f32_16x16x32_bf16 v[164:167], a[8:11], v[32:35], 0
    v_mfma_f32_16x16x32_bf16 v[168:171], a[16:19], v[32:35], 0
    v_mfma_f32_16x16x32_bf16 v[172:175], a[24:27], v[32:35], 0
    v_mfma_f32_16x16x32_bf16 v[176:179], a[32:35], v[32:35], 0
    v_mfma_f32_16x16x32_bf16 v[180:183], a[40:43], v[32:35], 0
    s_add_u32 s79, s60, 4096
    s_pack_lh_b32_b16 s60, s79, s60
    buffer_load_dwordx4 v[240:243], v3, s[8:11], s60 offen offset:0 nt
    v_mfma_f32_16x16x32_bf16 v[184:187], a[48:51], v[32:35], 0
    v_mfma_f32_16x16x32_bf16 v[188:191], a[56:59], v[32:35], 0
    v_mfma_f32_16x16x32_bf16 v[160:163], a[4:7], v[36:39], v[160:163]
    v_mfma_f32_16x16x32_bf16 v[164:167], a[12:15], v[36:39], v[164:167]
    v_mfma_f32_16x16x32_bf16 v[168:171], a[20:23], v[36:39], v[168:171]
    v_mfma_f32_16x16x32_bf16 v[172:175], a[28:31], v[36:39], v[172:175]
    v_mfma_f32_16x16x32_bf16 v[176:179], a[36:39], v[36:39], v[176:179]
    buffer_load_dwordx4 v[244:247], v3, s[8:11], s60 offen offset:1024 nt
    v_mfma_f32_16x16x32_bf16 v[180:183], a[44:47], v[36:39], v[180:183]
    v_mfma_f32_16x16x32_bf16 v[184:187], a[52:55], v[36:39], v[184:187]
    v_mfma_f32_16x16x32_bf16 v[188:191], a[60:63], v[36:39], v[188:191]
    v_mfma_f32_16x16x32_bf16 v[160:163], a[64:67], v[40:43], v[160:163]
    v_mfma_f32_16x16x32_bf16 v[164:167], a[72:75], v[40:43], v[164:167]
    v_mfma_f32_16x16x32_bf16 v[168:171], a[80:83], v[40:43], v[168:171]
    v_mfma_f32_16x16x32_bf16 v[172:175], a[88:91], v[40:43], v[172:175]
    v_mfma_f32_16x16x32_bf16 v[176:179], a[96:99], v[40:43], v[176:179]
    buffer_load_dwordx4 v[248:251], v3, s[8:11], s60 offen offset:2048 nt
    v_mfma_f32_16x16x32_bf16 v[180:183], a[104:107], v[40:43], v[180:183]
    v_mfma_f32_16x16x32_bf16 v[184:187], a[112:115], v[40:43], v[184:187]
    v_mfma_f32_16x16x32_bf16 v[188:191], a[120:123], v[40:43], v[188:191]
    v_mfma_f32_16x16x32_bf16 v[160:163], a[68:71], v[44:47], v[160:163]
    v_mfma_f32_16x16x32_bf16 v[164:167], a[76:79], v[44:47], v[164:167]
    v_mfma_f32_16x16x32_bf16 v[168:171], a[84:87], v[44:47], v[168:171]
    v_mfma_f32_16x16x32_bf16 v[172:175], a[92:95], v[44:47], v[172:175]
    buffer_load_dwordx4 v[252:255], v3, s[8:11], s60 offen offset:3072 nt
    s_add_u32 s79, s60, 4096
    s_pack_lh_b32_b16 s60, s79, s60
    v_mfma_f32_16x16x32_bf16 v[176:179], a[100:103], v[44:47], v[176:179]
    v_mfma_f32_16x16x32_bf16 v[180:183], a[108:111], v[44:47], v[180:183]
    v_mfma_f32_16x16x32_bf16 v[184:187], a[116:119], v[44:47], v[184:187]
    v_mfma_f32_16x16x32_bf16 v[188:191], a[124:127], v[44:47], v[188:191]
    v_mfma_f32_16x16x32_bf16 v[192:195], a[128:131], v[32:35], 0
    v_mfma_f32_16x16x32_bf16 v[196:199], a[136:139], v[32:35], 0
    v_mfma_f32_16x16x32_bf16 v[200:203], a[144:147], v[32:35], 0
    v_mfma_f32_16x16x32_bf16 v[204:207], a[152:155], v[32:35], 0
    v_mfma_f32_16x16x32_bf16 v[208:211], a[160:163], v[32:35], 0
    v_mfma_f32_16x16x32_bf16 v[212:215], a[168:171], v[32:35], 0
    v_mfma_f32_16x16x32_bf16 v[216:219], a[176:179], v[32:35], 0
    v_mfma_f32_16x16x32_bf16 v[220:223], a[184:187], v[32:35], 0
    v_mfma_f32_16x16x32_bf16 v[192:195], a[132:135], v[36:39], v[192:195]
    v_mfma_f32_16x16x32_bf16 v[196:199], a[140:143], v[36:39], v[196:199]
    v_mfma_f32_16x16x32_bf16 v[200:203], a[148:151], v[36:39], v[200:203]
    v_mfma_f32_16x16x32_bf16 v[204:207], a[156:159], v[36:39], v[204:207]
    v_mfma_f32_16x16x32_bf16 v[208:211], a[164:167], v[36:39], v[208:211]
    v_mfma_f32_16x16x32_bf16 v[212:215], a[172:175], v[36:39], v[212:215]
    v_mfma_f32_16x16x32_bf16 v[216:219], a[180:183], v[36:39], v[216:219]
    v_mfma_f32_16x16x32_bf16 v[220:223], a[188:191], v[36:39], v[220:223]
    v_mfma_f32_16x16x32_bf16 v[192:195], a[192:195], v[40:43], v[192:195]
    v_mfma_f32_16x16x32_bf16 v[196:199], a[200:203], v[40:43], v[196:199]
    v_mfma_f32_16x16x32_bf16 v[200:203], a[208:211], v[40:43], v[200:203]
    v_mfma_f32_16x16x32_bf16 v[204:207], a[216:219], v[40:43], v[204:207]
    v_mfma_f32_16x16x32_bf16 v[208:211], a[224:227], v[40:43], v[208:211]
    v_mfma_f32_16x16x32_bf16 v[212:215], a[232:235], v[40:43], v[212:215]
    v_mfma_f32_16x16x32_bf16 v[216:219], a[240:243], v[40:43], v[216:219]
    v_mfma_f32_16x16x32_bf16 v[220:223], a[248:251], v[40:43], v[220:223]
    v_mfma_f32_16x16x32_bf16 v[192:195], a[196:199], v[44:47], v[192:195]
    v_mfma_f32_16x16x32_bf16 v[196:199], a[204:207], v[44:47], v[196:199]
    v_mfma_f32_16x16x32_bf16 v[200:203], a[212:215], v[44:47], v[200:203]
    v_mfma_f32_16x16x32_bf16 v[204:207], a[220:223], v[44:47], v[204:207]
    v_mfma_f32_16x16x32_bf16 v[208:211], a[228:231], v[44:47], v[208:211]
    v_mfma_f32_16x16x32_bf16 v[212:215], a[236:239], v[44:47], v[212:215]
    v_mfma_f32_16x16x32_bf16 v[216:219], a[244:247], v[44:47], v[216:219]
    v_mfma_f32_16x16x32_bf16 v[220:223], a[252:255], v[44:47], v[220:223]
    v_add_f32_dpp v48, v161, v160 row_shl:4 row_mask:0xf bank_mask:0x5
    v_add_f32_dpp v49, v165, v164 row_shl:4 row_mask:0xf bank_mask:0x5
    v_add_f32_dpp v50, v169, v168 row_shl:4 row_mask:0xf bank_mask:0x5
    v_add_f32_dpp v51, v173, v172 row_shl:4 row_mask:0xf bank_mask:0x5
    v_add_f32_dpp v52, v177, v176 row_shl:4 row_mask:0xf bank_mask:0x5
    v_add_f32_dpp v53, v181, v180 row_shl:4 row_mask:0xf bank_mask:0x5
    v_add_f32_dpp v54, v185, v184 row_shl:4 row_mask:0xf bank_mask:0x5
    v_add_f32_dpp v55, v189, v188 row_shl:4 row_mask:0xf bank_mask:0x5
    v_add_f32_dpp v56, v193, v192 row_shl:4 row_mask:0xf bank_mask:0x5
    v_add_f32_dpp v57, v197, v196 row_shl:4 row_mask:0xf bank_mask:0x5
    v_add_f32_dpp v58, v201, v200 row_shl:4 row_mask:0xf bank_mask:0x5
    v_add_f32_dpp v59, v205, v204 row_shl:4 row_mask:0xf bank_mask:0x5
    v_add_f32_dpp v60, v209, v208 row_shl:4 row_mask:0xf bank_mask:0x5
    v_add_f32_dpp v61, v213, v212 row_shl:4 row_mask:0xf bank_mask:0x5
    v_add_f32_dpp v62, v217, v216 row_shl:4 row_mask:0xf bank_mask:0x5
    v_add_f32_dpp v63, v221, v220 row_shl:4 row_mask:0xf bank_mask:0x5
    v_add_f32_dpp v48, v162, v163 row_shr:4 row_mask:0xf bank_mask:0xa
    v_add_f32_dpp v49, v166, v167 row_shr:4 row_mask:0xf bank_mask:0xa
    v_add_f32_dpp v50, v170, v171 row_shr:4 row_mask:0xf bank_mask:0xa
    v_add_f32_dpp v51, v174, v175 row_shr:4 row_mask:0xf bank_mask:0xa
    v_add_f32_dpp v52, v178, v179 row_shr:4 row_mask:0xf bank_mask:0xa
    v_add_f32_dpp v53, v182, v183 row_shr:4 row_mask:0xf bank_mask:0xa
    v_add_f32_dpp v54, v186, v187 row_shr:4 row_mask:0xf bank_mask:0xa
    v_add_f32_dpp v55, v190, v191 row_shr:4 row_mask:0xf bank_mask:0xa
    v_add_f32_dpp v56, v194, v195 row_shr:4 row_mask:0xf bank_mask:0xa
    v_add_f32_dpp v57, v198, v199 row_shr:4 row_mask:0xf bank_mask:0xa
    v_add_f32_dpp v58, v202, v203 row_shr:4 row_mask:0xf bank_mask:0xa
    v_add_f32_dpp v59, v206, v207 row_shr:4 row_mask:0xf bank_mask:0xa
    v_add_f32_dpp v60, v210, v211 row_shr:4 row_mask:0xf bank_mask:0xa
    v_add_f32_dpp v61, v214, v215 row_shr:4 row_mask:0xf bank_mask:0xa
    v_add_f32_dpp v62, v218, v219 row_shr:4 row_mask:0xf bank_mask:0xa
    v_add_f32_dpp v63, v222, v223 row_shr:4 row_mask:0xf bank_mask:0xa
    buffer_load_dwordx4 v[160:163], v3, s[8:11], s60 offen offset:0 nt
    v_cvt_pk_bf16_f32 v32, v48, v49
    v_cvt_pk_bf16_f32 v33, v50, v51
    v_cvt_pk_bf16_f32 v34, v52, v53
    v_cvt_pk_bf16_f32 v35, v54, v55
    v_cvt_pk_bf16_f32 v36, v56, v57
    v_cvt_pk_bf16_f32 v37, v58, v59
    v_cvt_pk_bf16_f32 v38, v60, v61
    v_cvt_pk_bf16_f32 v39, v62, v63
    v_lshlrev_b32 v48, 16, v32
    buffer_load_dwordx4 v[164:167], v3, s[8:11], s60 offen offset:1024 nt
    v_and_b32 v49, s66, v32
    v_lshlrev_b32 v50, 16, v33
    v_and_b32 v51, s66, v33
    v_lshlrev_b32 v52, 16, v34
    v_and_b32 v53, s66, v34
    v_lshlrev_b32 v54, 16, v35
    v_and_b32 v55, s66, v35
    v_lshlrev_b32 v56, 16, v36
    v_and_b32 v57, s66, v36
    v_lshlrev_b32 v58, 16, v37
    buffer_load_dwordx4 v[168:171], v3, s[8:11], s60 offen offset:2048 nt
    v_and_b32 v59, s66, v37
    v_lshlrev_b32 v60, 16, v38
    v_and_b32 v61, s66, v38
    v_lshlrev_b32 v62, 16, v39
    v_and_b32 v63, s66, v39
    v_mul_f32 v48, s70, v48
    v_mul_f32 v49, s70, v49
    v_mul_f32 v50, s70, v50
    v_mul_f32 v51, s70, v51
    buffer_load_dwordx4 v[172:175], v3, s[8:11], s60 offen offset:3072 nt
    v_mul_f32 v52, s70, v52
    v_mul_f32 v53, s70, v53
    v_mul_f32 v54, s70, v54
    v_mul_f32 v55, s70, v55
    v_mul_f32 v56, s70, v56
    v_mul_f32 v57, s70, v57
    v_mul_f32 v58, s70, v58
    v_mul_f32 v59, s70, v59
    v_mul_f32 v60, s70, v60
    v_mul_f32 v61, s70, v61
    s_add_u32 s79, s60, 4096
    s_pack_lh_b32_b16 s60, s79, s60
    buffer_load_dwordx4 v[176:179], v3, s[8:11], s60 offen offset:0 nt
    v_mul_f32 v62, s70, v62
    v_mul_f32 v63, s70, v63
    v_cvt_pk_bf16_f32 v32, v48, v49
    v_cvt_pk_bf16_f32 v33, v50, v51
    v_cvt_pk_bf16_f32 v34, v52, v53
    v_cvt_pk_bf16_f32 v35, v54, v55
    v_cvt_pk_bf16_f32 v36, v56, v57
    v_cvt_pk_bf16_f32 v37, v58, v59
    v_cvt_pk_bf16_f32 v38, v60, v61
    buffer_load_dwordx4 v[180:183], v3, s[8:11], s60 offen offset:1024 nt
    v_cvt_pk_bf16_f32 v39, v62, v63
    v_lshlrev_b32 v48, 16, v32
    v_and_b32 v49, s66, v32
    v_lshlrev_b32 v50, 16, v33
    v_and_b32 v51, s66, v33
    v_lshlrev_b32 v52, 16, v34
    v_and_b32 v53, s66, v34
    v_lshlrev_b32 v54, 16, v35
    v_and_b32 v55, s66, v35
    v_lshlrev_b32 v56, 16, v36
    buffer_load_dwordx4 v[184:187], v3, s[8:11], s60 offen offset:2048 nt
    v_and_b32 v57, s66, v36
    v_lshlrev_b32 v58, 16, v37
    v_and_b32 v59, s66, v37
    v_lshlrev_b32 v60, 16, v38
    v_and_b32 v61, s66, v38
    v_lshlrev_b32 v62, 16, v39
    v_and_b32 v63, s66, v39
    v_max3_f32 v9, v48, v49, v50
    v_max3_f32 v9, v9, v51, v52
    buffer_load_dwordx4 v[188:191], v3, s[8:11], s60 offen offset:3072 nt
    v_max3_f32 v9, v9, v53, v54
    v_max3_f32 v9, v9, v55, v56
    v_max3_f32 v9, v9, v57, v58
    v_max3_f32 v9, v9, v59, v60
    v_max3_f32 v9, v9, v61, v62
    v_max_f32 v9, v9, v63
    s_nop 1
    v_max_f32_dpp v9, v9, v9 row_ror:4 row_mask:0xf bank_mask:0xf
    s_nop 1
    v_max_f32_dpp v9, v9, v9 row_ror:8 row_mask:0xf bank_mask:0xf
    v_mov_b32 v10, v9
    s_nop 1
    v_permlane16_swap_b32 v9, v10
    s_add_u32 s79, s60, 4096
    s_pack_lh_b32_b16 s60, s79, s60
    buffer_load_dwordx4 v[192:195], v3, s[8:11], s60 offen offset:0 nt
    v_max_f32 v9, v9, v10
    v_mov_b32 v10, v9
    s_nop 1
    v_permlane32_swap_b32 v9, v10
    v_max_f32 v9, v9, v10
    v_mul_f32 v11, s69, v9
    v_fma_f32 v48, v48, s69, -v11
    v_fma_f32 v49, v49, s69, -v11
    v_fma_f32 v50, v50, s69, -v11
    v_fma_f32 v51, v51, s69, -v11
    buffer_load_dwordx4 v[196:199], v3, s[8:11], s60 offen offset:1024 nt
    v_fma_f32 v52, v52, s69, -v11
    v_fma_f32 v53, v53, s69, -v11
    v_fma_f32 v54, v54, s69, -v11
    v_fma_f32 v55, v55, s69, -v11
    v_fma_f32 v56, v56, s69, -v11
    v_fma_f32 v57, v57, s69, -v11
    v_fma_f32 v58, v58, s69, -v11
    v_fma_f32 v59, v59, s69, -v11
    v_fma_f32 v60, v60, s69, -v11
    v_fma_f32 v61, v61, s69, -v11
    buffer_load_dwordx4 v[200:203], v3, s[8:11], s60 offen offset:2048 nt
    v_fma_f32 v62, v62, s69, -v11
    v_fma_f32 v63, v63, s69, -v11
    v_exp_f32 v48, v48
    v_exp_f32 v49, v49
    v_exp_f32 v50, v50
    v_exp_f32 v51, v51
    v_exp_f32 v52, v52
    v_exp_f32 v53, v53
    v_exp_f32 v54, v54
    buffer_load_dwordx4 v[204:207], v3, s[8:11], s60 offen offset:3072 nt
    v_exp_f32 v55, v55
    v_exp_f32 v56, v56
    v_exp_f32 v57, v57
    v_exp_f32 v58, v58
    v_exp_f32 v59, v59
    v_exp_f32 v60, v60
    v_exp_f32 v61, v61
    v_exp_f32 v62, v62
    v_exp_f32 v63, v63
    v_add_f32 v13, v48, v49
    s_add_u32 s79, s60, 4096
    s_pack_lh_b32_b16 s60, s79, s60
    buffer_load_dwordx4 v[208:211], v3, s[8:11], s60 offen offset:0 nt
    v_add_f32 v13, v13, v50
    v_add_f32 v13, v13, v51
    v_add_f32 v13, v13, v52
    v_add_f32 v13, v13, v53
    v_add_f32 v13, v13, v54
    v_add_f32 v13, v13, v55
    v_add_f32 v13, v13, v56
    v_add_f32 v13, v13, v57
    v_add_f32 v13, v13, v58
    buffer_load_dwordx4 v[212:215], v3, s[8:11], s60 offen offset:1024 nt
    v_add_f32 v13, v13, v59
    v_add_f32 v13, v13, v60
    v_add_f32 v13, v13, v61
    v_add_f32 v13, v13, v62
    v_add_f32 v13, v13, v63
    v_cvt_pk_bf16_f32 v16, v48, v49
    v_cvt_pk_bf16_f32 v17, v50, v51
    v_cvt_pk_bf16_f32 v18, v52, v53
    v_cvt_pk_bf16_f32 v19, v54, v55
    v_cvt_pk_bf16_f32 v20, v56, v57
    buffer_load_dwordx4 v[216:219], v3, s[8:11], s60 offen offset:2048 nt
    v_cvt_pk_bf16_f32 v21, v58, v59
    v_cvt_pk_bf16_f32 v22, v60, v61
    v_cvt_pk_bf16_f32 v23, v62, v63
    v_add_f32_dpp v13, v13, v13 row_ror:4 row_mask:0xf bank_mask:0xf
    s_nop 1
    v_add_f32_dpp v13, v13, v13 row_ror:8 row_mask:0xf bank_mask:0xf
    v_mov_b32 v10, v13
    s_nop 1
    v_permlane16_swap_b32 v13, v10
    v_add_f32 v13, v13, v10
    v_mov_b32 v10, v13
    buffer_load_dwordx4 v[220:223], v3, s[8:11], s60 offen offset:3072 nt
    s_add_u32 s79, s60, 4096
    s_pack_lh_b32_b16 s60, s79, s60
    v_permlane32_swap_b32 v13, v10
    v_add_f32 v13, v13, v10
    v_mov_b32 v12, v9
    v_mov_b32 v14, s58
    v_mov_b32 v15, s58
    s_lshl_b32 s64, s2, 8
    s_lshl_b32 s61, s3, 6
    s_add_u32 s64, s64, s61
    v_lshlrev_b32 v10, 4, v1
    v_add_u32 v6, s64, v10
    s_mov_b64 exec, 0xf
    s_mov_b32 s61, 0x20000
    buffer_store_dwordx4 v[12:15], v6, s[12:15], s61 offen offset:0 sc1
    s_mov_b64 exec, -1
    v_mov_b32 v24, 0
    v_mov_b32 v25, 0
    v_mov_b32 v26, 0
    v_mov_b32 v27, 0
    v_mov_b32 v28, 0
    v_mov_b32 v29, 0
    v_mov_b32 v30, 0
    v_mov_b32 v31, 0
    v_mov_b32 v40, 0
    v_mov_b32 v41, 0
    v_mov_b32 v42, 0
    v_mov_b32 v43, 0
    v_mov_b32 v44, 0
    v_mov_b32 v45, 0
    v_mov_b32 v46, 0
    v_mov_b32 v47, 0
    s_lshr_b32 s61, s2, 3
    s_lshl_b32 s61, s61, 11
    v_lshlrev_b32 v10, 4, v1
    v_add_u32 v6, s61, v10
    s_mov_b32 s20, s40
    s_mov_b32 s21, s41
    s_mov_b32 s22, 0x400000
    s_mov_b32 s23, 0x20000
    s_and_b32 s63, s2, 7
    s_lshr_b32 s37, s2, 3
    s_sub_u32 s37, s37, 0
    s_lshl_b32 s64, s37, 7
    s_lshl_b32 s62, s63, 19
    s_add_u32 s64, s64, s62
    v_lshrrev_b32 v10, 4, v1
    v_lshlrev_b32 v10, 5, v10
    s_lshl_b32 s61, s3, 7
    v_add_u32 v10, s61, v10
    s_movk_i32 s61, 1024
    v_mul_lo_u32 v10, v10, s61
    v_and_b32 v11, 3, v1
    v_lshl_add_u32 v10, v11, 4, v10
    v_bfe_u32 v11, v1, 2, 1
    v_lshl_add_u32 v10, v11, 3, v10
    v_bfe_u32 v11, v1, 3, 1
    v_lshl_add_u32 v10, v11, 6, v10
    v_add_u32 v7, s64, v10
    v_lshrrev_b32 v10, 4, v1
    v_add_u32 v10, v10, v1
    v_and_b32 v10, 3, v10
    v_and_b32 v11, 60, v1
    v_or_b32 v10, v10, v11
    v_lshlrev_b32 v10, 4, v10
    s_lshl_b32 s61, s3, 11
    v_add_u32 v8, s61, v10
    v_bfe_u32 v11, v0, 5, 2
    v_lshlrev_b32 v15, 4, v11
    v_bfe_u32 v10, v0, 3, 2
    v_add_u32 v11, v11, v10
    v_and_b32 v11, 3, v11
    v_lshlrev_b32 v11, 4, v11
    v_lshl_add_u32 v11, v10, 8, v11
    v_and_b32 v10, 3, v0
    v_lshl_add_u32 v11, v10, 6, v11
    v_bfe_u32 v10, v0, 2, 1
    v_lshl_add_u32 v2, v10, 10, v11
    v_and_b32 v10, 0x60, v0
    v_bfe_u32 v11, v0, 1, 4
    v_or_b32 v10, v10, v11
    v_and_b32 v11, 1, v0
    v_lshl_or_b32 v10, v11, 4, v10
    v_lshlrev_b32 v10, 4, v10
    s_lshl_b32 s64, s2, 11
    v_add_u32 v14, s64, v10
    v_mov_b32_dpp v24, v16 quad_perm:[0,1,2,3] row_mask:0xf bank_mask:0x1
    v_mov_b32_dpp v25, v17 quad_perm:[0,1,2,3] row_mask:0xf bank_mask:0x1
    v_mov_b32_dpp v26, v18 quad_perm:[0,1,2,3] row_mask:0xf bank_mask:0x1
    v_mov_b32_dpp v27, v19 quad_perm:[0,1,2,3] row_mask:0xf bank_mask:0x1
    v_mov_b32_dpp v28, v16 row_ror:4 row_mask:0xf bank_mask:0x2
    v_mov_b32_dpp v29, v17 row_ror:4 row_mask:0xf bank_mask:0x2
    v_mov_b32_dpp v30, v18 row_ror:4 row_mask:0xf bank_mask:0x2
    v_mov_b32_dpp v31, v19 row_ror:4 row_mask:0xf bank_mask:0x2
    v_mov_b32_dpp v40, v16 row_ror:8 row_mask:0xf bank_mask:0x4
    v_mov_b32_dpp v41, v17 row_ror:8 row_mask:0xf bank_mask:0x4
    v_mov_b32_dpp v42, v18 row_ror:8 row_mask:0xf bank_mask:0x4
    v_mov_b32_dpp v43, v19 row_ror:8 row_mask:0xf bank_mask:0x4
    v_mov_b32_dpp v44, v16 row_ror:12 row_mask:0xf bank_mask:0x8
    v_mov_b32_dpp v45, v17 row_ror:12 row_mask:0xf bank_mask:0x8
    v_mov_b32_dpp v46, v18 row_ror:12 row_mask:0xf bank_mask:0x8
    v_mov_b32_dpp v47, v19 row_ror:12 row_mask:0xf bank_mask:0x8
    s_waitcnt vmcnt(49)
    v_perm_b32 v32, v68, v64, s67
    v_perm_b32 v33, v76, v72, s67
    v_perm_b32 v34, v84, v80, s67
    v_perm_b32 v35, v92, v88, s67
    v_perm_b32 v36, v70, v66, s67
    v_perm_b32 v37, v78, v74, s67
    v_perm_b32 v38, v86, v82, s67
    v_perm_b32 v39, v94, v90, s67
    v_mfma_f32_16x16x32_bf16 a[0:3], v[32:35], v[24:27], 0
    v_perm_b32 v32, v68, v64, s68
    v_perm_b32 v33, v76, v72, s68
    v_perm_b32 v34, v84, v80, s68
    v_perm_b32 v35, v92, v88, s68
    v_mfma_f32_16x16x32_bf16 a[4:7], v[36:39], v[24:27], 0
    v_perm_b32 v36, v70, v66, s68
    v_perm_b32 v37, v78, v74, s68
    v_perm_b32 v38, v86, v82, s68
    v_perm_b32 v39, v94, v90, s68
    v_mfma_f32_16x16x32_bf16 a[0:3], v[32:35], v[28:31], a[0:3]
    v_perm_b32 v32, v69, v65, s67
    v_perm_b32 v33, v77, v73, s67
    v_perm_b32 v34, v85, v81, s67
    v_perm_b32 v35, v93, v89, s67
    v_mfma_f32_16x16x32_bf16 a[4:7], v[36:39], v[28:31], a[4:7]
    v_perm_b32 v36, v71, v67, s67
    v_perm_b32 v37, v79, v75, s67
    v_perm_b32 v38, v87, v83, s67
    v_perm_b32 v39, v95, v91, s67
    v_mfma_f32_16x16x32_bf16 a[0:3], v[32:35], v[40:43], a[0:3]
    v_perm_b32 v32, v69, v65, s68
    v_perm_b32 v33, v77, v73, s68
    v_perm_b32 v34, v85, v81, s68
    v_perm_b32 v35, v93, v89, s68
    v_mfma_f32_16x16x32_bf16 a[4:7], v[36:39], v[40:43], a[4:7]
    v_perm_b32 v36, v71, v67, s68
    v_perm_b32 v37, v79, v75, s68
    v_perm_b32 v38, v87, v83, s68
    v_perm_b32 v39, v95, v91, s68
    v_mfma_f32_16x16x32_bf16 a[0:3], v[32:35], v[44:47], a[0:3]
    s_nop 0
    v_mfma_f32_16x16x32_bf16 a[4:7], v[36:39], v[44:47], a[4:7]
    v_mov_b32_dpp v24, v16 row_ror:12 row_mask:0xf bank_mask:0x1
    v_mov_b32_dpp v25, v17 row_ror:12 row_mask:0xf bank_mask:0x1
    v_mov_b32_dpp v26, v18 row_ror:12 row_mask:0xf bank_mask:0x1
    v_mov_b32_dpp v27, v19 row_ror:12 row_mask:0xf bank_mask:0x1
    v_mov_b32_dpp v28, v16 quad_perm:[0,1,2,3] row_mask:0xf bank_mask:0x2
    v_mov_b32_dpp v29, v17 quad_perm:[0,1,2,3] row_mask:0xf bank_mask:0x2
    v_mov_b32_dpp v30, v18 quad_perm:[0,1,2,3] row_mask:0xf bank_mask:0x2
    v_mov_b32_dpp v31, v19 quad_perm:[0,1,2,3] row_mask:0xf bank_mask:0x2
    v_mov_b32_dpp v40, v16 row_ror:4 row_mask:0xf bank_mask:0x4
    v_mov_b32_dpp v41, v17 row_ror:4 row_mask:0xf bank_mask:0x4
    v_mov_b32_dpp v42, v18 row_ror:4 row_mask:0xf bank_mask:0x4
    v_mov_b32_dpp v43, v19 row_ror:4 row_mask:0xf bank_mask:0x4
    v_mov_b32_dpp v44, v16 row_ror:8 row_mask:0xf bank_mask:0x8
    v_mov_b32_dpp v45, v17 row_ror:8 row_mask:0xf bank_mask:0x8
    v_mov_b32_dpp v46, v18 row_ror:8 row_mask:0xf bank_mask:0x8
    v_mov_b32_dpp v47, v19 row_ror:8 row_mask:0xf bank_mask:0x8
    s_waitcnt vmcnt(37)
    buffer_load_dwordx4 v[64:67], v3, s[8:11], s60 offen offset:0 nt
    v_perm_b32 v32, v100, v96, s67
    v_perm_b32 v33, v108, v104, s67
    v_perm_b32 v34, v116, v112, s67
    v_perm_b32 v35, v124, v120, s67
    v_perm_b32 v36, v102, v98, s67
    buffer_load_dwordx4 v[68:71], v3, s[8:11], s60 offen offset:1024 nt
    v_perm_b32 v37, v110, v106, s67
    v_perm_b32 v38, v118, v114, s67
    v_perm_b32 v39, v126, v122, s67
    v_mfma_f32_16x16x32_bf16 a[0:3], v[32:35], v[24:27], a[0:3]
    v_perm_b32 v32, v100, v96, s68
    buffer_load_dwordx4 v[72:75], v3, s[8:11], s60 offen offset:2048 nt
    v_perm_b32 v33, v108, v104, s68
    v_perm_b32 v34, v116, v112, s68
    v_perm_b32 v35, v124, v120, s68
    v_mfma_f32_16x16x32_bf16 a[4:7], v[36:39], v[24:27], a[4:7]
    v_perm_b32 v36, v102, v98, s68
    buffer_load_dwordx4 v[76:79], v3, s[8:11], s60 offen offset:3072 nt
    v_perm_b32 v37, v110, v106, s68
    v_perm_b32 v38, v118, v114, s68
    v_perm_b32 v39, v126, v122, s68
    v_mfma_f32_16x16x32_bf16 a[0:3], v[32:35], v[28:31], a[0:3]
    v_perm_b32 v32, v101, v97, s67
    s_add_u32 s79, s60, 4096
    s_pack_lh_b32_b16 s60, s79, s60
    buffer_load_dwordx4 v[80:83], v3, s[8:11], s60 offen offset:0 nt
    v_perm_b32 v33, v109, v105, s67
    v_perm_b32 v34, v117, v113, s67
    v_perm_b32 v35, v125, v121, s67
    v_mfma_f32_16x16x32_bf16 a[4:7], v[36:39], v[28:31], a[4:7]
    v_perm_b32 v36, v103, v99, s67
    buffer_load_dwordx4 v[84:87], v3, s[8:11], s60 offen offset:1024 nt
    v_perm_b32 v37, v111, v107, s67
    v_perm_b32 v38, v119, v115, s67
    v_perm_b32 v39, v127, v123, s67
    v_mfma_f32_16x16x32_bf16 a[0:3], v[32:35], v[40:43], a[0:3]
    v_perm_b32 v32, v101, v97, s68
    buffer_load_dwordx4 v[88:91], v3, s[8:11], s60 offen offset:2048 nt
    v_perm_b32 v33, v109, v105, s68
    v_perm_b32 v34, v117, v113, s68
    v_perm_b32 v35, v125, v121, s68
    v_mfma_f32_16x16x32_bf16 a[4:7], v[36:39], v[40:43], a[4:7]
    v_perm_b32 v36, v103, v99, s68
    buffer_load_dwordx4 v[92:95], v3, s[8:11], s60 offen offset:3072 nt
    s_add_u32 s79, s60, 4096
    s_pack_lh_b32_b16 s60, s79, s60
    v_perm_b32 v37, v111, v107, s68
    v_perm_b32 v38, v119, v115, s68
    v_perm_b32 v39, v127, v123, s68
    v_mfma_f32_16x16x32_bf16 a[0:3], v[32:35], v[44:47], a[0:3]
    s_nop 0
    v_mfma_f32_16x16x32_bf16 a[4:7], v[36:39], v[44:47], a[4:7]
    v_mov_b32_dpp v24, v16 row_ror:8 row_mask:0xf bank_mask:0x1
    v_mov_b32_dpp v25, v17 row_ror:8 row_mask:0xf bank_mask:0x1
    v_mov_b32_dpp v26, v18 row_ror:8 row_mask:0xf bank_mask:0x1
    v_mov_b32_dpp v27, v19 row_ror:8 row_mask:0xf bank_mask:0x1
    v_mov_b32_dpp v28, v16 row_ror:12 row_mask:0xf bank_mask:0x2
    v_mov_b32_dpp v29, v17 row_ror:12 row_mask:0xf bank_mask:0x2
    v_mov_b32_dpp v30, v18 row_ror:12 row_mask:0xf bank_mask:0x2
    v_mov_b32_dpp v31, v19 row_ror:12 row_mask:0xf bank_mask:0x2
    v_mov_b32_dpp v40, v16 quad_perm:[0,1,2,3] row_mask:0xf bank_mask:0x4
    v_mov_b32_dpp v41, v17 quad_perm:[0,1,2,3] row_mask:0xf bank_mask:0x4
    v_mov_b32_dpp v42, v18 quad_perm:[0,1,2,3] row_mask:0xf bank_mask:0x4
    v_mov_b32_dpp v43, v19 quad_perm:[0,1,2,3] row_mask:0xf bank_mask:0x4
    v_mov_b32_dpp v44, v16 row_ror:4 row_mask:0xf bank_mask:0x8
    v_mov_b32_dpp v45, v17 row_ror:4 row_mask:0xf bank_mask:0x8
    v_mov_b32_dpp v46, v18 row_ror:4 row_mask:0xf bank_mask:0x8
    v_mov_b32_dpp v47, v19 row_ror:4 row_mask:0xf bank_mask:0x8
    s_waitcnt vmcnt(33)
    v_perm_b32 v32, v132, v128, s67
    v_perm_b32 v33, v140, v136, s67
    v_perm_b32 v34, v148, v144, s67
    v_perm_b32 v35, v156, v152, s67
    v_perm_b32 v36, v134, v130, s67
    v_perm_b32 v37, v142, v138, s67
    v_perm_b32 v38, v150, v146, s67
    v_perm_b32 v39, v158, v154, s67
    v_mfma_f32_16x16x32_bf16 a[0:3], v[32:35], v[24:27], a[0:3]
    v_perm_b32 v32, v132, v128, s68
    v_perm_b32 v33, v140, v136, s68
    v_perm_b32 v34, v148, v144, s68
    v_perm_b32 v35, v156, v152, s68
    v_mfma_f32_16x16x32_bf16 a[4:7], v[36:39], v[24:27], a[4:7]
    v_perm_b32 v36, v134, v130, s68
    v_perm_b32 v37, v142, v138, s68
    v_perm_b32 v38, v150, v146, s68
    v_perm_b32 v39, v158, v154, s68
    v_mfma_f32_16x16x32_bf16 a[0:3], v[32:35], v[28:31], a[0:3]
    v_perm_b32 v32, v133, v129, s67
    v_perm_b32 v33, v141, v137, s67
    v_perm_b32 v34, v149, v145, s67
    v_perm_b32 v35, v157, v153, s67
    v_mfma_f32_16x16x32_bf16 a[4:7], v[36:39], v[28:31], a[4:7]
    v_perm_b32 v36, v135, v131, s67
    v_perm_b32 v37, v143, v139, s67
    v_perm_b32 v38, v151, v147, s67
    v_perm_b32 v39, v159, v155, s67
    v_mfma_f32_16x16x32_bf16 a[0:3], v[32:35], v[40:43], a[0:3]
    v_perm_b32 v32, v133, v129, s68
    v_perm_b32 v33, v141, v137, s68
    v_perm_b32 v34, v149, v145, s68
    v_perm_b32 v35, v157, v153, s68
    v_mfma_f32_16x16x32_bf16 a[4:7], v[36:39], v[40:43], a[4:7]
    v_perm_b32 v36, v135, v131, s68
    v_perm_b32 v37, v143, v139, s68
    v_perm_b32 v38, v151, v147, s68
    v_perm_b32 v39, v159, v155, s68
    v_mfma_f32_16x16x32_bf16 a[0:3], v[32:35], v[44:47], a[0:3]
    s_nop 0
    v_mfma_f32_16x16x32_bf16 a[4:7], v[36:39], v[44:47], a[4:7]
    v_mov_b32_dpp v24, v16 row_ror:4 row_mask:0xf bank_mask:0x1
    v_mov_b32_dpp v25, v17 row_ror:4 row_mask:0xf bank_mask:0x1
    v_mov_b32_dpp v26, v18 row_ror:4 row_mask:0xf bank_mask:0x1
    v_mov_b32_dpp v27, v19 row_ror:4 row_mask:0xf bank_mask:0x1
    v_mov_b32_dpp v28, v16 row_ror:8 row_mask:0xf bank_mask:0x2
    v_mov_b32_dpp v29, v17 row_ror:8 row_mask:0xf bank_mask:0x2
    v_mov_b32_dpp v30, v18 row_ror:8 row_mask:0xf bank_mask:0x2
    v_mov_b32_dpp v31, v19 row_ror:8 row_mask:0xf bank_mask:0x2
    v_mov_b32_dpp v40, v16 row_ror:12 row_mask:0xf bank_mask:0x4
    v_mov_b32_dpp v41, v17 row_ror:12 row_mask:0xf bank_mask:0x4
    v_mov_b32_dpp v42, v18 row_ror:12 row_mask:0xf bank_mask:0x4
    v_mov_b32_dpp v43, v19 row_ror:12 row_mask:0xf bank_mask:0x4
    v_mov_b32_dpp v44, v16 quad_perm:[0,1,2,3] row_mask:0xf bank_mask:0x8
    v_mov_b32_dpp v45, v17 quad_perm:[0,1,2,3] row_mask:0xf bank_mask:0x8
    v_mov_b32_dpp v46, v18 quad_perm:[0,1,2,3] row_mask:0xf bank_mask:0x8
    v_mov_b32_dpp v47, v19 quad_perm:[0,1,2,3] row_mask:0xf bank_mask:0x8
    s_waitcnt vmcnt(25)
    s_mov_b32 s61, 0x20000
    buffer_load_dwordx4 v[48:51], v6, s[12:15], s61 offen offset:0 sc1
    v_perm_b32 v32, v228, v224, s67
    v_perm_b32 v33, v236, v232, s67
    v_perm_b32 v34, v244, v240, s67
    v_perm_b32 v35, v252, v248, s67
    s_mov_b32 s61, 0x20000
    buffer_load_dwordx4 v[52:55], v6, s[12:15], s61 offen offset:1024 sc1
    v_perm_b32 v36, v230, v226, s67
    v_perm_b32 v37, v238, v234, s67
    v_perm_b32 v38, v246, v242, s67
    v_perm_b32 v39, v254, v250, s67
    buffer_load_dwordx4 v[96:99], v3, s[8:11], s60 offen offset:0 nt
    v_mfma_f32_16x16x32_bf16 a[0:3], v[32:35], v[24:27], a[0:3]
    v_perm_b32 v32, v228, v224, s68
    v_perm_b32 v33, v236, v232, s68
    v_perm_b32 v34, v244, v240, s68
    buffer_load_dwordx4 v[100:103], v3, s[8:11], s60 offen offset:1024 nt
    v_perm_b32 v35, v252, v248, s68
    v_mfma_f32_16x16x32_bf16 a[4:7], v[36:39], v[24:27], a[4:7]
    v_perm_b32 v36, v230, v226, s68
    v_perm_b32 v37, v238, v234, s68
    buffer_load_dwordx4 v[104:107], v3, s[8:11], s60 offen offset:2048 nt
    v_perm_b32 v38, v246, v242, s68
    v_perm_b32 v39, v254, v250, s68
    v_mfma_f32_16x16x32_bf16 a[0:3], v[32:35], v[28:31], a[0:3]
    v_perm_b32 v32, v229, v225, s67
    buffer_load_dwordx4 v[108:111], v3, s[8:11], s60 offen offset:3072 nt
    v_perm_b32 v33, v237, v233, s67
    v_perm_b32 v34, v245, v241, s67
    v_perm_b32 v35, v253, v249, s67
    v_mfma_f32_16x16x32_bf16 a[4:7], v[36:39], v[28:31], a[4:7]
    s_add_u32 s79, s60, 4096
    s_pack_lh_b32_b16 s60, s79, s60
    buffer_load_dwordx4 v[112:115], v3, s[8:11], s60 offen offset:0 nt
    v_perm_b32 v36, v231, v227, s67
    v_perm_b32 v37, v239, v235, s67
    v_perm_b32 v38, v247, v243, s67
    v_perm_b32 v39, v255, v251, s67
    buffer_load_dwordx4 v[116:119], v3, s[8:11], s60 offen offset:1024 nt
    v_mfma_f32_16x16x32_bf16 a[0:3], v[32:35], v[40:43], a[0:3]
    v_perm_b32 v32, v229, v225, s68
    v_perm_b32 v33, v237, v233, s68
    v_perm_b32 v34, v245, v241, s68
    buffer_load_dwordx4 v[120:123], v3, s[8:11], s60 offen offset:2048 nt
    v_perm_b32 v35, v253, v249, s68
    v_mfma_f32_16x16x32_bf16 a[4:7], v[36:39], v[40:43], a[4:7]
    v_perm_b32 v36, v231, v227, s68
    v_perm_b32 v37, v239, v235, s68
    buffer_load_dwordx4 v[124:127], v3, s[8:11], s60 offen offset:3072 nt
    s_add_u32 s79, s60, 4096
    s_pack_lh_b32_b16 s60, s79, s60
    v_perm_b32 v38, v247, v243, s68
    v_perm_b32 v39, v255, v251, s68
    v_mfma_f32_16x16x32_bf16 a[0:3], v[32:35], v[44:47], a[0:3]
    s_nop 0
    v_mfma_f32_16x16x32_bf16 a[4:7], v[36:39], v[44:47], a[4:7]
    v_mov_b32_dpp v24, v20 quad_perm:[0,1,2,3] row_mask:0xf bank_mask:0x1
    v_mov_b32_dpp v25, v21 quad_perm:[0,1,2,3] row_mask:0xf bank_mask:0x1
    v_mov_b32_dpp v26, v22 quad_perm:[0,1,2,3] row_mask:0xf bank_mask:0x1
    v_mov_b32_dpp v27, v23 quad_perm:[0,1,2,3] row_mask:0xf bank_mask:0x1
    v_mov_b32_dpp v28, v20 row_ror:4 row_mask:0xf bank_mask:0x2
    v_mov_b32_dpp v29, v21 row_ror:4 row_mask:0xf bank_mask:0x2
    v_mov_b32_dpp v30, v22 row_ror:4 row_mask:0xf bank_mask:0x2
    v_mov_b32_dpp v31, v23 row_ror:4 row_mask:0xf bank_mask:0x2
    v_mov_b32_dpp v40, v20 row_ror:8 row_mask:0xf bank_mask:0x4
    v_mov_b32_dpp v41, v21 row_ror:8 row_mask:0xf bank_mask:0x4
    v_mov_b32_dpp v42, v22 row_ror:8 row_mask:0xf bank_mask:0x4
    v_mov_b32_dpp v43, v23 row_ror:8 row_mask:0xf bank_mask:0x4
    v_mov_b32_dpp v44, v20 row_ror:12 row_mask:0xf bank_mask:0x8
    v_mov_b32_dpp v45, v21 row_ror:12 row_mask:0xf bank_mask:0x8
    v_mov_b32_dpp v46, v22 row_ror:12 row_mask:0xf bank_mask:0x8
    v_mov_b32_dpp v47, v23 row_ror:12 row_mask:0xf bank_mask:0x8
    s_waitcnt vmcnt(27)
    v_perm_b32 v32, v164, v160, s67
    v_perm_b32 v33, v172, v168, s67
    v_perm_b32 v34, v180, v176, s67
    v_perm_b32 v35, v188, v184, s67
    v_perm_b32 v36, v166, v162, s67
    v_perm_b32 v37, v174, v170, s67
    v_perm_b32 v38, v182, v178, s67
    v_perm_b32 v39, v190, v186, s67
    v_mfma_f32_16x16x32_bf16 a[0:3], v[32:35], v[24:27], a[0:3]
    v_perm_b32 v32, v164, v160, s68
    v_perm_b32 v33, v172, v168, s68
    v_perm_b32 v34, v180, v176, s68
    v_perm_b32 v35, v188, v184, s68
    v_mfma_f32_16x16x32_bf16 a[4:7], v[36:39], v[24:27], a[4:7]
    v_perm_b32 v36, v166, v162, s68
    v_perm_b32 v37, v174, v170, s68
    v_perm_b32 v38, v182, v178, s68
    v_perm_b32 v39, v190, v186, s68
    v_mfma_f32_16x16x32_bf16 a[0:3], v[32:35], v[28:31], a[0:3]
    v_perm_b32 v32, v165, v161, s67
    v_perm_b32 v33, v173, v169, s67
    v_perm_b32 v34, v181, v177, s67
    v_perm_b32 v35, v189, v185, s67
    v_mfma_f32_16x16x32_bf16 a[4:7], v[36:39], v[28:31], a[4:7]
    v_perm_b32 v36, v167, v163, s67
    v_perm_b32 v37, v175, v171, s67
    v_perm_b32 v38, v183, v179, s67
    v_perm_b32 v39, v191, v187, s67
    v_mfma_f32_16x16x32_bf16 a[0:3], v[32:35], v[40:43], a[0:3]
    v_perm_b32 v32, v165, v161, s68
    v_perm_b32 v33, v173, v169, s68
    v_perm_b32 v34, v181, v177, s68
    v_perm_b32 v35, v189, v185, s68
    v_mfma_f32_16x16x32_bf16 a[4:7], v[36:39], v[40:43], a[4:7]
    v_perm_b32 v36, v167, v163, s68
    v_perm_b32 v37, v175, v171, s68
    v_perm_b32 v38, v183, v179, s68
    v_perm_b32 v39, v191, v187, s68
    v_mfma_f32_16x16x32_bf16 a[0:3], v[32:35], v[44:47], a[0:3]
    s_nop 0
    v_mfma_f32_16x16x32_bf16 a[4:7], v[36:39], v[44:47], a[4:7]
    v_mov_b32_dpp v24, v20 row_ror:12 row_mask:0xf bank_mask:0x1
    v_mov_b32_dpp v25, v21 row_ror:12 row_mask:0xf bank_mask:0x1
    v_mov_b32_dpp v26, v22 row_ror:12 row_mask:0xf bank_mask:0x1
    v_mov_b32_dpp v27, v23 row_ror:12 row_mask:0xf bank_mask:0x1
    v_mov_b32_dpp v28, v20 quad_perm:[0,1,2,3] row_mask:0xf bank_mask:0x2
    v_mov_b32_dpp v29, v21 quad_perm:[0,1,2,3] row_mask:0xf bank_mask:0x2
    v_mov_b32_dpp v30, v22 quad_perm:[0,1,2,3] row_mask:0xf bank_mask:0x2
    v_mov_b32_dpp v31, v23 quad_perm:[0,1,2,3] row_mask:0xf bank_mask:0x2
    v_mov_b32_dpp v40, v20 row_ror:4 row_mask:0xf bank_mask:0x4
    v_mov_b32_dpp v41, v21 row_ror:4 row_mask:0xf bank_mask:0x4
    v_mov_b32_dpp v42, v22 row_ror:4 row_mask:0xf bank_mask:0x4
    v_mov_b32_dpp v43, v23 row_ror:4 row_mask:0xf bank_mask:0x4
    v_mov_b32_dpp v44, v20 row_ror:8 row_mask:0xf bank_mask:0x8
    v_mov_b32_dpp v45, v21 row_ror:8 row_mask:0xf bank_mask:0x8
    v_mov_b32_dpp v46, v22 row_ror:8 row_mask:0xf bank_mask:0x8
    v_mov_b32_dpp v47, v23 row_ror:8 row_mask:0xf bank_mask:0x8
    s_waitcnt vmcnt(19)
    v_perm_b32 v32, v196, v192, s67
    v_perm_b32 v33, v204, v200, s67
    v_perm_b32 v34, v212, v208, s67
    v_perm_b32 v35, v220, v216, s67
    v_perm_b32 v36, v198, v194, s67
    v_perm_b32 v37, v206, v202, s67
    v_perm_b32 v38, v214, v210, s67
    v_perm_b32 v39, v222, v218, s67
    v_mfma_f32_16x16x32_bf16 a[0:3], v[32:35], v[24:27], a[0:3]
    v_perm_b32 v32, v196, v192, s68
    v_perm_b32 v33, v204, v200, s68
    v_perm_b32 v34, v212, v208, s68
    v_perm_b32 v35, v220, v216, s68
    v_mfma_f32_16x16x32_bf16 a[4:7], v[36:39], v[24:27], a[4:7]
    v_perm_b32 v36, v198, v194, s68
    v_perm_b32 v37, v206, v202, s68
    v_perm_b32 v38, v214, v210, s68
    v_perm_b32 v39, v222, v218, s68
    v_mfma_f32_16x16x32_bf16 a[0:3], v[32:35], v[28:31], a[0:3]
    v_perm_b32 v32, v197, v193, s67
    v_perm_b32 v33, v205, v201, s67
    v_perm_b32 v34, v213, v209, s67
    v_perm_b32 v35, v221, v217, s67
    v_mfma_f32_16x16x32_bf16 a[4:7], v[36:39], v[28:31], a[4:7]
    v_perm_b32 v36, v199, v195, s67
    v_perm_b32 v37, v207, v203, s67
    v_perm_b32 v38, v215, v211, s67
    v_perm_b32 v39, v223, v219, s67
    v_mfma_f32_16x16x32_bf16 a[0:3], v[32:35], v[40:43], a[0:3]
    v_perm_b32 v32, v197, v193, s68
    v_perm_b32 v33, v205, v201, s68
    v_perm_b32 v34, v213, v209, s68
    v_perm_b32 v35, v221, v217, s68
    v_mfma_f32_16x16x32_bf16 a[4:7], v[36:39], v[40:43], a[4:7]
    v_perm_b32 v36, v199, v195, s68
    v_perm_b32 v37, v207, v203, s68
    v_perm_b32 v38, v215, v211, s68
    v_perm_b32 v39, v223, v219, s68
    v_mfma_f32_16x16x32_bf16 a[0:3], v[32:35], v[44:47], a[0:3]
    s_nop 0
    v_mfma_f32_16x16x32_bf16 a[4:7], v[36:39], v[44:47], a[4:7]
    s_mov_b32 s61, 0x20000
    buffer_load_dwordx4 v[56:59], v6, s[12:15], s61 offen offset:0 sc1
    s_mov_b32 s61, 0x20000
    buffer_load_dwordx4 v[60:63], v6, s[12:15], s61 offen offset:1024 sc1
    v_mov_b32_dpp v24, v20 row_ror:8 row_mask:0xf bank_mask:0x1
    v_mov_b32_dpp v25, v21 row_ror:8 row_mask:0xf bank_mask:0x1
    v_mov_b32_dpp v26, v22 row_ror:8 row_mask:0xf bank_mask:0x1
    v_mov_b32_dpp v27, v23 row_ror:8 row_mask:0xf bank_mask:0x1
    v_mov_b32_dpp v28, v20 row_ror:12 row_mask:0xf bank_mask:0x2
    v_mov_b32_dpp v29, v21 row_ror:12 row_mask:0xf bank_mask:0x2
    v_mov_b32_dpp v30, v22 row_ror:12 row_mask:0xf bank_mask:0x2
    v_mov_b32_dpp v31, v23 row_ror:12 row_mask:0xf bank_mask:0x2
    v_mov_b32_dpp v40, v20 quad_perm:[0,1,2,3] row_mask:0xf bank_mask:0x4
    v_mov_b32_dpp v41, v21 quad_perm:[0,1,2,3] row_mask:0xf bank_mask:0x4
    v_mov_b32_dpp v42, v22 quad_perm:[0,1,2,3] row_mask:0xf bank_mask:0x4
    v_mov_b32_dpp v43, v23 quad_perm:[0,1,2,3] row_mask:0xf bank_mask:0x4
    v_mov_b32_dpp v44, v20 row_ror:4 row_mask:0xf bank_mask:0x8
    v_mov_b32_dpp v45, v21 row_ror:4 row_mask:0xf bank_mask:0x8
    v_mov_b32_dpp v46, v22 row_ror:4 row_mask:0xf bank_mask:0x8
    v_mov_b32_dpp v47, v23 row_ror:4 row_mask:0xf bank_mask:0x8
    s_waitcnt vmcnt(12)
    v_perm_b32 v32, v68, v64, s67
    v_perm_b32 v33, v76, v72, s67
    v_perm_b32 v34, v84, v80, s67
    v_perm_b32 v35, v92, v88, s67
    v_perm_b32 v36, v70, v66, s67
    v_perm_b32 v37, v78, v74, s67
    v_perm_b32 v38, v86, v82, s67
    v_perm_b32 v39, v94, v90, s67
    v_mfma_f32_16x16x32_bf16 a[0:3], v[32:35], v[24:27], a[0:3]
    v_perm_b32 v32, v68, v64, s68
    v_perm_b32 v33, v76, v72, s68
    v_perm_b32 v34, v84, v80, s68
    v_perm_b32 v35, v92, v88, s68
    v_mfma_f32_16x16x32_bf16 a[4:7], v[36:39], v[24:27], a[4:7]
    v_perm_b32 v36, v70, v66, s68
    v_perm_b32 v37, v78, v74, s68
    v_perm_b32 v38, v86, v82, s68
    v_perm_b32 v39, v94, v90, s68
    v_mfma_f32_16x16x32_bf16 a[0:3], v[32:35], v[28:31], a[0:3]
    v_perm_b32 v32, v69, v65, s67
    v_perm_b32 v33, v77, v73, s67
    v_perm_b32 v34, v85, v81, s67
    v_perm_b32 v35, v93, v89, s67
    v_mfma_f32_16x16x32_bf16 a[4:7], v[36:39], v[28:31], a[4:7]
    v_perm_b32 v36, v71, v67, s67
    v_perm_b32 v37, v79, v75, s67
    v_perm_b32 v38, v87, v83, s67
    v_perm_b32 v39, v95, v91, s67
    v_mfma_f32_16x16x32_bf16 a[0:3], v[32:35], v[40:43], a[0:3]
    v_perm_b32 v32, v69, v65, s68
    v_perm_b32 v33, v77, v73, s68
    v_perm_b32 v34, v85, v81, s68
    v_perm_b32 v35, v93, v89, s68
    v_mfma_f32_16x16x32_bf16 a[4:7], v[36:39], v[40:43], a[4:7]
    v_perm_b32 v36, v71, v67, s68
    v_perm_b32 v37, v79, v75, s68
    v_perm_b32 v38, v87, v83, s68
    v_perm_b32 v39, v95, v91, s68
    v_mfma_f32_16x16x32_bf16 a[0:3], v[32:35], v[44:47], a[0:3]
    s_nop 0
    v_mfma_f32_16x16x32_bf16 a[4:7], v[36:39], v[44:47], a[4:7]
    s_waitcnt vmcnt(10)
    v_xor_b32 v10, s58, v50
    v_bitop3_b32 v10, v51, s58, v10 bitop3:0xbe
    v_bitop3_b32 v10, v54, s58, v10 bitop3:0xbe
    v_bitop3_b32 v10, v55, s58, v10 bitop3:0xbe
    v_cmp_ne_u32 vcc, 0, v10
    s_mov_b32 s34, 1
    s_cbranch_vccnz MLS_X
    v_max_f32 v50, v48, v52
    s_nop 1
    v_max_f32_dpp v50, v50, v50 row_ror:4 row_mask:0xf bank_mask:0xf
    s_nop 1
    v_max_f32_dpp v50, v50, v50 row_ror:8 row_mask:0xf bank_mask:0xf
    v_mov_b32 v10, v50
    s_nop 1
    v_permlane16_swap_b32 v50, v10
    v_max_f32 v50, v50, v10
    v_mov_b32 v10, v50
    s_nop 1
    v_permlane32_swap_b32 v50, v10
    v_max_f32 v50, v50, v10
    v_sub_f32 v48, v48, v50
    v_sub_f32 v52, v52, v50
    v_sub_f32 v9, v9, v50
    v_mul_f32 v48, s69, v48
    v_mul_f32 v52, s69, v52
    v_mul_f32 v9, s69, v9
    v_exp_f32 v48, v48
    v_exp_f32 v52, v52
    v_exp_f32 v9, v9
    v_mul_f32 v49, v49, v48
    v_fmac_f32 v49, v53, v52
    s_nop 1
    v_add_f32_dpp v49, v49, v49 row_ror:4 row_mask:0xf bank_mask:0xf
    s_nop 1
    v_add_f32_dpp v49, v49, v49 row_ror:8 row_mask:0xf bank_mask:0xf
    v_mov_b32 v10, v49
    s_nop 1
    v_permlane16_swap_b32 v49, v10
    v_add_f32 v49, v49, v10
    v_mov_b32 v10, v49
    s_nop 1
    v_permlane32_swap_b32 v49, v10
    v_add_f32 v49, v49, v10
    v_rcp_f32 v49, v49
    s_nop 0
    v_mul_f32 v9, v9, v49
    v_lshlrev_b32 v10, 4, v1
    s_lshl_b32 s64, s3, 2
    v_add_u32 v10, s64, v10
    s_mov_b64 exec, 0xf
    ds_write_b32 v10, v9 offset:26880
    s_mov_b64 exec, -1
    s_mov_b32 s34, 0
MLS_X:
    v_mov_b32_dpp v24, v20 row_ror:4 row_mask:0xf bank_mask:0x1
    v_mov_b32_dpp v25, v21 row_ror:4 row_mask:0xf bank_mask:0x1
    v_mov_b32_dpp v26, v22 row_ror:4 row_mask:0xf bank_mask:0x1
    v_mov_b32_dpp v27, v23 row_ror:4 row_mask:0xf bank_mask:0x1
    v_mov_b32_dpp v28, v20 row_ror:8 row_mask:0xf bank_mask:0x2
    v_mov_b32_dpp v29, v21 row_ror:8 row_mask:0xf bank_mask:0x2
    v_mov_b32_dpp v30, v22 row_ror:8 row_mask:0xf bank_mask:0x2
    v_mov_b32_dpp v31, v23 row_ror:8 row_mask:0xf bank_mask:0x2
    v_mov_b32_dpp v40, v20 row_ror:12 row_mask:0xf bank_mask:0x4
    v_mov_b32_dpp v41, v21 row_ror:12 row_mask:0xf bank_mask:0x4
    v_mov_b32_dpp v42, v22 row_ror:12 row_mask:0xf bank_mask:0x4
    v_mov_b32_dpp v43, v23 row_ror:12 row_mask:0xf bank_mask:0x4
    v_mov_b32_dpp v44, v20 quad_perm:[0,1,2,3] row_mask:0xf bank_mask:0x8
    v_mov_b32_dpp v45, v21 quad_perm:[0,1,2,3] row_mask:0xf bank_mask:0x8
    v_mov_b32_dpp v46, v22 quad_perm:[0,1,2,3] row_mask:0xf bank_mask:0x8
    v_mov_b32_dpp v47, v23 quad_perm:[0,1,2,3] row_mask:0xf bank_mask:0x8
    s_waitcnt vmcnt(2)
    buffer_load_dwordx2 v[128:129], v7, s[20:23], 0 offen offset:0
    v_perm_b32 v32, v100, v96, s67
    buffer_load_dwordx2 v[130:131], v7, s[20:23], 0 offen offset:1024
    v_perm_b32 v33, v108, v104, s67
    buffer_load_dwordx2 v[144:145], v7, s[20:23], 0 offen offset:2048
    v_perm_b32 v34, v116, v112, s67
    buffer_load_dwordx2 v[146:147], v7, s[20:23], 0 offen offset:3072
    v_perm_b32 v35, v124, v120, s67
    v_perm_b32 v36, v102, v98, s67
    s_mov_b32 s61, 0x1000
    buffer_load_dwordx2 v[224:225], v7, s[20:23], s61 offen offset:0
    v_perm_b32 v37, v110, v106, s67
    s_mov_b32 s61, 0x1000
    buffer_load_dwordx2 v[226:227], v7, s[20:23], s61 offen offset:1024
    v_perm_b32 v38, v118, v114, s67
    s_mov_b32 s61, 0x1000
    buffer_load_dwordx2 v[240:241], v7, s[20:23], s61 offen offset:2048
    v_perm_b32 v39, v126, v122, s67
    s_mov_b32 s61, 0x1000
    buffer_load_dwordx2 v[242:243], v7, s[20:23], s61 offen offset:3072
    v_mfma_f32_16x16x32_bf16 a[0:3], v[32:35], v[24:27], a[0:3]
    v_perm_b32 v32, v100, v96, s68
    s_mov_b32 s61, 0x2000
    buffer_load_dwordx2 v[132:133], v7, s[20:23], s61 offen offset:0
    v_perm_b32 v33, v108, v104, s68
    s_mov_b32 s61, 0x2000
    buffer_load_dwordx2 v[134:135], v7, s[20:23], s61 offen offset:1024
    v_perm_b32 v34, v116, v112, s68
    s_mov_b32 s61, 0x2000
    buffer_load_dwordx2 v[148:149], v7, s[20:23], s61 offen offset:2048
    v_perm_b32 v35, v124, v120, s68
    s_mov_b32 s61, 0x2000
    buffer_load_dwordx2 v[150:151], v7, s[20:23], s61 offen offset:3072
    v_mfma_f32_16x16x32_bf16 a[4:7], v[36:39], v[24:27], a[4:7]
    v_perm_b32 v36, v102, v98, s68
    s_mov_b32 s61, 0x3000
    buffer_load_dwordx2 v[228:229], v7, s[20:23], s61 offen offset:0
    v_perm_b32 v37, v110, v106, s68
    s_mov_b32 s61, 0x3000
    buffer_load_dwordx2 v[230:231], v7, s[20:23], s61 offen offset:1024
    v_perm_b32 v38, v118, v114, s68
    s_mov_b32 s61, 0x3000
    buffer_load_dwordx2 v[244:245], v7, s[20:23], s61 offen offset:2048
    v_perm_b32 v39, v126, v122, s68
    s_mov_b32 s61, 0x3000
    buffer_load_dwordx2 v[246:247], v7, s[20:23], s61 offen offset:3072
    v_mfma_f32_16x16x32_bf16 a[0:3], v[32:35], v[28:31], a[0:3]
    v_perm_b32 v32, v101, v97, s67
    s_mov_b32 s61, 0x4000
    buffer_load_dwordx2 v[136:137], v7, s[20:23], s61 offen offset:0
    v_perm_b32 v33, v109, v105, s67
    s_mov_b32 s61, 0x4000
    buffer_load_dwordx2 v[138:139], v7, s[20:23], s61 offen offset:1024
    v_perm_b32 v34, v117, v113, s67
    s_mov_b32 s61, 0x4000
    buffer_load_dwordx2 v[152:153], v7, s[20:23], s61 offen offset:2048
    v_perm_b32 v35, v125, v121, s67
    s_mov_b32 s61, 0x4000
    buffer_load_dwordx2 v[154:155], v7, s[20:23], s61 offen offset:3072
    v_mfma_f32_16x16x32_bf16 a[4:7], v[36:39], v[28:31], a[4:7]
    v_perm_b32 v36, v103, v99, s67
    s_mov_b32 s61, 0x5000
    buffer_load_dwordx2 v[232:233], v7, s[20:23], s61 offen offset:0
    v_perm_b32 v37, v111, v107, s67
    s_mov_b32 s61, 0x5000
    buffer_load_dwordx2 v[234:235], v7, s[20:23], s61 offen offset:1024
    v_perm_b32 v38, v119, v115, s67
    s_mov_b32 s61, 0x5000
    buffer_load_dwordx2 v[248:249], v7, s[20:23], s61 offen offset:2048
    v_perm_b32 v39, v127, v123, s67
    s_mov_b32 s61, 0x5000
    buffer_load_dwordx2 v[250:251], v7, s[20:23], s61 offen offset:3072
    v_mfma_f32_16x16x32_bf16 a[0:3], v[32:35], v[40:43], a[0:3]
    v_perm_b32 v32, v101, v97, s68
    s_mov_b32 s61, 0x6000
    buffer_load_dwordx2 v[140:141], v7, s[20:23], s61 offen offset:0
    v_perm_b32 v33, v109, v105, s68
    s_mov_b32 s61, 0x6000
    buffer_load_dwordx2 v[142:143], v7, s[20:23], s61 offen offset:1024
    v_perm_b32 v34, v117, v113, s68
    s_mov_b32 s61, 0x6000
    buffer_load_dwordx2 v[156:157], v7, s[20:23], s61 offen offset:2048
    v_perm_b32 v35, v125, v121, s68
    s_mov_b32 s61, 0x6000
    buffer_load_dwordx2 v[158:159], v7, s[20:23], s61 offen offset:3072
    v_mfma_f32_16x16x32_bf16 a[4:7], v[36:39], v[40:43], a[4:7]
    v_perm_b32 v36, v103, v99, s68
    s_mov_b32 s61, 0x7000
    buffer_load_dwordx2 v[236:237], v7, s[20:23], s61 offen offset:0
    v_perm_b32 v37, v111, v107, s68
    s_mov_b32 s61, 0x7000
    buffer_load_dwordx2 v[238:239], v7, s[20:23], s61 offen offset:1024
    v_perm_b32 v38, v119, v115, s68
    s_mov_b32 s61, 0x7000
    buffer_load_dwordx2 v[252:253], v7, s[20:23], s61 offen offset:2048
    v_perm_b32 v39, v127, v123, s68
    s_mov_b32 s61, 0x7000
    buffer_load_dwordx2 v[254:255], v7, s[20:23], s61 offen offset:3072
    v_mfma_f32_16x16x32_bf16 a[0:3], v[32:35], v[44:47], a[0:3]
    v_mfma_f32_16x16x32_bf16 a[4:7], v[36:39], v[44:47], a[4:7]
    s_cmp_eq_u32 s34, 0
    s_cbranch_scc1 MLD_X
    s_mov_b32 s62, 0x40000
    s_waitcnt vmcnt(32)
MLR_X:
    v_xor_b32 v10, s58, v58
    v_bitop3_b32 v10, v59, s58, v10 bitop3:0xbe
    v_bitop3_b32 v10, v62, s58, v10 bitop3:0xbe
    v_bitop3_b32 v10, v63, s58, v10 bitop3:0xbe
    v_cmp_ne_u32 vcc, 0, v10
    s_cbranch_vccz MLF_X
    s_mov_b32 s61, 0x20000
    buffer_load_dwordx4 v[56:59], v6, s[12:15], s61 offen offset:0 sc1
    s_mov_b32 s61, 0x20000
    buffer_load_dwordx4 v[60:63], v6, s[12:15], s61 offen offset:1024 sc1
    s_waitcnt vmcnt(0)
    s_sub_u32 s62, s62, 1
    s_cbranch_scc0 MLR_X
MLF_X:
    v_max_f32 v58, v56, v60
    s_nop 1
    v_max_f32_dpp v58, v58, v58 row_ror:4 row_mask:0xf bank_mask:0xf
    s_nop 1
    v_max_f32_dpp v58, v58, v58 row_ror:8 row_mask:0xf bank_mask:0xf
    v_mov_b32 v10, v58
    s_nop 1
    v_permlane16_swap_b32 v58, v10
    v_max_f32 v58, v58, v10
    v_mov_b32 v10, v58
    s_nop 1
    v_permlane32_swap_b32 v58, v10
    v_max_f32 v58, v58, v10
    v_sub_f32 v56, v56, v58
    v_sub_f32 v60, v60, v58
    v_sub_f32 v9, v9, v58
    v_mul_f32 v56, s69, v56
    v_mul_f32 v60, s69, v60
    v_mul_f32 v9, s69, v9
    v_exp_f32 v56, v56
    v_exp_f32 v60, v60
    v_exp_f32 v9, v9
    v_mul_f32 v57, v57, v56
    v_fmac_f32 v57, v61, v60
    s_nop 1
    v_add_f32_dpp v57, v57, v57 row_ror:4 row_mask:0xf bank_mask:0xf
    s_nop 1
    v_add_f32_dpp v57, v57, v57 row_ror:8 row_mask:0xf bank_mask:0xf
    v_mov_b32 v10, v57
    s_nop 1
    v_permlane16_swap_b32 v57, v10
    v_add_f32 v57, v57, v10
    v_mov_b32 v10, v57
    s_nop 1
    v_permlane32_swap_b32 v57, v10
    v_add_f32 v57, v57, v10
    v_rcp_f32 v57, v57
    s_nop 0
    v_mul_f32 v9, v9, v57
    v_lshlrev_b32 v10, 4, v1
    s_lshl_b32 s64, s3, 2
    v_add_u32 v10, s64, v10
    s_mov_b64 exec, 0xf
    ds_write_b32 v10, v9 offset:26880
    s_mov_b64 exec, -1
MLD_X:
    s_nop 4
    ds_write_b128 v8, a[0:3] offset:18688
    ds_write_b128 v8, a[4:7] offset:19712
    s_waitcnt lgkmcnt(0)
    s_barrier
    s_cmp_ge_u32 s3, 2
    s_cbranch_scc1 SK2_X
    ds_read_b128 v[48:51], v15 offset:26880
    ds_read_b128 v[32:35], v2 offset:18688
    ds_read_b128 v[36:39], v2 offset:20736
    ds_read_b128 v[40:43], v2 offset:22784
    ds_read_b128 v[44:47], v2 offset:24832
    s_waitcnt lgkmcnt(2)
    v_pk_mul_f32 v[32:33], v[32:33], v[48:49] op_sel_hi:[1,0]
    v_pk_mul_f32 v[34:35], v[34:35], v[48:49] op_sel_hi:[1,0]
    v_pk_fma_f32 v[32:33], v[36:37], v[48:49], v[32:33] op_sel:[0,1,0] op_sel_hi:[1,1,1]
    v_pk_fma_f32 v[34:35], v[38:39], v[48:49], v[34:35] op_sel:[0,1,0] op_sel_hi:[1,1,1]
    s_waitcnt lgkmcnt(0)
    v_pk_fma_f32 v[32:33], v[40:41], v[50:51], v[32:33] op_sel_hi:[1,0,1]
    v_pk_fma_f32 v[34:35], v[42:43], v[50:51], v[34:35] op_sel_hi:[1,0,1]
    v_pk_fma_f32 v[32:33], v[44:45], v[50:51], v[32:33] op_sel:[0,1,0] op_sel_hi:[1,1,1]
    v_pk_fma_f32 v[34:35], v[46:47], v[50:51], v[34:35] op_sel:[0,1,0] op_sel_hi:[1,1,1]
    v_bfi_b32 v32, s65, v4, v32
    v_bfi_b32 v33, s65, v4, v33
    v_bfi_b32 v34, s65, v4, v34
    v_bfi_b32 v35, s65, v4, v35
    s_mov_b32 s61, 0x80000
    buffer_store_dwordx4 v[32:35], v14, s[12:15], s61 offen offset:0 sc1
SK2_X:
    s_barrier
    v_and_b32 v10, 3, v1
    v_lshlrev_b32 v10, 17, v10
    v_add_u32 v10, v10, v5
    s_lshl_b32 s64, s63, 14
    v_add_u32 v6, s64, v10
    v_mov_b32 v16, 0
    v_mov_b32 v17, 0
    v_mov_b32 v18, 0
    v_mov_b32 v19, 0
    v_mov_b32 v20, 0
    v_mov_b32 v21, 0
    v_mov_b32 v22, 0
    v_mov_b32 v23, 0
    v_mov_b32 v9, 0xffff
    v_mov_b32 v3, 0
    s_mov_b32 s74, 0xfffffeff
    s_mov_b32 s75, 0x80000
    s_mov_b32 s62, 0x40000
    s_mov_b32 exec_lo, 0x33333333
    s_mov_b32 exec_hi, 0x33333333
    v_mov_b32 v9, 0
    s_mov_b32 exec_lo, 0xcccccccc
    s_mov_b32 exec_hi, 0xcccccccc
    buffer_load_dwordx4 v[160:163], v6, s[12:15], s75 offen offset:0 sc1
    buffer_load_dwordx4 v[164:167], v6, s[12:15], s75 offen offset:256 sc1
    buffer_load_dwordx4 v[168:171], v6, s[12:15], s75 offen offset:2048 sc1
    buffer_load_dwordx4 v[172:175], v6, s[12:15], s75 offen offset:2304 sc1
    s_add_u32 s61, s75, 0x1000
    buffer_load_dwordx4 v[176:179], v6, s[12:15], s61 offen offset:0 sc1
    buffer_load_dwordx4 v[180:183], v6, s[12:15], s61 offen offset:256 sc1
    s_add_u32 s61, s75, 0x1000
    buffer_load_dwordx4 v[184:187], v6, s[12:15], s61 offen offset:2048 sc1
    buffer_load_dwordx4 v[188:191], v6, s[12:15], s61 offen offset:2304 sc1
    s_add_u32 s61, s75, 0x2000
    buffer_load_dwordx4 v[192:195], v6, s[12:15], s61 offen offset:0 sc1
    buffer_load_dwordx4 v[196:199], v6, s[12:15], s61 offen offset:256 sc1
    s_add_u32 s61, s75, 0x2000
    buffer_load_dwordx4 v[200:203], v6, s[12:15], s61 offen offset:2048 sc1
    buffer_load_dwordx4 v[204:207], v6, s[12:15], s61 offen offset:2304 sc1
    s_add_u32 s61, s75, 0x3000
    buffer_load_dwordx4 v[208:211], v6, s[12:15], s61 offen offset:0 sc1
    buffer_load_dwordx4 v[212:215], v6, s[12:15], s61 offen offset:256 sc1
    s_add_u32 s61, s75, 0x3000
    buffer_load_dwordx4 v[216:219], v6, s[12:15], s61 offen offset:2048 sc1
    buffer_load_dwordx4 v[220:223], v6, s[12:15], s61 offen offset:2304 sc1
    s_mov_b64 exec, -1
    v_lshrrev_b32 v10, 4, v1
    v_add_u32 v10, v10, v1
    v_and_b32 v10, 3, v10
    v_and_b32 v11, 60, v1
    v_or_b32 v10, v10, v11
    v_lshlrev_b32 v10, 4, v10
    s_lshl_b32 s61, s3, 10
    v_add_u32 v8, s61, v10
    v_lshrrev_b32 v10, 4, v1
    v_bfe_u32 v11, v1, 2, 2
    v_add_u32 v10, v10, v11
    v_and_b32 v10, 3, v10
    v_and_b32 v11, 15, v1
    v_lshl_or_b32 v10, v11, 2, v10
    v_lshlrev_b32 v14, 4, v10
    s_lshl_b32 s64, s63, 13
    s_lshr_b32 s61, s37, 1
    s_lshl_b32 s61, s61, 9
    s_add_u32 s64, s64, s61
    s_and_b32 s61, s37, 1
    s_lshl_b32 s61, s61, 7
    s_add_u32 s64, s64, s61
    v_lshrrev_b32 v10, 4, v1
    v_mul_u32_u24 v10, 0x800, v10
    v_and_b32 v11, 1, v1
    v_lshl_add_u32 v10, v11, 8, v10
    v_bfe_u32 v11, v1, 1, 3
    v_lshl_add_u32 v10, v11, 4, v10
    v_add_u32 v15, s64, v10
    s_mul_i32 s36, s3, 0x0
    s_add_u32 s36, s36, 0x200000
    s_waitcnt vmcnt(16)
    v_perm_b32 v64, v130, v128, s67
    v_perm_b32 v65, v134, v132, s67
    v_perm_b32 v66, v138, v136, s67
    v_perm_b32 v67, v142, v140, s67
    v_perm_b32 v68, v130, v128, s68
    v_perm_b32 v69, v134, v132, s68
    v_perm_b32 v70, v138, v136, s68
    v_perm_b32 v71, v142, v140, s68
    v_perm_b32 v72, v131, v129, s67
    v_perm_b32 v73, v135, v133, s67
    v_perm_b32 v74, v139, v137, s67
    v_perm_b32 v75, v143, v141, s67
    v_perm_b32 v76, v131, v129, s68
    v_perm_b32 v77, v135, v133, s68
    v_perm_b32 v78, v139, v137, s68
    v_perm_b32 v79, v143, v141, s68
    v_perm_b32 v80, v146, v144, s67
    v_perm_b32 v81, v150, v148, s67
    v_perm_b32 v82, v154, v152, s67
    v_perm_b32 v83, v158, v156, s67
    v_perm_b32 v84, v146, v144, s68
    v_perm_b32 v85, v150, v148, s68
    v_perm_b32 v86, v154, v152, s68
    v_perm_b32 v87, v158, v156, s68
    v_perm_b32 v88, v147, v145, s67
    v_perm_b32 v89, v151, v149, s67
    v_perm_b32 v90, v155, v153, s67
    v_perm_b32 v91, v159, v157, s67
    v_perm_b32 v92, v147, v145, s68
    v_perm_b32 v93, v151, v149, s68
    v_perm_b32 v94, v155, v153, s68
    v_perm_b32 v95, v159, v157, s68
    v_perm_b32 v96, v226, v224, s67
    v_perm_b32 v97, v230, v228, s67
    v_perm_b32 v98, v234, v232, s67
    v_perm_b32 v99, v238, v236, s67
    v_perm_b32 v100, v226, v224, s68
    v_perm_b32 v101, v230, v228, s68
    v_perm_b32 v102, v234, v232, s68
    v_perm_b32 v103, v238, v236, s68
    v_perm_b32 v104, v227, v225, s67
    v_perm_b32 v105, v231, v229, s67
    v_perm_b32 v106, v235, v233, s67
    v_perm_b32 v107, v239, v237, s67
    v_perm_b32 v108, v227, v225, s68
    v_perm_b32 v109, v231, v229, s68
    v_perm_b32 v110, v235, v233, s68
    v_perm_b32 v111, v239, v237, s68
    v_perm_b32 v112, v242, v240, s67
    v_perm_b32 v113, v246, v244, s67
    v_perm_b32 v114, v250, v248, s67
    v_perm_b32 v115, v254, v252, s67
    v_perm_b32 v116, v242, v240, s68
    v_perm_b32 v117, v246, v244, s68
    v_perm_b32 v118, v250, v248, s68
    v_perm_b32 v119, v254, v252, s68
    v_perm_b32 v120, v243, v241, s67
    v_perm_b32 v121, v247, v245, s67
    v_perm_b32 v122, v251, v249, s67
    v_perm_b32 v123, v255, v253, s67
    v_perm_b32 v124, v243, v241, s68
    v_perm_b32 v125, v247, v245, s68
    v_perm_b32 v126, v251, v249, s68
    v_perm_b32 v127, v255, v253, s68
    v_mov_b32 v48, 0
    v_mov_b32 v49, 0
    v_mov_b32 v50, 0
    v_mov_b32 v51, 0
    v_mov_b32 v52, 0
    v_mov_b32 v53, 0
    v_mov_b32 v54, 0
    v_mov_b32 v55, 0
    v_mov_b32 v56, 0
    v_mov_b32 v57, 0
    v_mov_b32 v58, 0
    v_mov_b32 v59, 0
    v_mov_b32 v60, 0
    v_mov_b32 v61, 0
    v_mov_b32 v62, 0
    v_mov_b32 v63, 0
    s_waitcnt vmcnt(14)
    v_xor_b32 v10, s58, v160
    v_bitop3_b32 v10, v161, s58, v10 bitop3:0xbe
    v_bitop3_b32 v10, v162, s58, v10 bitop3:0xbe
    v_bitop3_b32 v10, v163, s58, v10 bitop3:0xbe
    v_bitop3_b32 v10, v164, s58, v10 bitop3:0xbe
    v_bitop3_b32 v10, v165, s58, v10 bitop3:0xbe
    v_bitop3_b32 v10, v166, s58, v10 bitop3:0xbe
    v_bitop3_b32 v10, v167, s58, v10 bitop3:0xbe
    v_and_b32 v10, 0xff, v10
    v_cmp_eq_u32 vcc, 0, v10
    s_and_b32 exec_lo, vcc_lo, 0xcccccccc
    s_and_b32 exec_hi, vcc_hi, 0xcccccccc
    v_pk_add_f32 v[16:17], v[16:17], v[160:161]
    v_pk_add_f32 v[18:19], v[18:19], v[162:163]
    v_pk_add_f32 v[20:21], v[20:21], v[164:165]
    v_pk_add_f32 v[22:23], v[22:23], v[166:167]
    v_xor_b32 v9, 0x101, v9
    s_mov_b64 exec, -1
    s_waitcnt vmcnt(12)
    v_xor_b32 v10, s58, v168
    v_bitop3_b32 v10, v169, s58, v10 bitop3:0xbe
    v_bitop3_b32 v10, v170, s58, v10 bitop3:0xbe
    v_bitop3_b32 v10, v171, s58, v10 bitop3:0xbe
    v_bitop3_b32 v10, v172, s58, v10 bitop3:0xbe
    v_bitop3_b32 v10, v173, s58, v10 bitop3:0xbe
    v_bitop3_b32 v10, v174, s58, v10 bitop3:0xbe
    v_bitop3_b32 v10, v175, s58, v10 bitop3:0xbe
    v_and_b32 v10, 0xff, v10
    v_cmp_eq_u32 vcc, 0, v10
    s_and_b32 exec_lo, vcc_lo, 0xcccccccc
    s_and_b32 exec_hi, vcc_hi, 0xcccccccc
    v_pk_add_f32 v[16:17], v[16:17], v[168:169]
    v_pk_add_f32 v[18:19], v[18:19], v[170:171]
    v_pk_add_f32 v[20:21], v[20:21], v[172:173]
    v_pk_add_f32 v[22:23], v[22:23], v[174:175]
    v_xor_b32 v9, 0x202, v9
    s_mov_b64 exec, -1
    s_waitcnt vmcnt(10)
    v_xor_b32 v10, s58, v176
    v_bitop3_b32 v10, v177, s58, v10 bitop3:0xbe
    v_bitop3_b32 v10, v178, s58, v10 bitop3:0xbe
    v_bitop3_b32 v10, v179, s58, v10 bitop3:0xbe
    v_bitop3_b32 v10, v180, s58, v10 bitop3:0xbe
    v_bitop3_b32 v10, v181, s58, v10 bitop3:0xbe
    v_bitop3_b32 v10, v182, s58, v10 bitop3:0xbe
    v_bitop3_b32 v10, v183, s58, v10 bitop3:0xbe
    v_and_b32 v10, 0xff, v10
    v_cmp_eq_u32 vcc, 0, v10
    s_and_b32 exec_lo, vcc_lo, 0xcccccccc
    s_and_b32 exec_hi, vcc_hi, 0xcccccccc
    v_pk_add_f32 v[16:17], v[16:17], v[176:177]
    v_pk_add_f32 v[18:19], v[18:19], v[178:179]
    v_pk_add_f32 v[20:21], v[20:21], v[180:181]
    v_pk_add_f32 v[22:23], v[22:23], v[182:183]
    v_xor_b32 v9, 0x404, v9
    s_mov_b64 exec, -1
    s_waitcnt vmcnt(8)
    v_xor_b32 v10, s58, v184
    v_bitop3_b32 v10, v185, s58, v10 bitop3:0xbe
    v_bitop3_b32 v10, v186, s58, v10 bitop3:0xbe
    v_bitop3_b32 v10, v187, s58, v10 bitop3:0xbe
    v_bitop3_b32 v10, v188, s58, v10 bitop3:0xbe
    v_bitop3_b32 v10, v189, s58, v10 bitop3:0xbe
    v_bitop3_b32 v10, v190, s58, v10 bitop3:0xbe
    v_bitop3_b32 v10, v191, s58, v10 bitop3:0xbe
    v_and_b32 v10, 0xff, v10
    v_cmp_eq_u32 vcc, 0, v10
    s_and_b32 exec_lo, vcc_lo, 0xcccccccc
    s_and_b32 exec_hi, vcc_hi, 0xcccccccc
    v_pk_add_f32 v[16:17], v[16:17], v[184:185]
    v_pk_add_f32 v[18:19], v[18:19], v[186:187]
    v_pk_add_f32 v[20:21], v[20:21], v[188:189]
    v_pk_add_f32 v[22:23], v[22:23], v[190:191]
    v_xor_b32 v9, 0x808, v9
    s_mov_b64 exec, -1
    s_waitcnt vmcnt(6)
    v_xor_b32 v10, s58, v192
    v_bitop3_b32 v10, v193, s58, v10 bitop3:0xbe
    v_bitop3_b32 v10, v194, s58, v10 bitop3:0xbe
    v_bitop3_b32 v10, v195, s58, v10 bitop3:0xbe
    v_bitop3_b32 v10, v196, s58, v10 bitop3:0xbe
    v_bitop3_b32 v10, v197, s58, v10 bitop3:0xbe
    v_bitop3_b32 v10, v198, s58, v10 bitop3:0xbe
    v_bitop3_b32 v10, v199, s58, v10 bitop3:0xbe
    v_and_b32 v10, 0xff, v10
    v_cmp_eq_u32 vcc, 0, v10
    s_and_b32 exec_lo, vcc_lo, 0xcccccccc
    s_and_b32 exec_hi, vcc_hi, 0xcccccccc
    v_pk_add_f32 v[16:17], v[16:17], v[192:193]
    v_pk_add_f32 v[18:19], v[18:19], v[194:195]
    v_pk_add_f32 v[20:21], v[20:21], v[196:197]
    v_pk_add_f32 v[22:23], v[22:23], v[198:199]
    v_xor_b32 v9, 0x1010, v9
    s_mov_b64 exec, -1
    s_waitcnt vmcnt(4)
    v_xor_b32 v10, s58, v200
    v_bitop3_b32 v10, v201, s58, v10 bitop3:0xbe
    v_bitop3_b32 v10, v202, s58, v10 bitop3:0xbe
    v_bitop3_b32 v10, v203, s58, v10 bitop3:0xbe
    v_bitop3_b32 v10, v204, s58, v10 bitop3:0xbe
    v_bitop3_b32 v10, v205, s58, v10 bitop3:0xbe
    v_bitop3_b32 v10, v206, s58, v10 bitop3:0xbe
    v_bitop3_b32 v10, v207, s58, v10 bitop3:0xbe
    v_and_b32 v10, 0xff, v10
    v_cmp_eq_u32 vcc, 0, v10
    s_and_b32 exec_lo, vcc_lo, 0xcccccccc
    s_and_b32 exec_hi, vcc_hi, 0xcccccccc
    v_pk_add_f32 v[16:17], v[16:17], v[200:201]
    v_pk_add_f32 v[18:19], v[18:19], v[202:203]
    v_pk_add_f32 v[20:21], v[20:21], v[204:205]
    v_pk_add_f32 v[22:23], v[22:23], v[206:207]
    v_xor_b32 v9, 0x2020, v9
    s_mov_b64 exec, -1
    s_waitcnt vmcnt(2)
    v_xor_b32 v10, s58, v208
    v_bitop3_b32 v10, v209, s58, v10 bitop3:0xbe
    v_bitop3_b32 v10, v210, s58, v10 bitop3:0xbe
    v_bitop3_b32 v10, v211, s58, v10 bitop3:0xbe
    v_bitop3_b32 v10, v212, s58, v10 bitop3:0xbe
    v_bitop3_b32 v10, v213, s58, v10 bitop3:0xbe
    v_bitop3_b32 v10, v214, s58, v10 bitop3:0xbe
    v_bitop3_b32 v10, v215, s58, v10 bitop3:0xbe
    v_and_b32 v10, 0xff, v10
    v_cmp_eq_u32 vcc, 0, v10
    s_and_b32 exec_lo, vcc_lo, 0xcccccccc
    s_and_b32 exec_hi, vcc_hi, 0xcccccccc
    v_pk_add_f32 v[16:17], v[16:17], v[208:209]
    v_pk_add_f32 v[18:19], v[18:19], v[210:211]
    v_pk_add_f32 v[20:21], v[20:21], v[212:213]
    v_pk_add_f32 v[22:23], v[22:23], v[214:215]
    v_xor_b32 v9, 0x4040, v9
    s_mov_b64 exec, -1
    s_waitcnt vmcnt(0)
    v_xor_b32 v10, s58, v216
    v_bitop3_b32 v10, v217, s58, v10 bitop3:0xbe
    v_bitop3_b32 v10, v218, s58, v10 bitop3:0xbe
    v_bitop3_b32 v10, v219, s58, v10 bitop3:0xbe
    v_bitop3_b32 v10, v220, s58, v10 bitop3:0xbe
    v_bitop3_b32 v10, v221, s58, v10 bitop3:0xbe
    v_bitop3_b32 v10, v222, s58, v10 bitop3:0xbe
    v_bitop3_b32 v10, v223, s58, v10 bitop3:0xbe
    v_and_b32 v10, 0xff, v10
    v_cmp_eq_u32 vcc, 0, v10
    s_and_b32 exec_lo, vcc_lo, 0xcccccccc
    s_and_b32 exec_hi, vcc_hi, 0xcccccccc
    v_pk_add_f32 v[16:17], v[16:17], v[216:217]
    v_pk_add_f32 v[18:19], v[18:19], v[218:219]
    v_pk_add_f32 v[20:21], v[20:21], v[220:221]
    v_pk_add_f32 v[22:23], v[22:23], v[222:223]
    v_xor_b32 v9, 0x8080, v9
    s_mov_b64 exec, -1
    v_cmp_ne_u32 vcc, 0, v9
    s_mov_b64 exec, vcc
    s_cbranch_execz RD_Xm1
    v_lshrrev_b32 v11, v3, v9
    v_ffbl_b32 v11, v11
    v_add_u32 v11, v11, v3
    v_and_b32 v24, 7, v11
    v_add_u32 v3, 1, v24
    v_lshl_add_u32 v11, v24, 11, v6
    buffer_load_dwordx4 v[160:163], v11, s[12:15], s75 offen offset:0 sc1
    buffer_load_dwordx4 v[164:167], v11, s[12:15], s75 offen offset:256 sc1
    v_lshrrev_b32 v11, v3, v9
    v_ffbl_b32 v11, v11
    v_add_u32 v11, v11, v3
    v_and_b32 v25, 7, v11
    v_add_u32 v3, 1, v25
    v_lshl_add_u32 v11, v25, 11, v6
    buffer_load_dwordx4 v[168:171], v11, s[12:15], s75 offen offset:0 sc1
    buffer_load_dwordx4 v[172:175], v11, s[12:15], s75 offen offset:256 sc1
    v_lshrrev_b32 v11, v3, v9
    v_ffbl_b32 v11, v11
    v_add_u32 v11, v11, v3
    v_and_b32 v26, 7, v11
    v_add_u32 v3, 1, v26
    v_lshl_add_u32 v11, v26, 11, v6
    buffer_load_dwordx4 v[176:179], v11, s[12:15], s75 offen offset:0 sc1
    buffer_load_dwordx4 v[180:183], v11, s[12:15], s75 offen offset:256 sc1
RL_Xm1:
    v_lshrrev_b32 v11, v3, v9
    v_ffbl_b32 v11, v11
    v_add_u32 v11, v11, v3
    v_and_b32 v27, 7, v11
    v_add_u32 v3, 1, v27
    v_lshl_add_u32 v11, v27, 11, v6
    buffer_load_dwordx4 v[184:187], v11, s[12:15], s75 offen offset:0 sc1
    buffer_load_dwordx4 v[188:191], v11, s[12:15], s75 offen offset:256 sc1
    v_bfe_u32 v12, v9, v24, 1
    s_waitcnt vmcnt(6)
    v_xor_b32 v10, s58, v160
    v_bitop3_b32 v10, v161, s58, v10 bitop3:0xbe
    v_bitop3_b32 v10, v162, s58, v10 bitop3:0xbe
    v_bitop3_b32 v10, v163, s58, v10 bitop3:0xbe
    v_bitop3_b32 v10, v164, s58, v10 bitop3:0xbe
    v_bitop3_b32 v10, v165, s58, v10 bitop3:0xbe
    v_bitop3_b32 v10, v166, s58, v10 bitop3:0xbe
    v_bitop3_b32 v10, v167, s58, v10 bitop3:0xbe
    v_and_b32 v10, 0xff, v10
    v_cmp_lt_u32 vcc, v10, v12
    s_and_saveexec_b64 s[72:73], vcc
    v_pk_add_f32 v[16:17], v[16:17], v[160:161]
    v_pk_add_f32 v[18:19], v[18:19], v[162:163]
    v_pk_add_f32 v[20:21], v[20:21], v[164:165]
    v_pk_add_f32 v[22:23], v[22:23], v[166:167]
    v_lshl_add_u32 v9, s74, v24, v9
    s_mov_b64 exec, s[72:73]
    v_cmp_ne_u32 vcc, 0, v9
    s_mov_b64 exec, vcc
    s_cbranch_execz RD_Xm1
    v_lshrrev_b32 v11, v3, v9
    v_ffbl_b32 v11, v11
    v_add_u32 v11, v11, v3
    v_and_b32 v24, 7, v11
    v_add_u32 v3, 1, v24
    v_lshl_add_u32 v11, v24, 11, v6
    buffer_load_dwordx4 v[160:163], v11, s[12:15], s75 offen offset:0 sc1
    buffer_load_dwordx4 v[164:167], v11, s[12:15], s75 offen offset:256 sc1
    v_bfe_u32 v12, v9, v25, 1
    s_waitcnt vmcnt(6)
    v_xor_b32 v10, s58, v168
    v_bitop3_b32 v10, v169, s58, v10 bitop3:0xbe
    v_bitop3_b32 v10, v170, s58, v10 bitop3:0xbe
    v_bitop3_b32 v10, v171, s58, v10 bitop3:0xbe
    v_bitop3_b32 v10, v172, s58, v10 bitop3:0xbe
    v_bitop3_b32 v10, v173, s58, v10 bitop3:0xbe
    v_bitop3_b32 v10, v174, s58, v10 bitop3:0xbe
    v_bitop3_b32 v10, v175, s58, v10 bitop3:0xbe
    v_and_b32 v10, 0xff, v10
    v_cmp_lt_u32 vcc, v10, v12
    s_and_saveexec_b64 s[72:73], vcc
    v_pk_add_f32 v[16:17], v[16:17], v[168:169]
    v_pk_add_f32 v[18:19], v[18:19], v[170:171]
    v_pk_add_f32 v[20:21], v[20:21], v[172:173]
    v_pk_add_f32 v[22:23], v[22:23], v[174:175]
    v_lshl_add_u32 v9, s74, v25, v9
    s_mov_b64 exec, s[72:73]
    v_cmp_ne_u32 vcc, 0, v9
    s_mov_b64 exec, vcc
    s_cbranch_execz RD_Xm1
    v_lshrrev_b32 v11, v3, v9
    v_ffbl_b32 v11, v11
    v_add_u32 v11, v11, v3
    v_and_b32 v25, 7, v11
    v_add_u32 v3, 1, v25
    v_lshl_add_u32 v11, v25, 11, v6
    buffer_load_dwordx4 v[168:171], v11, s[12:15], s75 offen offset:0 sc1
    buffer_load_dwordx4 v[172:175], v11, s[12:15], s75 offen offset:256 sc1
    v_bfe_u32 v12, v9, v26, 1
    s_waitcnt vmcnt(6)
    v_xor_b32 v10, s58, v176
    v_bitop3_b32 v10, v177, s58, v10 bitop3:0xbe
    v_bitop3_b32 v10, v178, s58, v10 bitop3:0xbe
    v_bitop3_b32 v10, v179, s58, v10 bitop3:0xbe
    v_bitop3_b32 v10, v180, s58, v10 bitop3:0xbe
    v_bitop3_b32 v10, v181, s58, v10 bitop3:0xbe
    v_bitop3_b32 v10, v182, s58, v10 bitop3:0xbe
    v_bitop3_b32 v10, v183, s58, v10 bitop3:0xbe
    v_and_b32 v10, 0xff, v10
    v_cmp_lt_u32 vcc, v10, v12
    s_and_saveexec_b64 s[72:73], vcc
    v_pk_add_f32 v[16:17], v[16:17], v[176:177]
    v_pk_add_f32 v[18:19], v[18:19], v[178:179]
    v_pk_add_f32 v[20:21], v[20:21], v[180:181]
    v_pk_add_f32 v[22:23], v[22:23], v[182:183]
    v_lshl_add_u32 v9, s74, v26, v9
    s_mov_b64 exec, s[72:73]
    v_cmp_ne_u32 vcc, 0, v9
    s_mov_b64 exec, vcc
    s_cbranch_execz RD_Xm1
    v_lshrrev_b32 v11, v3, v9
    v_ffbl_b32 v11, v11
    v_add_u32 v11, v11, v3
    v_and_b32 v26, 7, v11
    v_add_u32 v3, 1, v26
    v_lshl_add_u32 v11, v26, 11, v6
    buffer_load_dwordx4 v[176:179], v11, s[12:15], s75 offen offset:0 sc1
    buffer_load_dwordx4 v[180:183], v11, s[12:15], s75 offen offset:256 sc1
    v_bfe_u32 v12, v9, v27, 1
    s_waitcnt vmcnt(6)
    v_xor_b32 v10, s58, v184
    v_bitop3_b32 v10, v185, s58, v10 bitop3:0xbe
    v_bitop3_b32 v10, v186, s58, v10 bitop3:0xbe
    v_bitop3_b32 v10, v187, s58, v10 bitop3:0xbe
    v_bitop3_b32 v10, v188, s58, v10 bitop3:0xbe
    v_bitop3_b32 v10, v189, s58, v10 bitop3:0xbe
    v_bitop3_b32 v10, v190, s58, v10 bitop3:0xbe
    v_bitop3_b32 v10, v191, s58, v10 bitop3:0xbe
    v_and_b32 v10, 0xff, v10
    v_cmp_lt_u32 vcc, v10, v12
    s_and_saveexec_b64 s[72:73], vcc
    v_pk_add_f32 v[16:17], v[16:17], v[184:185]
    v_pk_add_f32 v[18:19], v[18:19], v[186:187]
    v_pk_add_f32 v[20:21], v[20:21], v[188:189]
    v_pk_add_f32 v[22:23], v[22:23], v[190:191]
    v_lshl_add_u32 v9, s74, v27, v9
    s_mov_b64 exec, s[72:73]
    v_cmp_ne_u32 vcc, 0, v9
    s_mov_b64 exec, vcc
    s_cbranch_execz RD_Xm1
    s_sub_u32 s62, s62, 1
    s_cbranch_scc0 RL_Xm1
RD_Xm1:
    s_mov_b64 exec, -1
    v_cvt_pk_bf16_f32 v24, v16, v20
    v_cvt_pk_bf16_f32 v25, v17, v21
    v_cvt_pk_bf16_f32 v26, v18, v22
    v_cvt_pk_bf16_f32 v27, v19, v23
    v_mov_b32_dpp v48, v24 quad_perm:[0,1,2,3] row_mask:0xf bank_mask:0x1
    v_mov_b32_dpp v49, v25 quad_perm:[0,1,2,3] row_mask:0xf bank_mask:0x1
    v_mov_b32_dpp v50, v26 quad_perm:[0,1,2,3] row_mask:0xf bank_mask:0x1
    v_mov_b32_dpp v51, v27 quad_perm:[0,1,2,3] row_mask:0xf bank_mask:0x1
    s_nop 1
    v_mfma_f32_16x16x32_bf16 v[128:131], v[64:67], v[48:51], 0
    v_mov_b32_dpp v52, v24 quad_perm:[0,1,2,3] row_mask:0xf bank_mask:0x2
    v_mov_b32_dpp v53, v25 quad_perm:[0,1,2,3] row_mask:0xf bank_mask:0x2
    v_mfma_f32_16x16x32_bf16 v[132:135], v[68:71], v[48:51], 0
    v_mov_b32_dpp v54, v26 quad_perm:[0,1,2,3] row_mask:0xf bank_mask:0x2
    v_mov_b32_dpp v55, v27 quad_perm:[0,1,2,3] row_mask:0xf bank_mask:0x2
    s_nop 1
    v_mfma_f32_16x16x32_bf16 v[128:131], v[80:83], v[52:55], v[128:131]
    v_mov_b32_dpp v56, v24 quad_perm:[0,1,2,3] row_mask:0xf bank_mask:0x4
    v_mov_b32_dpp v57, v25 quad_perm:[0,1,2,3] row_mask:0xf bank_mask:0x4
    v_mfma_f32_16x16x32_bf16 v[132:135], v[84:87], v[52:55], v[132:135]
    v_mov_b32_dpp v58, v26 quad_perm:[0,1,2,3] row_mask:0xf bank_mask:0x4
    v_mov_b32_dpp v59, v27 quad_perm:[0,1,2,3] row_mask:0xf bank_mask:0x4
    s_nop 1
    v_mfma_f32_16x16x32_bf16 v[128:131], v[96:99], v[56:59], v[128:131]
    v_mov_b32_dpp v60, v24 quad_perm:[0,1,2,3] row_mask:0xf bank_mask:0x8
    v_mov_b32_dpp v61, v25 quad_perm:[0,1,2,3] row_mask:0xf bank_mask:0x8
    v_mfma_f32_16x16x32_bf16 v[132:135], v[100:103], v[56:59], v[132:135]
    v_mov_b32_dpp v62, v26 quad_perm:[0,1,2,3] row_mask:0xf bank_mask:0x8
    v_mov_b32_dpp v63, v27 quad_perm:[0,1,2,3] row_mask:0xf bank_mask:0x8
    s_nop 1
    v_mfma_f32_16x16x32_bf16 v[128:131], v[112:115], v[60:63], v[128:131]
    v_mfma_f32_16x16x32_bf16 v[132:135], v[116:119], v[60:63], v[132:135]
    v_mfma_f32_16x16x32_bf16 v[136:139], v[72:75], v[48:51], 0
    v_mfma_f32_16x16x32_bf16 v[140:143], v[76:79], v[48:51], 0
    v_mfma_f32_16x16x32_bf16 v[136:139], v[88:91], v[52:55], v[136:139]
    v_mfma_f32_16x16x32_bf16 v[140:143], v[92:95], v[52:55], v[140:143]
    s_nop 2
    v_add_f32_dpp v144, v128, v128 row_shl:4 row_mask:0xf bank_mask:0x5
    v_add_f32_dpp v146, v129, v129 row_shl:4 row_mask:0xf bank_mask:0x5
    v_mfma_f32_16x16x32_bf16 v[136:139], v[104:107], v[56:59], v[136:139]
    v_add_f32_dpp v148, v130, v130 row_shl:4 row_mask:0xf bank_mask:0x5
    v_add_f32_dpp v150, v131, v131 row_shl:4 row_mask:0xf bank_mask:0x5
    v_mfma_f32_16x16x32_bf16 v[140:143], v[108:111], v[56:59], v[140:143]
    v_add_f32_dpp v144, v132, v132 row_shr:4 row_mask:0xf bank_mask:0xa
    v_add_f32_dpp v146, v133, v133 row_shr:4 row_mask:0xf bank_mask:0xa
    v_mfma_f32_16x16x32_bf16 v[136:139], v[120:123], v[60:63], v[136:139]
    v_add_f32_dpp v148, v134, v134 row_shr:4 row_mask:0xf bank_mask:0xa
    v_add_f32_dpp v150, v135, v135 row_shr:4 row_mask:0xf bank_mask:0xa
    v_mfma_f32_16x16x32_bf16 v[140:143], v[124:127], v[60:63], v[140:143]
    s_nop 4
    v_add_f32_dpp v145, v136, v136 row_shl:4 row_mask:0xf bank_mask:0x5
    v_add_f32_dpp v147, v137, v137 row_shl:4 row_mask:0xf bank_mask:0x5
    v_add_f32_dpp v149, v138, v138 row_shl:4 row_mask:0xf bank_mask:0x5
    v_add_f32_dpp v151, v139, v139 row_shl:4 row_mask:0xf bank_mask:0x5
    v_add_f32_dpp v145, v140, v140 row_shr:4 row_mask:0xf bank_mask:0xa
    v_add_f32_dpp v147, v141, v141 row_shr:4 row_mask:0xf bank_mask:0xa
    v_add_f32_dpp v149, v142, v142 row_shr:4 row_mask:0xf bank_mask:0xa
    v_add_f32_dpp v151, v143, v143 row_shr:4 row_mask:0xf bank_mask:0xa
    v_add_f32_dpp v152, v144, v144 row_shl:8 row_mask:0xf bank_mask:0x3
    v_add_f32_dpp v153, v146, v146 row_shl:8 row_mask:0xf bank_mask:0x3
    v_add_f32_dpp v154, v148, v148 row_shl:8 row_mask:0xf bank_mask:0x3
    v_add_f32_dpp v155, v150, v150 row_shl:8 row_mask:0xf bank_mask:0x3
    v_add_f32_dpp v152, v145, v145 row_shr:8 row_mask:0xf bank_mask:0xc
    v_add_f32_dpp v153, v147, v147 row_shr:8 row_mask:0xf bank_mask:0xc
    v_add_f32_dpp v154, v149, v149 row_shr:8 row_mask:0xf bank_mask:0xc
    v_add_f32_dpp v155, v151, v151 row_shr:8 row_mask:0xf bank_mask:0xc
    ds_write_b128 v8, v[152:155] offset:0
    s_waitcnt lgkmcnt(0)
    s_barrier
    s_cmp_lg_u32 s3, 0
    s_cbranch_scc1 WS_X
    ds_read_b128 v[16:19], v14 offset:0
    ds_read_b128 v[20:23], v14 offset:1024
    ds_read_b128 v[24:27], v14 offset:2048
    ds_read_b128 v[28:31], v14 offset:3072
    s_waitcnt lgkmcnt(2)
    v_pk_add_f32 v[16:17], v[16:17], v[20:21]
    v_pk_add_f32 v[18:19], v[18:19], v[22:23]
    s_waitcnt lgkmcnt(0)
    v_pk_add_f32 v[24:25], v[24:25], v[28:29]
    v_pk_add_f32 v[26:27], v[26:27], v[30:31]
    v_pk_add_f32 v[16:17], v[16:17], v[24:25]
    v_pk_add_f32 v[18:19], v[18:19], v[26:27]
    v_bfi_b32 v16, s65, v4, v16
    v_bfi_b32 v17, s65, v4, v17
    v_bfi_b32 v18, s65, v4, v18
    v_bfi_b32 v19, s65, v4, v19
    s_mov_b32 exec_lo, 0
    buffer_store_dwordx4 v[16:19], v15, s[12:15], s36 offen sc1
    s_mov_b64 exec, -1
WS_X:
DONE_X:
    s_waitcnt vmcnt(0)
    s_endpgm
.p2align 6
CLS_G:
    s_mov_b32 s16, s38
    s_mov_b32 s17, s39
    s_mov_b32 s18, 0x400000
    s_mov_b32 s19, 0x20000
    s_and_b32 s63, s2, 7
    s_lshl_b32 s63, s63, 3
    s_sub_u32 s64, s2, 48
    s_lshr_b32 s64, s64, 3
    s_add_u32 s63, s63, s64
    s_lshl_b32 s64, s63, 7
    v_lshrrev_b32 v10, 4, v1
    v_lshlrev_b32 v10, 5, v10
    s_lshl_b32 s61, s3, 7
    v_add_u32 v10, s61, v10
    s_movk_i32 s61, 8192
    v_mul_lo_u32 v10, v10, s61
    v_and_b32 v11, 15, v1
    v_lshl_add_u32 v10, v11, 3, v10
    v_add_u32 v6, s64, v10
    v_and_b32 v10, 3, v1
    v_lshlrev_b32 v10, 10, v10
    v_lshrrev_b32 v11, 4, v1
    v_lshl_add_u32 v10, v11, 6, v10
    v_bfe_u32 v11, v1, 2, 2
    v_lshl_add_u32 v10, v11, 2, v10
    s_lshl_b32 s61, s3, 8
    v_add_u32 v7, s61, v10
    buffer_load_dword v244, v7, s[24:27], 0 offen offset:0
    buffer_load_dword v245, v7, s[24:27], 0 offen offset:16
    buffer_load_dword v246, v7, s[24:27], 0 offen offset:32
    buffer_load_dword v247, v7, s[24:27], 0 offen offset:48
    buffer_load_dwordx2 v[64:65], v6, s[16:19], 0 offen offset:0 nt
    s_mov_b32 s61, 0x2000
    buffer_load_dwordx2 v[66:67], v6, s[16:19], s61 offen offset:0 nt
    s_mov_b32 s61, 0x4000
    buffer_load_dwordx2 v[80:81], v6, s[16:19], s61 offen offset:0 nt
    s_mov_b32 s61, 0x6000
    buffer_load_dwordx2 v[82:83], v6, s[16:19], s61 offen offset:0 nt
    s_mov_b32 s61, 0x8000
    buffer_load_dwordx2 v[96:97], v6, s[16:19], s61 offen offset:0 nt
    s_mov_b32 s61, 0xa000
    buffer_load_dwordx2 v[98:99], v6, s[16:19], s61 offen offset:0 nt
    s_mov_b32 s61, 0xc000
    buffer_load_dwordx2 v[112:113], v6, s[16:19], s61 offen offset:0 nt
    s_mov_b32 s61, 0xe000
    buffer_load_dwordx2 v[114:115], v6, s[16:19], s61 offen offset:0 nt
    s_mov_b32 s61, 0x10000
    buffer_load_dwordx2 v[68:69], v6, s[16:19], s61 offen offset:0 nt
    s_mov_b32 s61, 0x12000
    buffer_load_dwordx2 v[70:71], v6, s[16:19], s61 offen offset:0 nt
    s_mov_b32 s61, 0x14000
    buffer_load_dwordx2 v[84:85], v6, s[16:19], s61 offen offset:0 nt
    s_mov_b32 s61, 0x16000
    buffer_load_dwordx2 v[86:87], v6, s[16:19], s61 offen offset:0 nt
    s_mov_b32 s61, 0x18000
    buffer_load_dwordx2 v[100:101], v6, s[16:19], s61 offen offset:0 nt
    s_mov_b32 s61, 0x1a000
    buffer_load_dwordx2 v[102:103], v6, s[16:19], s61 offen offset:0 nt
    s_mov_b32 s61, 0x1c000
    buffer_load_dwordx2 v[116:117], v6, s[16:19], s61 offen offset:0 nt
    s_mov_b32 s61, 0x1e000
    buffer_load_dwordx2 v[118:119], v6, s[16:19], s61 offen offset:0 nt
    s_mov_b32 s61, 0x20000
    buffer_load_dwordx2 v[72:73], v6, s[16:19], s61 offen offset:0 nt
    s_mov_b32 s61, 0x22000
    buffer_load_dwordx2 v[74:75], v6, s[16:19], s61 offen offset:0 nt
    s_mov_b32 s61, 0x24000
    buffer_load_dwordx2 v[88:89], v6, s[16:19], s61 offen offset:0 nt
    s_mov_b32 s61, 0x26000
    buffer_load_dwordx2 v[90:91], v6, s[16:19], s61 offen offset:0 nt
    s_mov_b32 s61, 0x28000
    buffer_load_dwordx2 v[104:105], v6, s[16:19], s61 offen offset:0 nt
    s_mov_b32 s61, 0x2a000
    buffer_load_dwordx2 v[106:107], v6, s[16:19], s61 offen offset:0 nt
    s_mov_b32 s61, 0x2c000
    buffer_load_dwordx2 v[120:121], v6, s[16:19], s61 offen offset:0 nt
    s_mov_b32 s61, 0x2e000
    buffer_load_dwordx2 v[122:123], v6, s[16:19], s61 offen offset:0 nt
    s_mov_b32 s61, 0x30000
    buffer_load_dwordx2 v[76:77], v6, s[16:19], s61 offen offset:0 nt
    s_mov_b32 s61, 0x32000
    buffer_load_dwordx2 v[78:79], v6, s[16:19], s61 offen offset:0 nt
    s_mov_b32 s61, 0x34000
    buffer_load_dwordx2 v[92:93], v6, s[16:19], s61 offen offset:0 nt
    s_mov_b32 s61, 0x36000
    buffer_load_dwordx2 v[94:95], v6, s[16:19], s61 offen offset:0 nt
    s_mov_b32 s61, 0x38000
    buffer_load_dwordx2 v[108:109], v6, s[16:19], s61 offen offset:0 nt
    s_mov_b32 s61, 0x3a000
    buffer_load_dwordx2 v[110:111], v6, s[16:19], s61 offen offset:0 nt
    s_mov_b32 s61, 0x3c000
    buffer_load_dwordx2 v[124:125], v6, s[16:19], s61 offen offset:0 nt
    s_mov_b32 s61, 0x3e000
    buffer_load_dwordx2 v[126:127], v6, s[16:19], s61 offen offset:0 nt
    s_waitcnt vmcnt(32)
    v_lshlrev_b32 v192, 16, v244
    v_and_b32 v196, s66, v244
    v_lshlrev_b32 v193, 16, v245
    v_and_b32 v197, s66, v245
    v_lshlrev_b32 v194, 16, v246
    v_and_b32 v198, s66, v246
    v_lshlrev_b32 v195, 16, v247
    v_and_b32 v199, s66, v247
    v_add_f32 v200, v192, v193
    v_add_f32 v200, v200, v194
    v_add_f32 v200, v200, v195
    v_add_f32 v200, v200, v196
    v_add_f32 v200, v200, v197
    v_add_f32 v200, v200, v198
    v_add_f32 v200, v200, v199
    s_nop 1
    v_add_f32_dpp v200, v200, v200 row_ror:4 row_mask:0xf bank_mask:0xf
    s_nop 1
    v_add_f32_dpp v200, v200, v200 row_ror:8 row_mask:0xf bank_mask:0xf
    v_mov_b32 v202, v200
    s_nop 1
    v_permlane16_swap_b32 v200, v202
    v_add_f32 v200, v200, v202
    v_mov_b32 v202, v200
    s_nop 1
    v_permlane32_swap_b32 v200, v202
    v_add_f32 v200, v200, v202
    v_mul_f32 v200, 0x3c000000, v200
    v_sub_f32 v204, v192, v200
    v_sub_f32 v205, v193, v200
    v_sub_f32 v206, v194, v200
    v_sub_f32 v207, v195, v200
    v_sub_f32 v208, v196, v200
    v_sub_f32 v209, v197, v200
    v_sub_f32 v210, v198, v200
    v_sub_f32 v211, v199, v200
    v_mul_f32 v201, v204, v204
    v_fmac_f32 v201, v205, v205
    v_fmac_f32 v201, v206, v206
    v_fmac_f32 v201, v207, v207
    v_fmac_f32 v201, v208, v208
    v_fmac_f32 v201, v209, v209
    v_fmac_f32 v201, v210, v210
    v_fmac_f32 v201, v211, v211
    s_nop 1
    v_add_f32_dpp v201, v201, v201 row_ror:4 row_mask:0xf bank_mask:0xf
    s_nop 1
    v_add_f32_dpp v201, v201, v201 row_ror:8 row_mask:0xf bank_mask:0xf
    v_mov_b32 v202, v201
    s_nop 1
    v_permlane16_swap_b32 v201, v202
    v_add_f32 v201, v201, v202
    v_mov_b32 v202, v201
    s_nop 1
    v_permlane32_swap_b32 v201, v202
    v_add_f32 v201, v201, v202
    v_and_b32 v202, 3, v1
    v_lshlrev_b32 v202, 5, v202
    s_lshl_b32 s61, s3, 3
    v_add_u32 v203, s61, v202
    s_mov_b64 exec, 0xf
    ds_write_b64 v203, v[200:201] offset:26944
    s_mov_b64 exec, -1
    s_waitcnt lgkmcnt(0)
    s_barrier
    ds_read_b128 v[204:207], v202 offset:26944
    ds_read_b128 v[208:211], v202 offset:26960
    s_waitcnt lgkmcnt(0)
    v_add_f32 v200, v204, v206
    v_add_f32 v201, v208, v210
    v_add_f32 v200, v200, v201
    v_mul_f32 v200, 0x3e800000, v200
    v_sub_f32 v204, v204, v200
    v_sub_f32 v206, v206, v200
    v_sub_f32 v208, v208, v200
    v_sub_f32 v210, v210, v200
    v_mul_f32 v201, v204, v204
    v_fmac_f32 v201, v206, v206
    v_fmac_f32 v201, v208, v208
    v_fmac_f32 v201, v210, v210
    v_mul_f32 v201, 0x43000000, v201
    v_add_f32 v201, v201, v205
    v_add_f32 v201, v201, v207
    v_add_f32 v201, v201, v209
    v_add_f32 v201, v201, v211
    v_mul_f32 v201, 0x3b000000, v201
    v_cvt_pk_bf16_f32 v202, v200, v201
    v_lshlrev_b32 v200, 16, v202
    v_and_b32 v201, s66, v202
    v_add_f32 v201, s71, v201
    v_cvt_pk_bf16_f32 v202, v203, v201
    v_lshlrev_b32 v203, 16, v202
    v_and_b32 v201, s66, v202
    v_sqrt_f32 v201, v201
    s_nop 0
    v_cvt_pk_bf16_f32 v202, v203, v201
    v_lshlrev_b32 v203, 16, v202
    v_and_b32 v201, s66, v202
    v_mov_b32 v202, v201
    v_rcp_f32 v201, v201
    buffer_load_dwordx4 a[0:3], v2, s[4:7], s59 offen offset:0 nt
    v_sub_f32 v192, v192, v200
    v_sub_f32 v193, v193, v200
    v_sub_f32 v194, v194, v200
    v_sub_f32 v195, v195, v200
    v_sub_f32 v196, v196, v200
    v_sub_f32 v197, v197, v200
    v_sub_f32 v198, v198, v200
    v_sub_f32 v199, v199, v200
    v_cvt_pk_bf16_f32 v204, v192, v193
    v_cvt_pk_bf16_f32 v205, v194, v195
    v_cvt_pk_bf16_f32 v206, v196, v197
    v_cvt_pk_bf16_f32 v207, v198, v199
    buffer_load_dwordx4 a[4:7], v2, s[4:7], s59 offen offset:128 nt
    v_lshlrev_b32 v192, 16, v204
    v_and_b32 v193, s66, v204
    v_lshlrev_b32 v194, 16, v205
    v_and_b32 v195, s66, v205
    v_lshlrev_b32 v196, 16, v206
    v_and_b32 v197, s66, v206
    v_lshlrev_b32 v198, 16, v207
    v_and_b32 v199, s66, v207
    v_mul_f32 v204, v192, v201
    v_mul_f32 v205, v193, v201
    v_mul_f32 v206, v194, v201
    v_mul_f32 v207, v195, v201
    buffer_load_dwordx4 a[8:11], v2, s[4:7], s59 offen offset:1024 nt
    v_mul_f32 v208, v196, v201
    v_mul_f32 v209, v197, v201
    v_mul_f32 v210, v198, v201
    v_mul_f32 v211, v199, v201
    v_fma_f32 v192, -v204, v202, v192
    v_fma_f32 v193, -v205, v202, v193
    v_fma_f32 v194, -v206, v202, v194
    v_fma_f32 v195, -v207, v202, v195
    v_fma_f32 v196, -v208, v202, v196
    v_fma_f32 v197, -v209, v202, v197
    v_fma_f32 v198, -v210, v202, v198
    v_fma_f32 v199, -v211, v202, v199
    buffer_load_dwordx4 a[12:15], v2, s[4:7], s59 offen offset:1152 nt
    v_fma_f32 v192, v192, v201, v204
    v_fma_f32 v193, v193, v201, v205
    v_fma_f32 v194, v194, v201, v206
    v_fma_f32 v195, v195, v201, v207
    v_fma_f32 v196, v196, v201, v208
    v_fma_f32 v197, v197, v201, v209
    v_fma_f32 v198, v198, v201, v210
    v_fma_f32 v199, v199, v201, v211
    v_cvt_pk_bf16_f32 v204, v192, v193
    v_cvt_pk_bf16_f32 v205, v194, v195
    v_cvt_pk_bf16_f32 v206, v196, v197
    v_cvt_pk_bf16_f32 v207, v198, v199
    buffer_load_dwordx4 a[16:19], v2, s[4:7], s59 offen offset:2048 nt
    v_lshlrev_b32 v192, 16, v204
    v_and_b32 v193, s66, v204
    v_lshlrev_b32 v194, 16, v205
    v_and_b32 v195, s66, v205
    v_lshlrev_b32 v196, 16, v206
    v_and_b32 v197, s66, v206
    v_lshlrev_b32 v198, 16, v207
    v_and_b32 v199, s66, v207
    v_lshrrev_b32 v192, 16, v192
    v_lshrrev_b32 v193, 16, v193
    v_lshrrev_b32 v194, 16, v194
    v_lshrrev_b32 v195, 16, v195
    buffer_load_dwordx4 a[20:23], v2, s[4:7], s59 offen offset:2176 nt
    v_mov_b32 v48, 0
    v_mov_b32 v49, 0
    v_mov_b32 v50, 0
    v_mov_b32 v51, 0
    v_mov_b32 v52, 0
    v_mov_b32 v53, 0
    v_mov_b32 v54, 0
    v_mov_b32 v55, 0
    v_mov_b32 v56, 0
    v_mov_b32 v57, 0
    v_mov_b32 v58, 0
    v_mov_b32 v59, 0
    buffer_load_dwordx4 a[24:27], v2, s[4:7], s59 offen offset:3072 nt
    v_mov_b32 v60, 0
    v_mov_b32 v61, 0
    v_mov_b32 v62, 0
    v_mov_b32 v63, 0
    v_lshrrev_b32 v10, 4, v1
    v_add_u32 v10, v10, v1
    v_and_b32 v10, 3, v10
    v_and_b32 v11, 60, v1
    v_or_b32 v10, v10, v11
    v_lshlrev_b32 v10, 4, v10
    s_lshl_b32 s61, s3, 10
    v_add_u32 v8, s61, v10
    buffer_load_dwordx4 a[28:31], v2, s[4:7], s59 offen offset:3200 nt
    s_add_u32 s79, s59, 4096
    s_pack_lh_b32_b16 s59, s79, s59
    v_lshrrev_b32 v10, 4, v1
    v_bfe_u32 v11, v1, 2, 2
    v_add_u32 v10, v10, v11
    v_and_b32 v10, 3, v10
    v_and_b32 v11, 15, v1
    v_lshl_or_b32 v10, v11, 2, v10
    v_lshlrev_b32 v14, 4, v10
    s_lshl_b32 s64, s63, 8
    v_lshrrev_b32 v10, 4, v1
    v_mul_u32_u24 v10, 0x4000, v10
    v_and_b32 v11, 15, v1
    v_lshl_add_u32 v10, v11, 4, v10
    v_add_u32 v15, s64, v10
    v_and_b32 v10, 3, v1
    v_mul_u32_u24 v10, 0x3000, v10
    v_add_u32 v6, v10, v5
    s_add_u32 s58, s58, 0x9e3779b9
    v_mov_b32 v4, s58
    s_waitcnt vmcnt(8)
    buffer_load_dwordx4 a[32:35], v2, s[4:7], s59 offen offset:0 nt
    v_perm_b32 v128, v66, v64, s67
    v_perm_b32 v129, v70, v68, s67
    v_perm_b32 v130, v74, v72, s67
    v_perm_b32 v131, v78, v76, s67
    v_perm_b32 v132, v66, v64, s68
    v_perm_b32 v133, v70, v68, s68
    v_perm_b32 v134, v74, v72, s68
    v_perm_b32 v135, v78, v76, s68
    buffer_load_dwordx4 a[36:39], v2, s[4:7], s59 offen offset:128 nt
    v_perm_b32 v136, v67, v65, s67
    v_perm_b32 v137, v71, v69, s67
    v_perm_b32 v138, v75, v73, s67
    v_perm_b32 v139, v79, v77, s67
    v_perm_b32 v140, v67, v65, s68
    v_perm_b32 v141, v71, v69, s68
    v_perm_b32 v142, v75, v73, s68
    v_perm_b32 v143, v79, v77, s68
    buffer_load_dwordx4 a[40:43], v2, s[4:7], s59 offen offset:1024 nt
    v_perm_b32 v144, v82, v80, s67
    v_perm_b32 v145, v86, v84, s67
    v_perm_b32 v146, v90, v88, s67
    v_perm_b32 v147, v94, v92, s67
    v_perm_b32 v148, v82, v80, s68
    v_perm_b32 v149, v86, v84, s68
    v_perm_b32 v150, v90, v88, s68
    v_perm_b32 v151, v94, v92, s68
    buffer_load_dwordx4 a[44:47], v2, s[4:7], s59 offen offset:1152 nt
    v_perm_b32 v152, v83, v81, s67
    v_perm_b32 v153, v87, v85, s67
    v_perm_b32 v154, v91, v89, s67
    v_perm_b32 v155, v95, v93, s67
    v_perm_b32 v156, v83, v81, s68
    v_perm_b32 v157, v87, v85, s68
    v_perm_b32 v158, v91, v89, s68
    v_perm_b32 v159, v95, v93, s68
    buffer_load_dwordx4 a[48:51], v2, s[4:7], s59 offen offset:2048 nt
    v_perm_b32 v160, v98, v96, s67
    v_perm_b32 v161, v102, v100, s67
    v_perm_b32 v162, v106, v104, s67
    v_perm_b32 v163, v110, v108, s67
    v_perm_b32 v164, v98, v96, s68
    v_perm_b32 v165, v102, v100, s68
    v_perm_b32 v166, v106, v104, s68
    v_perm_b32 v167, v110, v108, s68
    buffer_load_dwordx4 a[52:55], v2, s[4:7], s59 offen offset:2176 nt
    v_perm_b32 v168, v99, v97, s67
    v_perm_b32 v169, v103, v101, s67
    v_perm_b32 v170, v107, v105, s67
    v_perm_b32 v171, v111, v109, s67
    v_perm_b32 v172, v99, v97, s68
    v_perm_b32 v173, v103, v101, s68
    v_perm_b32 v174, v107, v105, s68
    v_perm_b32 v175, v111, v109, s68
    buffer_load_dwordx4 a[56:59], v2, s[4:7], s59 offen offset:3072 nt
    v_perm_b32 v176, v114, v112, s67
    v_perm_b32 v177, v118, v116, s67
    v_perm_b32 v178, v122, v120, s67
    v_perm_b32 v179, v126, v124, s67
    v_perm_b32 v180, v114, v112, s68
    v_perm_b32 v181, v118, v116, s68
    v_perm_b32 v182, v122, v120, s68
    v_perm_b32 v183, v126, v124, s68
    buffer_load_dwordx4 a[60:63], v2, s[4:7], s59 offen offset:3200 nt
    s_add_u32 s79, s59, 12288
    s_pack_lh_b32_b16 s59, s79, s59
    v_perm_b32 v184, v115, v113, s67
    v_perm_b32 v185, v119, v117, s67
    v_perm_b32 v186, v123, v121, s67
    v_perm_b32 v187, v127, v125, s67
    v_perm_b32 v188, v115, v113, s68
    v_perm_b32 v189, v119, v117, s68
    v_perm_b32 v190, v123, v121, s68
    v_perm_b32 v191, v127, v125, s68
    buffer_load_dwordx4 a[64:67], v2, s[4:7], s59 offen offset:0 nt
    buffer_load_dwordx4 a[68:71], v2, s[4:7], s59 offen offset:128 nt
    buffer_load_dwordx4 a[72:75], v2, s[4:7], s59 offen offset:1024 nt
    buffer_load_dwordx4 a[76:79], v2, s[4:7], s59 offen offset:1152 nt
    buffer_load_dwordx4 a[80:83], v2, s[4:7], s59 offen offset:2048 nt
    buffer_load_dwordx4 a[84:87], v2, s[4:7], s59 offen offset:2176 nt
    buffer_load_dwordx4 a[88:91], v2, s[4:7], s59 offen offset:3072 nt
    buffer_load_dwordx4 a[92:95], v2, s[4:7], s59 offen offset:3200 nt
    s_add_u32 s79, s59, 4096
    s_pack_lh_b32_b16 s59, s79, s59
    s_mov_b32 s61, 0x1000
    buffer_load_dwordx4 v[232:235], v6, s[12:15], s61 offen offset:0 sc1
    s_mov_b32 s61, 0x1000
    buffer_load_dwordx4 v[236:239], v6, s[12:15], s61 offen offset:256 sc1
    s_mov_b32 s61, 0x1000
    buffer_load_dwordx4 v[224:227], v6, s[12:15], s61 offen offset:2048 sc1
    s_mov_b32 s61, 0x1000
    buffer_load_dwordx4 v[228:231], v6, s[12:15], s61 offen offset:2304 sc1
    buffer_load_dwordx4 a[96:99], v2, s[4:7], s59 offen offset:0 nt
    buffer_load_dwordx4 a[100:103], v2, s[4:7], s59 offen offset:128 nt
    buffer_load_dwordx4 a[104:107], v2, s[4:7], s59 offen offset:1024 nt
    buffer_load_dwordx4 a[108:111], v2, s[4:7], s59 offen offset:1152 nt
    buffer_load_dwordx4 a[112:115], v2, s[4:7], s59 offen offset:2048 nt
    buffer_load_dwordx4 a[116:119], v2, s[4:7], s59 offen offset:2176 nt
    buffer_load_dwordx4 a[120:123], v2, s[4:7], s59 offen offset:3072 nt
    buffer_load_dwordx4 a[124:127], v2, s[4:7], s59 offen offset:3200 nt
    s_add_u32 s79, s59, 12288
    s_pack_lh_b32_b16 s59, s79, s59
    s_movk_i32 s34, 4
    s_waitcnt vmcnt(8)
    v_mov_b32 v32, v224
    v_mov_b32 v33, v225
    v_mov_b32 v34, v226
    v_mov_b32 v35, v227
    v_mov_b32 v36, v228
    v_mov_b32 v37, v229
    v_mov_b32 v38, v230
    v_mov_b32 v39, v231
    v_mov_b32 v40, v232
    v_mov_b32 v41, v233
    v_mov_b32 v42, v234
    v_mov_b32 v43, v235
    v_mov_b32 v44, v236
    v_mov_b32 v45, v237
    v_mov_b32 v46, v238
    v_mov_b32 v47, v239
    v_xor_b32 v10, s58, v32
    v_bitop3_b32 v10, v33, s58, v10 bitop3:0xbe
    v_bitop3_b32 v10, v34, s58, v10 bitop3:0xbe
    v_bitop3_b32 v10, v35, s58, v10 bitop3:0xbe
    v_bitop3_b32 v10, v36, s58, v10 bitop3:0xbe
    v_bitop3_b32 v10, v37, s58, v10 bitop3:0xbe
    v_bitop3_b32 v10, v38, s58, v10 bitop3:0xbe
    v_bitop3_b32 v10, v39, s58, v10 bitop3:0xbe
    v_bitop3_b32 v10, v40, s58, v10 bitop3:0xbe
    v_bitop3_b32 v10, v41, s58, v10 bitop3:0xbe
    v_bitop3_b32 v10, v42, s58, v10 bitop3:0xbe
    v_bitop3_b32 v10, v43, s58, v10 bitop3:0xbe
    v_bitop3_b32 v10, v44, s58, v10 bitop3:0xbe
    v_bitop3_b32 v10, v45, s58, v10 bitop3:0xbe
    v_bitop3_b32 v10, v46, s58, v10 bitop3:0xbe
    v_bitop3_b32 v10, v47, s58, v10 bitop3:0xbe
    v_and_b32 v10, 0xff, v10
    v_cmp_ne_u32 vcc, 0, v10
    s_cbranch_vccz QJOBG
    s_mov_b32 s61, 0x1000
    buffer_load_dwordx4 v[232:235], v6, s[12:15], s61 offen offset:0 sc1
    s_mov_b32 s61, 0x1000
    buffer_load_dwordx4 v[236:239], v6, s[12:15], s61 offen offset:256 sc1
    s_mov_b32 s61, 0x1000
    buffer_load_dwordx4 v[224:227], v6, s[12:15], s61 offen offset:2048 sc1
    s_mov_b32 s61, 0x1000
    buffer_load_dwordx4 v[228:231], v6, s[12:15], s61 offen offset:2304 sc1
    buffer_load_dwordx4 a[128:131], v2, s[4:7], s59 offen offset:0 nt
    buffer_load_dwordx4 a[132:135], v2, s[4:7], s59 offen offset:128 nt
    buffer_load_dwordx4 a[136:139], v2, s[4:7], s59 offen offset:1024 nt
    buffer_load_dwordx4 a[140:143], v2, s[4:7], s59 offen offset:1152 nt
    buffer_load_dwordx4 a[144:147], v2, s[4:7], s59 offen offset:2048 nt
    buffer_load_dwordx4 a[148:151], v2, s[4:7], s59 offen offset:2176 nt
    buffer_load_dwordx4 a[152:155], v2, s[4:7], s59 offen offset:3072 nt
    buffer_load_dwordx4 a[156:159], v2, s[4:7], s59 offen offset:3200 nt
    s_add_u32 s79, s59, 4096
    s_pack_lh_b32_b16 s59, s79, s59
    s_movk_i32 s34, 5
    s_waitcnt vmcnt(8)
    v_mov_b32 v32, v224
    v_mov_b32 v33, v225
    v_mov_b32 v34, v226
    v_mov_b32 v35, v227
    v_mov_b32 v36, v228
    v_mov_b32 v37, v229
    v_mov_b32 v38, v230
    v_mov_b32 v39, v231
    v_mov_b32 v40, v232
    v_mov_b32 v41, v233
    v_mov_b32 v42, v234
    v_mov_b32 v43, v235
    v_mov_b32 v44, v236
    v_mov_b32 v45, v237
    v_mov_b32 v46, v238
    v_mov_b32 v47, v239
    v_xor_b32 v10, s58, v32
    v_bitop3_b32 v10, v33, s58, v10 bitop3:0xbe
    v_bitop3_b32 v10, v34, s58, v10 bitop3:0xbe
    v_bitop3_b32 v10, v35, s58, v10 bitop3:0xbe
    v_bitop3_b32 v10, v36, s58, v10 bitop3:0xbe
    v_bitop3_b32 v10, v37, s58, v10 bitop3:0xbe
    v_bitop3_b32 v10, v38, s58, v10 bitop3:0xbe
    v_bitop3_b32 v10, v39, s58, v10 bitop3:0xbe
    v_bitop3_b32 v10, v40, s58, v10 bitop3:0xbe
    v_bitop3_b32 v10, v41, s58, v10 bitop3:0xbe
    v_bitop3_b32 v10, v42, s58, v10 bitop3:0xbe
    v_bitop3_b32 v10, v43, s58, v10 bitop3:0xbe
    v_bitop3_b32 v10, v44, s58, v10 bitop3:0xbe
    v_bitop3_b32 v10, v45, s58, v10 bitop3:0xbe
    v_bitop3_b32 v10, v46, s58, v10 bitop3:0xbe
    v_bitop3_b32 v10, v47, s58, v10 bitop3:0xbe
    v_and_b32 v10, 0xff, v10
    v_cmp_ne_u32 vcc, 0, v10
    s_cbranch_vccz QJOBG
    s_mov_b32 s61, 0x1000
    buffer_load_dwordx4 v[232:235], v6, s[12:15], s61 offen offset:0 sc1
    s_mov_b32 s61, 0x1000
    buffer_load_dwordx4 v[236:239], v6, s[12:15], s61 offen offset:256 sc1
    s_mov_b32 s61, 0x1000
    buffer_load_dwordx4 v[224:227], v6, s[12:15], s61 offen offset:2048 sc1
    s_mov_b32 s61, 0x1000
    buffer_load_dwordx4 v[228:231], v6, s[12:15], s61 offen offset:2304 sc1
    buffer_load_dwordx4 a[160:163], v2, s[4:7], s59 offen offset:0 nt
    buffer_load_dwordx4 a[164:167], v2, s[4:7], s59 offen offset:128 nt
    buffer_load_dwordx4 a[168:171], v2, s[4:7], s59 offen offset:1024 nt
    buffer_load_dwordx4 a[172:175], v2, s[4:7], s59 offen offset:1152 nt
    buffer_load_dwordx4 a[176:179], v2, s[4:7], s59 offen offset:2048 nt
    buffer_load_dwordx4 a[180:183], v2, s[4:7], s59 offen offset:2176 nt
    buffer_load_dwordx4 a[184:187], v2, s[4:7], s59 offen offset:3072 nt
    buffer_load_dwordx4 a[188:191], v2, s[4:7], s59 offen offset:3200 nt
    s_add_u32 s79, s59, 12288
    s_pack_lh_b32_b16 s59, s79, s59
    s_movk_i32 s34, 6
    s_waitcnt vmcnt(8)
    v_mov_b32 v32, v224
    v_mov_b32 v33, v225
    v_mov_b32 v34, v226
    v_mov_b32 v35, v227
    v_mov_b32 v36, v228
    v_mov_b32 v37, v229
    v_mov_b32 v38, v230
    v_mov_b32 v39, v231
    v_mov_b32 v40, v232
    v_mov_b32 v41, v233
    v_mov_b32 v42, v234
    v_mov_b32 v43, v235
    v_mov_b32 v44, v236
    v_mov_b32 v45, v237
    v_mov_b32 v46, v238
    v_mov_b32 v47, v239
    v_xor_b32 v10, s58, v32
    v_bitop3_b32 v10, v33, s58, v10 bitop3:0xbe
    v_bitop3_b32 v10, v34, s58, v10 bitop3:0xbe
    v_bitop3_b32 v10, v35, s58, v10 bitop3:0xbe
    v_bitop3_b32 v10, v36, s58, v10 bitop3:0xbe
    v_bitop3_b32 v10, v37, s58, v10 bitop3:0xbe
    v_bitop3_b32 v10, v38, s58, v10 bitop3:0xbe
    v_bitop3_b32 v10, v39, s58, v10 bitop3:0xbe
    v_bitop3_b32 v10, v40, s58, v10 bitop3:0xbe
    v_bitop3_b32 v10, v41, s58, v10 bitop3:0xbe
    v_bitop3_b32 v10, v42, s58, v10 bitop3:0xbe
    v_bitop3_b32 v10, v43, s58, v10 bitop3:0xbe
    v_bitop3_b32 v10, v44, s58, v10 bitop3:0xbe
    v_bitop3_b32 v10, v45, s58, v10 bitop3:0xbe
    v_bitop3_b32 v10, v46, s58, v10 bitop3:0xbe
    v_bitop3_b32 v10, v47, s58, v10 bitop3:0xbe
    v_and_b32 v10, 0xff, v10
    v_cmp_ne_u32 vcc, 0, v10
    s_cbranch_vccz QJOBG
    s_mov_b32 s61, 0x1000
    buffer_load_dwordx4 v[232:235], v6, s[12:15], s61 offen offset:0 sc1
    s_mov_b32 s61, 0x1000
    buffer_load_dwordx4 v[236:239], v6, s[12:15], s61 offen offset:256 sc1
    s_mov_b32 s61, 0x1000
    buffer_load_dwordx4 v[224:227], v6, s[12:15], s61 offen offset:2048 sc1
    s_mov_b32 s61, 0x1000
    buffer_load_dwordx4 v[228:231], v6, s[12:15], s61 offen offset:2304 sc1
    buffer_load_dwordx4 a[192:195], v2, s[4:7], s59 offen offset:0 nt
    buffer_load_dwordx4 a[196:199], v2, s[4:7], s59 offen offset:128 nt
    buffer_load_dwordx4 a[200:203], v2, s[4:7], s59 offen offset:1024 nt
    buffer_load_dwordx4 a[204:207], v2, s[4:7], s59 offen offset:1152 nt
    buffer_load_dwordx4 a[208:211], v2, s[4:7], s59 offen offset:2048 nt
    buffer_load_dwordx4 a[212:215], v2, s[4:7], s59 offen offset:2176 nt
    buffer_load_dwordx4 a[216:219], v2, s[4:7], s59 offen offset:3072 nt
    buffer_load_dwordx4 a[220:223], v2, s[4:7], s59 offen offset:3200 nt
    s_add_u32 s79, s59, 4096
    s_pack_lh_b32_b16 s59, s79, s59
    s_movk_i32 s34, 7
    s_waitcnt vmcnt(8)
    v_mov_b32 v32, v224
    v_mov_b32 v33, v225
    v_mov_b32 v34, v226
    v_mov_b32 v35, v227
    v_mov_b32 v36, v228
    v_mov_b32 v37, v229
    v_mov_b32 v38, v230
    v_mov_b32 v39, v231
    v_mov_b32 v40, v232
    v_mov_b32 v41, v233
    v_mov_b32 v42, v234
    v_mov_b32 v43, v235
    v_mov_b32 v44, v236
    v_mov_b32 v45, v237
    v_mov_b32 v46, v238
    v_mov_b32 v47, v239
    v_xor_b32 v10, s58, v32
    v_bitop3_b32 v10, v33, s58, v10 bitop3:0xbe
    v_bitop3_b32 v10, v34, s58, v10 bitop3:0xbe
    v_bitop3_b32 v10, v35, s58, v10 bitop3:0xbe
    v_bitop3_b32 v10, v36, s58, v10 bitop3:0xbe
    v_bitop3_b32 v10, v37, s58, v10 bitop3:0xbe
    v_bitop3_b32 v10, v38, s58, v10 bitop3:0xbe
    v_bitop3_b32 v10, v39, s58, v10 bitop3:0xbe
    v_bitop3_b32 v10, v40, s58, v10 bitop3:0xbe
    v_bitop3_b32 v10, v41, s58, v10 bitop3:0xbe
    v_bitop3_b32 v10, v42, s58, v10 bitop3:0xbe
    v_bitop3_b32 v10, v43, s58, v10 bitop3:0xbe
    v_bitop3_b32 v10, v44, s58, v10 bitop3:0xbe
    v_bitop3_b32 v10, v45, s58, v10 bitop3:0xbe
    v_bitop3_b32 v10, v46, s58, v10 bitop3:0xbe
    v_bitop3_b32 v10, v47, s58, v10 bitop3:0xbe
    v_and_b32 v10, 0xff, v10
    v_cmp_ne_u32 vcc, 0, v10
    s_cbranch_vccz QJOBG
    s_mov_b32 s61, 0x1000
    buffer_load_dwordx4 v[232:235], v6, s[12:15], s61 offen offset:0 sc1
    s_mov_b32 s61, 0x1000
    buffer_load_dwordx4 v[236:239], v6, s[12:15], s61 offen offset:256 sc1
    s_mov_b32 s61, 0x1000
    buffer_load_dwordx4 v[224:227], v6, s[12:15], s61 offen offset:2048 sc1
    s_mov_b32 s61, 0x1000
    buffer_load_dwordx4 v[228:231], v6, s[12:15], s61 offen offset:2304 sc1
    buffer_load_dwordx4 a[224:227], v2, s[4:7], s59 offen offset:0 nt
    buffer_load_dwordx4 a[228:231], v2, s[4:7], s59 offen offset:128 nt
    buffer_load_dwordx4 a[232:235], v2, s[4:7], s59 offen offset:1024 nt
    buffer_load_dwordx4 a[236:239], v2, s[4:7], s59 offen offset:1152 nt
    buffer_load_dwordx4 a[240:243], v2, s[4:7], s59 offen offset:2048 nt
    buffer_load_dwordx4 a[244:247], v2, s[4:7], s59 offen offset:2176 nt
    buffer_load_dwordx4 a[248:251], v2, s[4:7], s59 offen offset:3072 nt
    buffer_load_dwordx4 a[252:255], v2, s[4:7], s59 offen offset:3200 nt
    s_add_u32 s79, s59, 12288
    s_pack_lh_b32_b16 s59, s79, s59
    s_movk_i32 s34, 8
    s_waitcnt vmcnt(8)
    v_mov_b32 v32, v224
    v_mov_b32 v33, v225
    v_mov_b32 v34, v226
    v_mov_b32 v35, v227
    v_mov_b32 v36, v228
    v_mov_b32 v37, v229
    v_mov_b32 v38, v230
    v_mov_b32 v39, v231
    v_mov_b32 v40, v232
    v_mov_b32 v41, v233
    v_mov_b32 v42, v234
    v_mov_b32 v43, v235
    v_mov_b32 v44, v236
    v_mov_b32 v45, v237
    v_mov_b32 v46, v238
    v_mov_b32 v47, v239
    v_xor_b32 v10, s58, v32
    v_bitop3_b32 v10, v33, s58, v10 bitop3:0xbe
    v_bitop3_b32 v10, v34, s58, v10 bitop3:0xbe
    v_bitop3_b32 v10, v35, s58, v10 bitop3:0xbe
    v_bitop3_b32 v10, v36, s58, v10 bitop3:0xbe
    v_bitop3_b32 v10, v37, s58, v10 bitop3:0xbe
    v_bitop3_b32 v10, v38, s58, v10 bitop3:0xbe
    v_bitop3_b32 v10, v39, s58, v10 bitop3:0xbe
    v_bitop3_b32 v10, v40, s58, v10 bitop3:0xbe
    v_bitop3_b32 v10, v41, s58, v10 bitop3:0xbe
    v_bitop3_b32 v10, v42, s58, v10 bitop3:0xbe
    v_bitop3_b32 v10, v43, s58, v10 bitop3:0xbe
    v_bitop3_b32 v10, v44, s58, v10 bitop3:0xbe
    v_bitop3_b32 v10, v45, s58, v10 bitop3:0xbe
    v_bitop3_b32 v10, v46, s58, v10 bitop3:0xbe
    v_bitop3_b32 v10, v47, s58, v10 bitop3:0xbe
    v_and_b32 v10, 0xff, v10
    v_cmp_ne_u32 vcc, 0, v10
    s_cbranch_vccz QJOBG
    s_mov_b32 s62, 0x40000
QPXG:
    s_mov_b32 s61, 0x1000
    buffer_load_dwordx4 v[232:235], v6, s[12:15], s61 offen offset:0 sc1
    s_mov_b32 s61, 0x1000
    buffer_load_dwordx4 v[236:239], v6, s[12:15], s61 offen offset:256 sc1
    s_mov_b32 s61, 0x1000
    buffer_load_dwordx4 v[224:227], v6, s[12:15], s61 offen offset:2048 sc1
    s_mov_b32 s61, 0x1000
    buffer_load_dwordx4 v[228:231], v6, s[12:15], s61 offen offset:2304 sc1
    s_waitcnt vmcnt(0)
    v_mov_b32 v32, v224
    v_mov_b32 v33, v225
    v_mov_b32 v34, v226
    v_mov_b32 v35, v227
    v_mov_b32 v36, v228
    v_mov_b32 v37, v229
    v_mov_b32 v38, v230
    v_mov_b32 v39, v231
    v_mov_b32 v40, v232
    v_mov_b32 v41, v233
    v_mov_b32 v42, v234
    v_mov_b32 v43, v235
    v_mov_b32 v44, v236
    v_mov_b32 v45, v237
    v_mov_b32 v46, v238
    v_mov_b32 v47, v239
    v_xor_b32 v10, s58, v32
    v_bitop3_b32 v10, v33, s58, v10 bitop3:0xbe
    v_bitop3_b32 v10, v34, s58, v10 bitop3:0xbe
    v_bitop3_b32 v10, v35, s58, v10 bitop3:0xbe
    v_bitop3_b32 v10, v36, s58, v10 bitop3:0xbe
    v_bitop3_b32 v10, v37, s58, v10 bitop3:0xbe
    v_bitop3_b32 v10, v38, s58, v10 bitop3:0xbe
    v_bitop3_b32 v10, v39, s58, v10 bitop3:0xbe
    v_bitop3_b32 v10, v40, s58, v10 bitop3:0xbe
    v_bitop3_b32 v10, v41, s58, v10 bitop3:0xbe
    v_bitop3_b32 v10, v42, s58, v10 bitop3:0xbe
    v_bitop3_b32 v10, v43, s58, v10 bitop3:0xbe
    v_bitop3_b32 v10, v44, s58, v10 bitop3:0xbe
    v_bitop3_b32 v10, v45, s58, v10 bitop3:0xbe
    v_bitop3_b32 v10, v46, s58, v10 bitop3:0xbe
    v_bitop3_b32 v10, v47, s58, v10 bitop3:0xbe
    v_and_b32 v10, 0xff, v10
    v_cmp_ne_u32 vcc, 0, v10
    s_cbranch_vccz QJOBG
    s_sub_u32 s62, s62, 1
    s_cbranch_scc0 QPXG
QJOBG:
    v_perm_b32 v208, v36, v32, s68
    v_perm_b32 v209, v37, v33, s68
    v_perm_b32 v210, v38, v34, s68
    v_perm_b32 v211, v39, v35, s68
    v_and_b32 v40, s66, v40
    v_and_b32 v41, s66, v41
    v_and_b32 v42, s66, v42
    v_and_b32 v43, s66, v43
    v_and_b32 v44, s66, v44
    v_and_b32 v45, s66, v45
    v_and_b32 v46, s66, v46
    v_and_b32 v47, s66, v47
    v_dot2_f32_bf16 v200, v208, s76, 1.0
    v_dot2_f32_bf16 v201, v209, s76, 1.0
    v_dot2_f32_bf16 v202, v210, s76, 1.0
    v_dot2_f32_bf16 v203, v211, s76, 1.0
    v_dot2_f32_bf16 v204, v208, s77, 1.0
    v_dot2_f32_bf16 v205, v209, s77, 1.0
    v_dot2_f32_bf16 v206, v210, s77, 1.0
    v_dot2_f32_bf16 v207, v211, s77, 1.0
    v_cvt_pk_bf16_f32 v208, v200, v204
    v_cvt_pk_bf16_f32 v209, v201, v205
    v_cvt_pk_bf16_f32 v210, v202, v206
    v_cvt_pk_bf16_f32 v211, v203, v207
    v_dot2_f32_bf16 v200, v208, v192, 0
    v_dot2_f32_bf16 v201, v209, v193, 0
    v_dot2_f32_bf16 v202, v210, v194, 0
    v_dot2_f32_bf16 v203, v211, v195, 0
    v_dot2_f32_bf16 v204, v208, v196, 0
    v_dot2_f32_bf16 v205, v209, v197, 0
    v_dot2_f32_bf16 v206, v210, v198, 0
    v_dot2_f32_bf16 v207, v211, v199, 0
    v_cvt_pk_bf16_f32 v208, v200, v204
    v_cvt_pk_bf16_f32 v209, v201, v205
    v_cvt_pk_bf16_f32 v210, v202, v206
    v_cvt_pk_bf16_f32 v211, v203, v207
    v_dot2_f32_bf16 v200, v208, s76, v40
    v_dot2_f32_bf16 v201, v209, s76, v41
    v_dot2_f32_bf16 v202, v210, s76, v42
    v_dot2_f32_bf16 v203, v211, s76, v43
    v_dot2_f32_bf16 v204, v208, s77, v44
    v_dot2_f32_bf16 v205, v209, s77, v45
    v_dot2_f32_bf16 v206, v210, s77, v46
    v_dot2_f32_bf16 v207, v211, s77, v47
    v_cvt_pk_bf16_f32 v240, v200, v204
    v_cvt_pk_bf16_f32 v241, v201, v205
    v_cvt_pk_bf16_f32 v242, v202, v206
    v_cvt_pk_bf16_f32 v243, v203, v207
    v_mov_b32_dpp v48, v240 quad_perm:[0,1,2,3] row_mask:0xf bank_mask:0x1
    v_mov_b32_dpp v49, v241 quad_perm:[0,1,2,3] row_mask:0xf bank_mask:0x1
    v_mov_b32_dpp v50, v242 quad_perm:[0,1,2,3] row_mask:0xf bank_mask:0x1
    v_mov_b32_dpp v51, v243 quad_perm:[0,1,2,3] row_mask:0xf bank_mask:0x1
    s_nop 1
    v_mfma_f32_16x16x32_bf16 v[64:67], v[128:131], v[48:51], 0
    v_mov_b32_dpp v52, v240 quad_perm:[0,1,2,3] row_mask:0xf bank_mask:0x2
    v_mov_b32_dpp v53, v241 quad_perm:[0,1,2,3] row_mask:0xf bank_mask:0x2
    v_mfma_f32_16x16x32_bf16 v[68:71], v[132:135], v[48:51], 0
    v_mov_b32_dpp v54, v242 quad_perm:[0,1,2,3] row_mask:0xf bank_mask:0x2
    v_mov_b32_dpp v55, v243 quad_perm:[0,1,2,3] row_mask:0xf bank_mask:0x2
    s_nop 1
    v_mfma_f32_16x16x32_bf16 v[64:67], v[144:147], v[52:55], v[64:67]
    v_mov_b32_dpp v56, v240 quad_perm:[0,1,2,3] row_mask:0xf bank_mask:0x4
    v_mov_b32_dpp v57, v241 quad_perm:[0,1,2,3] row_mask:0xf bank_mask:0x4
    v_mfma_f32_16x16x32_bf16 v[68:71], v[148:151], v[52:55], v[68:71]
    v_mov_b32_dpp v58, v242 quad_perm:[0,1,2,3] row_mask:0xf bank_mask:0x4
    v_mov_b32_dpp v59, v243 quad_perm:[0,1,2,3] row_mask:0xf bank_mask:0x4
    s_nop 1
    v_mfma_f32_16x16x32_bf16 v[64:67], v[160:163], v[56:59], v[64:67]
    v_mov_b32_dpp v60, v240 quad_perm:[0,1,2,3] row_mask:0xf bank_mask:0x8
    v_mov_b32_dpp v61, v241 quad_perm:[0,1,2,3] row_mask:0xf bank_mask:0x8
    v_mfma_f32_16x16x32_bf16 v[68:71], v[164:167], v[56:59], v[68:71]
    v_mov_b32_dpp v62, v242 quad_perm:[0,1,2,3] row_mask:0xf bank_mask:0x8
    v_mov_b32_dpp v63, v243 quad_perm:[0,1,2,3] row_mask:0xf bank_mask:0x8
    s_nop 1
    v_mfma_f32_16x16x32_bf16 v[64:67], v[176:179], v[60:63], v[64:67]
    v_mfma_f32_16x16x32_bf16 v[68:71], v[180:183], v[60:63], v[68:71]
    v_mfma_f32_16x16x32_bf16 v[72:75], v[136:139], v[48:51], 0
    v_mfma_f32_16x16x32_bf16 v[76:79], v[140:143], v[48:51], 0
    v_mfma_f32_16x16x32_bf16 v[72:75], v[152:155], v[52:55], v[72:75]
    v_mfma_f32_16x16x32_bf16 v[76:79], v[156:159], v[52:55], v[76:79]
    s_nop 2
    v_add_f32_dpp v80, v64, v64 row_shl:4 row_mask:0xf bank_mask:0x5
    v_add_f32_dpp v81, v66, v66 row_shl:4 row_mask:0xf bank_mask:0x5
    v_mfma_f32_16x16x32_bf16 v[72:75], v[168:171], v[56:59], v[72:75]
    v_add_f32_dpp v82, v68, v68 row_shl:4 row_mask:0xf bank_mask:0x5
    v_add_f32_dpp v83, v70, v70 row_shl:4 row_mask:0xf bank_mask:0x5
    v_mfma_f32_16x16x32_bf16 v[76:79], v[172:175], v[56:59], v[76:79]
    v_add_f32_dpp v80, v65, v65 row_shr:4 row_mask:0xf bank_mask:0xa
    v_add_f32_dpp v81, v67, v67 row_shr:4 row_mask:0xf bank_mask:0xa
    v_mfma_f32_16x16x32_bf16 v[72:75], v[184:187], v[60:63], v[72:75]
    v_add_f32_dpp v82, v69, v69 row_shr:4 row_mask:0xf bank_mask:0xa
    v_add_f32_dpp v83, v71, v71 row_shr:4 row_mask:0xf bank_mask:0xa
    v_mfma_f32_16x16x32_bf16 v[76:79], v[188:191], v[60:63], v[76:79]
    s_nop 4
    v_add_f32_dpp v84, v72, v72 row_shl:4 row_mask:0xf bank_mask:0x5
    v_add_f32_dpp v85, v74, v74 row_shl:4 row_mask:0xf bank_mask:0x5
    s_nop 0
    v_add_f32_dpp v86, v76, v76 row_shl:4 row_mask:0xf bank_mask:0x5
    v_add_f32_dpp v87, v78, v78 row_shl:4 row_mask:0xf bank_mask:0x5
    v_add_f32_dpp v84, v73, v73 row_shr:4 row_mask:0xf bank_mask:0xa
    v_add_f32_dpp v85, v75, v75 row_shr:4 row_mask:0xf bank_mask:0xa
    v_add_f32_dpp v86, v77, v77 row_shr:4 row_mask:0xf bank_mask:0xa
    v_add_f32_dpp v87, v79, v79 row_shr:4 row_mask:0xf bank_mask:0xa
    v_add_f32_dpp v88, v80, v80 row_shl:8 row_mask:0xf bank_mask:0x3
    v_add_f32_dpp v89, v82, v82 row_shl:8 row_mask:0xf bank_mask:0x3
    v_add_f32_dpp v90, v84, v84 row_shl:8 row_mask:0xf bank_mask:0x3
    v_add_f32_dpp v91, v86, v86 row_shl:8 row_mask:0xf bank_mask:0x3
    v_add_f32_dpp v88, v81, v81 row_shr:8 row_mask:0xf bank_mask:0xc
    v_add_f32_dpp v89, v83, v83 row_shr:8 row_mask:0xf bank_mask:0xc
    v_add_f32_dpp v90, v85, v85 row_shr:8 row_mask:0xf bank_mask:0xc
    v_add_f32_dpp v91, v87, v87 row_shr:8 row_mask:0xf bank_mask:0xc
    ds_write_b128 v8, v[88:91] offset:0
    s_waitcnt lgkmcnt(0)
    s_barrier
    s_cmp_lg_u32 s3, 0
    s_cbranch_scc1 HS_G
    ds_read_b128 v[192:195], v14 offset:0
    ds_read_b128 v[196:199], v14 offset:1024
    ds_read_b128 v[200:203], v14 offset:2048
    ds_read_b128 v[204:207], v14 offset:3072
    s_waitcnt lgkmcnt(2)
    v_pk_add_f32 v[192:193], v[192:193], v[196:197]
    v_pk_add_f32 v[194:195], v[194:195], v[198:199]
    s_waitcnt lgkmcnt(0)
    v_pk_add_f32 v[200:201], v[200:201], v[204:205]
    v_pk_add_f32 v[202:203], v[202:203], v[206:207]
    v_pk_add_f32 v[192:193], v[192:193], v[200:201]
    v_pk_add_f32 v[194:195], v[194:195], v[202:203]
    v_cvt_pk_bf16_f32 v196, v192, v193
    v_cvt_pk_bf16_f32 v197, v194, v195
    v_perm_b32 v192, v196, v4, s67
    v_bfi_b32 v193, s66, v196, v4
    v_perm_b32 v194, v197, v4, s67
    v_bfi_b32 v195, s66, v197, v4
    s_mov_b32 s61, 0x10000
    buffer_store_dwordx4 v[192:195], v15, s[12:15], s61 offen offset:0 sc1
HS_G:
    s_cmp_eq_u32 s34, 8
    s_cbranch_scc1 QT8G
    s_cmp_eq_u32 s34, 7
    s_cbranch_scc1 QT7G
    s_cmp_eq_u32 s34, 6
    s_cbranch_scc1 QT6G
    s_cmp_eq_u32 s34, 5
    s_cbranch_scc1 QT5G
QT4G:
    buffer_load_dwordx4 a[128:131], v2, s[4:7], s59 offen offset:0 nt
    buffer_load_dwordx4 a[132:135], v2, s[4:7], s59 offen offset:128 nt
    buffer_load_dwordx4 a[136:139], v2, s[4:7], s59 offen offset:1024 nt
    buffer_load_dwordx4 a[140:143], v2, s[4:7], s59 offen offset:1152 nt
    buffer_load_dwordx4 a[144:147], v2, s[4:7], s59 offen offset:2048 nt
    buffer_load_dwordx4 a[148:151], v2, s[4:7], s59 offen offset:2176 nt
    buffer_load_dwordx4 a[152:155], v2, s[4:7], s59 offen offset:3072 nt
    buffer_load_dwordx4 a[156:159], v2, s[4:7], s59 offen offset:3200 nt
    s_add_u32 s79, s59, 4096
    s_pack_lh_b32_b16 s59, s79, s59
QT5G:
    buffer_load_dwordx4 a[160:163], v2, s[4:7], s59 offen offset:0 nt
    buffer_load_dwordx4 a[164:167], v2, s[4:7], s59 offen offset:128 nt
    buffer_load_dwordx4 a[168:171], v2, s[4:7], s59 offen offset:1024 nt
    buffer_load_dwordx4 a[172:175], v2, s[4:7], s59 offen offset:1152 nt
    buffer_load_dwordx4 a[176:179], v2, s[4:7], s59 offen offset:2048 nt
    buffer_load_dwordx4 a[180:183], v2, s[4:7], s59 offen offset:2176 nt
    buffer_load_dwordx4 a[184:187], v2, s[4:7], s59 offen offset:3072 nt
    buffer_load_dwordx4 a[188:191], v2, s[4:7], s59 offen offset:3200 nt
    s_add_u32 s79, s59, 12288
    s_pack_lh_b32_b16 s59, s79, s59
QT6G:
    buffer_load_dwordx4 a[192:195], v2, s[4:7], s59 offen offset:0 nt
    buffer_load_dwordx4 a[196:199], v2, s[4:7], s59 offen offset:128 nt
    buffer_load_dwordx4 a[200:203], v2, s[4:7], s59 offen offset:1024 nt
    buffer_load_dwordx4 a[204:207], v2, s[4:7], s59 offen offset:1152 nt
    buffer_load_dwordx4 a[208:211], v2, s[4:7], s59 offen offset:2048 nt
    buffer_load_dwordx4 a[212:215], v2, s[4:7], s59 offen offset:2176 nt
    buffer_load_dwordx4 a[216:219], v2, s[4:7], s59 offen offset:3072 nt
    buffer_load_dwordx4 a[220:223], v2, s[4:7], s59 offen offset:3200 nt
    s_add_u32 s79, s59, 4096
    s_pack_lh_b32_b16 s59, s79, s59
QT7G:
    buffer_load_dwordx4 a[224:227], v2, s[4:7], s59 offen offset:0 nt
    buffer_load_dwordx4 a[228:231], v2, s[4:7], s59 offen offset:128 nt
    buffer_load_dwordx4 a[232:235], v2, s[4:7], s59 offen offset:1024 nt
    buffer_load_dwordx4 a[236:239], v2, s[4:7], s59 offen offset:1152 nt
    buffer_load_dwordx4 a[240:243], v2, s[4:7], s59 offen offset:2048 nt
    buffer_load_dwordx4 a[244:247], v2, s[4:7], s59 offen offset:2176 nt
    buffer_load_dwordx4 a[248:251], v2, s[4:7], s59 offen offset:3072 nt
    buffer_load_dwordx4 a[252:255], v2, s[4:7], s59 offen offset:3200 nt
    s_add_u32 s79, s59, 12288
    s_pack_lh_b32_b16 s59, s79, s59
QT8G:
    v_and_b32 v10, 3, v1
    v_lshlrev_b32 v10, 9, v10
    v_lshrrev_b32 v11, 4, v1
    v_lshl_add_u32 v10, v11, 5, v10
    v_bfe_u32 v11, v1, 2, 1
    v_lshl_add_u32 v10, v11, 7, v10
    s_lshr_b32 s61, s2, 3
    s_lshl_b32 s61, s61, 11
    v_add_u32 v6, s61, v10
    s_mov_b32 s61, 0x10000
    buffer_load_dwordx4 v[224:227], v6, s[12:15], s61 offen offset:0 sc1
    s_mov_b32 s61, 0x10000
    buffer_load_dwordx4 v[228:231], v6, s[12:15], s61 offen offset:16 sc1
    s_mov_b32 s61, 0x10000
    buffer_load_dwordx4 v[232:235], v6, s[12:15], s61 offen offset:256 sc1
    s_mov_b32 s61, 0x10000
    buffer_load_dwordx4 v[236:239], v6, s[12:15], s61 offen offset:272 sc1
    buffer_load_dwordx4 v[64:67], v3, s[8:11], s60 offen offset:0 nt
    buffer_load_dwordx4 v[68:71], v3, s[8:11], s60 offen offset:1024 nt
    buffer_load_dwordx4 v[72:75], v3, s[8:11], s60 offen offset:2048 nt
    buffer_load_dwordx4 v[76:79], v3, s[8:11], s60 offen offset:3072 nt
    s_add_u32 s79, s60, 4096
    s_pack_lh_b32_b16 s60, s79, s60
    buffer_load_dwordx4 v[80:83], v3, s[8:11], s60 offen offset:0 nt
    buffer_load_dwordx4 v[84:87], v3, s[8:11], s60 offen offset:1024 nt
    buffer_load_dwordx4 v[88:91], v3, s[8:11], s60 offen offset:2048 nt
    buffer_load_dwordx4 v[92:95], v3, s[8:11], s60 offen offset:3072 nt
    s_add_u32 s79, s60, 4096
    s_pack_lh_b32_b16 s60, s79, s60
    s_mov_b32 s61, 0x10000
    buffer_load_dwordx4 v[224:227], v6, s[12:15], s61 offen offset:0 sc1
    s_mov_b32 s61, 0x10000
    buffer_load_dwordx4 v[228:231], v6, s[12:15], s61 offen offset:16 sc1
    s_mov_b32 s61, 0x10000
    buffer_load_dwordx4 v[232:235], v6, s[12:15], s61 offen offset:256 sc1
    s_mov_b32 s61, 0x10000
    buffer_load_dwordx4 v[236:239], v6, s[12:15], s61 offen offset:272 sc1
    buffer_load_dwordx4 v[96:99], v3, s[8:11], s60 offen offset:0 nt
    buffer_load_dwordx4 v[100:103], v3, s[8:11], s60 offen offset:1024 nt
    buffer_load_dwordx4 v[104:107], v3, s[8:11], s60 offen offset:2048 nt
    buffer_load_dwordx4 v[108:111], v3, s[8:11], s60 offen offset:3072 nt
    s_add_u32 s79, s60, 4096
    s_pack_lh_b32_b16 s60, s79, s60
    buffer_load_dwordx4 v[112:115], v3, s[8:11], s60 offen offset:0 nt
    buffer_load_dwordx4 v[116:119], v3, s[8:11], s60 offen offset:1024 nt
    buffer_load_dwordx4 v[120:123], v3, s[8:11], s60 offen offset:2048 nt
    buffer_load_dwordx4 v[124:127], v3, s[8:11], s60 offen offset:3072 nt
    s_add_u32 s79, s60, 4096
    s_pack_lh_b32_b16 s60, s79, s60
    s_mov_b32 s61, 0x10000
    buffer_load_dwordx4 v[224:227], v6, s[12:15], s61 offen offset:0 sc1
    s_mov_b32 s61, 0x10000
    buffer_load_dwordx4 v[228:231], v6, s[12:15], s61 offen offset:16 sc1
    s_mov_b32 s61, 0x10000
    buffer_load_dwordx4 v[232:235], v6, s[12:15], s61 offen offset:256 sc1
    s_mov_b32 s61, 0x10000
    buffer_load_dwordx4 v[236:239], v6, s[12:15], s61 offen offset:272 sc1
    buffer_load_dwordx4 v[128:131], v3, s[8:11], s60 offen offset:0 nt
    buffer_load_dwordx4 v[132:135], v3, s[8:11], s60 offen offset:1024 nt
    buffer_load_dwordx4 v[136:139], v3, s[8:11], s60 offen offset:2048 nt
    buffer_load_dwordx4 v[140:143], v3, s[8:11], s60 offen offset:3072 nt
    s_add_u32 s79, s60, 4096
    s_pack_lh_b32_b16 s60, s79, s60
    buffer_load_dwordx4 v[144:147], v3, s[8:11], s60 offen offset:0 nt
    buffer_load_dwordx4 v[148:151], v3, s[8:11], s60 offen offset:1024 nt
    buffer_load_dwordx4 v[152:155], v3, s[8:11], s60 offen offset:2048 nt
    buffer_load_dwordx4 v[156:159], v3, s[8:11], s60 offen offset:3072 nt
    s_add_u32 s79, s60, 4096
    s_pack_lh_b32_b16 s60, s79, s60
    s_waitcnt vmcnt(32)
    v_mov_b32 v48, v224
    v_mov_b32 v49, v225
    v_mov_b32 v50, v226
    v_mov_b32 v51, v227
    v_mov_b32 v52, v228
    v_mov_b32 v53, v229
    v_mov_b32 v54, v230
    v_mov_b32 v55, v231
    v_mov_b32 v56, v232
    v_mov_b32 v57, v233
    v_mov_b32 v58, v234
    v_mov_b32 v59, v235
    v_mov_b32 v60, v236
    v_mov_b32 v61, v237
    v_mov_b32 v62, v238
    v_mov_b32 v63, v239
    v_xor_b32 v10, s58, v48
    v_bitop3_b32 v10, v49, s58, v10 bitop3:0xbe
    v_bitop3_b32 v10, v50, s58, v10 bitop3:0xbe
    v_bitop3_b32 v10, v51, s58, v10 bitop3:0xbe
    v_bitop3_b32 v10, v52, s58, v10 bitop3:0xbe
    v_bitop3_b32 v10, v53, s58, v10 bitop3:0xbe
    v_bitop3_b32 v10, v54, s58, v10 bitop3:0xbe
    v_bitop3_b32 v10, v55, s58, v10 bitop3:0xbe
    v_bitop3_b32 v10, v56, s58, v10 bitop3:0xbe
    v_bitop3_b32 v10, v57, s58, v10 bitop3:0xbe
    v_bitop3_b32 v10, v58, s58, v10 bitop3:0xbe
    v_bitop3_b32 v10, v59, s58, v10 bitop3:0xbe
    v_bitop3_b32 v10, v60, s58, v10 bitop3:0xbe
    v_bitop3_b32 v10, v61, s58, v10 bitop3:0xbe
    v_bitop3_b32 v10, v62, s58, v10 bitop3:0xbe
    v_bitop3_b32 v10, v63, s58, v10 bitop3:0xbe
    v_and_b32 v10, 0xff, v10
    v_cmp_ne_u32 vcc, 0, v10
    s_cbranch_vccz QGO_G
    s_waitcnt vmcnt(20)
    v_mov_b32 v48, v224
    v_mov_b32 v49, v225
    v_mov_b32 v50, v226
    v_mov_b32 v51, v227
    v_mov_b32 v52, v228
    v_mov_b32 v53, v229
    v_mov_b32 v54, v230
    v_mov_b32 v55, v231
    v_mov_b32 v56, v232
    v_mov_b32 v57, v233
    v_mov_b32 v58, v234
    v_mov_b32 v59, v235
    v_mov_b32 v60, v236
    v_mov_b32 v61, v237
    v_mov_b32 v62, v238
    v_mov_b32 v63, v239
    v_xor_b32 v10, s58, v48
    v_bitop3_b32 v10, v49, s58, v10 bitop3:0xbe
    v_bitop3_b32 v10, v50, s58, v10 bitop3:0xbe
    v_bitop3_b32 v10, v51, s58, v10 bitop3:0xbe
    v_bitop3_b32 v10, v52, s58, v10 bitop3:0xbe
    v_bitop3_b32 v10, v53, s58, v10 bitop3:0xbe
    v_bitop3_b32 v10, v54, s58, v10 bitop3:0xbe
    v_bitop3_b32 v10, v55, s58, v10 bitop3:0xbe
    v_bitop3_b32 v10, v56, s58, v10 bitop3:0xbe
    v_bitop3_b32 v10, v57, s58, v10 bitop3:0xbe
    v_bitop3_b32 v10, v58, s58, v10 bitop3:0xbe
    v_bitop3_b32 v10, v59, s58, v10 bitop3:0xbe
    v_bitop3_b32 v10, v60, s58, v10 bitop3:0xbe
    v_bitop3_b32 v10, v61, s58, v10 bitop3:0xbe
    v_bitop3_b32 v10, v62, s58, v10 bitop3:0xbe
    v_bitop3_b32 v10, v63, s58, v10 bitop3:0xbe
    v_and_b32 v10, 0xff, v10
    v_cmp_ne_u32 vcc, 0, v10
    s_cbranch_vccz QGO_G
    s_waitcnt vmcnt(8)
    v_mov_b32 v48, v224
    v_mov_b32 v49, v225
    v_mov_b32 v50, v226
    v_mov_b32 v51, v227
    v_mov_b32 v52, v228
    v_mov_b32 v53, v229
    v_mov_b32 v54, v230
    v_mov_b32 v55, v231
    v_mov_b32 v56, v232
    v_mov_b32 v57, v233
    v_mov_b32 v58, v234
    v_mov_b32 v59, v235
    v_mov_b32 v60, v236
    v_mov_b32 v61, v237
    v_mov_b32 v62, v238
    v_mov_b32 v63, v239
    v_xor_b32 v10, s58, v48
    v_bitop3_b32 v10, v49, s58, v10 bitop3:0xbe
    v_bitop3_b32 v10, v50, s58, v10 bitop3:0xbe
    v_bitop3_b32 v10, v51, s58, v10 bitop3:0xbe
    v_bitop3_b32 v10, v52, s58, v10 bitop3:0xbe
    v_bitop3_b32 v10, v53, s58, v10 bitop3:0xbe
    v_bitop3_b32 v10, v54, s58, v10 bitop3:0xbe
    v_bitop3_b32 v10, v55, s58, v10 bitop3:0xbe
    v_bitop3_b32 v10, v56, s58, v10 bitop3:0xbe
    v_bitop3_b32 v10, v57, s58, v10 bitop3:0xbe
    v_bitop3_b32 v10, v58, s58, v10 bitop3:0xbe
    v_bitop3_b32 v10, v59, s58, v10 bitop3:0xbe
    v_bitop3_b32 v10, v60, s58, v10 bitop3:0xbe
    v_bitop3_b32 v10, v61, s58, v10 bitop3:0xbe
    v_bitop3_b32 v10, v62, s58, v10 bitop3:0xbe
    v_bitop3_b32 v10, v63, s58, v10 bitop3:0xbe
    v_and_b32 v10, 0xff, v10
    v_cmp_ne_u32 vcc, 0, v10
    s_cbranch_vccz QGO_G
    s_mov_b32 s62, 0x40000
QRX_G:
    s_mov_b32 s61, 0x10000
    buffer_load_dwordx4 v[224:227], v6, s[12:15], s61 offen offset:0 sc1
    s_mov_b32 s61, 0x10000
    buffer_load_dwordx4 v[228:231], v6, s[12:15], s61 offen offset:16 sc1
    s_mov_b32 s61, 0x10000
    buffer_load_dwordx4 v[232:235], v6, s[12:15], s61 offen offset:256 sc1
    s_mov_b32 s61, 0x10000
    buffer_load_dwordx4 v[236:239], v6, s[12:15], s61 offen offset:272 sc1
    s_waitcnt vmcnt(0)
    v_mov_b32 v48, v224
    v_mov_b32 v49, v225
    v_mov_b32 v50, v226
    v_mov_b32 v51, v227
    v_mov_b32 v52, v228
    v_mov_b32 v53, v229
    v_mov_b32 v54, v230
    v_mov_b32 v55, v231
    v_mov_b32 v56, v232
    v_mov_b32 v57, v233
    v_mov_b32 v58, v234
    v_mov_b32 v59, v235
    v_mov_b32 v60, v236
    v_mov_b32 v61, v237
    v_mov_b32 v62, v238
    v_mov_b32 v63, v239
    v_xor_b32 v10, s58, v48
    v_bitop3_b32 v10, v49, s58, v10 bitop3:0xbe
    v_bitop3_b32 v10, v50, s58, v10 bitop3:0xbe
    v_bitop3_b32 v10, v51, s58, v10 bitop3:0xbe
    v_bitop3_b32 v10, v52, s58, v10 bitop3:0xbe
    v_bitop3_b32 v10, v53, s58, v10 bitop3:0xbe
    v_bitop3_b32 v10, v54, s58, v10 bitop3:0xbe
    v_bitop3_b32 v10, v55, s58, v10 bitop3:0xbe
    v_bitop3_b32 v10, v56, s58, v10 bitop3:0xbe
    v_bitop3_b32 v10, v57, s58, v10 bitop3:0xbe
    v_bitop3_b32 v10, v58, s58, v10 bitop3:0xbe
    v_bitop3_b32 v10, v59, s58, v10 bitop3:0xbe
    v_bitop3_b32 v10, v60, s58, v10 bitop3:0xbe
    v_bitop3_b32 v10, v61, s58, v10 bitop3:0xbe
    v_bitop3_b32 v10, v62, s58, v10 bitop3:0xbe
    v_bitop3_b32 v10, v63, s58, v10 bitop3:0xbe
    v_and_b32 v10, 0xff, v10
    v_cmp_ne_u32 vcc, 0, v10
    s_cbranch_vccz QGO_G
    s_sub_u32 s62, s62, 1
    s_cbranch_scc0 QRX_G
QGO_G:
    buffer_load_dwordx4 v[224:227], v3, s[8:11], s60 offen offset:0 nt
    v_perm_b32 v16, v49, v48, s68
    v_perm_b32 v17, v51, v50, s68
    v_perm_b32 v18, v53, v52, s68
    v_perm_b32 v19, v55, v54, s68
    v_perm_b32 v20, v57, v56, s68
    v_perm_b32 v21, v59, v58, s68
    v_perm_b32 v22, v61, v60, s68
    buffer_load_dwordx4 v[228:231], v3, s[8:11], s60 offen offset:1024 nt
    v_perm_b32 v23, v63, v62, s68
    v_cndmask_b32 v32, 0, v16, s[72:73]
    v_cndmask_b32 v33, 0, v17, s[72:73]
    v_cndmask_b32 v34, 0, v18, s[72:73]
    v_cndmask_b32 v35, 0, v19, s[72:73]
    v_cndmask_b32 v36, 0, v20, s[72:73]
    v_cndmask_b32 v37, 0, v21, s[72:73]
    v_cndmask_b32 v38, 0, v22, s[72:73]
    buffer_load_dwordx4 v[232:235], v3, s[8:11], s60 offen offset:2048 nt
    v_cndmask_b32 v39, 0, v23, s[72:73]
    v_cndmask_b32 v40, 0, v16, s[74:75]
    v_cndmask_b32 v41, 0, v17, s[74:75]
    v_cndmask_b32 v42, 0, v18, s[74:75]
    v_cndmask_b32 v43, 0, v19, s[74:75]
    v_cndmask_b32 v44, 0, v20, s[74:75]
    v_cndmask_b32 v45, 0, v21, s[74:75]
    buffer_load_dwordx4 v[236:239], v3, s[8:11], s60 offen offset:3072 nt
    v_cndmask_b32 v46, 0, v22, s[74:75]
    v_cndmask_b32 v47, 0, v23, s[74:75]
    v_mfma_f32_16x16x32_bf16 v[160:163], a[0:3], v[32:35], 0
    v_mfma_f32_16x16x32_bf16 v[164:167], a[8:11], v[32:35], 0
    v_mfma_f32_16x16x32_bf16 v[168:171], a[16:19], v[32:35], 0
    v_mfma_f32_16x16x32_bf16 v[172:175], a[24:27], v[32:35], 0
    v_mfma_f32_16x16x32_bf16 v[176:179], a[32:35], v[32:35], 0
    v_mfma_f32_16x16x32_bf16 v[180:183], a[40:43], v[32:35], 0
    s_add_u32 s79, s60, 4096
    s_pack_lh_b32_b16 s60, s79, s60
    buffer_load_dwordx4 v[240:243], v3, s[8:11], s60 offen offset:0 nt
    v_mfma_f32_16x16x32_bf16 v[184:187], a[48:51], v[32:35], 0
    v_mfma_f32_16x16x32_bf16 v[188:191], a[56:59], v[32:35], 0
    v_mfma_f32_16x16x32_bf16 v[160:163], a[4:7], v[36:39], v[160:163]
    v_mfma_f32_16x16x32_bf16 v[164:167], a[12:15], v[36:39], v[164:167]
    v_mfma_f32_16x16x32_bf16 v[168:171], a[20:23], v[36:39], v[168:171]
    v_mfma_f32_16x16x32_bf16 v[172:175], a[28:31], v[36:39], v[172:175]
    v_mfma_f32_16x16x32_bf16 v[176:179], a[36:39], v[36:39], v[176:179]
    buffer_load_dwordx4 v[244:247], v3, s[8:11], s60 offen offset:1024 nt
    v_mfma_f32_16x16x32_bf16 v[180:183], a[44:47], v[36:39], v[180:183]
    v_mfma_f32_16x16x32_bf16 v[184:187], a[52:55], v[36:39], v[184:187]
    v_mfma_f32_16x16x32_bf16 v[188:191], a[60:63], v[36:39], v[188:191]
    v_mfma_f32_16x16x32_bf16 v[160:163], a[64:67], v[40:43], v[160:163]
    v_mfma_f32_16x16x32_bf16 v[164:167], a[72:75], v[40:43], v[164:167]
    v_mfma_f32_16x16x32_bf16 v[168:171], a[80:83], v[40:43], v[168:171]
    v_mfma_f32_16x16x32_bf16 v[172:175], a[88:91], v[40:43], v[172:175]
    v_mfma_f32_16x16x32_bf16 v[176:179], a[96:99], v[40:43], v[176:179]
    buffer_load_dwordx4 v[248:251], v3, s[8:11], s60 offen offset:2048 nt
    v_mfma_f32_16x16x32_bf16 v[180:183], a[104:107], v[40:43], v[180:183]
    v_mfma_f32_16x16x32_bf16 v[184:187], a[112:115], v[40:43], v[184:187]
    v_mfma_f32_16x16x32_bf16 v[188:191], a[120:123], v[40:43], v[188:191]
    v_mfma_f32_16x16x32_bf16 v[160:163], a[68:71], v[44:47], v[160:163]
    v_mfma_f32_16x16x32_bf16 v[164:167], a[76:79], v[44:47], v[164:167]
    v_mfma_f32_16x16x32_bf16 v[168:171], a[84:87], v[44:47], v[168:171]
    v_mfma_f32_16x16x32_bf16 v[172:175], a[92:95], v[44:47], v[172:175]
    buffer_load_dwordx4 v[252:255], v3, s[8:11], s60 offen offset:3072 nt
    s_add_u32 s79, s60, 4096
    s_pack_lh_b32_b16 s60, s79, s60
    v_mfma_f32_16x16x32_bf16 v[176:179], a[100:103], v[44:47], v[176:179]
    v_mfma_f32_16x16x32_bf16 v[180:183], a[108:111], v[44:47], v[180:183]
    v_mfma_f32_16x16x32_bf16 v[184:187], a[116:119], v[44:47], v[184:187]
    v_mfma_f32_16x16x32_bf16 v[188:191], a[124:127], v[44:47], v[188:191]
    v_mfma_f32_16x16x32_bf16 v[192:195], a[128:131], v[32:35], 0
    v_mfma_f32_16x16x32_bf16 v[196:199], a[136:139], v[32:35], 0
    v_mfma_f32_16x16x32_bf16 v[200:203], a[144:147], v[32:35], 0
    v_mfma_f32_16x16x32_bf16 v[204:207], a[152:155], v[32:35], 0
    v_mfma_f32_16x16x32_bf16 v[208:211], a[160:163], v[32:35], 0
    v_mfma_f32_16x16x32_bf16 v[212:215], a[168:171], v[32:35], 0
    v_mfma_f32_16x16x32_bf16 v[216:219], a[176:179], v[32:35], 0
    v_mfma_f32_16x16x32_bf16 v[220:223], a[184:187], v[32:35], 0
    v_mfma_f32_16x16x32_bf16 v[192:195], a[132:135], v[36:39], v[192:195]
    v_mfma_f32_16x16x32_bf16 v[196:199], a[140:143], v[36:39], v[196:199]
    v_mfma_f32_16x16x32_bf16 v[200:203], a[148:151], v[36:39], v[200:203]
    v_mfma_f32_16x16x32_bf16 v[204:207], a[156:159], v[36:39], v[204:207]
    v_mfma_f32_16x16x32_bf16 v[208:211], a[164:167], v[36:39], v[208:211]
    v_mfma_f32_16x16x32_bf16 v[212:215], a[172:175], v[36:39], v[212:215]
    v_mfma_f32_16x16x32_bf16 v[216:219], a[180:183], v[36:39], v[216:219]
    v_mfma_f32_16x16x32_bf16 v[220:223], a[188:191], v[36:39], v[220:223]
    v_mfma_f32_16x16x32_bf16 v[192:195], a[192:195], v[40:43], v[192:195]
    v_mfma_f32_16x16x32_bf16 v[196:199], a[200:203], v[40:43], v[196:199]
    v_mfma_f32_16x16x32_bf16 v[200:203], a[208:211], v[40:43], v[200:203]
    v_mfma_f32_16x16x32_bf16 v[204:207], a[216:219], v[40:43], v[204:207]
    v_mfma_f32_16x16x32_bf16 v[208:211], a[224:227], v[40:43], v[208:211]
    v_mfma_f32_16x16x32_bf16 v[212:215], a[232:235], v[40:43], v[212:215]
    v_mfma_f32_16x16x32_bf16 v[216:219], a[240:243], v[40:43], v[216:219]
    v_mfma_f32_16x16x32_bf16 v[220:223], a[248:251], v[40:43], v[220:223]
    v_mfma_f32_16x16x32_bf16 v[192:195], a[196:199], v[44:47], v[192:195]
    v_mfma_f32_16x16x32_bf16 v[196:199], a[204:207], v[44:47], v[196:199]
    v_mfma_f32_16x16x32_bf16 v[200:203], a[212:215], v[44:47], v[200:203]
    v_mfma_f32_16x16x32_bf16 v[204:207], a[220:223], v[44:47], v[204:207]
    v_mfma_f32_16x16x32_bf16 v[208:211], a[228:231], v[44:47], v[208:211]
    v_mfma_f32_16x16x32_bf16 v[212:215], a[236:239], v[44:47], v[212:215]
    v_mfma_f32_16x16x32_bf16 v[216:219], a[244:247], v[44:47], v[216:219]
    v_mfma_f32_16x16x32_bf16 v[220:223], a[252:255], v[44:47], v[220:223]
    v_add_f32_dpp v48, v161, v160 row_shl:4 row_mask:0xf bank_mask:0x5
    v_add_f32_dpp v49, v165, v164 row_shl:4 row_mask:0xf bank_mask:0x5
    v_add_f32_dpp v50, v169, v168 row_shl:4 row_mask:0xf bank_mask:0x5
    v_add_f32_dpp v51, v173, v172 row_shl:4 row_mask:0xf bank_mask:0x5
    v_add_f32_dpp v52, v177, v176 row_shl:4 row_mask:0xf bank_mask:0x5
    v_add_f32_dpp v53, v181, v180 row_shl:4 row_mask:0xf bank_mask:0x5
    v_add_f32_dpp v54, v185, v184 row_shl:4 row_mask:0xf bank_mask:0x5
    v_add_f32_dpp v55, v189, v188 row_shl:4 row_mask:0xf bank_mask:0x5
    v_add_f32_dpp v56, v193, v192 row_shl:4 row_mask:0xf bank_mask:0x5
    v_add_f32_dpp v57, v197, v196 row_shl:4 row_mask:0xf bank_mask:0x5
    v_add_f32_dpp v58, v201, v200 row_shl:4 row_mask:0xf bank_mask:0x5
    v_add_f32_dpp v59, v205, v204 row_shl:4 row_mask:0xf bank_mask:0x5
    v_add_f32_dpp v60, v209, v208 row_shl:4 row_mask:0xf bank_mask:0x5
    v_add_f32_dpp v61, v213, v212 row_shl:4 row_mask:0xf bank_mask:0x5
    v_add_f32_dpp v62, v217, v216 row_shl:4 row_mask:0xf bank_mask:0x5
    v_add_f32_dpp v63, v221, v220 row_shl:4 row_mask:0xf bank_mask:0x5
    v_add_f32_dpp v48, v162, v163 row_shr:4 row_mask:0xf bank_mask:0xa
    v_add_f32_dpp v49, v166, v167 row_shr:4 row_mask:0xf bank_mask:0xa
    v_add_f32_dpp v50, v170, v171 row_shr:4 row_mask:0xf bank_mask:0xa
    v_add_f32_dpp v51, v174, v175 row_shr:4 row_mask:0xf bank_mask:0xa
    v_add_f32_dpp v52, v178, v179 row_shr:4 row_mask:0xf bank_mask:0xa
    v_add_f32_dpp v53, v182, v183 row_shr:4 row_mask:0xf bank_mask:0xa
    v_add_f32_dpp v54, v186, v187 row_shr:4 row_mask:0xf bank_mask:0xa
    v_add_f32_dpp v55, v190, v191 row_shr:4 row_mask:0xf bank_mask:0xa
    v_add_f32_dpp v56, v194, v195 row_shr:4 row_mask:0xf bank_mask:0xa
    v_add_f32_dpp v57, v198, v199 row_shr:4 row_mask:0xf bank_mask:0xa
    v_add_f32_dpp v58, v202, v203 row_shr:4 row_mask:0xf bank_mask:0xa
    v_add_f32_dpp v59, v206, v207 row_shr:4 row_mask:0xf bank_mask:0xa
    v_add_f32_dpp v60, v210, v211 row_shr:4 row_mask:0xf bank_mask:0xa
    v_add_f32_dpp v61, v214, v215 row_shr:4 row_mask:0xf bank_mask:0xa
    v_add_f32_dpp v62, v218, v219 row_shr:4 row_mask:0xf bank_mask:0xa
    v_add_f32_dpp v63, v222, v223 row_shr:4 row_mask:0xf bank_mask:0xa
    buffer_load_dwordx4 v[160:163], v3, s[8:11], s60 offen offset:0 nt
    v_cvt_pk_bf16_f32 v32, v48, v49
    v_cvt_pk_bf16_f32 v33, v50, v51
    v_cvt_pk_bf16_f32 v34, v52, v53
    v_cvt_pk_bf16_f32 v35, v54, v55
    v_cvt_pk_bf16_f32 v36, v56, v57
    v_cvt_pk_bf16_f32 v37, v58, v59
    v_cvt_pk_bf16_f32 v38, v60, v61
    v_cvt_pk_bf16_f32 v39, v62, v63
    v_lshlrev_b32 v48, 16, v32
    buffer_load_dwordx4 v[164:167], v3, s[8:11], s60 offen offset:1024 nt
    v_and_b32 v49, s66, v32
    v_lshlrev_b32 v50, 16, v33
    v_and_b32 v51, s66, v33
    v_lshlrev_b32 v52, 16, v34
    v_and_b32 v53, s66, v34
    v_lshlrev_b32 v54, 16, v35
    v_and_b32 v55, s66, v35
    v_lshlrev_b32 v56, 16, v36
    v_and_b32 v57, s66, v36
    v_lshlrev_b32 v58, 16, v37
    buffer_load_dwordx4 v[168:171], v3, s[8:11], s60 offen offset:2048 nt
    v_and_b32 v59, s66, v37
    v_lshlrev_b32 v60, 16, v38
    v_and_b32 v61, s66, v38
    v_lshlrev_b32 v62, 16, v39
    v_and_b32 v63, s66, v39
    v_mul_f32 v48, s70, v48
    v_mul_f32 v49, s70, v49
    v_mul_f32 v50, s70, v50
    v_mul_f32 v51, s70, v51
    buffer_load_dwordx4 v[172:175], v3, s[8:11], s60 offen offset:3072 nt
    v_mul_f32 v52, s70, v52
    v_mul_f32 v53, s70, v53
    v_mul_f32 v54, s70, v54
    v_mul_f32 v55, s70, v55
    v_mul_f32 v56, s70, v56
    v_mul_f32 v57, s70, v57
    v_mul_f32 v58, s70, v58
    v_mul_f32 v59, s70, v59
    v_mul_f32 v60, s70, v60
    v_mul_f32 v61, s70, v61
    s_add_u32 s79, s60, 4096
    s_pack_lh_b32_b16 s60, s79, s60
    buffer_load_dwordx4 v[176:179], v3, s[8:11], s60 offen offset:0 nt
    v_mul_f32 v62, s70, v62
    v_mul_f32 v63, s70, v63
    v_cvt_pk_bf16_f32 v32, v48, v49
    v_cvt_pk_bf16_f32 v33, v50, v51
    v_cvt_pk_bf16_f32 v34, v52, v53
    v_cvt_pk_bf16_f32 v35, v54, v55
    v_cvt_pk_bf16_f32 v36, v56, v57
    v_cvt_pk_bf16_f32 v37, v58, v59
    v_cvt_pk_bf16_f32 v38, v60, v61
    buffer_load_dwordx4 v[180:183], v3, s[8:11], s60 offen offset:1024 nt
    v_cvt_pk_bf16_f32 v39, v62, v63
    v_lshlrev_b32 v48, 16, v32
    v_and_b32 v49, s66, v32
    v_lshlrev_b32 v50, 16, v33
    v_and_b32 v51, s66, v33
    v_lshlrev_b32 v52, 16, v34
    v_and_b32 v53, s66, v34
    v_lshlrev_b32 v54, 16, v35
    v_and_b32 v55, s66, v35
    v_lshlrev_b32 v56, 16, v36
    buffer_load_dwordx4 v[184:187], v3, s[8:11], s60 offen offset:2048 nt
    v_and_b32 v57, s66, v36
    v_lshlrev_b32 v58, 16, v37
    v_and_b32 v59, s66, v37
    v_lshlrev_b32 v60, 16, v38
    v_and_b32 v61, s66, v38
    v_lshlrev_b32 v62, 16, v39
    v_and_b32 v63, s66, v39
    v_max3_f32 v9, v48, v49, v50
    v_max3_f32 v9, v9, v51, v52
    buffer_load_dwordx4 v[188:191], v3, s[8:11], s60 offen offset:3072 nt
    v_max3_f32 v9, v9, v53, v54
    v_max3_f32 v9, v9, v55, v56
    v_max3_f32 v9, v9, v57, v58
    v_max3_f32 v9, v9, v59, v60
    v_max3_f32 v9, v9, v61, v62
    v_max_f32 v9, v9, v63
    s_nop 1
    v_max_f32_dpp v9, v9, v9 row_ror:4 row_mask:0xf bank_mask:0xf
    s_nop 1
    v_max_f32_dpp v9, v9, v9 row_ror:8 row_mask:0xf bank_mask:0xf
    v_mov_b32 v10, v9
    s_nop 1
    v_permlane16_swap_b32 v9, v10
    s_add_u32 s79, s60, 4096
    s_pack_lh_b32_b16 s60, s79, s60
    buffer_load_dwordx4 v[192:195], v3, s[8:11], s60 offen offset:0 nt
    v_max_f32 v9, v9, v10
    v_mov_b32 v10, v9
    s_nop 1
    v_permlane32_swap_b32 v9, v10
    v_max_f32 v9, v9, v10
    v_mul_f32 v11, s69, v9
    v_fma_f32 v48, v48, s69, -v11
    v_fma_f32 v49, v49, s69, -v11
    v_fma_f32 v50, v50, s69, -v11
    v_fma_f32 v51, v51, s69, -v11
    buffer_load_dwordx4 v[196:199], v3, s[8:11], s60 offen offset:1024 nt
    v_fma_f32 v52, v52, s69, -v11
    v_fma_f32 v53, v53, s69, -v11
    v_fma_f32 v54, v54, s69, -v11
    v_fma_f32 v55, v55, s69, -v11
    v_fma_f32 v56, v56, s69, -v11
    v_fma_f32 v57, v57, s69, -v11
    v_fma_f32 v58, v58, s69, -v11
    v_fma_f32 v59, v59, s69, -v11
    v_fma_f32 v60, v60, s69, -v11
    v_fma_f32 v61, v61, s69, -v11
    buffer_load_dwordx4 v[200:203], v3, s[8:11], s60 offen offset:2048 nt
    v_fma_f32 v62, v62, s69, -v11
    v_fma_f32 v63, v63, s69, -v11
    v_exp_f32 v48, v48
    v_exp_f32 v49, v49
    v_exp_f32 v50, v50
    v_exp_f32 v51, v51
    v_exp_f32 v52, v52
    v_exp_f32 v53, v53
    v_exp_f32 v54, v54
    buffer_load_dwordx4 v[204:207], v3, s[8:11], s60 offen offset:3072 nt
    v_exp_f32 v55, v55
    v_exp_f32 v56, v56
    v_exp_f32 v57, v57
    v_exp_f32 v58, v58
    v_exp_f32 v59, v59
    v_exp_f32 v60, v60
    v_exp_f32 v61, v61
    v_exp_f32 v62, v62
    v_exp_f32 v63, v63
    v_add_f32 v13, v48, v49
    s_add_u32 s79, s60, 4096
    s_pack_lh_b32_b16 s60, s79, s60
    buffer_load_dwordx4 v[208:211], v3, s[8:11], s60 offen offset:0 nt
    v_add_f32 v13, v13, v50
    v_add_f32 v13, v13, v51
    v_add_f32 v13, v13, v52
    v_add_f32 v13, v13, v53
    v_add_f32 v13, v13, v54
    v_add_f32 v13, v13, v55
    v_add_f32 v13, v13, v56
    v_add_f32 v13, v13, v57
    v_add_f32 v13, v13, v58
    buffer_load_dwordx4 v[212:215], v3, s[8:11], s60 offen offset:1024 nt
    v_add_f32 v13, v13, v59
    v_add_f32 v13, v13, v60
    v_add_f32 v13, v13, v61
    v_add_f32 v13, v13, v62
    v_add_f32 v13, v13, v63
    v_cvt_pk_bf16_f32 v16, v48, v49
    v_cvt_pk_bf16_f32 v17, v50, v51
    v_cvt_pk_bf16_f32 v18, v52, v53
    v_cvt_pk_bf16_f32 v19, v54, v55
    v_cvt_pk_bf16_f32 v20, v56, v57
    buffer_load_dwordx4 v[216:219], v3, s[8:11], s60 offen offset:2048 nt
    v_cvt_pk_bf16_f32 v21, v58, v59
    v_cvt_pk_bf16_f32 v22, v60, v61
    v_cvt_pk_bf16_f32 v23, v62, v63
    v_add_f32_dpp v13, v13, v13 row_ror:4 row_mask:0xf bank_mask:0xf
    s_nop 1
    v_add_f32_dpp v13, v13, v13 row_ror:8 row_mask:0xf bank_mask:0xf
    v_mov_b32 v10, v13
    s_nop 1
    v_permlane16_swap_b32 v13, v10
    v_add_f32 v13, v13, v10
    v_mov_b32 v10, v13
    buffer_load_dwordx4 v[220:223], v3, s[8:11], s60 offen offset:3072 nt
    s_add_u32 s79, s60, 4096
    s_pack_lh_b32_b16 s60, s79, s60
    v_permlane32_swap_b32 v13, v10
    v_add_f32 v13, v13, v10
    v_mov_b32 v12, v9
    v_mov_b32 v14, s58
    v_mov_b32 v15, s58
    s_lshl_b32 s64, s2, 8
    s_lshl_b32 s61, s3, 6
    s_add_u32 s64, s64, s61
    v_lshlrev_b32 v10, 4, v1
    v_add_u32 v6, s64, v10
    s_mov_b64 exec, 0xf
    s_mov_b32 s61, 0x20000
    buffer_store_dwordx4 v[12:15], v6, s[12:15], s61 offen offset:0 sc1
    s_mov_b64 exec, -1
    v_mov_b32 v24, 0
    v_mov_b32 v25, 0
    v_mov_b32 v26, 0
    v_mov_b32 v27, 0
    v_mov_b32 v28, 0
    v_mov_b32 v29, 0
    v_mov_b32 v30, 0
    v_mov_b32 v31, 0
    v_mov_b32 v40, 0
    v_mov_b32 v41, 0
    v_mov_b32 v42, 0
    v_mov_b32 v43, 0
    v_mov_b32 v44, 0
    v_mov_b32 v45, 0
    v_mov_b32 v46, 0
    v_mov_b32 v47, 0
    s_lshr_b32 s61, s2, 3
    s_lshl_b32 s61, s61, 11
    v_lshlrev_b32 v10, 4, v1
    v_add_u32 v6, s61, v10
    v_lshrrev_b32 v10, 4, v1
    v_add_u32 v10, v10, v1
    v_and_b32 v10, 3, v10
    v_and_b32 v11, 60, v1
    v_or_b32 v10, v10, v11
    v_lshlrev_b32 v10, 4, v10
    s_lshl_b32 s61, s3, 11
    v_add_u32 v8, s61, v10
    v_bfe_u32 v11, v0, 5, 2
    v_lshlrev_b32 v15, 4, v11
    v_bfe_u32 v10, v0, 3, 2
    v_add_u32 v11, v11, v10
    v_and_b32 v11, 3, v11
    v_lshlrev_b32 v11, 4, v11
    v_lshl_add_u32 v11, v10, 8, v11
    v_and_b32 v10, 3, v0
    v_lshl_add_u32 v11, v10, 6, v11
    v_bfe_u32 v10, v0, 2, 1
    v_lshl_add_u32 v2, v10, 10, v11
    v_and_b32 v10, 0x60, v0
    v_bfe_u32 v11, v0, 1, 4
    v_or_b32 v10, v10, v11
    v_and_b32 v11, 1, v0
    v_lshl_or_b32 v10, v11, 4, v10
    v_lshlrev_b32 v10, 4, v10
    s_lshl_b32 s64, s2, 11
    v_add_u32 v14, s64, v10
    v_mov_b32_dpp v24, v16 quad_perm:[0,1,2,3] row_mask:0xf bank_mask:0x1
    v_mov_b32_dpp v25, v17 quad_perm:[0,1,2,3] row_mask:0xf bank_mask:0x1
    v_mov_b32_dpp v26, v18 quad_perm:[0,1,2,3] row_mask:0xf bank_mask:0x1
    v_mov_b32_dpp v27, v19 quad_perm:[0,1,2,3] row_mask:0xf bank_mask:0x1
    v_mov_b32_dpp v28, v16 row_ror:4 row_mask:0xf bank_mask:0x2
    v_mov_b32_dpp v29, v17 row_ror:4 row_mask:0xf bank_mask:0x2
    v_mov_b32_dpp v30, v18 row_ror:4 row_mask:0xf bank_mask:0x2
    v_mov_b32_dpp v31, v19 row_ror:4 row_mask:0xf bank_mask:0x2
    v_mov_b32_dpp v40, v16 row_ror:8 row_mask:0xf bank_mask:0x4
    v_mov_b32_dpp v41, v17 row_ror:8 row_mask:0xf bank_mask:0x4
    v_mov_b32_dpp v42, v18 row_ror:8 row_mask:0xf bank_mask:0x4
    v_mov_b32_dpp v43, v19 row_ror:8 row_mask:0xf bank_mask:0x4
    v_mov_b32_dpp v44, v16 row_ror:12 row_mask:0xf bank_mask:0x8
    v_mov_b32_dpp v45, v17 row_ror:12 row_mask:0xf bank_mask:0x8
    v_mov_b32_dpp v46, v18 row_ror:12 row_mask:0xf bank_mask:0x8
    v_mov_b32_dpp v47, v19 row_ror:12 row_mask:0xf bank_mask:0x8
    s_waitcnt vmcnt(49)
    v_perm_b32 v32, v68, v64, s67
    v_perm_b32 v33, v76, v72, s67
    v_perm_b32 v34, v84, v80, s67
    v_perm_b32 v35, v92, v88, s67
    v_perm_b32 v36, v70, v66, s67
    v_perm_b32 v37, v78, v74, s67
    v_perm_b32 v38, v86, v82, s67
    v_perm_b32 v39, v94, v90, s67
    v_mfma_f32_16x16x32_bf16 a[0:3], v[32:35], v[24:27], 0
    v_perm_b32 v32, v68, v64, s68
    v_perm_b32 v33, v76, v72, s68
    v_perm_b32 v34, v84, v80, s68
    v_perm_b32 v35, v92, v88, s68
    v_mfma_f32_16x16x32_bf16 a[4:7], v[36:39], v[24:27], 0
    v_perm_b32 v36, v70, v66, s68
    v_perm_b32 v37, v78, v74, s68
    v_perm_b32 v38, v86, v82, s68
    v_perm_b32 v39, v94, v90, s68
    v_mfma_f32_16x16x32_bf16 a[0:3], v[32:35], v[28:31], a[0:3]
    v_perm_b32 v32, v69, v65, s67
    v_perm_b32 v33, v77, v73, s67
    v_perm_b32 v34, v85, v81, s67
    v_perm_b32 v35, v93, v89, s67
    v_mfma_f32_16x16x32_bf16 a[4:7], v[36:39], v[28:31], a[4:7]
    v_perm_b32 v36, v71, v67, s67
    v_perm_b32 v37, v79, v75, s67
    v_perm_b32 v38, v87, v83, s67
    v_perm_b32 v39, v95, v91, s67
    v_mfma_f32_16x16x32_bf16 a[0:3], v[32:35], v[40:43], a[0:3]
    v_perm_b32 v32, v69, v65, s68
    v_perm_b32 v33, v77, v73, s68
    v_perm_b32 v34, v85, v81, s68
    v_perm_b32 v35, v93, v89, s68
    v_mfma_f32_16x16x32_bf16 a[4:7], v[36:39], v[40:43], a[4:7]
    v_perm_b32 v36, v71, v67, s68
    v_perm_b32 v37, v79, v75, s68
    v_perm_b32 v38, v87, v83, s68
    v_perm_b32 v39, v95, v91, s68
    v_mfma_f32_16x16x32_bf16 a[0:3], v[32:35], v[44:47], a[0:3]
    s_nop 0
    v_mfma_f32_16x16x32_bf16 a[4:7], v[36:39], v[44:47], a[4:7]
    v_mov_b32_dpp v24, v16 row_ror:12 row_mask:0xf bank_mask:0x1
    v_mov_b32_dpp v25, v17 row_ror:12 row_mask:0xf bank_mask:0x1
    v_mov_b32_dpp v26, v18 row_ror:12 row_mask:0xf bank_mask:0x1
    v_mov_b32_dpp v27, v19 row_ror:12 row_mask:0xf bank_mask:0x1
    v_mov_b32_dpp v28, v16 quad_perm:[0,1,2,3] row_mask:0xf bank_mask:0x2
    v_mov_b32_dpp v29, v17 quad_perm:[0,1,2,3] row_mask:0xf bank_mask:0x2
    v_mov_b32_dpp v30, v18 quad_perm:[0,1,2,3] row_mask:0xf bank_mask:0x2
    v_mov_b32_dpp v31, v19 quad_perm:[0,1,2,3] row_mask:0xf bank_mask:0x2
    v_mov_b32_dpp v40, v16 row_ror:4 row_mask:0xf bank_mask:0x4
    v_mov_b32_dpp v41, v17 row_ror:4 row_mask:0xf bank_mask:0x4
    v_mov_b32_dpp v42, v18 row_ror:4 row_mask:0xf bank_mask:0x4
    v_mov_b32_dpp v43, v19 row_ror:4 row_mask:0xf bank_mask:0x4
    v_mov_b32_dpp v44, v16 row_ror:8 row_mask:0xf bank_mask:0x8
    v_mov_b32_dpp v45, v17 row_ror:8 row_mask:0xf bank_mask:0x8
    v_mov_b32_dpp v46, v18 row_ror:8 row_mask:0xf bank_mask:0x8
    v_mov_b32_dpp v47, v19 row_ror:8 row_mask:0xf bank_mask:0x8
    s_waitcnt vmcnt(37)
    buffer_load_dwordx4 v[64:67], v3, s[8:11], s60 offen offset:0 nt
    v_perm_b32 v32, v100, v96, s67
    v_perm_b32 v33, v108, v104, s67
    v_perm_b32 v34, v116, v112, s67
    v_perm_b32 v35, v124, v120, s67
    v_perm_b32 v36, v102, v98, s67
    buffer_load_dwordx4 v[68:71], v3, s[8:11], s60 offen offset:1024 nt
    v_perm_b32 v37, v110, v106, s67
    v_perm_b32 v38, v118, v114, s67
    v_perm_b32 v39, v126, v122, s67
    v_mfma_f32_16x16x32_bf16 a[0:3], v[32:35], v[24:27], a[0:3]
    v_perm_b32 v32, v100, v96, s68
    buffer_load_dwordx4 v[72:75], v3, s[8:11], s60 offen offset:2048 nt
    v_perm_b32 v33, v108, v104, s68
    v_perm_b32 v34, v116, v112, s68
    v_perm_b32 v35, v124, v120, s68
    v_mfma_f32_16x16x32_bf16 a[4:7], v[36:39], v[24:27], a[4:7]
    v_perm_b32 v36, v102, v98, s68
    buffer_load_dwordx4 v[76:79], v3, s[8:11], s60 offen offset:3072 nt
    v_perm_b32 v37, v110, v106, s68
    v_perm_b32 v38, v118, v114, s68
    v_perm_b32 v39, v126, v122, s68
    v_mfma_f32_16x16x32_bf16 a[0:3], v[32:35], v[28:31], a[0:3]
    v_perm_b32 v32, v101, v97, s67
    s_add_u32 s79, s60, 4096
    s_pack_lh_b32_b16 s60, s79, s60
    buffer_load_dwordx4 v[80:83], v3, s[8:11], s60 offen offset:0 nt
    v_perm_b32 v33, v109, v105, s67
    v_perm_b32 v34, v117, v113, s67
    v_perm_b32 v35, v125, v121, s67
    v_mfma_f32_16x16x32_bf16 a[4:7], v[36:39], v[28:31], a[4:7]
    v_perm_b32 v36, v103, v99, s67
    buffer_load_dwordx4 v[84:87], v3, s[8:11], s60 offen offset:1024 nt
    v_perm_b32 v37, v111, v107, s67
    v_perm_b32 v38, v119, v115, s67
    v_perm_b32 v39, v127, v123, s67
    v_mfma_f32_16x16x32_bf16 a[0:3], v[32:35], v[40:43], a[0:3]
    v_perm_b32 v32, v101, v97, s68
    buffer_load_dwordx4 v[88:91], v3, s[8:11], s60 offen offset:2048 nt
    v_perm_b32 v33, v109, v105, s68
    v_perm_b32 v34, v117, v113, s68
    v_perm_b32 v35, v125, v121, s68
    v_mfma_f32_16x16x32_bf16 a[4:7], v[36:39], v[40:43], a[4:7]
    v_perm_b32 v36, v103, v99, s68
    buffer_load_dwordx4 v[92:95], v3, s[8:11], s60 offen offset:3072 nt
    s_add_u32 s79, s60, 4096
    s_pack_lh_b32_b16 s60, s79, s60
    v_perm_b32 v37, v111, v107, s68
    v_perm_b32 v38, v119, v115, s68
    v_perm_b32 v39, v127, v123, s68
    v_mfma_f32_16x16x32_bf16 a[0:3], v[32:35], v[44:47], a[0:3]
    s_nop 0
    v_mfma_f32_16x16x32_bf16 a[4:7], v[36:39], v[44:47], a[4:7]
    v_mov_b32_dpp v24, v16 row_ror:8 row_mask:0xf bank_mask:0x1
    v_mov_b32_dpp v25, v17 row_ror:8 row_mask:0xf bank_mask:0x1
    v_mov_b32_dpp v26, v18 row_ror:8 row_mask:0xf bank_mask:0x1
    v_mov_b32_dpp v27, v19 row_ror:8 row_mask:0xf bank_mask:0x1
    v_mov_b32_dpp v28, v16 row_ror:12 row_mask:0xf bank_mask:0x2
    v_mov_b32_dpp v29, v17 row_ror:12 row_mask:0xf bank_mask:0x2
    v_mov_b32_dpp v30, v18 row_ror:12 row_mask:0xf bank_mask:0x2
    v_mov_b32_dpp v31, v19 row_ror:12 row_mask:0xf bank_mask:0x2
    v_mov_b32_dpp v40, v16 quad_perm:[0,1,2,3] row_mask:0xf bank_mask:0x4
    v_mov_b32_dpp v41, v17 quad_perm:[0,1,2,3] row_mask:0xf bank_mask:0x4
    v_mov_b32_dpp v42, v18 quad_perm:[0,1,2,3] row_mask:0xf bank_mask:0x4
    v_mov_b32_dpp v43, v19 quad_perm:[0,1,2,3] row_mask:0xf bank_mask:0x4
    v_mov_b32_dpp v44, v16 row_ror:4 row_mask:0xf bank_mask:0x8
    v_mov_b32_dpp v45, v17 row_ror:4 row_mask:0xf bank_mask:0x8
    v_mov_b32_dpp v46, v18 row_ror:4 row_mask:0xf bank_mask:0x8
    v_mov_b32_dpp v47, v19 row_ror:4 row_mask:0xf bank_mask:0x8
    s_waitcnt vmcnt(33)
    v_perm_b32 v32, v132, v128, s67
    v_perm_b32 v33, v140, v136, s67
    v_perm_b32 v34, v148, v144, s67
    v_perm_b32 v35, v156, v152, s67
    v_perm_b32 v36, v134, v130, s67
    v_perm_b32 v37, v142, v138, s67
    v_perm_b32 v38, v150, v146, s67
    v_perm_b32 v39, v158, v154, s67
    v_mfma_f32_16x16x32_bf16 a[0:3], v[32:35], v[24:27], a[0:3]
    v_perm_b32 v32, v132, v128, s68
    v_perm_b32 v33, v140, v136, s68
    v_perm_b32 v34, v148, v144, s68
    v_perm_b32 v35, v156, v152, s68
    v_mfma_f32_16x16x32_bf16 a[4:7], v[36:39], v[24:27], a[4:7]
    v_perm_b32 v36, v134, v130, s68
    v_perm_b32 v37, v142, v138, s68
    v_perm_b32 v38, v150, v146, s68
    v_perm_b32 v39, v158, v154, s68
    v_mfma_f32_16x16x32_bf16 a[0:3], v[32:35], v[28:31], a[0:3]
    v_perm_b32 v32, v133, v129, s67
    v_perm_b32 v33, v141, v137, s67
    v_perm_b32 v34, v149, v145, s67
    v_perm_b32 v35, v157, v153, s67
    v_mfma_f32_16x16x32_bf16 a[4:7], v[36:39], v[28:31], a[4:7]
    v_perm_b32 v36, v135, v131, s67
    v_perm_b32 v37, v143, v139, s67
    v_perm_b32 v38, v151, v147, s67
    v_perm_b32 v39, v159, v155, s67
    v_mfma_f32_16x16x32_bf16 a[0:3], v[32:35], v[40:43], a[0:3]
    v_perm_b32 v32, v133, v129, s68
    v_perm_b32 v33, v141, v137, s68
    v_perm_b32 v34, v149, v145, s68
    v_perm_b32 v35, v157, v153, s68
    v_mfma_f32_16x16x32_bf16 a[4:7], v[36:39], v[40:43], a[4:7]
    v_perm_b32 v36, v135, v131, s68
    v_perm_b32 v37, v143, v139, s68
    v_perm_b32 v38, v151, v147, s68
    v_perm_b32 v39, v159, v155, s68
    v_mfma_f32_16x16x32_bf16 a[0:3], v[32:35], v[44:47], a[0:3]
    s_nop 0
    v_mfma_f32_16x16x32_bf16 a[4:7], v[36:39], v[44:47], a[4:7]
    v_mov_b32_dpp v24, v16 row_ror:4 row_mask:0xf bank_mask:0x1
    v_mov_b32_dpp v25, v17 row_ror:4 row_mask:0xf bank_mask:0x1
    v_mov_b32_dpp v26, v18 row_ror:4 row_mask:0xf bank_mask:0x1
    v_mov_b32_dpp v27, v19 row_ror:4 row_mask:0xf bank_mask:0x1
    v_mov_b32_dpp v28, v16 row_ror:8 row_mask:0xf bank_mask:0x2
    v_mov_b32_dpp v29, v17 row_ror:8 row_mask:0xf bank_mask:0x2
    v_mov_b32_dpp v30, v18 row_ror:8 row_mask:0xf bank_mask:0x2
    v_mov_b32_dpp v31, v19 row_ror:8 row_mask:0xf bank_mask:0x2
    v_mov_b32_dpp v40, v16 row_ror:12 row_mask:0xf bank_mask:0x4
    v_mov_b32_dpp v41, v17 row_ror:12 row_mask:0xf bank_mask:0x4
    v_mov_b32_dpp v42, v18 row_ror:12 row_mask:0xf bank_mask:0x4
    v_mov_b32_dpp v43, v19 row_ror:12 row_mask:0xf bank_mask:0x4
    v_mov_b32_dpp v44, v16 quad_perm:[0,1,2,3] row_mask:0xf bank_mask:0x8
    v_mov_b32_dpp v45, v17 quad_perm:[0,1,2,3] row_mask:0xf bank_mask:0x8
    v_mov_b32_dpp v46, v18 quad_perm:[0,1,2,3] row_mask:0xf bank_mask:0x8
    v_mov_b32_dpp v47, v19 quad_perm:[0,1,2,3] row_mask:0xf bank_mask:0x8
    s_waitcnt vmcnt(25)
    s_mov_b32 s61, 0x20000
    buffer_load_dwordx4 v[48:51], v6, s[12:15], s61 offen offset:0 sc1
    v_perm_b32 v32, v228, v224, s67
    v_perm_b32 v33, v236, v232, s67
    v_perm_b32 v34, v244, v240, s67
    v_perm_b32 v35, v252, v248, s67
    s_mov_b32 s61, 0x20000
    buffer_load_dwordx4 v[52:55], v6, s[12:15], s61 offen offset:1024 sc1
    v_perm_b32 v36, v230, v226, s67
    v_perm_b32 v37, v238, v234, s67
    v_perm_b32 v38, v246, v242, s67
    v_perm_b32 v39, v254, v250, s67
    buffer_load_dwordx4 v[96:99], v3, s[8:11], s60 offen offset:0 nt
    v_mfma_f32_16x16x32_bf16 a[0:3], v[32:35], v[24:27], a[0:3]
    v_perm_b32 v32, v228, v224, s68
    v_perm_b32 v33, v236, v232, s68
    v_perm_b32 v34, v244, v240, s68
    buffer_load_dwordx4 v[100:103], v3, s[8:11], s60 offen offset:1024 nt
    v_perm_b32 v35, v252, v248, s68
    v_mfma_f32_16x16x32_bf16 a[4:7], v[36:39], v[24:27], a[4:7]
    v_perm_b32 v36, v230, v226, s68
    v_perm_b32 v37, v238, v234, s68
    buffer_load_dwordx4 v[104:107], v3, s[8:11], s60 offen offset:2048 nt
    v_perm_b32 v38, v246, v242, s68
    v_perm_b32 v39, v254, v250, s68
    v_mfma_f32_16x16x32_bf16 a[0:3], v[32:35], v[28:31], a[0:3]
    v_perm_b32 v32, v229, v225, s67
    buffer_load_dwordx4 v[108:111], v3, s[8:11], s60 offen offset:3072 nt
    v_perm_b32 v33, v237, v233, s67
    v_perm_b32 v34, v245, v241, s67
    v_perm_b32 v35, v253, v249, s67
    v_mfma_f32_16x16x32_bf16 a[4:7], v[36:39], v[28:31], a[4:7]
    s_add_u32 s79, s60, 4096
    s_pack_lh_b32_b16 s60, s79, s60
    buffer_load_dwordx4 v[112:115], v3, s[8:11], s60 offen offset:0 nt
    v_perm_b32 v36, v231, v227, s67
    v_perm_b32 v37, v239, v235, s67
    v_perm_b32 v38, v247, v243, s67
    v_perm_b32 v39, v255, v251, s67
    buffer_load_dwordx4 v[116:119], v3, s[8:11], s60 offen offset:1024 nt
    v_mfma_f32_16x16x32_bf16 a[0:3], v[32:35], v[40:43], a[0:3]
    v_perm_b32 v32, v229, v225, s68
    v_perm_b32 v33, v237, v233, s68
    v_perm_b32 v34, v245, v241, s68
    buffer_load_dwordx4 v[120:123], v3, s[8:11], s60 offen offset:2048 nt
    v_perm_b32 v35, v253, v249, s68
    v_mfma_f32_16x16x32_bf16 a[4:7], v[36:39], v[40:43], a[4:7]
    v_perm_b32 v36, v231, v227, s68
    v_perm_b32 v37, v239, v235, s68
    buffer_load_dwordx4 v[124:127], v3, s[8:11], s60 offen offset:3072 nt
    s_add_u32 s79, s60, 4096
    s_pack_lh_b32_b16 s60, s79, s60
    v_perm_b32 v38, v247, v243, s68
    v_perm_b32 v39, v255, v251, s68
    v_mfma_f32_16x16x32_bf16 a[0:3], v[32:35], v[44:47], a[0:3]
    s_nop 0
    v_mfma_f32_16x16x32_bf16 a[4:7], v[36:39], v[44:47], a[4:7]
    v_mov_b32_dpp v24, v20 quad_perm:[0,1,2,3] row_mask:0xf bank_mask:0x1
    v_mov_b32_dpp v25, v21 quad_perm:[0,1,2,3] row_mask:0xf bank_mask:0x1
    v_mov_b32_dpp v26, v22 quad_perm:[0,1,2,3] row_mask:0xf bank_mask:0x1
    v_mov_b32_dpp v27, v23 quad_perm:[0,1,2,3] row_mask:0xf bank_mask:0x1
    v_mov_b32_dpp v28, v20 row_ror:4 row_mask:0xf bank_mask:0x2
    v_mov_b32_dpp v29, v21 row_ror:4 row_mask:0xf bank_mask:0x2
    v_mov_b32_dpp v30, v22 row_ror:4 row_mask:0xf bank_mask:0x2
    v_mov_b32_dpp v31, v23 row_ror:4 row_mask:0xf bank_mask:0x2
    v_mov_b32_dpp v40, v20 row_ror:8 row_mask:0xf bank_mask:0x4
    v_mov_b32_dpp v41, v21 row_ror:8 row_mask:0xf bank_mask:0x4
    v_mov_b32_dpp v42, v22 row_ror:8 row_mask:0xf bank_mask:0x4
    v_mov_b32_dpp v43, v23 row_ror:8 row_mask:0xf bank_mask:0x4
    v_mov_b32_dpp v44, v20 row_ror:12 row_mask:0xf bank_mask:0x8
    v_mov_b32_dpp v45, v21 row_ror:12 row_mask:0xf bank_mask:0x8
    v_mov_b32_dpp v46, v22 row_ror:12 row_mask:0xf bank_mask:0x8
    v_mov_b32_dpp v47, v23 row_ror:12 row_mask:0xf bank_mask:0x8
    s_waitcnt vmcnt(27)
    v_perm_b32 v32, v164, v160, s67
    v_perm_b32 v33, v172, v168, s67
    v_perm_b32 v34, v180, v176, s67
    v_perm_b32 v35, v188, v184, s67
    v_perm_b32 v36, v166, v162, s67
    v_perm_b32 v37, v174, v170, s67
    v_perm_b32 v38, v182, v178, s67
    v_perm_b32 v39, v190, v186, s67
    v_mfma_f32_16x16x32_bf16 a[0:3], v[32:35], v[24:27], a[0:3]
    v_perm_b32 v32, v164, v160, s68
    v_perm_b32 v33, v172, v168, s68
    v_perm_b32 v34, v180, v176, s68
    v_perm_b32 v35, v188, v184, s68
    v_mfma_f32_16x16x32_bf16 a[4:7], v[36:39], v[24:27], a[4:7]
    v_perm_b32 v36, v166, v162, s68
    v_perm_b32 v37, v174, v170, s68
    v_perm_b32 v38, v182, v178, s68
    v_perm_b32 v39, v190, v186, s68
    v_mfma_f32_16x16x32_bf16 a[0:3], v[32:35], v[28:31], a[0:3]
    v_perm_b32 v32, v165, v161, s67
    v_perm_b32 v33, v173, v169, s67
    v_perm_b32 v34, v181, v177, s67
    v_perm_b32 v35, v189, v185, s67
    v_mfma_f32_16x16x32_bf16 a[4:7], v[36:39], v[28:31], a[4:7]
    v_perm_b32 v36, v167, v163, s67
    v_perm_b32 v37, v175, v171, s67
    v_perm_b32 v38, v183, v179, s67
    v_perm_b32 v39, v191, v187, s67
    v_mfma_f32_16x16x32_bf16 a[0:3], v[32:35], v[40:43], a[0:3]
    v_perm_b32 v32, v165, v161, s68
    v_perm_b32 v33, v173, v169, s68
    v_perm_b32 v34, v181, v177, s68
    v_perm_b32 v35, v189, v185, s68
    v_mfma_f32_16x16x32_bf16 a[4:7], v[36:39], v[40:43], a[4:7]
    v_perm_b32 v36, v167, v163, s68
    v_perm_b32 v37, v175, v171, s68
    v_perm_b32 v38, v183, v179, s68
    v_perm_b32 v39, v191, v187, s68
    v_mfma_f32_16x16x32_bf16 a[0:3], v[32:35], v[44:47], a[0:3]
    s_nop 0
    v_mfma_f32_16x16x32_bf16 a[4:7], v[36:39], v[44:47], a[4:7]
    v_mov_b32_dpp v24, v20 row_ror:12 row_mask:0xf bank_mask:0x1
    v_mov_b32_dpp v25, v21 row_ror:12 row_mask:0xf bank_mask:0x1
    v_mov_b32_dpp v26, v22 row_ror:12 row_mask:0xf bank_mask:0x1
    v_mov_b32_dpp v27, v23 row_ror:12 row_mask:0xf bank_mask:0x1
    v_mov_b32_dpp v28, v20 quad_perm:[0,1,2,3] row_mask:0xf bank_mask:0x2
    v_mov_b32_dpp v29, v21 quad_perm:[0,1,2,3] row_mask:0xf bank_mask:0x2
    v_mov_b32_dpp v30, v22 quad_perm:[0,1,2,3] row_mask:0xf bank_mask:0x2
    v_mov_b32_dpp v31, v23 quad_perm:[0,1,2,3] row_mask:0xf bank_mask:0x2
    v_mov_b32_dpp v40, v20 row_ror:4 row_mask:0xf bank_mask:0x4
    v_mov_b32_dpp v41, v21 row_ror:4 row_mask:0xf bank_mask:0x4
    v_mov_b32_dpp v42, v22 row_ror:4 row_mask:0xf bank_mask:0x4
    v_mov_b32_dpp v43, v23 row_ror:4 row_mask:0xf bank_mask:0x4
    v_mov_b32_dpp v44, v20 row_ror:8 row_mask:0xf bank_mask:0x8
    v_mov_b32_dpp v45, v21 row_ror:8 row_mask:0xf bank_mask:0x8
    v_mov_b32_dpp v46, v22 row_ror:8 row_mask:0xf bank_mask:0x8
    v_mov_b32_dpp v47, v23 row_ror:8 row_mask:0xf bank_mask:0x8
    s_waitcnt vmcnt(19)
    v_perm_b32 v32, v196, v192, s67
    v_perm_b32 v33, v204, v200, s67
    v_perm_b32 v34, v212, v208, s67
    v_perm_b32 v35, v220, v216, s67
    v_perm_b32 v36, v198, v194, s67
    v_perm_b32 v37, v206, v202, s67
    v_perm_b32 v38, v214, v210, s67
    v_perm_b32 v39, v222, v218, s67
    v_mfma_f32_16x16x32_bf16 a[0:3], v[32:35], v[24:27], a[0:3]
    v_perm_b32 v32, v196, v192, s68
    v_perm_b32 v33, v204, v200, s68
    v_perm_b32 v34, v212, v208, s68
    v_perm_b32 v35, v220, v216, s68
    v_mfma_f32_16x16x32_bf16 a[4:7], v[36:39], v[24:27], a[4:7]
    v_perm_b32 v36, v198, v194, s68
    v_perm_b32 v37, v206, v202, s68
    v_perm_b32 v38, v214, v210, s68
    v_perm_b32 v39, v222, v218, s68
    v_mfma_f32_16x16x32_bf16 a[0:3], v[32:35], v[28:31], a[0:3]
    v_perm_b32 v32, v197, v193, s67
    v_perm_b32 v33, v205, v201, s67
    v_perm_b32 v34, v213, v209, s67
    v_perm_b32 v35, v221, v217, s67
    v_mfma_f32_16x16x32_bf16 a[4:7], v[36:39], v[28:31], a[4:7]
    v_perm_b32 v36, v199, v195, s67
    v_perm_b32 v37, v207, v203, s67
    v_perm_b32 v38, v215, v211, s67
    v_perm_b32 v39, v223, v219, s67
    v_mfma_f32_16x16x32_bf16 a[0:3], v[32:35], v[40:43], a[0:3]
    v_perm_b32 v32, v197, v193, s68
    v_perm_b32 v33, v205, v201, s68
    v_perm_b32 v34, v213, v209, s68
    v_perm_b32 v35, v221, v217, s68
    v_mfma_f32_16x16x32_bf16 a[4:7], v[36:39], v[40:43], a[4:7]
    v_perm_b32 v36, v199, v195, s68
    v_perm_b32 v37, v207, v203, s68
    v_perm_b32 v38, v215, v211, s68
    v_perm_b32 v39, v223, v219, s68
    v_mfma_f32_16x16x32_bf16 a[0:3], v[32:35], v[44:47], a[0:3]
    s_nop 0
    v_mfma_f32_16x16x32_bf16 a[4:7], v[36:39], v[44:47], a[4:7]
    s_mov_b32 s61, 0x20000
    buffer_load_dwordx4 v[56:59], v6, s[12:15], s61 offen offset:0 sc1
    s_mov_b32 s61, 0x20000
    buffer_load_dwordx4 v[60:63], v6, s[12:15], s61 offen offset:1024 sc1
    v_mov_b32_dpp v24, v20 row_ror:8 row_mask:0xf bank_mask:0x1
    v_mov_b32_dpp v25, v21 row_ror:8 row_mask:0xf bank_mask:0x1
    v_mov_b32_dpp v26, v22 row_ror:8 row_mask:0xf bank_mask:0x1
    v_mov_b32_dpp v27, v23 row_ror:8 row_mask:0xf bank_mask:0x1
    v_mov_b32_dpp v28, v20 row_ror:12 row_mask:0xf bank_mask:0x2
    v_mov_b32_dpp v29, v21 row_ror:12 row_mask:0xf bank_mask:0x2
    v_mov_b32_dpp v30, v22 row_ror:12 row_mask:0xf bank_mask:0x2
    v_mov_b32_dpp v31, v23 row_ror:12 row_mask:0xf bank_mask:0x2
    v_mov_b32_dpp v40, v20 quad_perm:[0,1,2,3] row_mask:0xf bank_mask:0x4
    v_mov_b32_dpp v41, v21 quad_perm:[0,1,2,3] row_mask:0xf bank_mask:0x4
    v_mov_b32_dpp v42, v22 quad_perm:[0,1,2,3] row_mask:0xf bank_mask:0x4
    v_mov_b32_dpp v43, v23 quad_perm:[0,1,2,3] row_mask:0xf bank_mask:0x4
    v_mov_b32_dpp v44, v20 row_ror:4 row_mask:0xf bank_mask:0x8
    v_mov_b32_dpp v45, v21 row_ror:4 row_mask:0xf bank_mask:0x8
    v_mov_b32_dpp v46, v22 row_ror:4 row_mask:0xf bank_mask:0x8
    v_mov_b32_dpp v47, v23 row_ror:4 row_mask:0xf bank_mask:0x8
    s_waitcnt vmcnt(12)
    v_perm_b32 v32, v68, v64, s67
    v_perm_b32 v33, v76, v72, s67
    v_perm_b32 v34, v84, v80, s67
    v_perm_b32 v35, v92, v88, s67
    v_perm_b32 v36, v70, v66, s67
    v_perm_b32 v37, v78, v74, s67
    v_perm_b32 v38, v86, v82, s67
    v_perm_b32 v39, v94, v90, s67
    v_mfma_f32_16x16x32_bf16 a[0:3], v[32:35], v[24:27], a[0:3]
    v_perm_b32 v32, v68, v64, s68
    v_perm_b32 v33, v76, v72, s68
    v_perm_b32 v34, v84, v80, s68
    v_perm_b32 v35, v92, v88, s68
    v_mfma_f32_16x16x32_bf16 a[4:7], v[36:39], v[24:27], a[4:7]
    v_perm_b32 v36, v70, v66, s68
    v_perm_b32 v37, v78, v74, s68
    v_perm_b32 v38, v86, v82, s68
    v_perm_b32 v39, v94, v90, s68
    v_mfma_f32_16x16x32_bf16 a[0:3], v[32:35], v[28:31], a[0:3]
    v_perm_b32 v32, v69, v65, s67
    v_perm_b32 v33, v77, v73, s67
    v_perm_b32 v34, v85, v81, s67
    v_perm_b32 v35, v93, v89, s67
    v_mfma_f32_16x16x32_bf16 a[4:7], v[36:39], v[28:31], a[4:7]
    v_perm_b32 v36, v71, v67, s67
    v_perm_b32 v37, v79, v75, s67
    v_perm_b32 v38, v87, v83, s67
    v_perm_b32 v39, v95, v91, s67
    v_mfma_f32_16x16x32_bf16 a[0:3], v[32:35], v[40:43], a[0:3]
    v_perm_b32 v32, v69, v65, s68
    v_perm_b32 v33, v77, v73, s68
    v_perm_b32 v34, v85, v81, s68
    v_perm_b32 v35, v93, v89, s68
    v_mfma_f32_16x16x32_bf16 a[4:7], v[36:39], v[40:43], a[4:7]
    v_perm_b32 v36, v71, v67, s68
    v_perm_b32 v37, v79, v75, s68
    v_perm_b32 v38, v87, v83, s68
    v_perm_b32 v39, v95, v91, s68
    v_mfma_f32_16x16x32_bf16 a[0:3], v[32:35], v[44:47], a[0:3]
    s_nop 0
    v_mfma_f32_16x16x32_bf16 a[4:7], v[36:39], v[44:47], a[4:7]
    s_waitcnt vmcnt(10)
    v_xor_b32 v10, s58, v50
    v_bitop3_b32 v10, v51, s58, v10 bitop3:0xbe
    v_bitop3_b32 v10, v54, s58, v10 bitop3:0xbe
    v_bitop3_b32 v10, v55, s58, v10 bitop3:0xbe
    v_cmp_ne_u32 vcc, 0, v10
    s_mov_b32 s34, 1
    s_cbranch_vccnz MLS_G
    v_max_f32 v50, v48, v52
    s_nop 1
    v_max_f32_dpp v50, v50, v50 row_ror:4 row_mask:0xf bank_mask:0xf
    s_nop 1
    v_max_f32_dpp v50, v50, v50 row_ror:8 row_mask:0xf bank_mask:0xf
    v_mov_b32 v10, v50
    s_nop 1
    v_permlane16_swap_b32 v50, v10
    v_max_f32 v50, v50, v10
    v_mov_b32 v10, v50
    s_nop 1
    v_permlane32_swap_b32 v50, v10
    v_max_f32 v50, v50, v10
    v_sub_f32 v48, v48, v50
    v_sub_f32 v52, v52, v50
    v_sub_f32 v9, v9, v50
    v_mul_f32 v48, s69, v48
    v_mul_f32 v52, s69, v52
    v_mul_f32 v9, s69, v9
    v_exp_f32 v48, v48
    v_exp_f32 v52, v52
    v_exp_f32 v9, v9
    v_mul_f32 v49, v49, v48
    v_fmac_f32 v49, v53, v52
    s_nop 1
    v_add_f32_dpp v49, v49, v49 row_ror:4 row_mask:0xf bank_mask:0xf
    s_nop 1
    v_add_f32_dpp v49, v49, v49 row_ror:8 row_mask:0xf bank_mask:0xf
    v_mov_b32 v10, v49
    s_nop 1
    v_permlane16_swap_b32 v49, v10
    v_add_f32 v49, v49, v10
    v_mov_b32 v10, v49
    s_nop 1
    v_permlane32_swap_b32 v49, v10
    v_add_f32 v49, v49, v10
    v_rcp_f32 v49, v49
    s_nop 0
    v_mul_f32 v9, v9, v49
    v_lshlrev_b32 v10, 4, v1
    s_lshl_b32 s64, s3, 2
    v_add_u32 v10, s64, v10
    s_mov_b64 exec, 0xf
    ds_write_b32 v10, v9 offset:26880
    s_mov_b64 exec, -1
    s_mov_b32 s34, 0
MLS_G:
    v_mov_b32_dpp v24, v20 row_ror:4 row_mask:0xf bank_mask:0x1
    v_mov_b32_dpp v25, v21 row_ror:4 row_mask:0xf bank_mask:0x1
    v_mov_b32_dpp v26, v22 row_ror:4 row_mask:0xf bank_mask:0x1
    v_mov_b32_dpp v27, v23 row_ror:4 row_mask:0xf bank_mask:0x1
    v_mov_b32_dpp v28, v20 row_ror:8 row_mask:0xf bank_mask:0x2
    v_mov_b32_dpp v29, v21 row_ror:8 row_mask:0xf bank_mask:0x2
    v_mov_b32_dpp v30, v22 row_ror:8 row_mask:0xf bank_mask:0x2
    v_mov_b32_dpp v31, v23 row_ror:8 row_mask:0xf bank_mask:0x2
    v_mov_b32_dpp v40, v20 row_ror:12 row_mask:0xf bank_mask:0x4
    v_mov_b32_dpp v41, v21 row_ror:12 row_mask:0xf bank_mask:0x4
    v_mov_b32_dpp v42, v22 row_ror:12 row_mask:0xf bank_mask:0x4
    v_mov_b32_dpp v43, v23 row_ror:12 row_mask:0xf bank_mask:0x4
    v_mov_b32_dpp v44, v20 quad_perm:[0,1,2,3] row_mask:0xf bank_mask:0x8
    v_mov_b32_dpp v45, v21 quad_perm:[0,1,2,3] row_mask:0xf bank_mask:0x8
    v_mov_b32_dpp v46, v22 quad_perm:[0,1,2,3] row_mask:0xf bank_mask:0x8
    v_mov_b32_dpp v47, v23 quad_perm:[0,1,2,3] row_mask:0xf bank_mask:0x8
    s_waitcnt vmcnt(2)
    v_perm_b32 v32, v100, v96, s67
    v_perm_b32 v33, v108, v104, s67
    v_perm_b32 v34, v116, v112, s67
    v_perm_b32 v35, v124, v120, s67
    v_perm_b32 v36, v102, v98, s67
    v_perm_b32 v37, v110, v106, s67
    v_perm_b32 v38, v118, v114, s67
    v_perm_b32 v39, v126, v122, s67
    v_mfma_f32_16x16x32_bf16 a[0:3], v[32:35], v[24:27], a[0:3]
    v_perm_b32 v32, v100, v96, s68
    v_perm_b32 v33, v108, v104, s68
    v_perm_b32 v34, v116, v112, s68
    v_perm_b32 v35, v124, v120, s68
    v_mfma_f32_16x16x32_bf16 a[4:7], v[36:39], v[24:27], a[4:7]
    v_perm_b32 v36, v102, v98, s68
    v_perm_b32 v37, v110, v106, s68
    v_perm_b32 v38, v118, v114, s68
    v_perm_b32 v39, v126, v122, s68
    v_mfma_f32_16x16x32_bf16 a[0:3], v[32:35], v[28:31], a[0:3]
    v_perm_b32 v32, v101, v97, s67
    v_perm_b32 v33, v109, v105, s67
    v_perm_b32 v34, v117, v113, s67
    v_perm_b32 v35, v125, v121, s67
    v_mfma_f32_16x16x32_bf16 a[4:7], v[36:39], v[28:31], a[4:7]
    v_perm_b32 v36, v103, v99, s67
    v_perm_b32 v37, v111, v107, s67
    v_perm_b32 v38, v119, v115, s67
    v_perm_b32 v39, v127, v123, s67
    v_mfma_f32_16x16x32_bf16 a[0:3], v[32:35], v[40:43], a[0:3]
    v_perm_b32 v32, v101, v97, s68
    v_perm_b32 v33, v109, v105, s68
    v_perm_b32 v34, v117, v113, s68
    v_perm_b32 v35, v125, v121, s68
    v_mfma_f32_16x16x32_bf16 a[4:7], v[36:39], v[40:43], a[4:7]
    v_perm_b32 v36, v103, v99, s68
    v_perm_b32 v37, v111, v107, s68
    v_perm_b32 v38, v119, v115, s68
    v_perm_b32 v39, v127, v123, s68
    v_mfma_f32_16x16x32_bf16 a[0:3], v[32:35], v[44:47], a[0:3]
    s_nop 0
    v_mfma_f32_16x16x32_bf16 a[4:7], v[36:39], v[44:47], a[4:7]
    s_cmp_eq_u32 s34, 0
    s_cbranch_scc1 MLD_G
    s_mov_b32 s62, 0x40000
    s_waitcnt vmcnt(0)
MLR_G:
    v_xor_b32 v10, s58, v58
    v_bitop3_b32 v10, v59, s58, v10 bitop3:0xbe
    v_bitop3_b32 v10, v62, s58, v10 bitop3:0xbe
    v_bitop3_b32 v10, v63, s58, v10 bitop3:0xbe
    v_cmp_ne_u32 vcc, 0, v10
    s_cbranch_vccz MLF_G
    s_mov_b32 s61, 0x20000
    buffer_load_dwordx4 v[56:59], v6, s[12:15], s61 offen offset:0 sc1
    s_mov_b32 s61, 0x20000
    buffer_load_dwordx4 v[60:63], v6, s[12:15], s61 offen offset:1024 sc1
    s_waitcnt vmcnt(0)
    s_sub_u32 s62, s62, 1
    s_cbranch_scc0 MLR_G
MLF_G:
    v_max_f32 v58, v56, v60
    s_nop 1
    v_max_f32_dpp v58, v58, v58 row_ror:4 row_mask:0xf bank_mask:0xf
    s_nop 1
    v_max_f32_dpp v58, v58, v58 row_ror:8 row_mask:0xf bank_mask:0xf
    v_mov_b32 v10, v58
    s_nop 1
    v_permlane16_swap_b32 v58, v10
    v_max_f32 v58, v58, v10
    v_mov_b32 v10, v58
    s_nop 1
    v_permlane32_swap_b32 v58, v10
    v_max_f32 v58, v58, v10
    v_sub_f32 v56, v56, v58
    v_sub_f32 v60, v60, v58
    v_sub_f32 v9, v9, v58
    v_mul_f32 v56, s69, v56
    v_mul_f32 v60, s69, v60
    v_mul_f32 v9, s69, v9
    v_exp_f32 v56, v56
    v_exp_f32 v60, v60
    v_exp_f32 v9, v9
    v_mul_f32 v57, v57, v56
    v_fmac_f32 v57, v61, v60
    s_nop 1
    v_add_f32_dpp v57, v57, v57 row_ror:4 row_mask:0xf bank_mask:0xf
    s_nop 1
    v_add_f32_dpp v57, v57, v57 row_ror:8 row_mask:0xf bank_mask:0xf
    v_mov_b32 v10, v57
    s_nop 1
    v_permlane16_swap_b32 v57, v10
    v_add_f32 v57, v57, v10
    v_mov_b32 v10, v57
    s_nop 1
    v_permlane32_swap_b32 v57, v10
    v_add_f32 v57, v57, v10
    v_rcp_f32 v57, v57
    s_nop 0
    v_mul_f32 v9, v9, v57
    v_lshlrev_b32 v10, 4, v1
    s_lshl_b32 s64, s3, 2
    v_add_u32 v10, s64, v10
    s_mov_b64 exec, 0xf
    ds_write_b32 v10, v9 offset:26880
    s_mov_b64 exec, -1
MLD_G:
    s_nop 3
    ds_write_b128 v8, a[0:3] offset:18688
    s_nop 0
    ds_write_b128 v8, a[4:7] offset:19712
    s_waitcnt lgkmcnt(0)
    s_barrier
    s_cmp_ge_u32 s3, 2
    s_cbranch_scc1 SK2_G
    ds_read_b128 v[48:51], v15 offset:26880
    ds_read_b128 v[32:35], v2 offset:18688
    ds_read_b128 v[36:39], v2 offset:20736
    ds_read_b128 v[40:43], v2 offset:22784
    ds_read_b128 v[44:47], v2 offset:24832
    s_waitcnt lgkmcnt(2)
    v_pk_mul_f32 v[32:33], v[32:33], v[48:49] op_sel_hi:[1,0]
    v_pk_mul_f32 v[34:35], v[34:35], v[48:49] op_sel_hi:[1,0]
    v_pk_fma_f32 v[32:33], v[36:37], v[48:49], v[32:33] op_sel:[0,1,0] op_sel_hi:[1,1,1]
    v_pk_fma_f32 v[34:35], v[38:39], v[48:49], v[34:35] op_sel:[0,1,0] op_sel_hi:[1,1,1]
    s_waitcnt lgkmcnt(0)
    v_pk_fma_f32 v[32:33], v[40:41], v[50:51], v[32:33] op_sel_hi:[1,0,1]
    v_pk_fma_f32 v[34:35], v[42:43], v[50:51], v[34:35] op_sel_hi:[1,0,1]
    v_pk_fma_f32 v[32:33], v[44:45], v[50:51], v[32:33] op_sel:[0,1,0] op_sel_hi:[1,1,1]
    v_pk_fma_f32 v[34:35], v[46:47], v[50:51], v[34:35] op_sel:[0,1,0] op_sel_hi:[1,1,1]
    v_bfi_b32 v32, s65, v4, v32
    v_bfi_b32 v33, s65, v4, v33
    v_bfi_b32 v34, s65, v4, v34
    v_bfi_b32 v35, s65, v4, v35
    s_mov_b32 s61, 0x80000
    buffer_store_dwordx4 v[32:35], v14, s[12:15], s61 offen offset:0 sc1
SK2_G:
    s_barrier
    s_and_b32 s63, s2, 7
    s_mul_i32 s63, s63, 7
    s_sub_u32 s64, s2, 48
    s_lshr_b32 s64, s64, 3
    s_add_u32 s63, s63, s64
    s_lshl_b32 s64, s63, 6
    v_lshrrev_b32 v10, 4, v1
    v_lshlrev_b32 v10, 5, v10
    s_lshl_b32 s61, s3, 7
    v_add_u32 v10, s61, v10
    s_movk_i32 s61, 3584
    v_mul_lo_u32 v10, v10, s61
    v_and_b32 v11, 3, v1
    v_lshl_add_u32 v10, v11, 4, v10
    v_bfe_u32 v11, v1, 2, 1
    v_lshl_add_u32 v10, v11, 3, v10
    v_add_u32 v7, s64, v10
    s_mov_b32 s72, 0xff00ff00
    s_mov_b32 s73, 0xff00ff00
    v_mov_b32 v10, s44
    v_mov_b32 v11, s45
    v_mov_b32 v12, s46
    v_mov_b32 v13, s47
    v_cndmask_b32 v10, v10, v12, s[72:73]
    v_cndmask_b32 v11, v11, v13, s[72:73]
    v_mov_b32 v12, v7
    v_mov_b32 v13, 0
    v_lshl_add_u64 v[12:13], v[10:11], 0, v[12:13]
    s_movk_i32 s74, 7168
    s_mov_b32 s75, 0
    v_and_b32 v10, 3, v1
    v_mul_u32_u24 v10, 0x3000, v10
    v_add_u32 v3, v10, v5
    s_mov_b32 s61, 0x2000
    buffer_load_dwordx4 v[160:163], v3, s[12:15], s61 offen offset:0 sc1
    s_mov_b32 s61, 0x2000
    buffer_load_dwordx4 v[164:167], v3, s[12:15], s61 offen offset:256 sc1
    s_mov_b32 s61, 0x2000
    buffer_load_dwordx4 v[168:171], v3, s[12:15], s61 offen offset:2048 sc1
    s_mov_b32 s61, 0x2000
    buffer_load_dwordx4 v[172:175], v3, s[12:15], s61 offen offset:2304 sc1
    s_mov_b32 s61, 0x3000
    buffer_load_dwordx4 v[176:179], v3, s[12:15], s61 offen offset:0 sc1
    s_mov_b32 s61, 0x3000
    buffer_load_dwordx4 v[180:183], v3, s[12:15], s61 offen offset:256 sc1
    v_and_b32 v10, 3, v1
    v_lshlrev_b32 v10, 10, v10
    v_lshrrev_b32 v11, 4, v1
    v_lshl_add_u32 v10, v11, 6, v10
    v_bfe_u32 v11, v1, 2, 2
    v_lshl_add_u32 v10, v11, 2, v10
    s_lshl_b32 s61, s3, 8
    v_add_u32 v7, s61, v10
    buffer_load_dword v184, v7, s[24:27], 0 offen offset:0
    buffer_load_dword v185, v7, s[24:27], 0 offen offset:16
    buffer_load_dword v186, v7, s[24:27], 0 offen offset:32
    buffer_load_dword v187, v7, s[24:27], 0 offen offset:48
    global_load_dwordx2 v[128:129], v[12:13], off offset:0
    global_load_dwordx2 v[130:131], v[12:13], off offset:3584
    v_lshl_add_u64 v[12:13], v[12:13], 0, s[74:75]
    global_load_dwordx2 v[144:145], v[12:13], off offset:0
    global_load_dwordx2 v[146:147], v[12:13], off offset:3584
    v_lshl_add_u64 v[12:13], v[12:13], 0, s[74:75]
    global_load_dwordx2 v[224:225], v[12:13], off offset:0
    global_load_dwordx2 v[226:227], v[12:13], off offset:3584
    v_lshl_add_u64 v[12:13], v[12:13], 0, s[74:75]
    global_load_dwordx2 v[240:241], v[12:13], off offset:0
    global_load_dwordx2 v[242:243], v[12:13], off offset:3584
    v_lshl_add_u64 v[12:13], v[12:13], 0, s[74:75]
    global_load_dwordx2 v[132:133], v[12:13], off offset:0
    global_load_dwordx2 v[134:135], v[12:13], off offset:3584
    v_lshl_add_u64 v[12:13], v[12:13], 0, s[74:75]
    global_load_dwordx2 v[148:149], v[12:13], off offset:0
    global_load_dwordx2 v[150:151], v[12:13], off offset:3584
    v_lshl_add_u64 v[12:13], v[12:13], 0, s[74:75]
    global_load_dwordx2 v[228:229], v[12:13], off offset:0
    global_load_dwordx2 v[230:231], v[12:13], off offset:3584
    v_lshl_add_u64 v[12:13], v[12:13], 0, s[74:75]
    global_load_dwordx2 v[244:245], v[12:13], off offset:0
    global_load_dwordx2 v[246:247], v[12:13], off offset:3584
    v_lshl_add_u64 v[12:13], v[12:13], 0, s[74:75]
    global_load_dwordx2 v[136:137], v[12:13], off offset:0
    global_load_dwordx2 v[138:139], v[12:13], off offset:3584
    v_lshl_add_u64 v[12:13], v[12:13], 0, s[74:75]
    global_load_dwordx2 v[152:153], v[12:13], off offset:0
    global_load_dwordx2 v[154:155], v[12:13], off offset:3584
    v_lshl_add_u64 v[12:13], v[12:13], 0, s[74:75]
    global_load_dwordx2 v[232:233], v[12:13], off offset:0
    global_load_dwordx2 v[234:235], v[12:13], off offset:3584
    v_lshl_add_u64 v[12:13], v[12:13], 0, s[74:75]
    global_load_dwordx2 v[248:249], v[12:13], off offset:0
    global_load_dwordx2 v[250:251], v[12:13], off offset:3584
    v_lshl_add_u64 v[12:13], v[12:13], 0, s[74:75]
    global_load_dwordx2 v[140:141], v[12:13], off offset:0
    global_load_dwordx2 v[142:143], v[12:13], off offset:3584
    v_lshl_add_u64 v[12:13], v[12:13], 0, s[74:75]
    global_load_dwordx2 v[156:157], v[12:13], off offset:0
    global_load_dwordx2 v[158:159], v[12:13], off offset:3584
    v_lshl_add_u64 v[12:13], v[12:13], 0, s[74:75]
    global_load_dwordx2 v[236:237], v[12:13], off offset:0
    global_load_dwordx2 v[238:239], v[12:13], off offset:3584
    v_lshl_add_u64 v[12:13], v[12:13], 0, s[74:75]
    global_load_dwordx2 v[252:253], v[12:13], off offset:0
    global_load_dwordx2 v[254:255], v[12:13], off offset:3584
    s_mov_b32 s28, s48
    s_mov_b32 s29, s49
    s_mov_b32 s30, 0x1c0000
    s_mov_b32 s31, 0x20000
    v_lshrrev_b32 v10, 4, v1
    v_lshlrev_b32 v10, 11, v10
    v_and_b32 v11, 15, v1
    v_lshl_add_u32 v10, v11, 4, v10
    s_lshl_b32 s64, s63, 15
    s_lshl_b32 s61, s3, 8
    s_add_u32 s64, s64, s61
    v_add_u32 v7, s64, v10
    buffer_load_dwordx4 v[192:195], v7, s[28:31], 0 offen offset:0
    s_mov_b32 s61, 0x2000
    buffer_load_dwordx4 v[196:199], v7, s[28:31], s61 offen offset:0
    s_mov_b32 s61, 0x4000
    buffer_load_dwordx4 v[200:203], v7, s[28:31], s61 offen offset:0
    s_mov_b32 s61, 0x6000
    buffer_load_dwordx4 v[204:207], v7, s[28:31], s61 offen offset:0
    buffer_load_dwordx4 v[208:211], v7, s[28:31], 0 offen offset:1024
    s_mov_b32 s61, 0x2000
    buffer_load_dwordx4 v[212:215], v7, s[28:31], s61 offen offset:1024
    s_mov_b32 s61, 0x4000
    buffer_load_dwordx4 v[216:219], v7, s[28:31], s61 offen offset:1024
    s_mov_b32 s61, 0x6000
    buffer_load_dwordx4 v[220:223], v7, s[28:31], s61 offen offset:1024
    v_and_b32 v10, 3, v1
    v_mul_u32_u24 v10, 0x3000, v10
    v_add_u32 v3, v10, v5
    s_waitcnt vmcnt(40)
    s_mov_b32 s62, 0x40000
CG_md2:
    v_xor_b32 v10, s58, v160
    v_bitop3_b32 v10, v161, s58, v10 bitop3:0xbe
    v_bitop3_b32 v10, v162, s58, v10 bitop3:0xbe
    v_bitop3_b32 v10, v163, s58, v10 bitop3:0xbe
    v_bitop3_b32 v10, v164, s58, v10 bitop3:0xbe
    v_bitop3_b32 v10, v165, s58, v10 bitop3:0xbe
    v_bitop3_b32 v10, v166, s58, v10 bitop3:0xbe
    v_bitop3_b32 v10, v167, s58, v10 bitop3:0xbe
    v_bitop3_b32 v10, v168, s58, v10 bitop3:0xbe
    v_bitop3_b32 v10, v169, s58, v10 bitop3:0xbe
    v_bitop3_b32 v10, v170, s58, v10 bitop3:0xbe
    v_bitop3_b32 v10, v171, s58, v10 bitop3:0xbe
    v_bitop3_b32 v10, v172, s58, v10 bitop3:0xbe
    v_bitop3_b32 v10, v173, s58, v10 bitop3:0xbe
    v_bitop3_b32 v10, v174, s58, v10 bitop3:0xbe
    v_bitop3_b32 v10, v175, s58, v10 bitop3:0xbe
    v_bitop3_b32 v10, v176, s58, v10 bitop3:0xbe
    v_bitop3_b32 v10, v177, s58, v10 bitop3:0xbe
    v_bitop3_b32 v10, v178, s58, v10 bitop3:0xbe
    v_bitop3_b32 v10, v179, s58, v10 bitop3:0xbe
    v_bitop3_b32 v10, v180, s58, v10 bitop3:0xbe
    v_bitop3_b32 v10, v181, s58, v10 bitop3:0xbe
    v_bitop3_b32 v10, v182, s58, v10 bitop3:0xbe
    v_bitop3_b32 v10, v183, s58, v10 bitop3:0xbe
    v_and_b32 v10, 0xff, v10
    v_cmp_ne_u32 vcc, 0, v10
    s_cbranch_vccnz RG_md2
KG_md2:
    v_lshlrev_b32 v40, 16, v184
    v_and_b32 v44, s66, v184
    v_lshlrev_b32 v41, 16, v185
    v_and_b32 v45, s66, v185
    v_lshlrev_b32 v42, 16, v186
    v_and_b32 v46, s66, v186
    v_lshlrev_b32 v43, 16, v187
    v_and_b32 v47, s66, v187
    v_and_b32 v176, s66, v176
    v_and_b32 v177, s66, v177
    v_and_b32 v178, s66, v178
    v_and_b32 v179, s66, v179
    v_and_b32 v180, s66, v180
    v_and_b32 v181, s66, v181
    v_and_b32 v182, s66, v182
    v_and_b32 v183, s66, v183
    v_and_b32 v168, s66, v168
    v_and_b32 v169, s66, v169
    v_and_b32 v170, s66, v170
    v_and_b32 v171, s66, v171
    v_and_b32 v172, s66, v172
    v_and_b32 v173, s66, v173
    v_and_b32 v174, s66, v174
    v_and_b32 v175, s66, v175
    v_add_f32 v176, 1.0, v176
    v_add_f32 v177, 1.0, v177
    v_add_f32 v178, 1.0, v178
    v_add_f32 v179, 1.0, v179
    v_add_f32 v180, 1.0, v180
    v_add_f32 v181, 1.0, v181
    v_add_f32 v182, 1.0, v182
    v_add_f32 v183, 1.0, v183
    v_cvt_pk_bf16_f32 v24, v176, v177
    v_cvt_pk_bf16_f32 v25, v178, v179
    v_cvt_pk_bf16_f32 v26, v180, v181
    v_cvt_pk_bf16_f32 v27, v182, v183
    v_lshlrev_b32 v176, 16, v24
    v_and_b32 v177, s66, v24
    v_lshlrev_b32 v178, 16, v25
    v_and_b32 v179, s66, v25
    v_lshlrev_b32 v180, 16, v26
    v_and_b32 v181, s66, v26
    v_lshlrev_b32 v182, 16, v27
    v_and_b32 v183, s66, v27
    v_and_b32 v10, 3, v1
    v_lshl_add_u32 v6, v10, 11, v5
    s_waitcnt vmcnt(8)
    v_perm_b32 v64, v130, v128, s67
    v_perm_b32 v65, v134, v132, s67
    v_perm_b32 v66, v138, v136, s67
    v_perm_b32 v67, v142, v140, s67
    v_perm_b32 v68, v130, v128, s68
    v_perm_b32 v69, v134, v132, s68
    v_perm_b32 v70, v138, v136, s68
    v_perm_b32 v71, v142, v140, s68
    v_perm_b32 v72, v131, v129, s67
    v_perm_b32 v73, v135, v133, s67
    v_perm_b32 v74, v139, v137, s67
    v_perm_b32 v75, v143, v141, s67
    v_perm_b32 v76, v131, v129, s68
    v_perm_b32 v77, v135, v133, s68
    v_perm_b32 v78, v139, v137, s68
    v_perm_b32 v79, v143, v141, s68
    v_perm_b32 v80, v146, v144, s67
    v_perm_b32 v81, v150, v148, s67
    v_perm_b32 v82, v154, v152, s67
    v_perm_b32 v83, v158, v156, s67
    v_perm_b32 v84, v146, v144, s68
    v_perm_b32 v85, v150, v148, s68
    v_perm_b32 v86, v154, v152, s68
    v_perm_b32 v87, v158, v156, s68
    v_perm_b32 v88, v147, v145, s67
    v_perm_b32 v89, v151, v149, s67
    v_perm_b32 v90, v155, v153, s67
    v_perm_b32 v91, v159, v157, s67
    v_perm_b32 v92, v147, v145, s68
    v_perm_b32 v93, v151, v149, s68
    v_perm_b32 v94, v155, v153, s68
    v_perm_b32 v95, v159, v157, s68
    v_perm_b32 v96, v226, v224, s67
    v_perm_b32 v97, v230, v228, s67
    v_perm_b32 v98, v234, v232, s67
    v_perm_b32 v99, v238, v236, s67
    v_perm_b32 v100, v226, v224, s68
    v_perm_b32 v101, v230, v228, s68
    v_perm_b32 v102, v234, v232, s68
    v_perm_b32 v103, v238, v236, s68
    v_perm_b32 v104, v227, v225, s67
    v_perm_b32 v105, v231, v229, s67
    v_perm_b32 v106, v235, v233, s67
    v_perm_b32 v107, v239, v237, s67
    v_perm_b32 v108, v227, v225, s68
    v_perm_b32 v109, v231, v229, s68
    v_perm_b32 v110, v235, v233, s68
    v_perm_b32 v111, v239, v237, s68
    v_perm_b32 v112, v242, v240, s67
    v_perm_b32 v113, v246, v244, s67
    v_perm_b32 v114, v250, v248, s67
    v_perm_b32 v115, v254, v252, s67
    v_perm_b32 v116, v242, v240, s68
    v_perm_b32 v117, v246, v244, s68
    v_perm_b32 v118, v250, v248, s68
    v_perm_b32 v119, v254, v252, s68
    v_perm_b32 v120, v243, v241, s67
    v_perm_b32 v121, v247, v245, s67
    v_perm_b32 v122, v251, v249, s67
    v_perm_b32 v123, v255, v253, s67
    v_perm_b32 v124, v243, v241, s68
    v_perm_b32 v125, v247, v245, s68
    v_perm_b32 v126, v251, v249, s68
    v_perm_b32 v127, v255, v253, s68
    v_mov_b32 v48, 0
    v_mov_b32 v49, 0
    v_mov_b32 v50, 0
    v_mov_b32 v51, 0
    v_mov_b32 v52, 0
    v_mov_b32 v53, 0
    v_mov_b32 v54, 0
    v_mov_b32 v55, 0
    v_mov_b32 v56, 0
    v_mov_b32 v57, 0
    v_mov_b32 v58, 0
    v_mov_b32 v59, 0
    v_mov_b32 v60, 0
    v_mov_b32 v61, 0
    v_mov_b32 v62, 0
    v_mov_b32 v63, 0
    v_lshrrev_b32 v224, 16, v160
    v_and_b32 v228, s66, v164
    v_lshrrev_b32 v240, 16, v176
    v_mov_b32 v244, v180
    v_lshrrev_b32 v225, 16, v161
    v_and_b32 v229, s66, v165
    v_lshrrev_b32 v241, 16, v177
    v_mov_b32 v245, v181
    v_lshrrev_b32 v226, 16, v162
    v_and_b32 v230, s66, v166
    v_lshrrev_b32 v242, 16, v178
    v_mov_b32 v246, v182
    v_lshrrev_b32 v227, 16, v163
    v_and_b32 v231, s66, v167
    v_lshrrev_b32 v243, 16, v179
    v_mov_b32 v247, v183
    v_mov_b32 v232, v168
    v_mov_b32 v233, v169
    v_mov_b32 v234, v170
    v_mov_b32 v235, v171
    v_mov_b32 v236, v172
    v_mov_b32 v237, v173
    v_mov_b32 v238, v174
    v_mov_b32 v239, v175
    s_waitcnt vmcnt(0)
    v_perm_b32 v128, v196, v192, s67
    v_perm_b32 v129, v204, v200, s67
    v_perm_b32 v130, v212, v208, s67
    v_perm_b32 v131, v220, v216, s67
    v_perm_b32 v132, v196, v192, s68
    v_perm_b32 v133, v204, v200, s68
    v_perm_b32 v134, v212, v208, s68
    v_perm_b32 v135, v220, v216, s68
    v_perm_b32 v136, v197, v193, s67
    v_perm_b32 v137, v205, v201, s67
    v_perm_b32 v138, v213, v209, s67
    v_perm_b32 v139, v221, v217, s67
    v_perm_b32 v140, v197, v193, s68
    v_perm_b32 v141, v205, v201, s68
    v_perm_b32 v142, v213, v209, s68
    v_perm_b32 v143, v221, v217, s68
    v_perm_b32 v144, v198, v194, s67
    v_perm_b32 v145, v206, v202, s67
    v_perm_b32 v146, v214, v210, s67
    v_perm_b32 v147, v222, v218, s67
    v_perm_b32 v148, v198, v194, s68
    v_perm_b32 v149, v206, v202, s68
    v_perm_b32 v150, v214, v210, s68
    v_perm_b32 v151, v222, v218, s68
    v_perm_b32 v152, v199, v195, s67
    v_perm_b32 v153, v207, v203, s67
    v_perm_b32 v154, v215, v211, s67
    v_perm_b32 v155, v223, v219, s67
    v_perm_b32 v156, v199, v195, s68
    v_perm_b32 v157, v207, v203, s68
    v_perm_b32 v158, v215, v211, s68
    v_perm_b32 v159, v223, v219, s68
    v_mov_b32 v16, 0
    v_mov_b32 v17, 0
    v_mov_b32 v18, 0
    v_mov_b32 v19, 0
    v_mov_b32 v20, 0
    v_mov_b32 v21, 0
    v_mov_b32 v22, 0
    v_mov_b32 v23, 0
    v_mov_b32 v9, 0xffff
    v_mov_b32 v3, 0
    s_mov_b32 s74, 0xfffffeff
    s_mov_b32 s75, 0x200000
    s_mov_b32 s62, 0x40000
    s_and_b32 s64, s2, 0
    s_lshl_b32 s64, s64, 16
    s_add_u32 s75, s75, s64
    s_mov_b32 exec_lo, 0x33333333
    s_mov_b32 exec_hi, 0x33333333
    v_mov_b32 v9, 0
    s_mov_b32 exec_lo, 0xcccccccc
    s_mov_b32 exec_hi, 0xcccccccc
    buffer_load_dwordx4 v[160:163], v6, s[12:15], s75 offen offset:0 sc1
    buffer_load_dwordx4 v[164:167], v6, s[12:15], s75 offen offset:256 sc1
    s_add_u32 s61, s75, 0x2000
    buffer_load_dwordx4 v[168:171], v6, s[12:15], s61 offen offset:0 sc1
    buffer_load_dwordx4 v[172:175], v6, s[12:15], s61 offen offset:256 sc1
    s_add_u32 s61, s75, 0x4000
    buffer_load_dwordx4 v[176:179], v6, s[12:15], s61 offen offset:0 sc1
    buffer_load_dwordx4 v[180:183], v6, s[12:15], s61 offen offset:256 sc1
    s_add_u32 s61, s75, 0x6000
    buffer_load_dwordx4 v[184:187], v6, s[12:15], s61 offen offset:0 sc1
    buffer_load_dwordx4 v[188:191], v6, s[12:15], s61 offen offset:256 sc1
    s_add_u32 s61, s75, 0x8000
    buffer_load_dwordx4 v[192:195], v6, s[12:15], s61 offen offset:0 sc1
    buffer_load_dwordx4 v[196:199], v6, s[12:15], s61 offen offset:256 sc1
    s_add_u32 s61, s75, 0xa000
    buffer_load_dwordx4 v[200:203], v6, s[12:15], s61 offen offset:0 sc1
    buffer_load_dwordx4 v[204:207], v6, s[12:15], s61 offen offset:256 sc1
    s_add_u32 s61, s75, 0xc000
    buffer_load_dwordx4 v[208:211], v6, s[12:15], s61 offen offset:0 sc1
    buffer_load_dwordx4 v[212:215], v6, s[12:15], s61 offen offset:256 sc1
    s_add_u32 s61, s75, 0xe000
    buffer_load_dwordx4 v[216:219], v6, s[12:15], s61 offen offset:0 sc1
    buffer_load_dwordx4 v[220:223], v6, s[12:15], s61 offen offset:256 sc1
    s_mov_b64 exec, -1
    v_mov_b32 v248, 0x3e800000
    v_mov_b32 v249, 0x3b000000
    v_and_b32 v11, 3, v1
    v_lshlrev_b32 v2, 5, v11
    s_lshl_b32 s61, s3, 3
    v_add_u32 v7, s61, v2
    v_lshrrev_b32 v10, 4, v1
    v_add_u32 v10, v10, v1
    v_and_b32 v10, 3, v10
    v_and_b32 v11, 60, v1
    v_or_b32 v10, v10, v11
    v_lshlrev_b32 v10, 4, v10
    s_lshl_b32 s61, s3, 10
    v_add_u32 v8, s61, v10
    v_bfe_u32 v10, v1, 3, 1
    v_lshlrev_b32 v10, 3, v10
    v_lshrrev_b32 v12, 4, v1
    v_lshl_add_u32 v10, v12, 1, v10
    v_bfe_u32 v13, v1, 2, 1
    v_add_u32 v10, v10, v13
    v_lshrrev_b32 v13, 2, v10
    v_add_u32 v13, v13, v1
    v_and_b32 v13, 3, v13
    v_lshl_or_b32 v10, v10, 2, v13
    v_lshlrev_b32 v14, 4, v10
    v_bfe_u32 v10, v1, 2, 2
    v_lshl_add_u32 v10, v12, 3, v10
    v_mul_u32_u24 v10, 0xe00, v10
    v_and_b32 v11, 3, v1
    v_lshl_add_u32 v10, v11, 4, v10
    s_mul_i32 s64, s3, 114688
    s_lshl_b32 s61, s63, 6
    s_add_u32 s64, s64, s61
    v_add_u32 v15, s64, v10
    s_waitcnt vmcnt(14)
    v_xor_b32 v10, s58, v160
    v_bitop3_b32 v10, v161, s58, v10 bitop3:0xbe
    v_bitop3_b32 v10, v162, s58, v10 bitop3:0xbe
    v_bitop3_b32 v10, v163, s58, v10 bitop3:0xbe
    v_bitop3_b32 v10, v164, s58, v10 bitop3:0xbe
    v_bitop3_b32 v10, v165, s58, v10 bitop3:0xbe
    v_bitop3_b32 v10, v166, s58, v10 bitop3:0xbe
    v_bitop3_b32 v10, v167, s58, v10 bitop3:0xbe
    v_and_b32 v10, 0xff, v10
    v_cmp_eq_u32 vcc, 0, v10
    s_and_b32 exec_lo, vcc_lo, 0xcccccccc
    s_and_b32 exec_hi, vcc_hi, 0xcccccccc
    v_pk_add_f32 v[16:17], v[16:17], v[160:161]
    v_pk_add_f32 v[18:19], v[18:19], v[162:163]
    v_pk_add_f32 v[20:21], v[20:21], v[164:165]
    v_pk_add_f32 v[22:23], v[22:23], v[166:167]
    v_xor_b32 v9, 0x101, v9
    s_mov_b64 exec, -1
    s_waitcnt vmcnt(12)
    v_xor_b32 v10, s58, v168
    v_bitop3_b32 v10, v169, s58, v10 bitop3:0xbe
    v_bitop3_b32 v10, v170, s58, v10 bitop3:0xbe
    v_bitop3_b32 v10, v171, s58, v10 bitop3:0xbe
    v_bitop3_b32 v10, v172, s58, v10 bitop3:0xbe
    v_bitop3_b32 v10, v173, s58, v10 bitop3:0xbe
    v_bitop3_b32 v10, v174, s58, v10 bitop3:0xbe
    v_bitop3_b32 v10, v175, s58, v10 bitop3:0xbe
    v_and_b32 v10, 0xff, v10
    v_cmp_eq_u32 vcc, 0, v10
    s_and_b32 exec_lo, vcc_lo, 0xcccccccc
    s_and_b32 exec_hi, vcc_hi, 0xcccccccc
    v_pk_add_f32 v[16:17], v[16:17], v[168:169]
    v_pk_add_f32 v[18:19], v[18:19], v[170:171]
    v_pk_add_f32 v[20:21], v[20:21], v[172:173]
    v_pk_add_f32 v[22:23], v[22:23], v[174:175]
    v_xor_b32 v9, 0x202, v9
    s_mov_b64 exec, -1
    s_waitcnt vmcnt(10)
    v_xor_b32 v10, s58, v176
    v_bitop3_b32 v10, v177, s58, v10 bitop3:0xbe
    v_bitop3_b32 v10, v178, s58, v10 bitop3:0xbe
    v_bitop3_b32 v10, v179, s58, v10 bitop3:0xbe
    v_bitop3_b32 v10, v180, s58, v10 bitop3:0xbe
    v_bitop3_b32 v10, v181, s58, v10 bitop3:0xbe
    v_bitop3_b32 v10, v182, s58, v10 bitop3:0xbe
    v_bitop3_b32 v10, v183, s58, v10 bitop3:0xbe
    v_and_b32 v10, 0xff, v10
    v_cmp_eq_u32 vcc, 0, v10
    s_and_b32 exec_lo, vcc_lo, 0xcccccccc
    s_and_b32 exec_hi, vcc_hi, 0xcccccccc
    v_pk_add_f32 v[16:17], v[16:17], v[176:177]
    v_pk_add_f32 v[18:19], v[18:19], v[178:179]
    v_pk_add_f32 v[20:21], v[20:21], v[180:181]
    v_pk_add_f32 v[22:23], v[22:23], v[182:183]
    v_xor_b32 v9, 0x404, v9
    s_mov_b64 exec, -1
    s_waitcnt vmcnt(8)
    v_xor_b32 v10, s58, v184
    v_bitop3_b32 v10, v185, s58, v10 bitop3:0xbe
    v_bitop3_b32 v10, v186, s58, v10 bitop3:0xbe
    v_bitop3_b32 v10, v187, s58, v10 bitop3:0xbe
    v_bitop3_b32 v10, v188, s58, v10 bitop3:0xbe
    v_bitop3_b32 v10, v189, s58, v10 bitop3:0xbe
    v_bitop3_b32 v10, v190, s58, v10 bitop3:0xbe
    v_bitop3_b32 v10, v191, s58, v10 bitop3:0xbe
    v_and_b32 v10, 0xff, v10
    v_cmp_eq_u32 vcc, 0, v10
    s_and_b32 exec_lo, vcc_lo, 0xcccccccc
    s_and_b32 exec_hi, vcc_hi, 0xcccccccc
    v_pk_add_f32 v[16:17], v[16:17], v[184:185]
    v_pk_add_f32 v[18:19], v[18:19], v[186:187]
    v_pk_add_f32 v[20:21], v[20:21], v[188:189]
    v_pk_add_f32 v[22:23], v[22:23], v[190:191]
    v_xor_b32 v9, 0x808, v9
    s_mov_b64 exec, -1
    s_waitcnt vmcnt(6)
    v_xor_b32 v10, s58, v192
    v_bitop3_b32 v10, v193, s58, v10 bitop3:0xbe
    v_bitop3_b32 v10, v194, s58, v10 bitop3:0xbe
    v_bitop3_b32 v10, v195, s58, v10 bitop3:0xbe
    v_bitop3_b32 v10, v196, s58, v10 bitop3:0xbe
    v_bitop3_b32 v10, v197, s58, v10 bitop3:0xbe
    v_bitop3_b32 v10, v198, s58, v10 bitop3:0xbe
    v_bitop3_b32 v10, v199, s58, v10 bitop3:0xbe
    v_and_b32 v10, 0xff, v10
    v_cmp_eq_u32 vcc, 0, v10
    s_and_b32 exec_lo, vcc_lo, 0xcccccccc
    s_and_b32 exec_hi, vcc_hi, 0xcccccccc
    v_pk_add_f32 v[16:17], v[16:17], v[192:193]
    v_pk_add_f32 v[18:19], v[18:19], v[194:195]
    v_pk_add_f32 v[20:21], v[20:21], v[196:197]
    v_pk_add_f32 v[22:23], v[22:23], v[198:199]
    v_xor_b32 v9, 0x1010, v9
    s_mov_b64 exec, -1
    s_waitcnt vmcnt(4)
    v_xor_b32 v10, s58, v200
    v_bitop3_b32 v10, v201, s58, v10 bitop3:0xbe
    v_bitop3_b32 v10, v202, s58, v10 bitop3:0xbe
    v_bitop3_b32 v10, v203, s58, v10 bitop3:0xbe
    v_bitop3_b32 v10, v204, s58, v10 bitop3:0xbe
    v_bitop3_b32 v10, v205, s58, v10 bitop3:0xbe
    v_bitop3_b32 v10, v206, s58, v10 bitop3:0xbe
    v_bitop3_b32 v10, v207, s58, v10 bitop3:0xbe
    v_and_b32 v10, 0xff, v10
    v_cmp_eq_u32 vcc, 0, v10
    s_and_b32 exec_lo, vcc_lo, 0xcccccccc
    s_and_b32 exec_hi, vcc_hi, 0xcccccccc
    v_pk_add_f32 v[16:17], v[16:17], v[200:201]
    v_pk_add_f32 v[18:19], v[18:19], v[202:203]
    v_pk_add_f32 v[20:21], v[20:21], v[204:205]
    v_pk_add_f32 v[22:23], v[22:23], v[206:207]
    v_xor_b32 v9, 0x2020, v9
    s_mov_b64 exec, -1
    s_waitcnt vmcnt(2)
    v_xor_b32 v10, s58, v208
    v_bitop3_b32 v10, v209, s58, v10 bitop3:0xbe
    v_bitop3_b32 v10, v210, s58, v10 bitop3:0xbe
    v_bitop3_b32 v10, v211, s58, v10 bitop3:0xbe
    v_bitop3_b32 v10, v212, s58, v10 bitop3:0xbe
    v_bitop3_b32 v10, v213, s58, v10 bitop3:0xbe
    v_bitop3_b32 v10, v214, s58, v10 bitop3:0xbe
    v_bitop3_b32 v10, v215, s58, v10 bitop3:0xbe
    v_and_b32 v10, 0xff, v10
    v_cmp_eq_u32 vcc, 0, v10
    s_and_b32 exec_lo, vcc_lo, 0xcccccccc
    s_and_b32 exec_hi, vcc_hi, 0xcccccccc
    v_pk_add_f32 v[16:17], v[16:17], v[208:209]
    v_pk_add_f32 v[18:19], v[18:19], v[210:211]
    v_pk_add_f32 v[20:21], v[20:21], v[212:213]
    v_pk_add_f32 v[22:23], v[22:23], v[214:215]
    v_xor_b32 v9, 0x4040, v9
    s_mov_b64 exec, -1
    s_waitcnt vmcnt(0)
    v_xor_b32 v10, s58, v216
    v_bitop3_b32 v10, v217, s58, v10 bitop3:0xbe
    v_bitop3_b32 v10, v218, s58, v10 bitop3:0xbe
    v_bitop3_b32 v10, v219, s58, v10 bitop3:0xbe
    v_bitop3_b32 v10, v220, s58, v10 bitop3:0xbe
    v_bitop3_b32 v10, v221, s58, v10 bitop3:0xbe
    v_bitop3_b32 v10, v222, s58, v10 bitop3:0xbe
    v_bitop3_b32 v10, v223, s58, v10 bitop3:0xbe
    v_and_b32 v10, 0xff, v10
    v_cmp_eq_u32 vcc, 0, v10
    s_and_b32 exec_lo, vcc_lo, 0xcccccccc
    s_and_b32 exec_hi, vcc_hi, 0xcccccccc
    v_pk_add_f32 v[16:17], v[16:17], v[216:217]
    v_pk_add_f32 v[18:19], v[18:19], v[218:219]
    v_pk_add_f32 v[20:21], v[20:21], v[220:221]
    v_pk_add_f32 v[22:23], v[22:23], v[222:223]
    v_xor_b32 v9, 0x8080, v9
    s_mov_b64 exec, -1
    v_cmp_ne_u32 vcc, 0, v9
    s_mov_b64 exec, vcc
    s_cbranch_execz RD_Gm2
    v_lshrrev_b32 v11, v3, v9
    v_ffbl_b32 v11, v11
    v_add_u32 v11, v11, v3
    v_and_b32 v24, 7, v11
    v_add_u32 v3, 1, v24
    v_lshl_add_u32 v11, v24, 13, v6
    buffer_load_dwordx4 v[160:163], v11, s[12:15], s75 offen offset:0 sc1
    buffer_load_dwordx4 v[164:167], v11, s[12:15], s75 offen offset:256 sc1
    v_lshrrev_b32 v11, v3, v9
    v_ffbl_b32 v11, v11
    v_add_u32 v11, v11, v3
    v_and_b32 v25, 7, v11
    v_add_u32 v3, 1, v25
    v_lshl_add_u32 v11, v25, 13, v6
    buffer_load_dwordx4 v[168:171], v11, s[12:15], s75 offen offset:0 sc1
    buffer_load_dwordx4 v[172:175], v11, s[12:15], s75 offen offset:256 sc1
    v_lshrrev_b32 v11, v3, v9
    v_ffbl_b32 v11, v11
    v_add_u32 v11, v11, v3
    v_and_b32 v26, 7, v11
    v_add_u32 v3, 1, v26
    v_lshl_add_u32 v11, v26, 13, v6
    buffer_load_dwordx4 v[176:179], v11, s[12:15], s75 offen offset:0 sc1
    buffer_load_dwordx4 v[180:183], v11, s[12:15], s75 offen offset:256 sc1
RL_Gm2:
    v_lshrrev_b32 v11, v3, v9
    v_ffbl_b32 v11, v11
    v_add_u32 v11, v11, v3
    v_and_b32 v27, 7, v11
    v_add_u32 v3, 1, v27
    v_lshl_add_u32 v11, v27, 13, v6
    buffer_load_dwordx4 v[184:187], v11, s[12:15], s75 offen offset:0 sc1
    buffer_load_dwordx4 v[188:191], v11, s[12:15], s75 offen offset:256 sc1
    v_bfe_u32 v12, v9, v24, 1
    s_waitcnt vmcnt(6)
    v_xor_b32 v10, s58, v160
    v_bitop3_b32 v10, v161, s58, v10 bitop3:0xbe
    v_bitop3_b32 v10, v162, s58, v10 bitop3:0xbe
    v_bitop3_b32 v10, v163, s58, v10 bitop3:0xbe
    v_bitop3_b32 v10, v164, s58, v10 bitop3:0xbe
    v_bitop3_b32 v10, v165, s58, v10 bitop3:0xbe
    v_bitop3_b32 v10, v166, s58, v10 bitop3:0xbe
    v_bitop3_b32 v10, v167, s58, v10 bitop3:0xbe
    v_and_b32 v10, 0xff, v10
    v_cmp_lt_u32 vcc, v10, v12
    s_and_saveexec_b64 s[72:73], vcc
    v_pk_add_f32 v[16:17], v[16:17], v[160:161]
    v_pk_add_f32 v[18:19], v[18:19], v[162:163]
    v_pk_add_f32 v[20:21], v[20:21], v[164:165]
    v_pk_add_f32 v[22:23], v[22:23], v[166:167]
    v_lshl_add_u32 v9, s74, v24, v9
    s_mov_b64 exec, s[72:73]
    v_cmp_ne_u32 vcc, 0, v9
    s_mov_b64 exec, vcc
    s_cbranch_execz RD_Gm2
    v_lshrrev_b32 v11, v3, v9
    v_ffbl_b32 v11, v11
    v_add_u32 v11, v11, v3
    v_and_b32 v24, 7, v11
    v_add_u32 v3, 1, v24
    v_lshl_add_u32 v11, v24, 13, v6
    buffer_load_dwordx4 v[160:163], v11, s[12:15], s75 offen offset:0 sc1
    buffer_load_dwordx4 v[164:167], v11, s[12:15], s75 offen offset:256 sc1
    v_bfe_u32 v12, v9, v25, 1
    s_waitcnt vmcnt(6)
    v_xor_b32 v10, s58, v168
    v_bitop3_b32 v10, v169, s58, v10 bitop3:0xbe
    v_bitop3_b32 v10, v170, s58, v10 bitop3:0xbe
    v_bitop3_b32 v10, v171, s58, v10 bitop3:0xbe
    v_bitop3_b32 v10, v172, s58, v10 bitop3:0xbe
    v_bitop3_b32 v10, v173, s58, v10 bitop3:0xbe
    v_bitop3_b32 v10, v174, s58, v10 bitop3:0xbe
    v_bitop3_b32 v10, v175, s58, v10 bitop3:0xbe
    v_and_b32 v10, 0xff, v10
    v_cmp_lt_u32 vcc, v10, v12
    s_and_saveexec_b64 s[72:73], vcc
    v_pk_add_f32 v[16:17], v[16:17], v[168:169]
    v_pk_add_f32 v[18:19], v[18:19], v[170:171]
    v_pk_add_f32 v[20:21], v[20:21], v[172:173]
    v_pk_add_f32 v[22:23], v[22:23], v[174:175]
    v_lshl_add_u32 v9, s74, v25, v9
    s_mov_b64 exec, s[72:73]
    v_cmp_ne_u32 vcc, 0, v9
    s_mov_b64 exec, vcc
    s_cbranch_execz RD_Gm2
    v_lshrrev_b32 v11, v3, v9
    v_ffbl_b32 v11, v11
    v_add_u32 v11, v11, v3
    v_and_b32 v25, 7, v11
    v_add_u32 v3, 1, v25
    v_lshl_add_u32 v11, v25, 13, v6
    buffer_load_dwordx4 v[168:171], v11, s[12:15], s75 offen offset:0 sc1
    buffer_load_dwordx4 v[172:175], v11, s[12:15], s75 offen offset:256 sc1
    v_bfe_u32 v12, v9, v26, 1
    s_waitcnt vmcnt(6)
    v_xor_b32 v10, s58, v176
    v_bitop3_b32 v10, v177, s58, v10 bitop3:0xbe
    v_bitop3_b32 v10, v178, s58, v10 bitop3:0xbe
    v_bitop3_b32 v10, v179, s58, v10 bitop3:0xbe
    v_bitop3_b32 v10, v180, s58, v10 bitop3:0xbe
    v_bitop3_b32 v10, v181, s58, v10 bitop3:0xbe
    v_bitop3_b32 v10, v182, s58, v10 bitop3:0xbe
    v_bitop3_b32 v10, v183, s58, v10 bitop3:0xbe
    v_and_b32 v10, 0xff, v10
    v_cmp_lt_u32 vcc, v10, v12
    s_and_saveexec_b64 s[72:73], vcc
    v_pk_add_f32 v[16:17], v[16:17], v[176:177]
    v_pk_add_f32 v[18:19], v[18:19], v[178:179]
    v_pk_add_f32 v[20:21], v[20:21], v[180:181]
    v_pk_add_f32 v[22:23], v[22:23], v[182:183]
    v_lshl_add_u32 v9, s74, v26, v9
    s_mov_b64 exec, s[72:73]
    v_cmp_ne_u32 vcc, 0, v9
    s_mov_b64 exec, vcc
    s_cbranch_execz RD_Gm2
    v_lshrrev_b32 v11, v3, v9
    v_ffbl_b32 v11, v11
    v_add_u32 v11, v11, v3
    v_and_b32 v26, 7, v11
    v_add_u32 v3, 1, v26
    v_lshl_add_u32 v11, v26, 13, v6
    buffer_load_dwordx4 v[176:179], v11, s[12:15], s75 offen offset:0 sc1
    buffer_load_dwordx4 v[180:183], v11, s[12:15], s75 offen offset:256 sc1
    v_bfe_u32 v12, v9, v27, 1
    s_waitcnt vmcnt(6)
    v_xor_b32 v10, s58, v184
    v_bitop3_b32 v10, v185, s58, v10 bitop3:0xbe
    v_bitop3_b32 v10, v186, s58, v10 bitop3:0xbe
    v_bitop3_b32 v10, v187, s58, v10 bitop3:0xbe
    v_bitop3_b32 v10, v188, s58, v10 bitop3:0xbe
    v_bitop3_b32 v10, v189, s58, v10 bitop3:0xbe
    v_bitop3_b32 v10, v190, s58, v10 bitop3:0xbe
    v_bitop3_b32 v10, v191, s58, v10 bitop3:0xbe
    v_and_b32 v10, 0xff, v10
    v_cmp_lt_u32 vcc, v10, v12
    s_and_saveexec_b64 s[72:73], vcc
    v_pk_add_f32 v[16:17], v[16:17], v[184:185]
    v_pk_add_f32 v[18:19], v[18:19], v[186:187]
    v_pk_add_f32 v[20:21], v[20:21], v[188:189]
    v_pk_add_f32 v[22:23], v[22:23], v[190:191]
    v_lshl_add_u32 v9, s74, v27, v9
    s_mov_b64 exec, s[72:73]
    v_cmp_ne_u32 vcc, 0, v9
    s_mov_b64 exec, vcc
    s_cbranch_execz RD_Gm2
    s_sub_u32 s62, s62, 1
    s_cbranch_scc0 RL_Gm2
RD_Gm2:
    s_mov_b64 exec, -1
    v_cvt_pk_bf16_f32 v24, v16, v20
    v_cvt_pk_bf16_f32 v25, v17, v21
    v_cvt_pk_bf16_f32 v26, v18, v22
    v_cvt_pk_bf16_f32 v27, v19, v23
    v_dot2_f32_bf16 v16, v24, v224, 0
    v_dot2_f32_bf16 v17, v25, v225, 0
    v_dot2_f32_bf16 v18, v26, v226, 0
    v_dot2_f32_bf16 v19, v27, v227, 0
    v_dot2_f32_bf16 v20, v24, v228, 0
    v_dot2_f32_bf16 v21, v25, v229, 0
    v_dot2_f32_bf16 v22, v26, v230, 0
    v_dot2_f32_bf16 v23, v27, v231, 0
    v_cvt_pk_bf16_f32 v24, v16, v20
    v_cvt_pk_bf16_f32 v25, v17, v21
    v_cvt_pk_bf16_f32 v26, v18, v22
    v_cvt_pk_bf16_f32 v27, v19, v23
    v_dot2_f32_bf16 v16, v24, s76, v40
    v_dot2_f32_bf16 v17, v25, s76, v41
    v_dot2_f32_bf16 v18, v26, s76, v42
    v_dot2_f32_bf16 v19, v27, s76, v43
    v_dot2_f32_bf16 v20, v24, s77, v44
    v_dot2_f32_bf16 v21, v25, s77, v45
    v_dot2_f32_bf16 v22, v26, s77, v46
    v_dot2_f32_bf16 v23, v27, s77, v47
    v_cvt_pk_bf16_f32 v24, v16, v20
    v_cvt_pk_bf16_f32 v25, v17, v21
    v_cvt_pk_bf16_f32 v26, v18, v22
    v_cvt_pk_bf16_f32 v27, v19, v23
    v_dot2_f32_bf16 v28, v24, s78, 0
    v_dot2_f32_bf16 v28, v25, s78, v28
    v_dot2_f32_bf16 v28, v26, s78, v28
    v_dot2_f32_bf16 v28, v27, s78, v28
    s_nop 2
    v_add_f32_dpp v28, v28, v28 row_ror:4 row_mask:0xf bank_mask:0xf
    s_nop 1
    v_add_f32_dpp v28, v28, v28 row_ror:8 row_mask:0xf bank_mask:0xf
    v_mov_b32 v30, v28
    s_nop 1
    v_permlane16_swap_b32 v28, v30
    v_add_f32 v28, v28, v30
    v_mov_b32 v30, v28
    s_nop 1
    v_permlane32_swap_b32 v28, v30
    v_add_f32 v28, v28, v30
    v_mul_f32 v28, 0xbc000000, v28
    v_dot2_f32_bf16 v16, v24, s76, v28
    v_dot2_f32_bf16 v17, v25, s76, v28
    v_dot2_f32_bf16 v18, v26, s76, v28
    v_dot2_f32_bf16 v19, v27, s76, v28
    v_dot2_f32_bf16 v20, v24, s77, v28
    v_dot2_f32_bf16 v21, v25, s77, v28
    v_dot2_f32_bf16 v22, v26, s77, v28
    v_dot2_f32_bf16 v23, v27, s77, v28
    v_pk_mul_f32 v[30:31], v[16:17], v[16:17]
    v_pk_fma_f32 v[30:31], v[18:19], v[18:19], v[30:31]
    v_pk_fma_f32 v[30:31], v[20:21], v[20:21], v[30:31]
    v_pk_fma_f32 v[30:31], v[22:23], v[22:23], v[30:31]
    v_add_f32 v29, v30, v31
    s_nop 1
    v_add_f32_dpp v29, v29, v29 row_ror:4 row_mask:0xf bank_mask:0xf
    s_nop 1
    v_add_f32_dpp v29, v29, v29 row_ror:8 row_mask:0xf bank_mask:0xf
    v_mov_b32 v30, v29
    s_nop 1
    v_permlane16_swap_b32 v29, v30
    v_add_f32 v29, v29, v30
    v_mov_b32 v30, v29
    s_nop 1
    v_permlane32_swap_b32 v29, v30
    v_add_f32 v29, v29, v30
    s_mov_b64 exec, 0xf
    ds_write_b64 v7, v[28:29] offset:27072
    s_mov_b64 exec, -1
    s_waitcnt lgkmcnt(0)
    s_barrier
    ds_read_b128 v[32:35], v2 offset:27072
    ds_read_b128 v[36:39], v2 offset:27088
    s_waitcnt lgkmcnt(0)
    v_pk_add_f32 v[28:29], v[32:33], v[34:35]
    v_pk_add_f32 v[30:31], v[36:37], v[38:39]
    v_pk_add_f32 v[28:29], v[28:29], v[30:31]
    v_pk_mul_f32 v[28:29], v[28:29], v[248:249]
    v_mul_f32 v30, -0.5, v28
    v_fma_f32 v32, v32, 0.5, v30
    v_fma_f32 v34, v34, 0.5, v30
    v_fma_f32 v36, v36, 0.5, v30
    v_fma_f32 v38, v38, 0.5, v30
    v_fmac_f32 v29, v32, v32
    v_fmac_f32 v29, v34, v34
    v_fmac_f32 v29, v36, v36
    v_fmac_f32 v29, v38, v38
    v_cvt_pk_bf16_f32 v30, v28, v29
    v_and_b32 v29, s66, v30
    v_lshlrev_b32 v28, 16, v30
    v_add_f32 v29, s71, v29
    v_cvt_pk_bf16_f32 v29, v29, v29
    v_dot2_f32_bf16 v16, v24, s76, v28
    v_and_b32 v29, s66, v29
    v_dot2_f32_bf16 v17, v25, s76, v28
    v_sqrt_f32 v29, v29
    v_dot2_f32_bf16 v18, v26, s76, v28
    v_dot2_f32_bf16 v19, v27, s76, v28
    v_cvt_pk_bf16_f32 v29, v29, v29
    v_dot2_f32_bf16 v20, v24, s77, v28
    v_and_b32 v29, s66, v29
    v_dot2_f32_bf16 v21, v25, s77, v28
    v_rcp_f32 v30, v29
    v_dot2_f32_bf16 v22, v26, s77, v28
    v_dot2_f32_bf16 v23, v27, s77, v28
    v_cvt_pk_bf16_f32 v24, v16, v20
    v_cvt_pk_bf16_f32 v25, v17, v21
    v_cvt_pk_bf16_f32 v26, v18, v22
    v_cvt_pk_bf16_f32 v27, v19, v23
    v_lshlrev_b32 v16, 16, v24
    v_and_b32 v20, s66, v24
    v_lshlrev_b32 v17, 16, v25
    v_and_b32 v21, s66, v25
    v_lshlrev_b32 v18, 16, v26
    v_and_b32 v22, s66, v26
    v_lshlrev_b32 v19, 16, v27
    v_and_b32 v23, s66, v27
    v_pk_mul_f32 v[16:17], v[16:17], v[30:31] op_sel_hi:[1,0]
    v_pk_mul_f32 v[20:21], v[20:21], v[30:31] op_sel_hi:[1,0]
    v_pk_mul_f32 v[18:19], v[18:19], v[30:31] op_sel_hi:[1,0]
    v_pk_mul_f32 v[22:23], v[22:23], v[30:31] op_sel_hi:[1,0]
    v_cvt_pk_bf16_f32 v24, v16, v20
    v_cvt_pk_bf16_f32 v25, v17, v21
    v_cvt_pk_bf16_f32 v26, v18, v22
    v_cvt_pk_bf16_f32 v27, v19, v23
    v_dot2_f32_bf16 v16, v24, v240, 0
    v_dot2_f32_bf16 v17, v25, v241, 0
    v_dot2_f32_bf16 v18, v26, v242, 0
    v_dot2_f32_bf16 v19, v27, v243, 0
    v_dot2_f32_bf16 v20, v24, v244, 0
    v_dot2_f32_bf16 v21, v25, v245, 0
    v_dot2_f32_bf16 v22, v26, v246, 0
    v_dot2_f32_bf16 v23, v27, v247, 0
    v_cvt_pk_bf16_f32 v24, v16, v20
    v_cvt_pk_bf16_f32 v25, v17, v21
    v_cvt_pk_bf16_f32 v26, v18, v22
    v_cvt_pk_bf16_f32 v27, v19, v23
    v_dot2_f32_bf16 v16, v24, s76, v232
    v_dot2_f32_bf16 v17, v25, s76, v233
    v_dot2_f32_bf16 v18, v26, s76, v234
    v_dot2_f32_bf16 v19, v27, s76, v235
    v_dot2_f32_bf16 v20, v24, s77, v236
    v_dot2_f32_bf16 v21, v25, s77, v237
    v_dot2_f32_bf16 v22, v26, s77, v238
    v_dot2_f32_bf16 v23, v27, s77, v239
    v_cvt_pk_bf16_f32 v24, v16, v20
    v_cvt_pk_bf16_f32 v25, v17, v21
    v_cvt_pk_bf16_f32 v26, v18, v22
    v_cvt_pk_bf16_f32 v27, v19, v23
    v_mov_b32_dpp v48, v24 quad_perm:[0,1,2,3] row_mask:0xf bank_mask:0x1
    v_mov_b32_dpp v49, v25 quad_perm:[0,1,2,3] row_mask:0xf bank_mask:0x1
    v_mov_b32_dpp v50, v26 quad_perm:[0,1,2,3] row_mask:0xf bank_mask:0x1
    v_mov_b32_dpp v51, v27 quad_perm:[0,1,2,3] row_mask:0xf bank_mask:0x1
    s_nop 1
    v_mfma_f32_16x16x32_bf16 v[192:195], v[64:67], v[48:51], 0
    v_mov_b32_dpp v52, v24 quad_perm:[0,1,2,3] row_mask:0xf bank_mask:0x2
    v_mov_b32_dpp v53, v25 quad_perm:[0,1,2,3] row_mask:0xf bank_mask:0x2
    v_mfma_f32_16x16x32_bf16 v[196:199], v[68:71], v[48:51], 0
    v_mov_b32_dpp v54, v26 quad_perm:[0,1,2,3] row_mask:0xf bank_mask:0x2
    v_mov_b32_dpp v55, v27 quad_perm:[0,1,2,3] row_mask:0xf bank_mask:0x2
    s_nop 1
    v_mfma_f32_16x16x32_bf16 v[192:195], v[80:83], v[52:55], v[192:195]
    v_mov_b32_dpp v56, v24 quad_perm:[0,1,2,3] row_mask:0xf bank_mask:0x4
    v_mov_b32_dpp v57, v25 quad_perm:[0,1,2,3] row_mask:0xf bank_mask:0x4
    v_mfma_f32_16x16x32_bf16 v[196:199], v[84:87], v[52:55], v[196:199]
    v_mov_b32_dpp v58, v26 quad_perm:[0,1,2,3] row_mask:0xf bank_mask:0x4
    v_mov_b32_dpp v59, v27 quad_perm:[0,1,2,3] row_mask:0xf bank_mask:0x4
    s_nop 1
    v_mfma_f32_16x16x32_bf16 v[192:195], v[96:99], v[56:59], v[192:195]
    v_mov_b32_dpp v60, v24 quad_perm:[0,1,2,3] row_mask:0xf bank_mask:0x8
    v_mov_b32_dpp v61, v25 quad_perm:[0,1,2,3] row_mask:0xf bank_mask:0x8
    v_mfma_f32_16x16x32_bf16 v[196:199], v[100:103], v[56:59], v[196:199]
    v_mov_b32_dpp v62, v26 quad_perm:[0,1,2,3] row_mask:0xf bank_mask:0x8
    v_mov_b32_dpp v63, v27 quad_perm:[0,1,2,3] row_mask:0xf bank_mask:0x8
    s_nop 1
    v_mfma_f32_16x16x32_bf16 v[192:195], v[112:115], v[60:63], v[192:195]
    v_mfma_f32_16x16x32_bf16 v[196:199], v[116:119], v[60:63], v[196:199]
    v_mfma_f32_16x16x32_bf16 v[200:203], v[72:75], v[48:51], 0
    v_mfma_f32_16x16x32_bf16 v[204:207], v[76:79], v[48:51], 0
    v_mfma_f32_16x16x32_bf16 v[200:203], v[88:91], v[52:55], v[200:203]
    v_mfma_f32_16x16x32_bf16 v[204:207], v[92:95], v[52:55], v[204:207]
    s_nop 2
    v_add_f32_dpp v208, v192, v192 row_shl:4 row_mask:0xf bank_mask:0x5
    v_add_f32_dpp v210, v193, v193 row_shl:4 row_mask:0xf bank_mask:0x5
    v_mfma_f32_16x16x32_bf16 v[200:203], v[104:107], v[56:59], v[200:203]
    v_add_f32_dpp v212, v194, v194 row_shl:4 row_mask:0xf bank_mask:0x5
    v_add_f32_dpp v214, v195, v195 row_shl:4 row_mask:0xf bank_mask:0x5
    v_mfma_f32_16x16x32_bf16 v[204:207], v[108:111], v[56:59], v[204:207]
    v_add_f32_dpp v208, v196, v196 row_shr:4 row_mask:0xf bank_mask:0xa
    v_add_f32_dpp v210, v197, v197 row_shr:4 row_mask:0xf bank_mask:0xa
    v_mfma_f32_16x16x32_bf16 v[200:203], v[120:123], v[60:63], v[200:203]
    v_add_f32_dpp v212, v198, v198 row_shr:4 row_mask:0xf bank_mask:0xa
    v_add_f32_dpp v214, v199, v199 row_shr:4 row_mask:0xf bank_mask:0xa
    v_mfma_f32_16x16x32_bf16 v[204:207], v[124:127], v[60:63], v[204:207]
    s_nop 4
    v_add_f32_dpp v209, v200, v200 row_shl:4 row_mask:0xf bank_mask:0x5
    v_add_f32_dpp v211, v201, v201 row_shl:4 row_mask:0xf bank_mask:0x5
    v_add_f32_dpp v213, v202, v202 row_shl:4 row_mask:0xf bank_mask:0x5
    v_add_f32_dpp v215, v203, v203 row_shl:4 row_mask:0xf bank_mask:0x5
    v_add_f32_dpp v209, v204, v204 row_shr:4 row_mask:0xf bank_mask:0xa
    v_add_f32_dpp v211, v205, v205 row_shr:4 row_mask:0xf bank_mask:0xa
    v_add_f32_dpp v213, v206, v206 row_shr:4 row_mask:0xf bank_mask:0xa
    v_add_f32_dpp v215, v207, v207 row_shr:4 row_mask:0xf bank_mask:0xa
    v_add_f32_dpp v216, v208, v208 row_shl:8 row_mask:0xf bank_mask:0x3
    v_add_f32_dpp v217, v210, v210 row_shl:8 row_mask:0xf bank_mask:0x3
    v_add_f32_dpp v218, v212, v212 row_shl:8 row_mask:0xf bank_mask:0x3
    v_add_f32_dpp v219, v214, v214 row_shl:8 row_mask:0xf bank_mask:0x3
    v_add_f32_dpp v216, v209, v209 row_shr:8 row_mask:0xf bank_mask:0xc
    v_add_f32_dpp v217, v211, v211 row_shr:8 row_mask:0xf bank_mask:0xc
    v_add_f32_dpp v218, v213, v213 row_shr:8 row_mask:0xf bank_mask:0xc
    v_add_f32_dpp v219, v215, v215 row_shr:8 row_mask:0xf bank_mask:0xc
    ds_write_b128 v8, v[216:219] offset:0
    s_waitcnt lgkmcnt(0)
    s_barrier
    ds_read_b128 v[16:19], v14 offset:0
    ds_read_b128 v[20:23], v14 offset:1024
    ds_read_b128 v[24:27], v14 offset:2048
    ds_read_b128 v[28:31], v14 offset:3072
    s_waitcnt lgkmcnt(2)
    v_pk_add_f32 v[16:17], v[16:17], v[20:21]
    v_pk_add_f32 v[18:19], v[18:19], v[22:23]
    s_waitcnt lgkmcnt(0)
    v_pk_add_f32 v[24:25], v[24:25], v[28:29]
    v_pk_add_f32 v[26:27], v[26:27], v[30:31]
    v_pk_add_f32 v[16:17], v[16:17], v[24:25]
    v_pk_add_f32 v[18:19], v[18:19], v[26:27]
    v_cvt_pk_bf16_f32 v20, v16, v17
    v_cvt_pk_bf16_f32 v21, v18, v19
    v_lshlrev_b32 v16, 16, v20
    v_and_b32 v17, s66, v20
    v_lshlrev_b32 v18, 16, v21
    v_and_b32 v19, s66, v21
    v_mul_f32_dpp v20, v16, v16 row_ror:8 row_mask:0xf bank_mask:0xf
    v_mul_f32_dpp v21, v17, v17 row_ror:8 row_mask:0xf bank_mask:0xf
    v_mul_f32_dpp v22, v18, v18 row_ror:8 row_mask:0xf bank_mask:0xf
    v_mul_f32_dpp v23, v19, v19 row_ror:8 row_mask:0xf bank_mask:0xf
    v_cvt_pk_bf16_f32 v16, v20, v21
    v_cvt_pk_bf16_f32 v17, v22, v23
    s_nop 0
    v_mov_b32_dpp v48, v16 quad_perm:[0,1,2,3] row_mask:0xf bank_mask:0x1
    v_mov_b32_dpp v49, v17 quad_perm:[0,1,2,3] row_mask:0xf bank_mask:0x1
    v_mov_b32_dpp v50, v16 row_ror:4 row_mask:0xf bank_mask:0x1
    v_mov_b32_dpp v51, v17 row_ror:4 row_mask:0xf bank_mask:0x1
    s_nop 1
    v_mfma_f32_16x16x32_bf16 v[192:195], v[128:131], v[48:51], 0
    v_mov_b32_dpp v52, v16 row_ror:4 row_mask:0xf bank_mask:0x2
    v_mov_b32_dpp v53, v17 row_ror:4 row_mask:0xf bank_mask:0x2
    v_mfma_f32_16x16x32_bf16 v[196:199], v[144:147], v[48:51], 0
    v_mov_b32_dpp v54, v16 quad_perm:[0,1,2,3] row_mask:0xf bank_mask:0x2
    v_mov_b32_dpp v55, v17 quad_perm:[0,1,2,3] row_mask:0xf bank_mask:0x2
    s_nop 1
    v_mfma_f32_16x16x32_bf16 v[192:195], v[132:135], v[52:55], v[192:195]
    v_mov_b32_dpp v56, v16 quad_perm:[0,1,2,3] row_mask:0xf bank_mask:0x4
    v_mov_b32_dpp v57, v17 quad_perm:[0,1,2,3] row_mask:0xf bank_mask:0x4
    v_mfma_f32_16x16x32_bf16 v[196:199], v[148:151], v[52:55], v[196:199]
    v_mov_b32_dpp v58, v16 row_ror:4 row_mask:0xf bank_mask:0x4
    v_mov_b32_dpp v59, v17 row_ror:4 row_mask:0xf bank_mask:0x4
    s_nop 1
    v_mfma_f32_16x16x32_bf16 v[192:195], v[136:139], v[56:59], v[192:195]
    v_mov_b32_dpp v60, v16 row_ror:4 row_mask:0xf bank_mask:0x8
    v_mov_b32_dpp v61, v17 row_ror:4 row_mask:0xf bank_mask:0x8
    v_mfma_f32_16x16x32_bf16 v[196:199], v[152:155], v[56:59], v[196:199]
    v_mov_b32_dpp v62, v16 quad_perm:[0,1,2,3] row_mask:0xf bank_mask:0x8
    v_mov_b32_dpp v63, v17 quad_perm:[0,1,2,3] row_mask:0xf bank_mask:0x8
    s_nop 1
    v_mfma_f32_16x16x32_bf16 v[192:195], v[140:143], v[60:63], v[192:195]
    v_mfma_f32_16x16x32_bf16 v[196:199], v[156:159], v[60:63], v[196:199]
    s_mov_b32 s61, 0x100000
    s_mov_b32 s64, 0x103800
    s_mov_b32 exec_lo, 0xcccccccc
    s_mov_b32 exec_hi, 0xcccccccc
    s_nop 2
    v_bfi_b32 v192, s65, v4, v192
    v_bfi_b32 v193, s65, v4, v193
    v_bfi_b32 v194, s65, v4, v194
    v_bfi_b32 v195, s65, v4, v195
    buffer_store_dwordx4 v[192:195], v15, s[12:15], s61 offen sc1
    v_bfi_b32 v196, s65, v4, v196
    v_bfi_b32 v197, s65, v4, v197
    v_bfi_b32 v198, s65, v4, v198
    v_bfi_b32 v199, s65, v4, v199
    buffer_store_dwordx4 v[196:199], v15, s[12:15], s64 offen sc1
DONE_G:
    s_waitcnt vmcnt(0)
    s_endpgm
RG_md2:
    s_sub_u32 s62, s62, 1
    s_cbranch_scc1 KG_md2
    s_mov_b32 s61, 0x2000
    buffer_load_dwordx4 v[160:163], v3, s[12:15], s61 offen offset:0 sc1
    s_mov_b32 s61, 0x2000
    buffer_load_dwordx4 v[164:167], v3, s[12:15], s61 offen offset:256 sc1
    s_mov_b32 s61, 0x2000
    buffer_load_dwordx4 v[168:171], v3, s[12:15], s61 offen offset:2048 sc1
    s_mov_b32 s61, 0x2000
    buffer_load_dwordx4 v[172:175], v3, s[12:15], s61 offen offset:2304 sc1
    s_mov_b32 s61, 0x3000
    buffer_load_dwordx4 v[176:179], v3, s[12:15], s61 offen offset:0 sc1
    s_mov_b32 s61, 0x3000
    buffer_load_dwordx4 v[180:183], v3, s[12:15], s61 offen offset:256 sc1
    s_waitcnt vmcnt(0)
    s_branch CG_md2
.p2align 6
CLS_Q:
    s_mov_b32 s16, s38
    s_mov_b32 s17, s39
    s_mov_b32 s18, 0x400000
    s_mov_b32 s19, 0x20000
    s_and_b32 s63, s2, 7
    s_lshl_b32 s63, s63, 3
    s_sub_u32 s64, s2, 48
    s_lshr_b32 s64, s64, 3
    s_add_u32 s63, s63, s64
    s_lshl_b32 s64, s63, 7
    v_lshrrev_b32 v10, 4, v1
    v_lshlrev_b32 v10, 5, v10
    s_lshl_b32 s61, s3, 7
    v_add_u32 v10, s61, v10
    s_movk_i32 s61, 8192
    v_mul_lo_u32 v10, v10, s61
    v_and_b32 v11, 15, v1
    v_lshl_add_u32 v10, v11, 3, v10
    v_add_u32 v6, s64, v10
    v_and_b32 v10, 3, v1
    v_lshlrev_b32 v10, 10, v10
    v_lshrrev_b32 v11, 4, v1
    v_lshl_add_u32 v10, v11, 6, v10
    v_bfe_u32 v11, v1, 2, 2
    v_lshl_add_u32 v10, v11, 2, v10
    s_lshl_b32 s61, s3, 8
    v_add_u32 v7, s61, v10
    buffer_load_dword v244, v7, s[24:27], 0 offen offset:0
    buffer_load_dword v245, v7, s[24:27], 0 offen offset:16
    buffer_load_dword v246, v7, s[24:27], 0 offen offset:32
    buffer_load_dword v247, v7, s[24:27], 0 offen offset:48
    buffer_load_dwordx2 v[64:65], v6, s[16:19], 0 offen offset:0 nt
    s_mov_b32 s61, 0x2000
    buffer_load_dwordx2 v[66:67], v6, s[16:19], s61 offen offset:0 nt
    s_mov_b32 s61, 0x4000
    buffer_load_dwordx2 v[80:81], v6, s[16:19], s61 offen offset:0 nt
    s_mov_b32 s61, 0x6000
    buffer_load_dwordx2 v[82:83], v6, s[16:19], s61 offen offset:0 nt
    s_mov_b32 s61, 0x8000
    buffer_load_dwordx2 v[96:97], v6, s[16:19], s61 offen offset:0 nt
    s_mov_b32 s61, 0xa000
    buffer_load_dwordx2 v[98:99], v6, s[16:19], s61 offen offset:0 nt
    s_mov_b32 s61, 0xc000
    buffer_load_dwordx2 v[112:113], v6, s[16:19], s61 offen offset:0 nt
    s_mov_b32 s61, 0xe000
    buffer_load_dwordx2 v[114:115], v6, s[16:19], s61 offen offset:0 nt
    s_mov_b32 s61, 0x10000
    buffer_load_dwordx2 v[68:69], v6, s[16:19], s61 offen offset:0 nt
    s_mov_b32 s61, 0x12000
    buffer_load_dwordx2 v[70:71], v6, s[16:19], s61 offen offset:0 nt
    s_mov_b32 s61, 0x14000
    buffer_load_dwordx2 v[84:85], v6, s[16:19], s61 offen offset:0 nt
    s_mov_b32 s61, 0x16000
    buffer_load_dwordx2 v[86:87], v6, s[16:19], s61 offen offset:0 nt
    s_mov_b32 s61, 0x18000
    buffer_load_dwordx2 v[100:101], v6, s[16:19], s61 offen offset:0 nt
    s_mov_b32 s61, 0x1a000
    buffer_load_dwordx2 v[102:103], v6, s[16:19], s61 offen offset:0 nt
    s_mov_b32 s61, 0x1c000
    buffer_load_dwordx2 v[116:117], v6, s[16:19], s61 offen offset:0 nt
    s_mov_b32 s61, 0x1e000
    buffer_load_dwordx2 v[118:119], v6, s[16:19], s61 offen offset:0 nt
    s_mov_b32 s61, 0x20000
    buffer_load_dwordx2 v[72:73], v6, s[16:19], s61 offen offset:0 nt
    s_mov_b32 s61, 0x22000
    buffer_load_dwordx2 v[74:75], v6, s[16:19], s61 offen offset:0 nt
    s_mov_b32 s61, 0x24000
    buffer_load_dwordx2 v[88:89], v6, s[16:19], s61 offen offset:0 nt
    s_mov_b32 s61, 0x26000
    buffer_load_dwordx2 v[90:91], v6, s[16:19], s61 offen offset:0 nt
    s_mov_b32 s61, 0x28000
    buffer_load_dwordx2 v[104:105], v6, s[16:19], s61 offen offset:0 nt
    s_mov_b32 s61, 0x2a000
    buffer_load_dwordx2 v[106:107], v6, s[16:19], s61 offen offset:0 nt
    s_mov_b32 s61, 0x2c000
    buffer_load_dwordx2 v[120:121], v6, s[16:19], s61 offen offset:0 nt
    s_mov_b32 s61, 0x2e000
    buffer_load_dwordx2 v[122:123], v6, s[16:19], s61 offen offset:0 nt
    s_mov_b32 s61, 0x30000
    buffer_load_dwordx2 v[76:77], v6, s[16:19], s61 offen offset:0 nt
    s_mov_b32 s61, 0x32000
    buffer_load_dwordx2 v[78:79], v6, s[16:19], s61 offen offset:0 nt
    s_mov_b32 s61, 0x34000
    buffer_load_dwordx2 v[92:93], v6, s[16:19], s61 offen offset:0 nt
    s_mov_b32 s61, 0x36000
    buffer_load_dwordx2 v[94:95], v6, s[16:19], s61 offen offset:0 nt
    s_mov_b32 s61, 0x38000
    buffer_load_dwordx2 v[108:109], v6, s[16:19], s61 offen offset:0 nt
    s_mov_b32 s61, 0x3a000
    buffer_load_dwordx2 v[110:111], v6, s[16:19], s61 offen offset:0 nt
    s_mov_b32 s61, 0x3c000
    buffer_load_dwordx2 v[124:125], v6, s[16:19], s61 offen offset:0 nt
    s_mov_b32 s61, 0x3e000
    buffer_load_dwordx2 v[126:127], v6, s[16:19], s61 offen offset:0 nt
    s_waitcnt vmcnt(32)
    v_lshlrev_b32 v192, 16, v244
    v_and_b32 v196, s66, v244
    v_lshlrev_b32 v193, 16, v245
    v_and_b32 v197, s66, v245
    v_lshlrev_b32 v194, 16, v246
    v_and_b32 v198, s66, v246
    v_lshlrev_b32 v195, 16, v247
    v_and_b32 v199, s66, v247
    v_add_f32 v200, v192, v193
    v_add_f32 v200, v200, v194
    v_add_f32 v200, v200, v195
    v_add_f32 v200, v200, v196
    v_add_f32 v200, v200, v197
    v_add_f32 v200, v200, v198
    v_add_f32 v200, v200, v199
    s_nop 1
    v_add_f32_dpp v200, v200, v200 row_ror:4 row_mask:0xf bank_mask:0xf
    s_nop 1
    v_add_f32_dpp v200, v200, v200 row_ror:8 row_mask:0xf bank_mask:0xf
    v_mov_b32 v202, v200
    s_nop 1
    v_permlane16_swap_b32 v200, v202
    v_add_f32 v200, v200, v202
    v_mov_b32 v202, v200
    s_nop 1
    v_permlane32_swap_b32 v200, v202
    v_add_f32 v200, v200, v202
    v_mul_f32 v200, 0x3c000000, v200
    v_sub_f32 v204, v192, v200
    v_sub_f32 v205, v193, v200
    v_sub_f32 v206, v194, v200
    v_sub_f32 v207, v195, v200
    v_sub_f32 v208, v196, v200
    v_sub_f32 v209, v197, v200
    v_sub_f32 v210, v198, v200
    v_sub_f32 v211, v199, v200
    v_mul_f32 v201, v204, v204
    v_fmac_f32 v201, v205, v205
    v_fmac_f32 v201, v206, v206
    v_fmac_f32 v201, v207, v207
    v_fmac_f32 v201, v208, v208
    v_fmac_f32 v201, v209, v209
    v_fmac_f32 v201, v210, v210
    v_fmac_f32 v201, v211, v211
    s_nop 1
    v_add_f32_dpp v201, v201, v201 row_ror:4 row_mask:0xf bank_mask:0xf
    s_nop 1
    v_add_f32_dpp v201, v201, v201 row_ror:8 row_mask:0xf bank_mask:0xf
    v_mov_b32 v202, v201
    s_nop 1
    v_permlane16_swap_b32 v201, v202
    v_add_f32 v201, v201, v202
    v_mov_b32 v202, v201
    s_nop 1
    v_permlane32_swap_b32 v201, v202
    v_add_f32 v201, v201, v202
    v_and_b32 v202, 3, v1
    v_lshlrev_b32 v202, 5, v202
    s_lshl_b32 s61, s3, 3
    v_add_u32 v203, s61, v202
    s_mov_b64 exec, 0xf
    ds_write_b64 v203, v[200:201] offset:26944
    s_mov_b64 exec, -1
    s_waitcnt lgkmcnt(0)
    s_barrier
    ds_read_b128 v[204:207], v202 offset:26944
    ds_read_b128 v[208:211], v202 offset:26960
    s_waitcnt lgkmcnt(0)
    v_add_f32 v200, v204, v206
    v_add_f32 v201, v208, v210
    v_add_f32 v200, v200, v201
    v_mul_f32 v200, 0x3e800000, v200
    v_sub_f32 v204, v204, v200
    v_sub_f32 v206, v206, v200
    v_sub_f32 v208, v208, v200
    v_sub_f32 v210, v210, v200
    v_mul_f32 v201, v204, v204
    v_fmac_f32 v201, v206, v206
    v_fmac_f32 v201, v208, v208
    v_fmac_f32 v201, v210, v210
    v_mul_f32 v201, 0x43000000, v201
    v_add_f32 v201, v201, v205
    v_add_f32 v201, v201, v207
    v_add_f32 v201, v201, v209
    v_add_f32 v201, v201, v211
    v_mul_f32 v201, 0x3b000000, v201
    v_cvt_pk_bf16_f32 v202, v200, v201
    v_lshlrev_b32 v200, 16, v202
    v_and_b32 v201, s66, v202
    v_add_f32 v201, s71, v201
    v_cvt_pk_bf16_f32 v202, v203, v201
    v_lshlrev_b32 v203, 16, v202
    v_and_b32 v201, s66, v202
    v_sqrt_f32 v201, v201
    s_nop 0
    v_cvt_pk_bf16_f32 v202, v203, v201
    v_lshlrev_b32 v203, 16, v202
    v_and_b32 v201, s66, v202
    v_mov_b32 v202, v201
    v_rcp_f32 v201, v201
    buffer_load_dwordx4 a[0:3], v2, s[4:7], s59 offen offset:0 nt
    v_sub_f32 v192, v192, v200
    v_sub_f32 v193, v193, v200
    v_sub_f32 v194, v194, v200
    v_sub_f32 v195, v195, v200
    v_sub_f32 v196, v196, v200
    v_sub_f32 v197, v197, v200
    v_sub_f32 v198, v198, v200
    v_sub_f32 v199, v199, v200
    v_cvt_pk_bf16_f32 v204, v192, v193
    v_cvt_pk_bf16_f32 v205, v194, v195
    v_cvt_pk_bf16_f32 v206, v196, v197
    v_cvt_pk_bf16_f32 v207, v198, v199
    buffer_load_dwordx4 a[4:7], v2, s[4:7], s59 offen offset:128 nt
    v_lshlrev_b32 v192, 16, v204
    v_and_b32 v193, s66, v204
    v_lshlrev_b32 v194, 16, v205
    v_and_b32 v195, s66, v205
    v_lshlrev_b32 v196, 16, v206
    v_and_b32 v197, s66, v206
    v_lshlrev_b32 v198, 16, v207
    v_and_b32 v199, s66, v207
    v_mul_f32 v204, v192, v201
    v_mul_f32 v205, v193, v201
    v_mul_f32 v206, v194, v201
    v_mul_f32 v207, v195, v201
    buffer_load_dwordx4 a[8:11], v2, s[4:7], s59 offen offset:1024 nt
    v_mul_f32 v208, v196, v201
    v_mul_f32 v209, v197, v201
    v_mul_f32 v210, v198, v201
    v_mul_f32 v211, v199, v201
    v_fma_f32 v192, -v204, v202, v192
    v_fma_f32 v193, -v205, v202, v193
    v_fma_f32 v194, -v206, v202, v194
    v_fma_f32 v195, -v207, v202, v195
    v_fma_f32 v196, -v208, v202, v196
    v_fma_f32 v197, -v209, v202, v197
    v_fma_f32 v198, -v210, v202, v198
    v_fma_f32 v199, -v211, v202, v199
    buffer_load_dwordx4 a[12:15], v2, s[4:7], s59 offen offset:1152 nt
    v_fma_f32 v192, v192, v201, v204
    v_fma_f32 v193, v193, v201, v205
    v_fma_f32 v194, v194, v201, v206
    v_fma_f32 v195, v195, v201, v207
    v_fma_f32 v196, v196, v201, v208
    v_fma_f32 v197, v197, v201, v209
    v_fma_f32 v198, v198, v201, v210
    v_fma_f32 v199, v199, v201, v211
    v_cvt_pk_bf16_f32 v204, v192, v193
    v_cvt_pk_bf16_f32 v205, v194, v195
    v_cvt_pk_bf16_f32 v206, v196, v197
    v_cvt_pk_bf16_f32 v207, v198, v199
    buffer_load_dwordx4 a[16:19], v2, s[4:7], s59 offen offset:2048 nt
    v_lshlrev_b32 v192, 16, v204
    v_and_b32 v193, s66, v204
    v_lshlrev_b32 v194, 16, v205
    v_and_b32 v195, s66, v205
    v_lshlrev_b32 v196, 16, v206
    v_and_b32 v197, s66, v206
    v_lshlrev_b32 v198, 16, v207
    v_and_b32 v199, s66, v207
    v_lshrrev_b32 v192, 16, v192
    v_lshrrev_b32 v193, 16, v193
    v_lshrrev_b32 v194, 16, v194
    v_lshrrev_b32 v195, 16, v195
    buffer_load_dwordx4 a[20:23], v2, s[4:7], s59 offen offset:2176 nt
    v_mov_b32 v48, 0
    v_mov_b32 v49, 0
    v_mov_b32 v50, 0
    v_mov_b32 v51, 0
    v_mov_b32 v52, 0
    v_mov_b32 v53, 0
    v_mov_b32 v54, 0
    v_mov_b32 v55, 0
    v_mov_b32 v56, 0
    v_mov_b32 v57, 0
    v_mov_b32 v58, 0
    v_mov_b32 v59, 0
    buffer_load_dwordx4 a[24:27], v2, s[4:7], s59 offen offset:3072 nt
    v_mov_b32 v60, 0
    v_mov_b32 v61, 0
    v_mov_b32 v62, 0
    v_mov_b32 v63, 0
    v_lshrrev_b32 v10, 4, v1
    v_add_u32 v10, v10, v1
    v_and_b32 v10, 3, v10
    v_and_b32 v11, 60, v1
    v_or_b32 v10, v10, v11
    v_lshlrev_b32 v10, 4, v10
    s_lshl_b32 s61, s3, 10
    v_add_u32 v8, s61, v10
    buffer_load_dwordx4 a[28:31], v2, s[4:7], s59 offen offset:3200 nt
    s_add_u32 s79, s59, 4096
    s_pack_lh_b32_b16 s59, s79, s59
    v_lshrrev_b32 v10, 4, v1
    v_bfe_u32 v11, v1, 2, 2
    v_add_u32 v10, v10, v11
    v_and_b32 v10, 3, v10
    v_and_b32 v11, 15, v1
    v_lshl_or_b32 v10, v11, 2, v10
    v_lshlrev_b32 v14, 4, v10
    s_lshl_b32 s64, s63, 8
    v_lshrrev_b32 v10, 4, v1
    v_mul_u32_u24 v10, 0x4000, v10
    v_and_b32 v11, 15, v1
    v_lshl_add_u32 v10, v11, 4, v10
    v_add_u32 v15, s64, v10
    v_and_b32 v10, 3, v1
    v_mul_u32_u24 v10, 0x3000, v10
    v_add_u32 v6, v10, v5
    s_add_u32 s58, s58, 0x9e3779b9
    v_mov_b32 v4, s58
    s_waitcnt vmcnt(8)
    buffer_load_dwordx4 a[32:35], v2, s[4:7], s59 offen offset:0 nt
    v_perm_b32 v128, v66, v64, s67
    v_perm_b32 v129, v70, v68, s67
    v_perm_b32 v130, v74, v72, s67
    v_perm_b32 v131, v78, v76, s67
    v_perm_b32 v132, v66, v64, s68
    v_perm_b32 v133, v70, v68, s68
    v_perm_b32 v134, v74, v72, s68
    v_perm_b32 v135, v78, v76, s68
    buffer_load_dwordx4 a[36:39], v2, s[4:7], s59 offen offset:128 nt
    v_perm_b32 v136, v67, v65, s67
    v_perm_b32 v137, v71, v69, s67
    v_perm_b32 v138, v75, v73, s67
    v_perm_b32 v139, v79, v77, s67
    v_perm_b32 v140, v67, v65, s68
    v_perm_b32 v141, v71, v69, s68
    v_perm_b32 v142, v75, v73, s68
    v_perm_b32 v143, v79, v77, s68
    buffer_load_dwordx4 a[40:43], v2, s[4:7], s59 offen offset:1024 nt
    v_perm_b32 v144, v82, v80, s67
    v_perm_b32 v145, v86, v84, s67
    v_perm_b32 v146, v90, v88, s67
    v_perm_b32 v147, v94, v92, s67
    v_perm_b32 v148, v82, v80, s68
    v_perm_b32 v149, v86, v84, s68
    v_perm_b32 v150, v90, v88, s68
    v_perm_b32 v151, v94, v92, s68
    buffer_load_dwordx4 a[44:47], v2, s[4:7], s59 offen offset:1152 nt
    v_perm_b32 v152, v83, v81, s67
    v_perm_b32 v153, v87, v85, s67
    v_perm_b32 v154, v91, v89, s67
    v_perm_b32 v155, v95, v93, s67
    v_perm_b32 v156, v83, v81, s68
    v_perm_b32 v157, v87, v85, s68
    v_perm_b32 v158, v91, v89, s68
    v_perm_b32 v159, v95, v93, s68
    buffer_load_dwordx4 a[48:51], v2, s[4:7], s59 offen offset:2048 nt
    v_perm_b32 v160, v98, v96, s67
    v_perm_b32 v161, v102, v100, s67
    v_perm_b32 v162, v106, v104, s67
    v_perm_b32 v163, v110, v108, s67
    v_perm_b32 v164, v98, v96, s68
    v_perm_b32 v165, v102, v100, s68
    v_perm_b32 v166, v106, v104, s68
    v_perm_b32 v167, v110, v108, s68
    buffer_load_dwordx4 a[52:55], v2, s[4:7], s59 offen offset:2176 nt
    v_perm_b32 v168, v99, v97, s67
    v_perm_b32 v169, v103, v101, s67
    v_perm_b32 v170, v107, v105, s67
    v_perm_b32 v171, v111, v109, s67
    v_perm_b32 v172, v99, v97, s68
    v_perm_b32 v173, v103, v101, s68
    v_perm_b32 v174, v107, v105, s68
    v_perm_b32 v175, v111, v109, s68
    buffer_load_dwordx4 a[56:59], v2, s[4:7], s59 offen offset:3072 nt
    v_perm_b32 v176, v114, v112, s67
    v_perm_b32 v177, v118, v116, s67
    v_perm_b32 v178, v122, v120, s67
    v_perm_b32 v179, v126, v124, s67
    v_perm_b32 v180, v114, v112, s68
    v_perm_b32 v181, v118, v116, s68
    v_perm_b32 v182, v122, v120, s68
    v_perm_b32 v183, v126, v124, s68
    buffer_load_dwordx4 a[60:63], v2, s[4:7], s59 offen offset:3200 nt
    s_add_u32 s79, s59, 12288
    s_pack_lh_b32_b16 s59, s79, s59
    v_perm_b32 v184, v115, v113, s67
    v_perm_b32 v185, v119, v117, s67
    v_perm_b32 v186, v123, v121, s67
    v_perm_b32 v187, v127, v125, s67
    v_perm_b32 v188, v115, v113, s68
    v_perm_b32 v189, v119, v117, s68
    v_perm_b32 v190, v123, v121, s68
    v_perm_b32 v191, v127, v125, s68
    buffer_load_dwordx4 a[64:67], v2, s[4:7], s59 offen offset:0 nt
    buffer_load_dwordx4 a[68:71], v2, s[4:7], s59 offen offset:128 nt
    buffer_load_dwordx4 a[72:75], v2, s[4:7], s59 offen offset:1024 nt
    buffer_load_dwordx4 a[76:79], v2, s[4:7], s59 offen offset:1152 nt
    buffer_load_dwordx4 a[80:83], v2, s[4:7], s59 offen offset:2048 nt
    buffer_load_dwordx4 a[84:87], v2, s[4:7], s59 offen offset:2176 nt
    buffer_load_dwordx4 a[88:91], v2, s[4:7], s59 offen offset:3072 nt
    buffer_load_dwordx4 a[92:95], v2, s[4:7], s59 offen offset:3200 nt
    s_add_u32 s79, s59, 4096
    s_pack_lh_b32_b16 s59, s79, s59
    s_mov_b32 s61, 0x1000
    buffer_load_dwordx4 v[232:235], v6, s[12:15], s61 offen offset:0 sc1
    s_mov_b32 s61, 0x1000
    buffer_load_dwordx4 v[236:239], v6, s[12:15], s61 offen offset:256 sc1
    s_mov_b32 s61, 0x1000
    buffer_load_dwordx4 v[224:227], v6, s[12:15], s61 offen offset:2048 sc1
    s_mov_b32 s61, 0x1000
    buffer_load_dwordx4 v[228:231], v6, s[12:15], s61 offen offset:2304 sc1
    buffer_load_dwordx4 a[96:99], v2, s[4:7], s59 offen offset:0 nt
    buffer_load_dwordx4 a[100:103], v2, s[4:7], s59 offen offset:128 nt
    buffer_load_dwordx4 a[104:107], v2, s[4:7], s59 offen offset:1024 nt
    buffer_load_dwordx4 a[108:111], v2, s[4:7], s59 offen offset:1152 nt
    buffer_load_dwordx4 a[112:115], v2, s[4:7], s59 offen offset:2048 nt
    buffer_load_dwordx4 a[116:119], v2, s[4:7], s59 offen offset:2176 nt
    buffer_load_dwordx4 a[120:123], v2, s[4:7], s59 offen offset:3072 nt
    buffer_load_dwordx4 a[124:127], v2, s[4:7], s59 offen offset:3200 nt
    s_add_u32 s79, s59, 12288
    s_pack_lh_b32_b16 s59, s79, s59
    s_movk_i32 s34, 4
    s_waitcnt vmcnt(8)
    v_mov_b32 v32, v224
    v_mov_b32 v33, v225
    v_mov_b32 v34, v226
    v_mov_b32 v35, v227
    v_mov_b32 v36, v228
    v_mov_b32 v37, v229
    v_mov_b32 v38, v230
    v_mov_b32 v39, v231
    v_mov_b32 v40, v232
    v_mov_b32 v41, v233
    v_mov_b32 v42, v234
    v_mov_b32 v43, v235
    v_mov_b32 v44, v236
    v_mov_b32 v45, v237
    v_mov_b32 v46, v238
    v_mov_b32 v47, v239
    v_xor_b32 v10, s58, v32
    v_bitop3_b32 v10, v33, s58, v10 bitop3:0xbe
    v_bitop3_b32 v10, v34, s58, v10 bitop3:0xbe
    v_bitop3_b32 v10, v35, s58, v10 bitop3:0xbe
    v_bitop3_b32 v10, v36, s58, v10 bitop3:0xbe
    v_bitop3_b32 v10, v37, s58, v10 bitop3:0xbe
    v_bitop3_b32 v10, v38, s58, v10 bitop3:0xbe
    v_bitop3_b32 v10, v39, s58, v10 bitop3:0xbe
    v_bitop3_b32 v10, v40, s58, v10 bitop3:0xbe
    v_bitop3_b32 v10, v41, s58, v10 bitop3:0xbe
    v_bitop3_b32 v10, v42, s58, v10 bitop3:0xbe
    v_bitop3_b32 v10, v43, s58, v10 bitop3:0xbe
    v_bitop3_b32 v10, v44, s58, v10 bitop3:0xbe
    v_bitop3_b32 v10, v45, s58, v10 bitop3:0xbe
    v_bitop3_b32 v10, v46, s58, v10 bitop3:0xbe
    v_bitop3_b32 v10, v47, s58, v10 bitop3:0xbe
    v_and_b32 v10, 0xff, v10
    v_cmp_ne_u32 vcc, 0, v10
    s_cbranch_vccz QJOBQ
    s_mov_b32 s61, 0x1000
    buffer_load_dwordx4 v[232:235], v6, s[12:15], s61 offen offset:0 sc1
    s_mov_b32 s61, 0x1000
    buffer_load_dwordx4 v[236:239], v6, s[12:15], s61 offen offset:256 sc1
    s_mov_b32 s61, 0x1000
    buffer_load_dwordx4 v[224:227], v6, s[12:15], s61 offen offset:2048 sc1
    s_mov_b32 s61, 0x1000
    buffer_load_dwordx4 v[228:231], v6, s[12:15], s61 offen offset:2304 sc1
    buffer_load_dwordx4 a[128:131], v2, s[4:7], s59 offen offset:0 nt
    buffer_load_dwordx4 a[132:135], v2, s[4:7], s59 offen offset:128 nt
    buffer_load_dwordx4 a[136:139], v2, s[4:7], s59 offen offset:1024 nt
    buffer_load_dwordx4 a[140:143], v2, s[4:7], s59 offen offset:1152 nt
    buffer_load_dwordx4 a[144:147], v2, s[4:7], s59 offen offset:2048 nt
    buffer_load_dwordx4 a[148:151], v2, s[4:7], s59 offen offset:2176 nt
    buffer_load_dwordx4 a[152:155], v2, s[4:7], s59 offen offset:3072 nt
    buffer_load_dwordx4 a[156:159], v2, s[4:7], s59 offen offset:3200 nt
    s_add_u32 s79, s59, 4096
    s_pack_lh_b32_b16 s59, s79, s59
    s_movk_i32 s34, 5
    s_waitcnt vmcnt(8)
    v_mov_b32 v32, v224
    v_mov_b32 v33, v225
    v_mov_b32 v34, v226
    v_mov_b32 v35, v227
    v_mov_b32 v36, v228
    v_mov_b32 v37, v229
    v_mov_b32 v38, v230
    v_mov_b32 v39, v231
    v_mov_b32 v40, v232
    v_mov_b32 v41, v233
    v_mov_b32 v42, v234
    v_mov_b32 v43, v235
    v_mov_b32 v44, v236
    v_mov_b32 v45, v237
    v_mov_b32 v46, v238
    v_mov_b32 v47, v239
    v_xor_b32 v10, s58, v32
    v_bitop3_b32 v10, v33, s58, v10 bitop3:0xbe
    v_bitop3_b32 v10, v34, s58, v10 bitop3:0xbe
    v_bitop3_b32 v10, v35, s58, v10 bitop3:0xbe
    v_bitop3_b32 v10, v36, s58, v10 bitop3:0xbe
    v_bitop3_b32 v10, v37, s58, v10 bitop3:0xbe
    v_bitop3_b32 v10, v38, s58, v10 bitop3:0xbe
    v_bitop3_b32 v10, v39, s58, v10 bitop3:0xbe
    v_bitop3_b32 v10, v40, s58, v10 bitop3:0xbe
    v_bitop3_b32 v10, v41, s58, v10 bitop3:0xbe
    v_bitop3_b32 v10, v42, s58, v10 bitop3:0xbe
    v_bitop3_b32 v10, v43, s58, v10 bitop3:0xbe
    v_bitop3_b32 v10, v44, s58, v10 bitop3:0xbe
    v_bitop3_b32 v10, v45, s58, v10 bitop3:0xbe
    v_bitop3_b32 v10, v46, s58, v10 bitop3:0xbe
    v_bitop3_b32 v10, v47, s58, v10 bitop3:0xbe
    v_and_b32 v10, 0xff, v10
    v_cmp_ne_u32 vcc, 0, v10
    s_cbranch_vccz QJOBQ
    s_mov_b32 s61, 0x1000
    buffer_load_dwordx4 v[232:235], v6, s[12:15], s61 offen offset:0 sc1
    s_mov_b32 s61, 0x1000
    buffer_load_dwordx4 v[236:239], v6, s[12:15], s61 offen offset:256 sc1
    s_mov_b32 s61, 0x1000
    buffer_load_dwordx4 v[224:227], v6, s[12:15], s61 offen offset:2048 sc1
    s_mov_b32 s61, 0x1000
    buffer_load_dwordx4 v[228:231], v6, s[12:15], s61 offen offset:2304 sc1
    buffer_load_dwordx4 a[160:163], v2, s[4:7], s59 offen offset:0 nt
    buffer_load_dwordx4 a[164:167], v2, s[4:7], s59 offen offset:128 nt
    buffer_load_dwordx4 a[168:171], v2, s[4:7], s59 offen offset:1024 nt
    buffer_load_dwordx4 a[172:175], v2, s[4:7], s59 offen offset:1152 nt
    buffer_load_dwordx4 a[176:179], v2, s[4:7], s59 offen offset:2048 nt
    buffer_load_dwordx4 a[180:183], v2, s[4:7], s59 offen offset:2176 nt
    buffer_load_dwordx4 a[184:187], v2, s[4:7], s59 offen offset:3072 nt
    buffer_load_dwordx4 a[188:191], v2, s[4:7], s59 offen offset:3200 nt
    s_add_u32 s79, s59, 12288
    s_pack_lh_b32_b16 s59, s79, s59
    s_movk_i32 s34, 6
    s_waitcnt vmcnt(8)
    v_mov_b32 v32, v224
    v_mov_b32 v33, v225
    v_mov_b32 v34, v226
    v_mov_b32 v35, v227
    v_mov_b32 v36, v228
    v_mov_b32 v37, v229
    v_mov_b32 v38, v230
    v_mov_b32 v39, v231
    v_mov_b32 v40, v232
    v_mov_b32 v41, v233
    v_mov_b32 v42, v234
    v_mov_b32 v43, v235
    v_mov_b32 v44, v236
    v_mov_b32 v45, v237
    v_mov_b32 v46, v238
    v_mov_b32 v47, v239
    v_xor_b32 v10, s58, v32
    v_bitop3_b32 v10, v33, s58, v10 bitop3:0xbe
    v_bitop3_b32 v10, v34, s58, v10 bitop3:0xbe
    v_bitop3_b32 v10, v35, s58, v10 bitop3:0xbe
    v_bitop3_b32 v10, v36, s58, v10 bitop3:0xbe
    v_bitop3_b32 v10, v37, s58, v10 bitop3:0xbe
    v_bitop3_b32 v10, v38, s58, v10 bitop3:0xbe
    v_bitop3_b32 v10, v39, s58, v10 bitop3:0xbe
    v_bitop3_b32 v10, v40, s58, v10 bitop3:0xbe
    v_bitop3_b32 v10, v41, s58, v10 bitop3:0xbe
    v_bitop3_b32 v10, v42, s58, v10 bitop3:0xbe
    v_bitop3_b32 v10, v43, s58, v10 bitop3:0xbe
    v_bitop3_b32 v10, v44, s58, v10 bitop3:0xbe
    v_bitop3_b32 v10, v45, s58, v10 bitop3:0xbe
    v_bitop3_b32 v10, v46, s58, v10 bitop3:0xbe
    v_bitop3_b32 v10, v47, s58, v10 bitop3:0xbe
    v_and_b32 v10, 0xff, v10
    v_cmp_ne_u32 vcc, 0, v10
    s_cbranch_vccz QJOBQ
    s_mov_b32 s61, 0x1000
    buffer_load_dwordx4 v[232:235], v6, s[12:15], s61 offen offset:0 sc1
    s_mov_b32 s61, 0x1000
    buffer_load_dwordx4 v[236:239], v6, s[12:15], s61 offen offset:256 sc1
    s_mov_b32 s61, 0x1000
    buffer_load_dwordx4 v[224:227], v6, s[12:15], s61 offen offset:2048 sc1
    s_mov_b32 s61, 0x1000
    buffer_load_dwordx4 v[228:231], v6, s[12:15], s61 offen offset:2304 sc1
    buffer_load_dwordx4 a[192:195], v2, s[4:7], s59 offen offset:0 nt
    buffer_load_dwordx4 a[196:199], v2, s[4:7], s59 offen offset:128 nt
    buffer_load_dwordx4 a[200:203], v2, s[4:7], s59 offen offset:1024 nt
    buffer_load_dwordx4 a[204:207], v2, s[4:7], s59 offen offset:1152 nt
    buffer_load_dwordx4 a[208:211], v2, s[4:7], s59 offen offset:2048 nt
    buffer_load_dwordx4 a[212:215], v2, s[4:7], s59 offen offset:2176 nt
    buffer_load_dwordx4 a[216:219], v2, s[4:7], s59 offen offset:3072 nt
    buffer_load_dwordx4 a[220:223], v2, s[4:7], s59 offen offset:3200 nt
    s_add_u32 s79, s59, 4096
    s_pack_lh_b32_b16 s59, s79, s59
    s_movk_i32 s34, 7
    s_waitcnt vmcnt(8)
    v_mov_b32 v32, v224
    v_mov_b32 v33, v225
    v_mov_b32 v34, v226
    v_mov_b32 v35, v227
    v_mov_b32 v36, v228
    v_mov_b32 v37, v229
    v_mov_b32 v38, v230
    v_mov_b32 v39, v231
    v_mov_b32 v40, v232
    v_mov_b32 v41, v233
    v_mov_b32 v42, v234
    v_mov_b32 v43, v235
    v_mov_b32 v44, v236
    v_mov_b32 v45, v237
    v_mov_b32 v46, v238
    v_mov_b32 v47, v239
    v_xor_b32 v10, s58, v32
    v_bitop3_b32 v10, v33, s58, v10 bitop3:0xbe
    v_bitop3_b32 v10, v34, s58, v10 bitop3:0xbe
    v_bitop3_b32 v10, v35, s58, v10 bitop3:0xbe
    v_bitop3_b32 v10, v36, s58, v10 bitop3:0xbe
    v_bitop3_b32 v10, v37, s58, v10 bitop3:0xbe
    v_bitop3_b32 v10, v38, s58, v10 bitop3:0xbe
    v_bitop3_b32 v10, v39, s58, v10 bitop3:0xbe
    v_bitop3_b32 v10, v40, s58, v10 bitop3:0xbe
    v_bitop3_b32 v10, v41, s58, v10 bitop3:0xbe
    v_bitop3_b32 v10, v42, s58, v10 bitop3:0xbe
    v_bitop3_b32 v10, v43, s58, v10 bitop3:0xbe
    v_bitop3_b32 v10, v44, s58, v10 bitop3:0xbe
    v_bitop3_b32 v10, v45, s58, v10 bitop3:0xbe
    v_bitop3_b32 v10, v46, s58, v10 bitop3:0xbe
    v_bitop3_b32 v10, v47, s58, v10 bitop3:0xbe
    v_and_b32 v10, 0xff, v10
    v_cmp_ne_u32 vcc, 0, v10
    s_cbranch_vccz QJOBQ
    s_mov_b32 s61, 0x1000
    buffer_load_dwordx4 v[232:235], v6, s[12:15], s61 offen offset:0 sc1
    s_mov_b32 s61, 0x1000
    buffer_load_dwordx4 v[236:239], v6, s[12:15], s61 offen offset:256 sc1
    s_mov_b32 s61, 0x1000
    buffer_load_dwordx4 v[224:227], v6, s[12:15], s61 offen offset:2048 sc1
    s_mov_b32 s61, 0x1000
    buffer_load_dwordx4 v[228:231], v6, s[12:15], s61 offen offset:2304 sc1
    buffer_load_dwordx4 a[224:227], v2, s[4:7], s59 offen offset:0 nt
    buffer_load_dwordx4 a[228:231], v2, s[4:7], s59 offen offset:128 nt
    buffer_load_dwordx4 a[232:235], v2, s[4:7], s59 offen offset:1024 nt
    buffer_load_dwordx4 a[236:239], v2, s[4:7], s59 offen offset:1152 nt
    buffer_load_dwordx4 a[240:243], v2, s[4:7], s59 offen offset:2048 nt
    buffer_load_dwordx4 a[244:247], v2, s[4:7], s59 offen offset:2176 nt
    buffer_load_dwordx4 a[248:251], v2, s[4:7], s59 offen offset:3072 nt
    buffer_load_dwordx4 a[252:255], v2, s[4:7], s59 offen offset:3200 nt
    s_add_u32 s79, s59, 12288
    s_pack_lh_b32_b16 s59, s79, s59
    s_movk_i32 s34, 8
    s_waitcnt vmcnt(8)
    v_mov_b32 v32, v224
    v_mov_b32 v33, v225
    v_mov_b32 v34, v226
    v_mov_b32 v35, v227
    v_mov_b32 v36, v228
    v_mov_b32 v37, v229
    v_mov_b32 v38, v230
    v_mov_b32 v39, v231
    v_mov_b32 v40, v232
    v_mov_b32 v41, v233
    v_mov_b32 v42, v234
    v_mov_b32 v43, v235
    v_mov_b32 v44, v236
    v_mov_b32 v45, v237
    v_mov_b32 v46, v238
    v_mov_b32 v47, v239
    v_xor_b32 v10, s58, v32
    v_bitop3_b32 v10, v33, s58, v10 bitop3:0xbe
    v_bitop3_b32 v10, v34, s58, v10 bitop3:0xbe
    v_bitop3_b32 v10, v35, s58, v10 bitop3:0xbe
    v_bitop3_b32 v10, v36, s58, v10 bitop3:0xbe
    v_bitop3_b32 v10, v37, s58, v10 bitop3:0xbe
    v_bitop3_b32 v10, v38, s58, v10 bitop3:0xbe
    v_bitop3_b32 v10, v39, s58, v10 bitop3:0xbe
    v_bitop3_b32 v10, v40, s58, v10 bitop3:0xbe
    v_bitop3_b32 v10, v41, s58, v10 bitop3:0xbe
    v_bitop3_b32 v10, v42, s58, v10 bitop3:0xbe
    v_bitop3_b32 v10, v43, s58, v10 bitop3:0xbe
    v_bitop3_b32 v10, v44, s58, v10 bitop3:0xbe
    v_bitop3_b32 v10, v45, s58, v10 bitop3:0xbe
    v_bitop3_b32 v10, v46, s58, v10 bitop3:0xbe
    v_bitop3_b32 v10, v47, s58, v10 bitop3:0xbe
    v_and_b32 v10, 0xff, v10
    v_cmp_ne_u32 vcc, 0, v10
    s_cbranch_vccz QJOBQ
    s_mov_b32 s62, 0x40000
QPXQ:
    s_mov_b32 s61, 0x1000
    buffer_load_dwordx4 v[232:235], v6, s[12:15], s61 offen offset:0 sc1
    s_mov_b32 s61, 0x1000
    buffer_load_dwordx4 v[236:239], v6, s[12:15], s61 offen offset:256 sc1
    s_mov_b32 s61, 0x1000
    buffer_load_dwordx4 v[224:227], v6, s[12:15], s61 offen offset:2048 sc1
    s_mov_b32 s61, 0x1000
    buffer_load_dwordx4 v[228:231], v6, s[12:15], s61 offen offset:2304 sc1
    s_waitcnt vmcnt(0)
    v_mov_b32 v32, v224
    v_mov_b32 v33, v225
    v_mov_b32 v34, v226
    v_mov_b32 v35, v227
    v_mov_b32 v36, v228
    v_mov_b32 v37, v229
    v_mov_b32 v38, v230
    v_mov_b32 v39, v231
    v_mov_b32 v40, v232
    v_mov_b32 v41, v233
    v_mov_b32 v42, v234
    v_mov_b32 v43, v235
    v_mov_b32 v44, v236
    v_mov_b32 v45, v237
    v_mov_b32 v46, v238
    v_mov_b32 v47, v239
    v_xor_b32 v10, s58, v32
    v_bitop3_b32 v10, v33, s58, v10 bitop3:0xbe
    v_bitop3_b32 v10, v34, s58, v10 bitop3:0xbe
    v_bitop3_b32 v10, v35, s58, v10 bitop3:0xbe
    v_bitop3_b32 v10, v36, s58, v10 bitop3:0xbe
    v_bitop3_b32 v10, v37, s58, v10 bitop3:0xbe
    v_bitop3_b32 v10, v38, s58, v10 bitop3:0xbe
    v_bitop3_b32 v10, v39, s58, v10 bitop3:0xbe
    v_bitop3_b32 v10, v40, s58, v10 bitop3:0xbe
    v_bitop3_b32 v10, v41, s58, v10 bitop3:0xbe
    v_bitop3_b32 v10, v42, s58, v10 bitop3:0xbe
    v_bitop3_b32 v10, v43, s58, v10 bitop3:0xbe
    v_bitop3_b32 v10, v44, s58, v10 bitop3:0xbe
    v_bitop3_b32 v10, v45, s58, v10 bitop3:0xbe
    v_bitop3_b32 v10, v46, s58, v10 bitop3:0xbe
    v_bitop3_b32 v10, v47, s58, v10 bitop3:0xbe
    v_and_b32 v10, 0xff, v10
    v_cmp_ne_u32 vcc, 0, v10
    s_cbranch_vccz QJOBQ
    s_sub_u32 s62, s62, 1
    s_cbranch_scc0 QPXQ
QJOBQ:
    v_perm_b32 v208, v36, v32, s68
    v_perm_b32 v209, v37, v33, s68
    v_perm_b32 v210, v38, v34, s68
    v_perm_b32 v211, v39, v35, s68
    v_and_b32 v40, s66, v40
    v_and_b32 v41, s66, v41
    v_and_b32 v42, s66, v42
    v_and_b32 v43, s66, v43
    v_and_b32 v44, s66, v44
    v_and_b32 v45, s66, v45
    v_and_b32 v46, s66, v46
    v_and_b32 v47, s66, v47
    v_dot2_f32_bf16 v200, v208, s76, 1.0
    v_dot2_f32_bf16 v201, v209, s76, 1.0
    v_dot2_f32_bf16 v202, v210, s76, 1.0
    v_dot2_f32_bf16 v203, v211, s76, 1.0
    v_dot2_f32_bf16 v204, v208, s77, 1.0
    v_dot2_f32_bf16 v205, v209, s77, 1.0
    v_dot2_f32_bf16 v206, v210, s77, 1.0
    v_dot2_f32_bf16 v207, v211, s77, 1.0
    v_cvt_pk_bf16_f32 v208, v200, v204
    v_cvt_pk_bf16_f32 v209, v201, v205
    v_cvt_pk_bf16_f32 v210, v202, v206
    v_cvt_pk_bf16_f32 v211, v203, v207
    v_dot2_f32_bf16 v200, v208, v192, 0
    v_dot2_f32_bf16 v201, v209, v193, 0
    v_dot2_f32_bf16 v202, v210, v194, 0
    v_dot2_f32_bf16 v203, v211, v195, 0
    v_dot2_f32_bf16 v204, v208, v196, 0
    v_dot2_f32_bf16 v205, v209, v197, 0
    v_dot2_f32_bf16 v206, v210, v198, 0
    v_dot2_f32_bf16 v207, v211, v199, 0
    v_cvt_pk_bf16_f32 v208, v200, v204
    v_cvt_pk_bf16_f32 v209, v201, v205
    v_cvt_pk_bf16_f32 v210, v202, v206
    v_cvt_pk_bf16_f32 v211, v203, v207
    v_dot2_f32_bf16 v200, v208, s76, v40
    v_dot2_f32_bf16 v201, v209, s76, v41
    v_dot2_f32_bf16 v202, v210, s76, v42
    v_dot2_f32_bf16 v203, v211, s76, v43
    v_dot2_f32_bf16 v204, v208, s77, v44
    v_dot2_f32_bf16 v205, v209, s77, v45
    v_dot2_f32_bf16 v206, v210, s77, v46
    v_dot2_f32_bf16 v207, v211, s77, v47
    v_cvt_pk_bf16_f32 v240, v200, v204
    v_cvt_pk_bf16_f32 v241, v201, v205
    v_cvt_pk_bf16_f32 v242, v202, v206
    v_cvt_pk_bf16_f32 v243, v203, v207
    v_mov_b32_dpp v48, v240 quad_perm:[0,1,2,3] row_mask:0xf bank_mask:0x1
    v_mov_b32_dpp v49, v241 quad_perm:[0,1,2,3] row_mask:0xf bank_mask:0x1
    v_mov_b32_dpp v50, v242 quad_perm:[0,1,2,3] row_mask:0xf bank_mask:0x1
    v_mov_b32_dpp v51, v243 quad_perm:[0,1,2,3] row_mask:0xf bank_mask:0x1
    s_nop 1
    v_mfma_f32_16x16x32_bf16 v[64:67], v[128:131], v[48:51], 0
    v_mov_b32_dpp v52, v240 quad_perm:[0,1,2,3] row_mask:0xf bank_mask:0x2
    v_mov_b32_dpp v53, v241 quad_perm:[0,1,2,3] row_mask:0xf bank_mask:0x2
    v_mfma_f32_16x16x32_bf16 v[68:71], v[132:135], v[48:51], 0
    v_mov_b32_dpp v54, v242 quad_perm:[0,1,2,3] row_mask:0xf bank_mask:0x2
    v_mov_b32_dpp v55, v243 quad_perm:[0,1,2,3] row_mask:0xf bank_mask:0x2
    s_nop 1
    v_mfma_f32_16x16x32_bf16 v[64:67], v[144:147], v[52:55], v[64:67]
    v_mov_b32_dpp v56, v240 quad_perm:[0,1,2,3] row_mask:0xf bank_mask:0x4
    v_mov_b32_dpp v57, v241 quad_perm:[0,1,2,3] row_mask:0xf bank_mask:0x4
    v_mfma_f32_16x16x32_bf16 v[68:71], v[148:151], v[52:55], v[68:71]
    v_mov_b32_dpp v58, v242 quad_perm:[0,1,2,3] row_mask:0xf bank_mask:0x4
    v_mov_b32_dpp v59, v243 quad_perm:[0,1,2,3] row_mask:0xf bank_mask:0x4
    s_nop 1
    v_mfma_f32_16x16x32_bf16 v[64:67], v[160:163], v[56:59], v[64:67]
    v_mov_b32_dpp v60, v240 quad_perm:[0,1,2,3] row_mask:0xf bank_mask:0x8
    v_mov_b32_dpp v61, v241 quad_perm:[0,1,2,3] row_mask:0xf bank_mask:0x8
    v_mfma_f32_16x16x32_bf16 v[68:71], v[164:167], v[56:59], v[68:71]
    v_mov_b32_dpp v62, v242 quad_perm:[0,1,2,3] row_mask:0xf bank_mask:0x8
    v_mov_b32_dpp v63, v243 quad_perm:[0,1,2,3] row_mask:0xf bank_mask:0x8
    s_nop 1
    v_mfma_f32_16x16x32_bf16 v[64:67], v[176:179], v[60:63], v[64:67]
    v_mfma_f32_16x16x32_bf16 v[68:71], v[180:183], v[60:63], v[68:71]
    v_mfma_f32_16x16x32_bf16 v[72:75], v[136:139], v[48:51], 0
    v_mfma_f32_16x16x32_bf16 v[76:79], v[140:143], v[48:51], 0
    v_mfma_f32_16x16x32_bf16 v[72:75], v[152:155], v[52:55], v[72:75]
    v_mfma_f32_16x16x32_bf16 v[76:79], v[156:159], v[52:55], v[76:79]
    s_nop 2
    v_add_f32_dpp v80, v64, v64 row_shl:4 row_mask:0xf bank_mask:0x5
    v_add_f32_dpp v81, v66, v66 row_shl:4 row_mask:0xf bank_mask:0x5
    v_mfma_f32_16x16x32_bf16 v[72:75], v[168:171], v[56:59], v[72:75]
    v_add_f32_dpp v82, v68, v68 row_shl:4 row_mask:0xf bank_mask:0x5
    v_add_f32_dpp v83, v70, v70 row_shl:4 row_mask:0xf bank_mask:0x5
    v_mfma_f32_16x16x32_bf16 v[76:79], v[172:175], v[56:59], v[76:79]
    v_add_f32_dpp v80, v65, v65 row_shr:4 row_mask:0xf bank_mask:0xa
    v_add_f32_dpp v81, v67, v67 row_shr:4 row_mask:0xf bank_mask:0xa
    v_mfma_f32_16x16x32_bf16 v[72:75], v[184:187], v[60:63], v[72:75]
    v_add_f32_dpp v82, v69, v69 row_shr:4 row_mask:0xf bank_mask:0xa
    v_add_f32_dpp v83, v71, v71 row_shr:4 row_mask:0xf bank_mask:0xa
    v_mfma_f32_16x16x32_bf16 v[76:79], v[188:191], v[60:63], v[76:79]
    s_nop 4
    v_add_f32_dpp v84, v72, v72 row_shl:4 row_mask:0xf bank_mask:0x5
    v_add_f32_dpp v85, v74, v74 row_shl:4 row_mask:0xf bank_mask:0x5
    s_nop 0
    v_add_f32_dpp v86, v76, v76 row_shl:4 row_mask:0xf bank_mask:0x5
    v_add_f32_dpp v87, v78, v78 row_shl:4 row_mask:0xf bank_mask:0x5
    v_add_f32_dpp v84, v73, v73 row_shr:4 row_mask:0xf bank_mask:0xa
    v_add_f32_dpp v85, v75, v75 row_shr:4 row_mask:0xf bank_mask:0xa
    v_add_f32_dpp v86, v77, v77 row_shr:4 row_mask:0xf bank_mask:0xa
    v_add_f32_dpp v87, v79, v79 row_shr:4 row_mask:0xf bank_mask:0xa
    v_add_f32_dpp v88, v80, v80 row_shl:8 row_mask:0xf bank_mask:0x3
    v_add_f32_dpp v89, v82, v82 row_shl:8 row_mask:0xf bank_mask:0x3
    v_add_f32_dpp v90, v84, v84 row_shl:8 row_mask:0xf bank_mask:0x3
    v_add_f32_dpp v91, v86, v86 row_shl:8 row_mask:0xf bank_mask:0x3
    v_add_f32_dpp v88, v81, v81 row_shr:8 row_mask:0xf bank_mask:0xc
    v_add_f32_dpp v89, v83, v83 row_shr:8 row_mask:0xf bank_mask:0xc
    v_add_f32_dpp v90, v85, v85 row_shr:8 row_mask:0xf bank_mask:0xc
    v_add_f32_dpp v91, v87, v87 row_shr:8 row_mask:0xf bank_mask:0xc
    ds_write_b128 v8, v[88:91] offset:0
    s_waitcnt lgkmcnt(0)
    s_barrier
    s_cmp_lg_u32 s3, 0
    s_cbranch_scc1 HS_Q
    ds_read_b128 v[192:195], v14 offset:0
    ds_read_b128 v[196:199], v14 offset:1024
    ds_read_b128 v[200:203], v14 offset:2048
    ds_read_b128 v[204:207], v14 offset:3072
    s_waitcnt lgkmcnt(2)
    v_pk_add_f32 v[192:193], v[192:193], v[196:197]
    v_pk_add_f32 v[194:195], v[194:195], v[198:199]
    s_waitcnt lgkmcnt(0)
    v_pk_add_f32 v[200:201], v[200:201], v[204:205]
    v_pk_add_f32 v[202:203], v[202:203], v[206:207]
    v_pk_add_f32 v[192:193], v[192:193], v[200:201]
    v_pk_add_f32 v[194:195], v[194:195], v[202:203]
    v_cvt_pk_bf16_f32 v196, v192, v193
    v_cvt_pk_bf16_f32 v197, v194, v195
    v_perm_b32 v192, v196, v4, s67
    v_bfi_b32 v193, s66, v196, v4
    v_perm_b32 v194, v197, v4, s67
    v_bfi_b32 v195, s66, v197, v4
    s_mov_b32 s61, 0x10000
    buffer_store_dwordx4 v[192:195], v15, s[12:15], s61 offen offset:0 sc1
HS_Q:
    s_cmp_eq_u32 s34, 8
    s_cbranch_scc1 QT8Q
    s_cmp_eq_u32 s34, 7
    s_cbranch_scc1 QT7Q
    s_cmp_eq_u32 s34, 6
    s_cbranch_scc1 QT6Q
    s_cmp_eq_u32 s34, 5
    s_cbranch_scc1 QT5Q
QT4Q:
    buffer_load_dwordx4 a[128:131], v2, s[4:7], s59 offen offset:0 nt
    buffer_load_dwordx4 a[132:135], v2, s[4:7], s59 offen offset:128 nt
    buffer_load_dwordx4 a[136:139], v2, s[4:7], s59 offen offset:1024 nt
    buffer_load_dwordx4 a[140:143], v2, s[4:7], s59 offen offset:1152 nt
    buffer_load_dwordx4 a[144:147], v2, s[4:7], s59 offen offset:2048 nt
    buffer_load_dwordx4 a[148:151], v2, s[4:7], s59 offen offset:2176 nt
    buffer_load_dwordx4 a[152:155], v2, s[4:7], s59 offen offset:3072 nt
    buffer_load_dwordx4 a[156:159], v2, s[4:7], s59 offen offset:3200 nt
    s_add_u32 s79, s59, 4096
    s_pack_lh_b32_b16 s59, s79, s59
QT5Q:
    buffer_load_dwordx4 a[160:163], v2, s[4:7], s59 offen offset:0 nt
    buffer_load_dwordx4 a[164:167], v2, s[4:7], s59 offen offset:128 nt
    buffer_load_dwordx4 a[168:171], v2, s[4:7], s59 offen offset:1024 nt
    buffer_load_dwordx4 a[172:175], v2, s[4:7], s59 offen offset:1152 nt
    buffer_load_dwordx4 a[176:179], v2, s[4:7], s59 offen offset:2048 nt
    buffer_load_dwordx4 a[180:183], v2, s[4:7], s59 offen offset:2176 nt
    buffer_load_dwordx4 a[184:187], v2, s[4:7], s59 offen offset:3072 nt
    buffer_load_dwordx4 a[188:191], v2, s[4:7], s59 offen offset:3200 nt
    s_add_u32 s79, s59, 12288
    s_pack_lh_b32_b16 s59, s79, s59
QT6Q:
    buffer_load_dwordx4 a[192:195], v2, s[4:7], s59 offen offset:0 nt
    buffer_load_dwordx4 a[196:199], v2, s[4:7], s59 offen offset:128 nt
    buffer_load_dwordx4 a[200:203], v2, s[4:7], s59 offen offset:1024 nt
    buffer_load_dwordx4 a[204:207], v2, s[4:7], s59 offen offset:1152 nt
    buffer_load_dwordx4 a[208:211], v2, s[4:7], s59 offen offset:2048 nt
    buffer_load_dwordx4 a[212:215], v2, s[4:7], s59 offen offset:2176 nt
    buffer_load_dwordx4 a[216:219], v2, s[4:7], s59 offen offset:3072 nt
    buffer_load_dwordx4 a[220:223], v2, s[4:7], s59 offen offset:3200 nt
    s_add_u32 s79, s59, 4096
    s_pack_lh_b32_b16 s59, s79, s59
QT7Q:
    buffer_load_dwordx4 a[224:227], v2, s[4:7], s59 offen offset:0 nt
    buffer_load_dwordx4 a[228:231], v2, s[4:7], s59 offen offset:128 nt
    buffer_load_dwordx4 a[232:235], v2, s[4:7], s59 offen offset:1024 nt
    buffer_load_dwordx4 a[236:239], v2, s[4:7], s59 offen offset:1152 nt
    buffer_load_dwordx4 a[240:243], v2, s[4:7], s59 offen offset:2048 nt
    buffer_load_dwordx4 a[244:247], v2, s[4:7], s59 offen offset:2176 nt
    buffer_load_dwordx4 a[248:251], v2, s[4:7], s59 offen offset:3072 nt
    buffer_load_dwordx4 a[252:255], v2, s[4:7], s59 offen offset:3200 nt
    s_add_u32 s79, s59, 12288
    s_pack_lh_b32_b16 s59, s79, s59
QT8Q:
    v_and_b32 v10, 3, v1
    v_lshlrev_b32 v10, 9, v10
    v_lshrrev_b32 v11, 4, v1
    v_lshl_add_u32 v10, v11, 5, v10
    v_bfe_u32 v11, v1, 2, 1
    v_lshl_add_u32 v10, v11, 7, v10
    s_lshr_b32 s61, s2, 3
    s_lshl_b32 s61, s61, 11
    v_add_u32 v6, s61, v10
    s_mov_b32 s61, 0x10000
    buffer_load_dwordx4 v[224:227], v6, s[12:15], s61 offen offset:0 sc1
    s_mov_b32 s61, 0x10000
    buffer_load_dwordx4 v[228:231], v6, s[12:15], s61 offen offset:16 sc1
    s_mov_b32 s61, 0x10000
    buffer_load_dwordx4 v[232:235], v6, s[12:15], s61 offen offset:256 sc1
    s_mov_b32 s61, 0x10000
    buffer_load_dwordx4 v[236:239], v6, s[12:15], s61 offen offset:272 sc1
    buffer_load_dwordx4 v[64:67], v3, s[8:11], s60 offen offset:0 nt
    buffer_load_dwordx4 v[68:71], v3, s[8:11], s60 offen offset:1024 nt
    buffer_load_dwordx4 v[72:75], v3, s[8:11], s60 offen offset:2048 nt
    buffer_load_dwordx4 v[76:79], v3, s[8:11], s60 offen offset:3072 nt
    s_add_u32 s79, s60, 4096
    s_pack_lh_b32_b16 s60, s79, s60
    buffer_load_dwordx4 v[80:83], v3, s[8:11], s60 offen offset:0 nt
    buffer_load_dwordx4 v[84:87], v3, s[8:11], s60 offen offset:1024 nt
    buffer_load_dwordx4 v[88:91], v3, s[8:11], s60 offen offset:2048 nt
    buffer_load_dwordx4 v[92:95], v3, s[8:11], s60 offen offset:3072 nt
    s_add_u32 s79, s60, 4096
    s_pack_lh_b32_b16 s60, s79, s60
    s_mov_b32 s61, 0x10000
    buffer_load_dwordx4 v[224:227], v6, s[12:15], s61 offen offset:0 sc1
    s_mov_b32 s61, 0x10000
    buffer_load_dwordx4 v[228:231], v6, s[12:15], s61 offen offset:16 sc1
    s_mov_b32 s61, 0x10000
    buffer_load_dwordx4 v[232:235], v6, s[12:15], s61 offen offset:256 sc1
    s_mov_b32 s61, 0x10000
    buffer_load_dwordx4 v[236:239], v6, s[12:15], s61 offen offset:272 sc1
    buffer_load_dwordx4 v[96:99], v3, s[8:11], s60 offen offset:0 nt
    buffer_load_dwordx4 v[100:103], v3, s[8:11], s60 offen offset:1024 nt
    buffer_load_dwordx4 v[104:107], v3, s[8:11], s60 offen offset:2048 nt
    buffer_load_dwordx4 v[108:111], v3, s[8:11], s60 offen offset:3072 nt
    s_add_u32 s79, s60, 4096
    s_pack_lh_b32_b16 s60, s79, s60
    buffer_load_dwordx4 v[112:115], v3, s[8:11], s60 offen offset:0 nt
    buffer_load_dwordx4 v[116:119], v3, s[8:11], s60 offen offset:1024 nt
    buffer_load_dwordx4 v[120:123], v3, s[8:11], s60 offen offset:2048 nt
    buffer_load_dwordx4 v[124:127], v3, s[8:11], s60 offen offset:3072 nt
    s_add_u32 s79, s60, 4096
    s_pack_lh_b32_b16 s60, s79, s60
    s_mov_b32 s61, 0x10000
    buffer_load_dwordx4 v[224:227], v6, s[12:15], s61 offen offset:0 sc1
    s_mov_b32 s61, 0x10000
    buffer_load_dwordx4 v[228:231], v6, s[12:15], s61 offen offset:16 sc1
    s_mov_b32 s61, 0x10000
    buffer_load_dwordx4 v[232:235], v6, s[12:15], s61 offen offset:256 sc1
    s_mov_b32 s61, 0x10000
    buffer_load_dwordx4 v[236:239], v6, s[12:15], s61 offen offset:272 sc1
    buffer_load_dwordx4 v[128:131], v3, s[8:11], s60 offen offset:0 nt
    buffer_load_dwordx4 v[132:135], v3, s[8:11], s60 offen offset:1024 nt
    buffer_load_dwordx4 v[136:139], v3, s[8:11], s60 offen offset:2048 nt
    buffer_load_dwordx4 v[140:143], v3, s[8:11], s60 offen offset:3072 nt
    s_add_u32 s79, s60, 4096
    s_pack_lh_b32_b16 s60, s79, s60
    buffer_load_dwordx4 v[144:147], v3, s[8:11], s60 offen offset:0 nt
    buffer_load_dwordx4 v[148:151], v3, s[8:11], s60 offen offset:1024 nt
    buffer_load_dwordx4 v[152:155], v3, s[8:11], s60 offen offset:2048 nt
    buffer_load_dwordx4 v[156:159], v3, s[8:11], s60 offen offset:3072 nt
    s_add_u32 s79, s60, 4096
    s_pack_lh_b32_b16 s60, s79, s60
    s_waitcnt vmcnt(32)
    v_mov_b32 v48, v224
    v_mov_b32 v49, v225
    v_mov_b32 v50, v226
    v_mov_b32 v51, v227
    v_mov_b32 v52, v228
    v_mov_b32 v53, v229
    v_mov_b32 v54, v230
    v_mov_b32 v55, v231
    v_mov_b32 v56, v232
    v_mov_b32 v57, v233
    v_mov_b32 v58, v234
    v_mov_b32 v59, v235
    v_mov_b32 v60, v236
    v_mov_b32 v61, v237
    v_mov_b32 v62, v238
    v_mov_b32 v63, v239
    v_xor_b32 v10, s58, v48
    v_bitop3_b32 v10, v49, s58, v10 bitop3:0xbe
    v_bitop3_b32 v10, v50, s58, v10 bitop3:0xbe
    v_bitop3_b32 v10, v51, s58, v10 bitop3:0xbe
    v_bitop3_b32 v10, v52, s58, v10 bitop3:0xbe
    v_bitop3_b32 v10, v53, s58, v10 bitop3:0xbe
    v_bitop3_b32 v10, v54, s58, v10 bitop3:0xbe
    v_bitop3_b32 v10, v55, s58, v10 bitop3:0xbe
    v_bitop3_b32 v10, v56, s58, v10 bitop3:0xbe
    v_bitop3_b32 v10, v57, s58, v10 bitop3:0xbe
    v_bitop3_b32 v10, v58, s58, v10 bitop3:0xbe
    v_bitop3_b32 v10, v59, s58, v10 bitop3:0xbe
    v_bitop3_b32 v10, v60, s58, v10 bitop3:0xbe
    v_bitop3_b32 v10, v61, s58, v10 bitop3:0xbe
    v_bitop3_b32 v10, v62, s58, v10 bitop3:0xbe
    v_bitop3_b32 v10, v63, s58, v10 bitop3:0xbe
    v_and_b32 v10, 0xff, v10
    v_cmp_ne_u32 vcc, 0, v10
    s_cbranch_vccz QGO_Q
    s_waitcnt vmcnt(20)
    v_mov_b32 v48, v224
    v_mov_b32 v49, v225
    v_mov_b32 v50, v226
    v_mov_b32 v51, v227
    v_mov_b32 v52, v228
    v_mov_b32 v53, v229
    v_mov_b32 v54, v230
    v_mov_b32 v55, v231
    v_mov_b32 v56, v232
    v_mov_b32 v57, v233
    v_mov_b32 v58, v234
    v_mov_b32 v59, v235
    v_mov_b32 v60, v236
    v_mov_b32 v61, v237
    v_mov_b32 v62, v238
    v_mov_b32 v63, v239
    v_xor_b32 v10, s58, v48
    v_bitop3_b32 v10, v49, s58, v10 bitop3:0xbe
    v_bitop3_b32 v10, v50, s58, v10 bitop3:0xbe
    v_bitop3_b32 v10, v51, s58, v10 bitop3:0xbe
    v_bitop3_b32 v10, v52, s58, v10 bitop3:0xbe
    v_bitop3_b32 v10, v53, s58, v10 bitop3:0xbe
    v_bitop3_b32 v10, v54, s58, v10 bitop3:0xbe
    v_bitop3_b32 v10, v55, s58, v10 bitop3:0xbe
    v_bitop3_b32 v10, v56, s58, v10 bitop3:0xbe
    v_bitop3_b32 v10, v57, s58, v10 bitop3:0xbe
    v_bitop3_b32 v10, v58, s58, v10 bitop3:0xbe
    v_bitop3_b32 v10, v59, s58, v10 bitop3:0xbe
    v_bitop3_b32 v10, v60, s58, v10 bitop3:0xbe
    v_bitop3_b32 v10, v61, s58, v10 bitop3:0xbe
    v_bitop3_b32 v10, v62, s58, v10 bitop3:0xbe
    v_bitop3_b32 v10, v63, s58, v10 bitop3:0xbe
    v_and_b32 v10, 0xff, v10
    v_cmp_ne_u32 vcc, 0, v10
    s_cbranch_vccz QGO_Q
    s_waitcnt vmcnt(8)
    v_mov_b32 v48, v224
    v_mov_b32 v49, v225
    v_mov_b32 v50, v226
    v_mov_b32 v51, v227
    v_mov_b32 v52, v228
    v_mov_b32 v53, v229
    v_mov_b32 v54, v230
    v_mov_b32 v55, v231
    v_mov_b32 v56, v232
    v_mov_b32 v57, v233
    v_mov_b32 v58, v234
    v_mov_b32 v59, v235
    v_mov_b32 v60, v236
    v_mov_b32 v61, v237
    v_mov_b32 v62, v238
    v_mov_b32 v63, v239
    v_xor_b32 v10, s58, v48
    v_bitop3_b32 v10, v49, s58, v10 bitop3:0xbe
    v_bitop3_b32 v10, v50, s58, v10 bitop3:0xbe
    v_bitop3_b32 v10, v51, s58, v10 bitop3:0xbe
    v_bitop3_b32 v10, v52, s58, v10 bitop3:0xbe
    v_bitop3_b32 v10, v53, s58, v10 bitop3:0xbe
    v_bitop3_b32 v10, v54, s58, v10 bitop3:0xbe
    v_bitop3_b32 v10, v55, s58, v10 bitop3:0xbe
    v_bitop3_b32 v10, v56, s58, v10 bitop3:0xbe
    v_bitop3_b32 v10, v57, s58, v10 bitop3:0xbe
    v_bitop3_b32 v10, v58, s58, v10 bitop3:0xbe
    v_bitop3_b32 v10, v59, s58, v10 bitop3:0xbe
    v_bitop3_b32 v10, v60, s58, v10 bitop3:0xbe
    v_bitop3_b32 v10, v61, s58, v10 bitop3:0xbe
    v_bitop3_b32 v10, v62, s58, v10 bitop3:0xbe
    v_bitop3_b32 v10, v63, s58, v10 bitop3:0xbe
    v_and_b32 v10, 0xff, v10
    v_cmp_ne_u32 vcc, 0, v10
    s_cbranch_vccz QGO_Q
    s_mov_b32 s62, 0x40000
QRX_Q:
    s_mov_b32 s61, 0x10000
    buffer_load_dwordx4 v[224:227], v6, s[12:15], s61 offen offset:0 sc1
    s_mov_b32 s61, 0x10000
    buffer_load_dwordx4 v[228:231], v6, s[12:15], s61 offen offset:16 sc1
    s_mov_b32 s61, 0x10000
    buffer_load_dwordx4 v[232:235], v6, s[12:15], s61 offen offset:256 sc1
    s_mov_b32 s61, 0x10000
    buffer_load_dwordx4 v[236:239], v6, s[12:15], s61 offen offset:272 sc1
    s_waitcnt vmcnt(0)
    v_mov_b32 v48, v224
    v_mov_b32 v49, v225
    v_mov_b32 v50, v226
    v_mov_b32 v51, v227
    v_mov_b32 v52, v228
    v_mov_b32 v53, v229
    v_mov_b32 v54, v230
    v_mov_b32 v55, v231
    v_mov_b32 v56, v232
    v_mov_b32 v57, v233
    v_mov_b32 v58, v234
    v_mov_b32 v59, v235
    v_mov_b32 v60, v236
    v_mov_b32 v61, v237
    v_mov_b32 v62, v238
    v_mov_b32 v63, v239
    v_xor_b32 v10, s58, v48
    v_bitop3_b32 v10, v49, s58, v10 bitop3:0xbe
    v_bitop3_b32 v10, v50, s58, v10 bitop3:0xbe
    v_bitop3_b32 v10, v51, s58, v10 bitop3:0xbe
    v_bitop3_b32 v10, v52, s58, v10 bitop3:0xbe
    v_bitop3_b32 v10, v53, s58, v10 bitop3:0xbe
    v_bitop3_b32 v10, v54, s58, v10 bitop3:0xbe
    v_bitop3_b32 v10, v55, s58, v10 bitop3:0xbe
    v_bitop3_b32 v10, v56, s58, v10 bitop3:0xbe
    v_bitop3_b32 v10, v57, s58, v10 bitop3:0xbe
    v_bitop3_b32 v10, v58, s58, v10 bitop3:0xbe
    v_bitop3_b32 v10, v59, s58, v10 bitop3:0xbe
    v_bitop3_b32 v10, v60, s58, v10 bitop3:0xbe
    v_bitop3_b32 v10, v61, s58, v10 bitop3:0xbe
    v_bitop3_b32 v10, v62, s58, v10 bitop3:0xbe
    v_bitop3_b32 v10, v63, s58, v10 bitop3:0xbe
    v_and_b32 v10, 0xff, v10
    v_cmp_ne_u32 vcc, 0, v10
    s_cbranch_vccz QGO_Q
    s_sub_u32 s62, s62, 1
    s_cbranch_scc0 QRX_Q
QGO_Q:
    buffer_load_dwordx4 v[224:227], v3, s[8:11], s60 offen offset:0 nt
    v_perm_b32 v16, v49, v48, s68
    v_perm_b32 v17, v51, v50, s68
    v_perm_b32 v18, v53, v52, s68
    v_perm_b32 v19, v55, v54, s68
    v_perm_b32 v20, v57, v56, s68
    v_perm_b32 v21, v59, v58, s68
    v_perm_b32 v22, v61, v60, s68
    buffer_load_dwordx4 v[228:231], v3, s[8:11], s60 offen offset:1024 nt
    v_perm_b32 v23, v63, v62, s68
    v_cndmask_b32 v32, 0, v16, s[72:73]
    v_cndmask_b32 v33, 0, v17, s[72:73]
    v_cndmask_b32 v34, 0, v18, s[72:73]
    v_cndmask_b32 v35, 0, v19, s[72:73]
    v_cndmask_b32 v36, 0, v20, s[72:73]
    v_cndmask_b32 v37, 0, v21, s[72:73]
    v_cndmask_b32 v38, 0, v22, s[72:73]
    buffer_load_dwordx4 v[232:235], v3, s[8:11], s60 offen offset:2048 nt
    v_cndmask_b32 v39, 0, v23, s[72:73]
    v_cndmask_b32 v40, 0, v16, s[74:75]
    v_cndmask_b32 v41, 0, v17, s[74:75]
    v_cndmask_b32 v42, 0, v18, s[74:75]
    v_cndmask_b32 v43, 0, v19, s[74:75]
    v_cndmask_b32 v44, 0, v20, s[74:75]
    v_cndmask_b32 v45, 0, v21, s[74:75]
    buffer_load_dwordx4 v[236:239], v3, s[8:11], s60 offen offset:3072 nt
    v_cndmask_b32 v46, 0, v22, s[74:75]
    v_cndmask_b32 v47, 0, v23, s[74:75]
    v_mfma_f32_16x16x32_bf16 v[160:163], a[0:3], v[32:35], 0
    v_mfma_f32_16x16x32_bf16 v[164:167], a[8:11], v[32:35], 0
    v_mfma_f32_16x16x32_bf16 v[168:171], a[16:19], v[32:35], 0
    v_mfma_f32_16x16x32_bf16 v[172:175], a[24:27], v[32:35], 0
    v_mfma_f32_16x16x32_bf16 v[176:179], a[32:35], v[32:35], 0
    v_mfma_f32_16x16x32_bf16 v[180:183], a[40:43], v[32:35], 0
    s_add_u32 s79, s60, 4096
    s_pack_lh_b32_b16 s60, s79, s60
    buffer_load_dwordx4 v[240:243], v3, s[8:11], s60 offen offset:0 nt
    v_mfma_f32_16x16x32_bf16 v[184:187], a[48:51], v[32:35], 0
    v_mfma_f32_16x16x32_bf16 v[188:191], a[56:59], v[32:35], 0
    v_mfma_f32_16x16x32_bf16 v[160:163], a[4:7], v[36:39], v[160:163]
    v_mfma_f32_16x16x32_bf16 v[164:167], a[12:15], v[36:39], v[164:167]
    v_mfma_f32_16x16x32_bf16 v[168:171], a[20:23], v[36:39], v[168:171]
    v_mfma_f32_16x16x32_bf16 v[172:175], a[28:31], v[36:39], v[172:175]
    v_mfma_f32_16x16x32_bf16 v[176:179], a[36:39], v[36:39], v[176:179]
    buffer_load_dwordx4 v[244:247], v3, s[8:11], s60 offen offset:1024 nt
    v_mfma_f32_16x16x32_bf16 v[180:183], a[44:47], v[36:39], v[180:183]
    v_mfma_f32_16x16x32_bf16 v[184:187], a[52:55], v[36:39], v[184:187]
    v_mfma_f32_16x16x32_bf16 v[188:191], a[60:63], v[36:39], v[188:191]
    v_mfma_f32_16x16x32_bf16 v[160:163], a[64:67], v[40:43], v[160:163]
    v_mfma_f32_16x16x32_bf16 v[164:167], a[72:75], v[40:43], v[164:167]
    v_mfma_f32_16x16x32_bf16 v[168:171], a[80:83], v[40:43], v[168:171]
    v_mfma_f32_16x16x32_bf16 v[172:175], a[88:91], v[40:43], v[172:175]
    v_mfma_f32_16x16x32_bf16 v[176:179], a[96:99], v[40:43], v[176:179]
    buffer_load_dwordx4 v[248:251], v3, s[8:11], s60 offen offset:2048 nt
    v_mfma_f32_16x16x32_bf16 v[180:183], a[104:107], v[40:43], v[180:183]
    v_mfma_f32_16x16x32_bf16 v[184:187], a[112:115], v[40:43], v[184:187]
    v_mfma_f32_16x16x32_bf16 v[188:191], a[120:123], v[40:43], v[188:191]
    v_mfma_f32_16x16x32_bf16 v[160:163], a[68:71], v[44:47], v[160:163]
    v_mfma_f32_16x16x32_bf16 v[164:167], a[76:79], v[44:47], v[164:167]
    v_mfma_f32_16x16x32_bf16 v[168:171], a[84:87], v[44:47], v[168:171]
    v_mfma_f32_16x16x32_bf16 v[172:175], a[92:95], v[44:47], v[172:175]
    buffer_load_dwordx4 v[252:255], v3, s[8:11], s60 offen offset:3072 nt
    s_add_u32 s79, s60, 4096
    s_pack_lh_b32_b16 s60, s79, s60
    v_mfma_f32_16x16x32_bf16 v[176:179], a[100:103], v[44:47], v[176:179]
    v_mfma_f32_16x16x32_bf16 v[180:183], a[108:111], v[44:47], v[180:183]
    v_mfma_f32_16x16x32_bf16 v[184:187], a[116:119], v[44:47], v[184:187]
    v_mfma_f32_16x16x32_bf16 v[188:191], a[124:127], v[44:47], v[188:191]
    v_mfma_f32_16x16x32_bf16 v[192:195], a[128:131], v[32:35], 0
    v_mfma_f32_16x16x32_bf16 v[196:199], a[136:139], v[32:35], 0
    v_mfma_f32_16x16x32_bf16 v[200:203], a[144:147], v[32:35], 0
    v_mfma_f32_16x16x32_bf16 v[204:207], a[152:155], v[32:35], 0
    v_mfma_f32_16x16x32_bf16 v[208:211], a[160:163], v[32:35], 0
    v_mfma_f32_16x16x32_bf16 v[212:215], a[168:171], v[32:35], 0
    v_mfma_f32_16x16x32_bf16 v[216:219], a[176:179], v[32:35], 0
    v_mfma_f32_16x16x32_bf16 v[220:223], a[184:187], v[32:35], 0
    v_mfma_f32_16x16x32_bf16 v[192:195], a[132:135], v[36:39], v[192:195]
    v_mfma_f32_16x16x32_bf16 v[196:199], a[140:143], v[36:39], v[196:199]
    v_mfma_f32_16x16x32_bf16 v[200:203], a[148:151], v[36:39], v[200:203]
    v_mfma_f32_16x16x32_bf16 v[204:207], a[156:159], v[36:39], v[204:207]
    v_mfma_f32_16x16x32_bf16 v[208:211], a[164:167], v[36:39], v[208:211]
    v_mfma_f32_16x16x32_bf16 v[212:215], a[172:175], v[36:39], v[212:215]
    v_mfma_f32_16x16x32_bf16 v[216:219], a[180:183], v[36:39], v[216:219]
    v_mfma_f32_16x16x32_bf16 v[220:223], a[188:191], v[36:39], v[220:223]
    v_mfma_f32_16x16x32_bf16 v[192:195], a[192:195], v[40:43], v[192:195]
    v_mfma_f32_16x16x32_bf16 v[196:199], a[200:203], v[40:43], v[196:199]
    v_mfma_f32_16x16x32_bf16 v[200:203], a[208:211], v[40:43], v[200:203]
    v_mfma_f32_16x16x32_bf16 v[204:207], a[216:219], v[40:43], v[204:207]
    v_mfma_f32_16x16x32_bf16 v[208:211], a[224:227], v[40:43], v[208:211]
    v_mfma_f32_16x16x32_bf16 v[212:215], a[232:235], v[40:43], v[212:215]
    v_mfma_f32_16x16x32_bf16 v[216:219], a[240:243], v[40:43], v[216:219]
    v_mfma_f32_16x16x32_bf16 v[220:223], a[248:251], v[40:43], v[220:223]
    v_mfma_f32_16x16x32_bf16 v[192:195], a[196:199], v[44:47], v[192:195]
    v_mfma_f32_16x16x32_bf16 v[196:199], a[204:207], v[44:47], v[196:199]
    v_mfma_f32_16x16x32_bf16 v[200:203], a[212:215], v[44:47], v[200:203]
    v_mfma_f32_16x16x32_bf16 v[204:207], a[220:223], v[44:47], v[204:207]
    v_mfma_f32_16x16x32_bf16 v[208:211], a[228:231], v[44:47], v[208:211]
    v_mfma_f32_16x16x32_bf16 v[212:215], a[236:239], v[44:47], v[212:215]
    v_mfma_f32_16x16x32_bf16 v[216:219], a[244:247], v[44:47], v[216:219]
    v_mfma_f32_16x16x32_bf16 v[220:223], a[252:255], v[44:47], v[220:223]
    v_add_f32_dpp v48, v161, v160 row_shl:4 row_mask:0xf bank_mask:0x5
    v_add_f32_dpp v49, v165, v164 row_shl:4 row_mask:0xf bank_mask:0x5
    v_add_f32_dpp v50, v169, v168 row_shl:4 row_mask:0xf bank_mask:0x5
    v_add_f32_dpp v51, v173, v172 row_shl:4 row_mask:0xf bank_mask:0x5
    v_add_f32_dpp v52, v177, v176 row_shl:4 row_mask:0xf bank_mask:0x5
    v_add_f32_dpp v53, v181, v180 row_shl:4 row_mask:0xf bank_mask:0x5
    v_add_f32_dpp v54, v185, v184 row_shl:4 row_mask:0xf bank_mask:0x5
    v_add_f32_dpp v55, v189, v188 row_shl:4 row_mask:0xf bank_mask:0x5
    v_add_f32_dpp v56, v193, v192 row_shl:4 row_mask:0xf bank_mask:0x5
    v_add_f32_dpp v57, v197, v196 row_shl:4 row_mask:0xf bank_mask:0x5
    v_add_f32_dpp v58, v201, v200 row_shl:4 row_mask:0xf bank_mask:0x5
    v_add_f32_dpp v59, v205, v204 row_shl:4 row_mask:0xf bank_mask:0x5
    v_add_f32_dpp v60, v209, v208 row_shl:4 row_mask:0xf bank_mask:0x5
    v_add_f32_dpp v61, v213, v212 row_shl:4 row_mask:0xf bank_mask:0x5
    v_add_f32_dpp v62, v217, v216 row_shl:4 row_mask:0xf bank_mask:0x5
    v_add_f32_dpp v63, v221, v220 row_shl:4 row_mask:0xf bank_mask:0x5
    v_add_f32_dpp v48, v162, v163 row_shr:4 row_mask:0xf bank_mask:0xa
    v_add_f32_dpp v49, v166, v167 row_shr:4 row_mask:0xf bank_mask:0xa
    v_add_f32_dpp v50, v170, v171 row_shr:4 row_mask:0xf bank_mask:0xa
    v_add_f32_dpp v51, v174, v175 row_shr:4 row_mask:0xf bank_mask:0xa
    v_add_f32_dpp v52, v178, v179 row_shr:4 row_mask:0xf bank_mask:0xa
    v_add_f32_dpp v53, v182, v183 row_shr:4 row_mask:0xf bank_mask:0xa
    v_add_f32_dpp v54, v186, v187 row_shr:4 row_mask:0xf bank_mask:0xa
    v_add_f32_dpp v55, v190, v191 row_shr:4 row_mask:0xf bank_mask:0xa
    v_add_f32_dpp v56, v194, v195 row_shr:4 row_mask:0xf bank_mask:0xa
    v_add_f32_dpp v57, v198, v199 row_shr:4 row_mask:0xf bank_mask:0xa
    v_add_f32_dpp v58, v202, v203 row_shr:4 row_mask:0xf bank_mask:0xa
    v_add_f32_dpp v59, v206, v207 row_shr:4 row_mask:0xf bank_mask:0xa
    v_add_f32_dpp v60, v210, v211 row_shr:4 row_mask:0xf bank_mask:0xa
    v_add_f32_dpp v61, v214, v215 row_shr:4 row_mask:0xf bank_mask:0xa
    v_add_f32_dpp v62, v218, v219 row_shr:4 row_mask:0xf bank_mask:0xa
    v_add_f32_dpp v63, v222, v223 row_shr:4 row_mask:0xf bank_mask:0xa
    buffer_load_dwordx4 v[160:163], v3, s[8:11], s60 offen offset:0 nt
    v_cvt_pk_bf16_f32 v32, v48, v49
    v_cvt_pk_bf16_f32 v33, v50, v51
    v_cvt_pk_bf16_f32 v34, v52, v53
    v_cvt_pk_bf16_f32 v35, v54, v55
    v_cvt_pk_bf16_f32 v36, v56, v57
    v_cvt_pk_bf16_f32 v37, v58, v59
    v_cvt_pk_bf16_f32 v38, v60, v61
    v_cvt_pk_bf16_f32 v39, v62, v63
    v_lshlrev_b32 v48, 16, v32
    buffer_load_dwordx4 v[164:167], v3, s[8:11], s60 offen offset:1024 nt
    v_and_b32 v49, s66, v32
    v_lshlrev_b32 v50, 16, v33
    v_and_b32 v51, s66, v33
    v_lshlrev_b32 v52, 16, v34
    v_and_b32 v53, s66, v34
    v_lshlrev_b32 v54, 16, v35
    v_and_b32 v55, s66, v35
    v_lshlrev_b32 v56, 16, v36
    v_and_b32 v57, s66, v36
    v_lshlrev_b32 v58, 16, v37
    buffer_load_dwordx4 v[168:171], v3, s[8:11], s60 offen offset:2048 nt
    v_and_b32 v59, s66, v37
    v_lshlrev_b32 v60, 16, v38
    v_and_b32 v61, s66, v38
    v_lshlrev_b32 v62, 16, v39
    v_and_b32 v63, s66, v39
    v_mul_f32 v48, s70, v48
    v_mul_f32 v49, s70, v49
    v_mul_f32 v50, s70, v50
    v_mul_f32 v51, s70, v51
    buffer_load_dwordx4 v[172:175], v3, s[8:11], s60 offen offset:3072 nt
    v_mul_f32 v52, s70, v52
    v_mul_f32 v53, s70, v53
    v_mul_f32 v54, s70, v54
    v_mul_f32 v55, s70, v55
    v_mul_f32 v56, s70, v56
    v_mul_f32 v57, s70, v57
    v_mul_f32 v58, s70, v58
    v_mul_f32 v59, s70, v59
    v_mul_f32 v60, s70, v60
    v_mul_f32 v61, s70, v61
    s_add_u32 s79, s60, 4096
    s_pack_lh_b32_b16 s60, s79, s60
    buffer_load_dwordx4 v[176:179], v3, s[8:11], s60 offen offset:0 nt
    v_mul_f32 v62, s70, v62
    v_mul_f32 v63, s70, v63
    v_cvt_pk_bf16_f32 v32, v48, v49
    v_cvt_pk_bf16_f32 v33, v50, v51
    v_cvt_pk_bf16_f32 v34, v52, v53
    v_cvt_pk_bf16_f32 v35, v54, v55
    v_cvt_pk_bf16_f32 v36, v56, v57
    v_cvt_pk_bf16_f32 v37, v58, v59
    v_cvt_pk_bf16_f32 v38, v60, v61
    buffer_load_dwordx4 v[180:183], v3, s[8:11], s60 offen offset:1024 nt
    v_cvt_pk_bf16_f32 v39, v62, v63
    v_lshlrev_b32 v48, 16, v32
    v_and_b32 v49, s66, v32
    v_lshlrev_b32 v50, 16, v33
    v_and_b32 v51, s66, v33
    v_lshlrev_b32 v52, 16, v34
    v_and_b32 v53, s66, v34
    v_lshlrev_b32 v54, 16, v35
    v_and_b32 v55, s66, v35
    v_lshlrev_b32 v56, 16, v36
    buffer_load_dwordx4 v[184:187], v3, s[8:11], s60 offen offset:2048 nt
    v_and_b32 v57, s66, v36
    v_lshlrev_b32 v58, 16, v37
    v_and_b32 v59, s66, v37
    v_lshlrev_b32 v60, 16, v38
    v_and_b32 v61, s66, v38
    v_lshlrev_b32 v62, 16, v39
    v_and_b32 v63, s66, v39
    v_max3_f32 v9, v48, v49, v50
    v_max3_f32 v9, v9, v51, v52
    buffer_load_dwordx4 v[188:191], v3, s[8:11], s60 offen offset:3072 nt
    v_max3_f32 v9, v9, v53, v54
    v_max3_f32 v9, v9, v55, v56
    v_max3_f32 v9, v9, v57, v58
    v_max3_f32 v9, v9, v59, v60
    v_max3_f32 v9, v9, v61, v62
    v_max_f32 v9, v9, v63
    s_nop 1
    v_max_f32_dpp v9, v9, v9 row_ror:4 row_mask:0xf bank_mask:0xf
    s_nop 1
    v_max_f32_dpp v9, v9, v9 row_ror:8 row_mask:0xf bank_mask:0xf
    v_mov_b32 v10, v9
    s_nop 1
    v_permlane16_swap_b32 v9, v10
    s_add_u32 s79, s60, 4096
    s_pack_lh_b32_b16 s60, s79, s60
    buffer_load_dwordx4 v[192:195], v3, s[8:11], s60 offen offset:0 nt
    v_max_f32 v9, v9, v10
    v_mov_b32 v10, v9
    s_nop 1
    v_permlane32_swap_b32 v9, v10
    v_max_f32 v9, v9, v10
    v_mul_f32 v11, s69, v9
    v_fma_f32 v48, v48, s69, -v11
    v_fma_f32 v49, v49, s69, -v11
    v_fma_f32 v50, v50, s69, -v11
    v_fma_f32 v51, v51, s69, -v11
    buffer_load_dwordx4 v[196:199], v3, s[8:11], s60 offen offset:1024 nt
    v_fma_f32 v52, v52, s69, -v11
    v_fma_f32 v53, v53, s69, -v11
    v_fma_f32 v54, v54, s69, -v11
    v_fma_f32 v55, v55, s69, -v11
    v_fma_f32 v56, v56, s69, -v11
    v_fma_f32 v57, v57, s69, -v11
    v_fma_f32 v58, v58, s69, -v11
    v_fma_f32 v59, v59, s69, -v11
    v_fma_f32 v60, v60, s69, -v11
    v_fma_f32 v61, v61, s69, -v11
    buffer_load_dwordx4 v[200:203], v3, s[8:11], s60 offen offset:2048 nt
    v_fma_f32 v62, v62, s69, -v11
    v_fma_f32 v63, v63, s69, -v11
    v_exp_f32 v48, v48
    v_exp_f32 v49, v49
    v_exp_f32 v50, v50
    v_exp_f32 v51, v51
    v_exp_f32 v52, v52
    v_exp_f32 v53, v53
    v_exp_f32 v54, v54
    buffer_load_dwordx4 v[204:207], v3, s[8:11], s60 offen offset:3072 nt
    v_exp_f32 v55, v55
    v_exp_f32 v56, v56
    v_exp_f32 v57, v57
    v_exp_f32 v58, v58
    v_exp_f32 v59, v59
    v_exp_f32 v60, v60
    v_exp_f32 v61, v61
    v_exp_f32 v62, v62
    v_exp_f32 v63, v63
    v_add_f32 v13, v48, v49
    s_add_u32 s79, s60, 4096
    s_pack_lh_b32_b16 s60, s79, s60
    buffer_load_dwordx4 v[208:211], v3, s[8:11], s60 offen offset:0 nt
    v_add_f32 v13, v13, v50
    v_add_f32 v13, v13, v51
    v_add_f32 v13, v13, v52
    v_add_f32 v13, v13, v53
    v_add_f32 v13, v13, v54
    v_add_f32 v13, v13, v55
    v_add_f32 v13, v13, v56
    v_add_f32 v13, v13, v57
    v_add_f32 v13, v13, v58
    buffer_load_dwordx4 v[212:215], v3, s[8:11], s60 offen offset:1024 nt
    v_add_f32 v13, v13, v59
    v_add_f32 v13, v13, v60
    v_add_f32 v13, v13, v61
    v_add_f32 v13, v13, v62
    v_add_f32 v13, v13, v63
    v_cvt_pk_bf16_f32 v16, v48, v49
    v_cvt_pk_bf16_f32 v17, v50, v51
    v_cvt_pk_bf16_f32 v18, v52, v53
    v_cvt_pk_bf16_f32 v19, v54, v55
    v_cvt_pk_bf16_f32 v20, v56, v57
    buffer_load_dwordx4 v[216:219], v3, s[8:11], s60 offen offset:2048 nt
    v_cvt_pk_bf16_f32 v21, v58, v59
    v_cvt_pk_bf16_f32 v22, v60, v61
    v_cvt_pk_bf16_f32 v23, v62, v63
    v_add_f32_dpp v13, v13, v13 row_ror:4 row_mask:0xf bank_mask:0xf
    s_nop 1
    v_add_f32_dpp v13, v13, v13 row_ror:8 row_mask:0xf bank_mask:0xf
    v_mov_b32 v10, v13
    s_nop 1
    v_permlane16_swap_b32 v13, v10
    v_add_f32 v13, v13, v10
    v_mov_b32 v10, v13
    buffer_load_dwordx4 v[220:223], v3, s[8:11], s60 offen offset:3072 nt
    s_add_u32 s79, s60, 4096
    s_pack_lh_b32_b16 s60, s79, s60
    v_permlane32_swap_b32 v13, v10
    v_add_f32 v13, v13, v10
    v_mov_b32 v12, v9
    v_mov_b32 v14, s58
    v_mov_b32 v15, s58
    s_lshl_b32 s64, s2, 8
    s_lshl_b32 s61, s3, 6
    s_add_u32 s64, s64, s61
    v_lshlrev_b32 v10, 4, v1
    v_add_u32 v6, s64, v10
    s_mov_b64 exec, 0xf
    s_mov_b32 s61, 0x20000
    buffer_store_dwordx4 v[12:15], v6, s[12:15], s61 offen offset:0 sc1
    s_mov_b64 exec, -1
    v_mov_b32 v24, 0
    v_mov_b32 v25, 0
    v_mov_b32 v26, 0
    v_mov_b32 v27, 0
    v_mov_b32 v28, 0
    v_mov_b32 v29, 0
    v_mov_b32 v30, 0
    v_mov_b32 v31, 0
    v_mov_b32 v40, 0
    v_mov_b32 v41, 0
    v_mov_b32 v42, 0
    v_mov_b32 v43, 0
    v_mov_b32 v44, 0
    v_mov_b32 v45, 0
    v_mov_b32 v46, 0
    v_mov_b32 v47, 0
    s_lshr_b32 s61, s2, 3
    s_lshl_b32 s61, s61, 11
    v_lshlrev_b32 v10, 4, v1
    v_add_u32 v6, s61, v10
    v_lshrrev_b32 v10, 4, v1
    v_add_u32 v10, v10, v1
    v_and_b32 v10, 3, v10
    v_and_b32 v11, 60, v1
    v_or_b32 v10, v10, v11
    v_lshlrev_b32 v10, 4, v10
    s_lshl_b32 s61, s3, 11
    v_add_u32 v8, s61, v10
    v_bfe_u32 v11, v0, 5, 2
    v_lshlrev_b32 v15, 4, v11
    v_bfe_u32 v10, v0, 3, 2
    v_add_u32 v11, v11, v10
    v_and_b32 v11, 3, v11
    v_lshlrev_b32 v11, 4, v11
    v_lshl_add_u32 v11, v10, 8, v11
    v_and_b32 v10, 3, v0
    v_lshl_add_u32 v11, v10, 6, v11
    v_bfe_u32 v10, v0, 2, 1
    v_lshl_add_u32 v2, v10, 10, v11
    v_and_b32 v10, 0x60, v0
    v_bfe_u32 v11, v0, 1, 4
    v_or_b32 v10, v10, v11
    v_and_b32 v11, 1, v0
    v_lshl_or_b32 v10, v11, 4, v10
    v_lshlrev_b32 v10, 4, v10
    s_lshl_b32 s64, s2, 11
    v_add_u32 v14, s64, v10
    v_mov_b32_dpp v24, v16 quad_perm:[0,1,2,3] row_mask:0xf bank_mask:0x1
    v_mov_b32_dpp v25, v17 quad_perm:[0,1,2,3] row_mask:0xf bank_mask:0x1
    v_mov_b32_dpp v26, v18 quad_perm:[0,1,2,3] row_mask:0xf bank_mask:0x1
    v_mov_b32_dpp v27, v19 quad_perm:[0,1,2,3] row_mask:0xf bank_mask:0x1
    v_mov_b32_dpp v28, v16 row_ror:4 row_mask:0xf bank_mask:0x2
    v_mov_b32_dpp v29, v17 row_ror:4 row_mask:0xf bank_mask:0x2
    v_mov_b32_dpp v30, v18 row_ror:4 row_mask:0xf bank_mask:0x2
    v_mov_b32_dpp v31, v19 row_ror:4 row_mask:0xf bank_mask:0x2
    v_mov_b32_dpp v40, v16 row_ror:8 row_mask:0xf bank_mask:0x4
    v_mov_b32_dpp v41, v17 row_ror:8 row_mask:0xf bank_mask:0x4
    v_mov_b32_dpp v42, v18 row_ror:8 row_mask:0xf bank_mask:0x4
    v_mov_b32_dpp v43, v19 row_ror:8 row_mask:0xf bank_mask:0x4
    v_mov_b32_dpp v44, v16 row_ror:12 row_mask:0xf bank_mask:0x8
    v_mov_b32_dpp v45, v17 row_ror:12 row_mask:0xf bank_mask:0x8
    v_mov_b32_dpp v46, v18 row_ror:12 row_mask:0xf bank_mask:0x8
    v_mov_b32_dpp v47, v19 row_ror:12 row_mask:0xf bank_mask:0x8
    s_waitcnt vmcnt(49)
    v_perm_b32 v32, v68, v64, s67
    v_perm_b32 v33, v76, v72, s67
    v_perm_b32 v34, v84, v80, s67
    v_perm_b32 v35, v92, v88, s67
    v_perm_b32 v36, v70, v66, s67
    v_perm_b32 v37, v78, v74, s67
    v_perm_b32 v38, v86, v82, s67
    v_perm_b32 v39, v94, v90, s67
    v_mfma_f32_16x16x32_bf16 a[0:3], v[32:35], v[24:27], 0
    v_perm_b32 v32, v68, v64, s68
    v_perm_b32 v33, v76, v72, s68
    v_perm_b32 v34, v84, v80, s68
    v_perm_b32 v35, v92, v88, s68
    v_mfma_f32_16x16x32_bf16 a[4:7], v[36:39], v[24:27], 0
    v_perm_b32 v36, v70, v66, s68
    v_perm_b32 v37, v78, v74, s68
    v_perm_b32 v38, v86, v82, s68
    v_perm_b32 v39, v94, v90, s68
    v_mfma_f32_16x16x32_bf16 a[0:3], v[32:35], v[28:31], a[0:3]
    v_perm_b32 v32, v69, v65, s67
    v_perm_b32 v33, v77, v73, s67
    v_perm_b32 v34, v85, v81, s67
    v_perm_b32 v35, v93, v89, s67
    v_mfma_f32_16x16x32_bf16 a[4:7], v[36:39], v[28:31], a[4:7]
    v_perm_b32 v36, v71, v67, s67
    v_perm_b32 v37, v79, v75, s67
    v_perm_b32 v38, v87, v83, s67
    v_perm_b32 v39, v95, v91, s67
    v_mfma_f32_16x16x32_bf16 a[0:3], v[32:35], v[40:43], a[0:3]
    v_perm_b32 v32, v69, v65, s68
    v_perm_b32 v33, v77, v73, s68
    v_perm_b32 v34, v85, v81, s68
    v_perm_b32 v35, v93, v89, s68
    v_mfma_f32_16x16x32_bf16 a[4:7], v[36:39], v[40:43], a[4:7]
    v_perm_b32 v36, v71, v67, s68
    v_perm_b32 v37, v79, v75, s68
    v_perm_b32 v38, v87, v83, s68
    v_perm_b32 v39, v95, v91, s68
    v_mfma_f32_16x16x32_bf16 a[0:3], v[32:35], v[44:47], a[0:3]
    s_nop 0
    v_mfma_f32_16x16x32_bf16 a[4:7], v[36:39], v[44:47], a[4:7]
    v_mov_b32_dpp v24, v16 row_ror:12 row_mask:0xf bank_mask:0x1
    v_mov_b32_dpp v25, v17 row_ror:12 row_mask:0xf bank_mask:0x1
    v_mov_b32_dpp v26, v18 row_ror:12 row_mask:0xf bank_mask:0x1
    v_mov_b32_dpp v27, v19 row_ror:12 row_mask:0xf bank_mask:0x1
    v_mov_b32_dpp v28, v16 quad_perm:[0,1,2,3] row_mask:0xf bank_mask:0x2
    v_mov_b32_dpp v29, v17 quad_perm:[0,1,2,3] row_mask:0xf bank_mask:0x2
    v_mov_b32_dpp v30, v18 quad_perm:[0,1,2,3] row_mask:0xf bank_mask:0x2
    v_mov_b32_dpp v31, v19 quad_perm:[0,1,2,3] row_mask:0xf bank_mask:0x2
    v_mov_b32_dpp v40, v16 row_ror:4 row_mask:0xf bank_mask:0x4
    v_mov_b32_dpp v41, v17 row_ror:4 row_mask:0xf bank_mask:0x4
    v_mov_b32_dpp v42, v18 row_ror:4 row_mask:0xf bank_mask:0x4
    v_mov_b32_dpp v43, v19 row_ror:4 row_mask:0xf bank_mask:0x4
    v_mov_b32_dpp v44, v16 row_ror:8 row_mask:0xf bank_mask:0x8
    v_mov_b32_dpp v45, v17 row_ror:8 row_mask:0xf bank_mask:0x8
    v_mov_b32_dpp v46, v18 row_ror:8 row_mask:0xf bank_mask:0x8
    v_mov_b32_dpp v47, v19 row_ror:8 row_mask:0xf bank_mask:0x8
    s_waitcnt vmcnt(37)
    buffer_load_dwordx4 v[64:67], v3, s[8:11], s60 offen offset:0 nt
    v_perm_b32 v32, v100, v96, s67
    v_perm_b32 v33, v108, v104, s67
    v_perm_b32 v34, v116, v112, s67
    v_perm_b32 v35, v124, v120, s67
    v_perm_b32 v36, v102, v98, s67
    buffer_load_dwordx4 v[68:71], v3, s[8:11], s60 offen offset:1024 nt
    v_perm_b32 v37, v110, v106, s67
    v_perm_b32 v38, v118, v114, s67
    v_perm_b32 v39, v126, v122, s67
    v_mfma_f32_16x16x32_bf16 a[0:3], v[32:35], v[24:27], a[0:3]
    v_perm_b32 v32, v100, v96, s68
    buffer_load_dwordx4 v[72:75], v3, s[8:11], s60 offen offset:2048 nt
    v_perm_b32 v33, v108, v104, s68
    v_perm_b32 v34, v116, v112, s68
    v_perm_b32 v35, v124, v120, s68
    v_mfma_f32_16x16x32_bf16 a[4:7], v[36:39], v[24:27], a[4:7]
    v_perm_b32 v36, v102, v98, s68
    buffer_load_dwordx4 v[76:79], v3, s[8:11], s60 offen offset:3072 nt
    v_perm_b32 v37, v110, v106, s68
    v_perm_b32 v38, v118, v114, s68
    v_perm_b32 v39, v126, v122, s68
    v_mfma_f32_16x16x32_bf16 a[0:3], v[32:35], v[28:31], a[0:3]
    v_perm_b32 v32, v101, v97, s67
    s_add_u32 s79, s60, 4096
    s_pack_lh_b32_b16 s60, s79, s60
    buffer_load_dwordx4 v[80:83], v3, s[8:11], s60 offen offset:0 nt
    v_perm_b32 v33, v109, v105, s67
    v_perm_b32 v34, v117, v113, s67
    v_perm_b32 v35, v125, v121, s67
    v_mfma_f32_16x16x32_bf16 a[4:7], v[36:39], v[28:31], a[4:7]
    v_perm_b32 v36, v103, v99, s67
    buffer_load_dwordx4 v[84:87], v3, s[8:11], s60 offen offset:1024 nt
    v_perm_b32 v37, v111, v107, s67
    v_perm_b32 v38, v119, v115, s67
    v_perm_b32 v39, v127, v123, s67
    v_mfma_f32_16x16x32_bf16 a[0:3], v[32:35], v[40:43], a[0:3]
    v_perm_b32 v32, v101, v97, s68
    buffer_load_dwordx4 v[88:91], v3, s[8:11], s60 offen offset:2048 nt
    v_perm_b32 v33, v109, v105, s68
    v_perm_b32 v34, v117, v113, s68
    v_perm_b32 v35, v125, v121, s68
    v_mfma_f32_16x16x32_bf16 a[4:7], v[36:39], v[40:43], a[4:7]
    v_perm_b32 v36, v103, v99, s68
    buffer_load_dwordx4 v[92:95], v3, s[8:11], s60 offen offset:3072 nt
    s_add_u32 s79, s60, 4096
    s_pack_lh_b32_b16 s60, s79, s60
    v_perm_b32 v37, v111, v107, s68
    v_perm_b32 v38, v119, v115, s68
    v_perm_b32 v39, v127, v123, s68
    v_mfma_f32_16x16x32_bf16 a[0:3], v[32:35], v[44:47], a[0:3]
    s_nop 0
    v_mfma_f32_16x16x32_bf16 a[4:7], v[36:39], v[44:47], a[4:7]
    v_mov_b32_dpp v24, v16 row_ror:8 row_mask:0xf bank_mask:0x1
    v_mov_b32_dpp v25, v17 row_ror:8 row_mask:0xf bank_mask:0x1
    v_mov_b32_dpp v26, v18 row_ror:8 row_mask:0xf bank_mask:0x1
    v_mov_b32_dpp v27, v19 row_ror:8 row_mask:0xf bank_mask:0x1
    v_mov_b32_dpp v28, v16 row_ror:12 row_mask:0xf bank_mask:0x2
    v_mov_b32_dpp v29, v17 row_ror:12 row_mask:0xf bank_mask:0x2
    v_mov_b32_dpp v30, v18 row_ror:12 row_mask:0xf bank_mask:0x2
    v_mov_b32_dpp v31, v19 row_ror:12 row_mask:0xf bank_mask:0x2
    v_mov_b32_dpp v40, v16 quad_perm:[0,1,2,3] row_mask:0xf bank_mask:0x4
    v_mov_b32_dpp v41, v17 quad_perm:[0,1,2,3] row_mask:0xf bank_mask:0x4
    v_mov_b32_dpp v42, v18 quad_perm:[0,1,2,3] row_mask:0xf bank_mask:0x4
    v_mov_b32_dpp v43, v19 quad_perm:[0,1,2,3] row_mask:0xf bank_mask:0x4
    v_mov_b32_dpp v44, v16 row_ror:4 row_mask:0xf bank_mask:0x8
    v_mov_b32_dpp v45, v17 row_ror:4 row_mask:0xf bank_mask:0x8
    v_mov_b32_dpp v46, v18 row_ror:4 row_mask:0xf bank_mask:0x8
    v_mov_b32_dpp v47, v19 row_ror:4 row_mask:0xf bank_mask:0x8
    s_waitcnt vmcnt(33)
    v_perm_b32 v32, v132, v128, s67
    v_perm_b32 v33, v140, v136, s67
    v_perm_b32 v34, v148, v144, s67
    v_perm_b32 v35, v156, v152, s67
    v_perm_b32 v36, v134, v130, s67
    v_perm_b32 v37, v142, v138, s67
    v_perm_b32 v38, v150, v146, s67
    v_perm_b32 v39, v158, v154, s67
    v_mfma_f32_16x16x32_bf16 a[0:3], v[32:35], v[24:27], a[0:3]
    v_perm_b32 v32, v132, v128, s68
    v_perm_b32 v33, v140, v136, s68
    v_perm_b32 v34, v148, v144, s68
    v_perm_b32 v35, v156, v152, s68
    v_mfma_f32_16x16x32_bf16 a[4:7], v[36:39], v[24:27], a[4:7]
    v_perm_b32 v36, v134, v130, s68
    v_perm_b32 v37, v142, v138, s68
    v_perm_b32 v38, v150, v146, s68
    v_perm_b32 v39, v158, v154, s68
    v_mfma_f32_16x16x32_bf16 a[0:3], v[32:35], v[28:31], a[0:3]
    v_perm_b32 v32, v133, v129, s67
    v_perm_b32 v33, v141, v137, s67
    v_perm_b32 v34, v149, v145, s67
    v_perm_b32 v35, v157, v153, s67
    v_mfma_f32_16x16x32_bf16 a[4:7], v[36:39], v[28:31], a[4:7]
    v_perm_b32 v36, v135, v131, s67
    v_perm_b32 v37, v143, v139, s67
    v_perm_b32 v38, v151, v147, s67
    v_perm_b32 v39, v159, v155, s67
    v_mfma_f32_16x16x32_bf16 a[0:3], v[32:35], v[40:43], a[0:3]
    v_perm_b32 v32, v133, v129, s68
    v_perm_b32 v33, v141, v137, s68
    v_perm_b32 v34, v149, v145, s68
    v_perm_b32 v35, v157, v153, s68
    v_mfma_f32_16x16x32_bf16 a[4:7], v[36:39], v[40:43], a[4:7]
    v_perm_b32 v36, v135, v131, s68
    v_perm_b32 v37, v143, v139, s68
    v_perm_b32 v38, v151, v147, s68
    v_perm_b32 v39, v159, v155, s68
    v_mfma_f32_16x16x32_bf16 a[0:3], v[32:35], v[44:47], a[0:3]
    s_nop 0
    v_mfma_f32_16x16x32_bf16 a[4:7], v[36:39], v[44:47], a[4:7]
    v_mov_b32_dpp v24, v16 row_ror:4 row_mask:0xf bank_mask:0x1
    v_mov_b32_dpp v25, v17 row_ror:4 row_mask:0xf bank_mask:0x1
    v_mov_b32_dpp v26, v18 row_ror:4 row_mask:0xf bank_mask:0x1
    v_mov_b32_dpp v27, v19 row_ror:4 row_mask:0xf bank_mask:0x1
    v_mov_b32_dpp v28, v16 row_ror:8 row_mask:0xf bank_mask:0x2
    v_mov_b32_dpp v29, v17 row_ror:8 row_mask:0xf bank_mask:0x2
    v_mov_b32_dpp v30, v18 row_ror:8 row_mask:0xf bank_mask:0x2
    v_mov_b32_dpp v31, v19 row_ror:8 row_mask:0xf bank_mask:0x2
    v_mov_b32_dpp v40, v16 row_ror:12 row_mask:0xf bank_mask:0x4
    v_mov_b32_dpp v41, v17 row_ror:12 row_mask:0xf bank_mask:0x4
    v_mov_b32_dpp v42, v18 row_ror:12 row_mask:0xf bank_mask:0x4
    v_mov_b32_dpp v43, v19 row_ror:12 row_mask:0xf bank_mask:0x4
    v_mov_b32_dpp v44, v16 quad_perm:[0,1,2,3] row_mask:0xf bank_mask:0x8
    v_mov_b32_dpp v45, v17 quad_perm:[0,1,2,3] row_mask:0xf bank_mask:0x8
    v_mov_b32_dpp v46, v18 quad_perm:[0,1,2,3] row_mask:0xf bank_mask:0x8
    v_mov_b32_dpp v47, v19 quad_perm:[0,1,2,3] row_mask:0xf bank_mask:0x8
    s_waitcnt vmcnt(25)
    s_mov_b32 s61, 0x20000
    buffer_load_dwordx4 v[48:51], v6, s[12:15], s61 offen offset:0 sc1
    v_perm_b32 v32, v228, v224, s67
    v_perm_b32 v33, v236, v232, s67
    v_perm_b32 v34, v244, v240, s67
    v_perm_b32 v35, v252, v248, s67
    s_mov_b32 s61, 0x20000
    buffer_load_dwordx4 v[52:55], v6, s[12:15], s61 offen offset:1024 sc1
    v_perm_b32 v36, v230, v226, s67
    v_perm_b32 v37, v238, v234, s67
    v_perm_b32 v38, v246, v242, s67
    v_perm_b32 v39, v254, v250, s67
    buffer_load_dwordx4 v[96:99], v3, s[8:11], s60 offen offset:0 nt
    v_mfma_f32_16x16x32_bf16 a[0:3], v[32:35], v[24:27], a[0:3]
    v_perm_b32 v32, v228, v224, s68
    v_perm_b32 v33, v236, v232, s68
    v_perm_b32 v34, v244, v240, s68
    buffer_load_dwordx4 v[100:103], v3, s[8:11], s60 offen offset:1024 nt
    v_perm_b32 v35, v252, v248, s68
    v_mfma_f32_16x16x32_bf16 a[4:7], v[36:39], v[24:27], a[4:7]
    v_perm_b32 v36, v230, v226, s68
    v_perm_b32 v37, v238, v234, s68
    buffer_load_dwordx4 v[104:107], v3, s[8:11], s60 offen offset:2048 nt
    v_perm_b32 v38, v246, v242, s68
    v_perm_b32 v39, v254, v250, s68
    v_mfma_f32_16x16x32_bf16 a[0:3], v[32:35], v[28:31], a[0:3]
    v_perm_b32 v32, v229, v225, s67
    buffer_load_dwordx4 v[108:111], v3, s[8:11], s60 offen offset:3072 nt
    v_perm_b32 v33, v237, v233, s67
    v_perm_b32 v34, v245, v241, s67
    v_perm_b32 v35, v253, v249, s67
    v_mfma_f32_16x16x32_bf16 a[4:7], v[36:39], v[28:31], a[4:7]
    s_add_u32 s79, s60, 4096
    s_pack_lh_b32_b16 s60, s79, s60
    buffer_load_dwordx4 v[112:115], v3, s[8:11], s60 offen offset:0 nt
    v_perm_b32 v36, v231, v227, s67
    v_perm_b32 v37, v239, v235, s67
    v_perm_b32 v38, v247, v243, s67
    v_perm_b32 v39, v255, v251, s67
    buffer_load_dwordx4 v[116:119], v3, s[8:11], s60 offen offset:1024 nt
    v_mfma_f32_16x16x32_bf16 a[0:3], v[32:35], v[40:43], a[0:3]
    v_perm_b32 v32, v229, v225, s68
    v_perm_b32 v33, v237, v233, s68
    v_perm_b32 v34, v245, v241, s68
    buffer_load_dwordx4 v[120:123], v3, s[8:11], s60 offen offset:2048 nt
    v_perm_b32 v35, v253, v249, s68
    v_mfma_f32_16x16x32_bf16 a[4:7], v[36:39], v[40:43], a[4:7]
    v_perm_b32 v36, v231, v227, s68
    v_perm_b32 v37, v239, v235, s68
    buffer_load_dwordx4 v[124:127], v3, s[8:11], s60 offen offset:3072 nt
    s_add_u32 s79, s60, 4096
    s_pack_lh_b32_b16 s60, s79, s60
    v_perm_b32 v38, v247, v243, s68
    v_perm_b32 v39, v255, v251, s68
    v_mfma_f32_16x16x32_bf16 a[0:3], v[32:35], v[44:47], a[0:3]
    s_nop 0
    v_mfma_f32_16x16x32_bf16 a[4:7], v[36:39], v[44:47], a[4:7]
    v_mov_b32_dpp v24, v20 quad_perm:[0,1,2,3] row_mask:0xf bank_mask:0x1
    v_mov_b32_dpp v25, v21 quad_perm:[0,1,2,3] row_mask:0xf bank_mask:0x1
    v_mov_b32_dpp v26, v22 quad_perm:[0,1,2,3] row_mask:0xf bank_mask:0x1
    v_mov_b32_dpp v27, v23 quad_perm:[0,1,2,3] row_mask:0xf bank_mask:0x1
    v_mov_b32_dpp v28, v20 row_ror:4 row_mask:0xf bank_mask:0x2
    v_mov_b32_dpp v29, v21 row_ror:4 row_mask:0xf bank_mask:0x2
    v_mov_b32_dpp v30, v22 row_ror:4 row_mask:0xf bank_mask:0x2
    v_mov_b32_dpp v31, v23 row_ror:4 row_mask:0xf bank_mask:0x2
    v_mov_b32_dpp v40, v20 row_ror:8 row_mask:0xf bank_mask:0x4
    v_mov_b32_dpp v41, v21 row_ror:8 row_mask:0xf bank_mask:0x4
    v_mov_b32_dpp v42, v22 row_ror:8 row_mask:0xf bank_mask:0x4
    v_mov_b32_dpp v43, v23 row_ror:8 row_mask:0xf bank_mask:0x4
    v_mov_b32_dpp v44, v20 row_ror:12 row_mask:0xf bank_mask:0x8
    v_mov_b32_dpp v45, v21 row_ror:12 row_mask:0xf bank_mask:0x8
    v_mov_b32_dpp v46, v22 row_ror:12 row_mask:0xf bank_mask:0x8
    v_mov_b32_dpp v47, v23 row_ror:12 row_mask:0xf bank_mask:0x8
    s_waitcnt vmcnt(27)
    v_perm_b32 v32, v164, v160, s67
    v_perm_b32 v33, v172, v168, s67
    v_perm_b32 v34, v180, v176, s67
    v_perm_b32 v35, v188, v184, s67
    v_perm_b32 v36, v166, v162, s67
    v_perm_b32 v37, v174, v170, s67
    v_perm_b32 v38, v182, v178, s67
    v_perm_b32 v39, v190, v186, s67
    v_mfma_f32_16x16x32_bf16 a[0:3], v[32:35], v[24:27], a[0:3]
    v_perm_b32 v32, v164, v160, s68
    v_perm_b32 v33, v172, v168, s68
    v_perm_b32 v34, v180, v176, s68
    v_perm_b32 v35, v188, v184, s68
    v_mfma_f32_16x16x32_bf16 a[4:7], v[36:39], v[24:27], a[4:7]
    v_perm_b32 v36, v166, v162, s68
    v_perm_b32 v37, v174, v170, s68
    v_perm_b32 v38, v182, v178, s68
    v_perm_b32 v39, v190, v186, s68
    v_mfma_f32_16x16x32_bf16 a[0:3], v[32:35], v[28:31], a[0:3]
    v_perm_b32 v32, v165, v161, s67
    v_perm_b32 v33, v173, v169, s67
    v_perm_b32 v34, v181, v177, s67
    v_perm_b32 v35, v189, v185, s67
    v_mfma_f32_16x16x32_bf16 a[4:7], v[36:39], v[28:31], a[4:7]
    v_perm_b32 v36, v167, v163, s67
    v_perm_b32 v37, v175, v171, s67
    v_perm_b32 v38, v183, v179, s67
    v_perm_b32 v39, v191, v187, s67
    v_mfma_f32_16x16x32_bf16 a[0:3], v[32:35], v[40:43], a[0:3]
    v_perm_b32 v32, v165, v161, s68
    v_perm_b32 v33, v173, v169, s68
    v_perm_b32 v34, v181, v177, s68
    v_perm_b32 v35, v189, v185, s68
    v_mfma_f32_16x16x32_bf16 a[4:7], v[36:39], v[40:43], a[4:7]
    v_perm_b32 v36, v167, v163, s68
    v_perm_b32 v37, v175, v171, s68
    v_perm_b32 v38, v183, v179, s68
    v_perm_b32 v39, v191, v187, s68
    v_mfma_f32_16x16x32_bf16 a[0:3], v[32:35], v[44:47], a[0:3]
    s_nop 0
    v_mfma_f32_16x16x32_bf16 a[4:7], v[36:39], v[44:47], a[4:7]
    v_mov_b32_dpp v24, v20 row_ror:12 row_mask:0xf bank_mask:0x1
    v_mov_b32_dpp v25, v21 row_ror:12 row_mask:0xf bank_mask:0x1
    v_mov_b32_dpp v26, v22 row_ror:12 row_mask:0xf bank_mask:0x1
    v_mov_b32_dpp v27, v23 row_ror:12 row_mask:0xf bank_mask:0x1
    v_mov_b32_dpp v28, v20 quad_perm:[0,1,2,3] row_mask:0xf bank_mask:0x2
    v_mov_b32_dpp v29, v21 quad_perm:[0,1,2,3] row_mask:0xf bank_mask:0x2
    v_mov_b32_dpp v30, v22 quad_perm:[0,1,2,3] row_mask:0xf bank_mask:0x2
    v_mov_b32_dpp v31, v23 quad_perm:[0,1,2,3] row_mask:0xf bank_mask:0x2
    v_mov_b32_dpp v40, v20 row_ror:4 row_mask:0xf bank_mask:0x4
    v_mov_b32_dpp v41, v21 row_ror:4 row_mask:0xf bank_mask:0x4
    v_mov_b32_dpp v42, v22 row_ror:4 row_mask:0xf bank_mask:0x4
    v_mov_b32_dpp v43, v23 row_ror:4 row_mask:0xf bank_mask:0x4
    v_mov_b32_dpp v44, v20 row_ror:8 row_mask:0xf bank_mask:0x8
    v_mov_b32_dpp v45, v21 row_ror:8 row_mask:0xf bank_mask:0x8
    v_mov_b32_dpp v46, v22 row_ror:8 row_mask:0xf bank_mask:0x8
    v_mov_b32_dpp v47, v23 row_ror:8 row_mask:0xf bank_mask:0x8
    s_waitcnt vmcnt(19)
    v_perm_b32 v32, v196, v192, s67
    v_perm_b32 v33, v204, v200, s67
    v_perm_b32 v34, v212, v208, s67
    v_perm_b32 v35, v220, v216, s67
    v_perm_b32 v36, v198, v194, s67
    v_perm_b32 v37, v206, v202, s67
    v_perm_b32 v38, v214, v210, s67
    v_perm_b32 v39, v222, v218, s67
    v_mfma_f32_16x16x32_bf16 a[0:3], v[32:35], v[24:27], a[0:3]
    v_perm_b32 v32, v196, v192, s68
    v_perm_b32 v33, v204, v200, s68
    v_perm_b32 v34, v212, v208, s68
    v_perm_b32 v35, v220, v216, s68
    v_mfma_f32_16x16x32_bf16 a[4:7], v[36:39], v[24:27], a[4:7]
    v_perm_b32 v36, v198, v194, s68
    v_perm_b32 v37, v206, v202, s68
    v_perm_b32 v38, v214, v210, s68
    v_perm_b32 v39, v222, v218, s68
    v_mfma_f32_16x16x32_bf16 a[0:3], v[32:35], v[28:31], a[0:3]
    v_perm_b32 v32, v197, v193, s67
    v_perm_b32 v33, v205, v201, s67
    v_perm_b32 v34, v213, v209, s67
    v_perm_b32 v35, v221, v217, s67
    v_mfma_f32_16x16x32_bf16 a[4:7], v[36:39], v[28:31], a[4:7]
    v_perm_b32 v36, v199, v195, s67
    v_perm_b32 v37, v207, v203, s67
    v_perm_b32 v38, v215, v211, s67
    v_perm_b32 v39, v223, v219, s67
    v_mfma_f32_16x16x32_bf16 a[0:3], v[32:35], v[40:43], a[0:3]
    v_perm_b32 v32, v197, v193, s68
    v_perm_b32 v33, v205, v201, s68
    v_perm_b32 v34, v213, v209, s68
    v_perm_b32 v35, v221, v217, s68
    v_mfma_f32_16x16x32_bf16 a[4:7], v[36:39], v[40:43], a[4:7]
    v_perm_b32 v36, v199, v195, s68
    v_perm_b32 v37, v207, v203, s68
    v_perm_b32 v38, v215, v211, s68
    v_perm_b32 v39, v223, v219, s68
    v_mfma_f32_16x16x32_bf16 a[0:3], v[32:35], v[44:47], a[0:3]
    s_nop 0
    v_mfma_f32_16x16x32_bf16 a[4:7], v[36:39], v[44:47], a[4:7]
    s_mov_b32 s61, 0x20000
    buffer_load_dwordx4 v[56:59], v6, s[12:15], s61 offen offset:0 sc1
    s_mov_b32 s61, 0x20000
    buffer_load_dwordx4 v[60:63], v6, s[12:15], s61 offen offset:1024 sc1
    v_mov_b32_dpp v24, v20 row_ror:8 row_mask:0xf bank_mask:0x1
    v_mov_b32_dpp v25, v21 row_ror:8 row_mask:0xf bank_mask:0x1
    v_mov_b32_dpp v26, v22 row_ror:8 row_mask:0xf bank_mask:0x1
    v_mov_b32_dpp v27, v23 row_ror:8 row_mask:0xf bank_mask:0x1
    v_mov_b32_dpp v28, v20 row_ror:12 row_mask:0xf bank_mask:0x2
    v_mov_b32_dpp v29, v21 row_ror:12 row_mask:0xf bank_mask:0x2
    v_mov_b32_dpp v30, v22 row_ror:12 row_mask:0xf bank_mask:0x2
    v_mov_b32_dpp v31, v23 row_ror:12 row_mask:0xf bank_mask:0x2
    v_mov_b32_dpp v40, v20 quad_perm:[0,1,2,3] row_mask:0xf bank_mask:0x4
    v_mov_b32_dpp v41, v21 quad_perm:[0,1,2,3] row_mask:0xf bank_mask:0x4
    v_mov_b32_dpp v42, v22 quad_perm:[0,1,2,3] row_mask:0xf bank_mask:0x4
    v_mov_b32_dpp v43, v23 quad_perm:[0,1,2,3] row_mask:0xf bank_mask:0x4
    v_mov_b32_dpp v44, v20 row_ror:4 row_mask:0xf bank_mask:0x8
    v_mov_b32_dpp v45, v21 row_ror:4 row_mask:0xf bank_mask:0x8
    v_mov_b32_dpp v46, v22 row_ror:4 row_mask:0xf bank_mask:0x8
    v_mov_b32_dpp v47, v23 row_ror:4 row_mask:0xf bank_mask:0x8
    s_waitcnt vmcnt(12)
    v_perm_b32 v32, v68, v64, s67
    v_perm_b32 v33, v76, v72, s67
    v_perm_b32 v34, v84, v80, s67
    v_perm_b32 v35, v92, v88, s67
    v_perm_b32 v36, v70, v66, s67
    v_perm_b32 v37, v78, v74, s67
    v_perm_b32 v38, v86, v82, s67
    v_perm_b32 v39, v94, v90, s67
    v_mfma_f32_16x16x32_bf16 a[0:3], v[32:35], v[24:27], a[0:3]
    v_perm_b32 v32, v68, v64, s68
    v_perm_b32 v33, v76, v72, s68
    v_perm_b32 v34, v84, v80, s68
    v_perm_b32 v35, v92, v88, s68
    v_mfma_f32_16x16x32_bf16 a[4:7], v[36:39], v[24:27], a[4:7]
    v_perm_b32 v36, v70, v66, s68
    v_perm_b32 v37, v78, v74, s68
    v_perm_b32 v38, v86, v82, s68
    v_perm_b32 v39, v94, v90, s68
    v_mfma_f32_16x16x32_bf16 a[0:3], v[32:35], v[28:31], a[0:3]
    v_perm_b32 v32, v69, v65, s67
    v_perm_b32 v33, v77, v73, s67
    v_perm_b32 v34, v85, v81, s67
    v_perm_b32 v35, v93, v89, s67
    v_mfma_f32_16x16x32_bf16 a[4:7], v[36:39], v[28:31], a[4:7]
    v_perm_b32 v36, v71, v67, s67
    v_perm_b32 v37, v79, v75, s67
    v_perm_b32 v38, v87, v83, s67
    v_perm_b32 v39, v95, v91, s67
    v_mfma_f32_16x16x32_bf16 a[0:3], v[32:35], v[40:43], a[0:3]
    v_perm_b32 v32, v69, v65, s68
    v_perm_b32 v33, v77, v73, s68
    v_perm_b32 v34, v85, v81, s68
    v_perm_b32 v35, v93, v89, s68
    v_mfma_f32_16x16x32_bf16 a[4:7], v[36:39], v[40:43], a[4:7]
    v_perm_b32 v36, v71, v67, s68
    v_perm_b32 v37, v79, v75, s68
    v_perm_b32 v38, v87, v83, s68
    v_perm_b32 v39, v95, v91, s68
    v_mfma_f32_16x16x32_bf16 a[0:3], v[32:35], v[44:47], a[0:3]
    s_nop 0
    v_mfma_f32_16x16x32_bf16 a[4:7], v[36:39], v[44:47], a[4:7]
    s_waitcnt vmcnt(10)
    v_xor_b32 v10, s58, v50
    v_bitop3_b32 v10, v51, s58, v10 bitop3:0xbe
    v_bitop3_b32 v10, v54, s58, v10 bitop3:0xbe
    v_bitop3_b32 v10, v55, s58, v10 bitop3:0xbe
    v_cmp_ne_u32 vcc, 0, v10
    s_mov_b32 s34, 1
    s_cbranch_vccnz MLS_Q
    v_max_f32 v50, v48, v52
    s_nop 1
    v_max_f32_dpp v50, v50, v50 row_ror:4 row_mask:0xf bank_mask:0xf
    s_nop 1
    v_max_f32_dpp v50, v50, v50 row_ror:8 row_mask:0xf bank_mask:0xf
    v_mov_b32 v10, v50
    s_nop 1
    v_permlane16_swap_b32 v50, v10
    v_max_f32 v50, v50, v10
    v_mov_b32 v10, v50
    s_nop 1
    v_permlane32_swap_b32 v50, v10
    v_max_f32 v50, v50, v10
    v_sub_f32 v48, v48, v50
    v_sub_f32 v52, v52, v50
    v_sub_f32 v9, v9, v50
    v_mul_f32 v48, s69, v48
    v_mul_f32 v52, s69, v52
    v_mul_f32 v9, s69, v9
    v_exp_f32 v48, v48
    v_exp_f32 v52, v52
    v_exp_f32 v9, v9
    v_mul_f32 v49, v49, v48
    v_fmac_f32 v49, v53, v52
    s_nop 1
    v_add_f32_dpp v49, v49, v49 row_ror:4 row_mask:0xf bank_mask:0xf
    s_nop 1
    v_add_f32_dpp v49, v49, v49 row_ror:8 row_mask:0xf bank_mask:0xf
    v_mov_b32 v10, v49
    s_nop 1
    v_permlane16_swap_b32 v49, v10
    v_add_f32 v49, v49, v10
    v_mov_b32 v10, v49
    s_nop 1
    v_permlane32_swap_b32 v49, v10
    v_add_f32 v49, v49, v10
    v_rcp_f32 v49, v49
    s_nop 0
    v_mul_f32 v9, v9, v49
    v_lshlrev_b32 v10, 4, v1
    s_lshl_b32 s64, s3, 2
    v_add_u32 v10, s64, v10
    s_mov_b64 exec, 0xf
    ds_write_b32 v10, v9 offset:26880
    s_mov_b64 exec, -1
    s_mov_b32 s34, 0
MLS_Q:
    v_mov_b32_dpp v24, v20 row_ror:4 row_mask:0xf bank_mask:0x1
    v_mov_b32_dpp v25, v21 row_ror:4 row_mask:0xf bank_mask:0x1
    v_mov_b32_dpp v26, v22 row_ror:4 row_mask:0xf bank_mask:0x1
    v_mov_b32_dpp v27, v23 row_ror:4 row_mask:0xf bank_mask:0x1
    v_mov_b32_dpp v28, v20 row_ror:8 row_mask:0xf bank_mask:0x2
    v_mov_b32_dpp v29, v21 row_ror:8 row_mask:0xf bank_mask:0x2
    v_mov_b32_dpp v30, v22 row_ror:8 row_mask:0xf bank_mask:0x2
    v_mov_b32_dpp v31, v23 row_ror:8 row_mask:0xf bank_mask:0x2
    v_mov_b32_dpp v40, v20 row_ror:12 row_mask:0xf bank_mask:0x4
    v_mov_b32_dpp v41, v21 row_ror:12 row_mask:0xf bank_mask:0x4
    v_mov_b32_dpp v42, v22 row_ror:12 row_mask:0xf bank_mask:0x4
    v_mov_b32_dpp v43, v23 row_ror:12 row_mask:0xf bank_mask:0x4
    v_mov_b32_dpp v44, v20 quad_perm:[0,1,2,3] row_mask:0xf bank_mask:0x8
    v_mov_b32_dpp v45, v21 quad_perm:[0,1,2,3] row_mask:0xf bank_mask:0x8
    v_mov_b32_dpp v46, v22 quad_perm:[0,1,2,3] row_mask:0xf bank_mask:0x8
    v_mov_b32_dpp v47, v23 quad_perm:[0,1,2,3] row_mask:0xf bank_mask:0x8
    s_waitcnt vmcnt(2)
    v_perm_b32 v32, v100, v96, s67
    v_perm_b32 v33, v108, v104, s67
    v_perm_b32 v34, v116, v112, s67
    v_perm_b32 v35, v124, v120, s67
    v_perm_b32 v36, v102, v98, s67
    v_perm_b32 v37, v110, v106, s67
    v_perm_b32 v38, v118, v114, s67
    v_perm_b32 v39, v126, v122, s67
    v_mfma_f32_16x16x32_bf16 a[0:3], v[32:35], v[24:27], a[0:3]
    v_perm_b32 v32, v100, v96, s68
    v_perm_b32 v33, v108, v104, s68
    v_perm_b32 v34, v116, v112, s68
    v_perm_b32 v35, v124, v120, s68
    v_mfma_f32_16x16x32_bf16 a[4:7], v[36:39], v[24:27], a[4:7]
    v_perm_b32 v36, v102, v98, s68
    v_perm_b32 v37, v110, v106, s68
    v_perm_b32 v38, v118, v114, s68
    v_perm_b32 v39, v126, v122, s68
    v_mfma_f32_16x16x32_bf16 a[0:3], v[32:35], v[28:31], a[0:3]
    v_perm_b32 v32, v101, v97, s67
    v_perm_b32 v33, v109, v105, s67
    v_perm_b32 v34, v117, v113, s67
    v_perm_b32 v35, v125, v121, s67
    v_mfma_f32_16x16x32_bf16 a[4:7], v[36:39], v[28:31], a[4:7]
    v_perm_b32 v36, v103, v99, s67
    v_perm_b32 v37, v111, v107, s67
    v_perm_b32 v38, v119, v115, s67
    v_perm_b32 v39, v127, v123, s67
    v_mfma_f32_16x16x32_bf16 a[0:3], v[32:35], v[40:43], a[0:3]
    v_perm_b32 v32, v101, v97, s68
    v_perm_b32 v33, v109, v105, s68
    v_perm_b32 v34, v117, v113, s68
    v_perm_b32 v35, v125, v121, s68
    v_mfma_f32_16x16x32_bf16 a[4:7], v[36:39], v[40:43], a[4:7]
    v_perm_b32 v36, v103, v99, s68
    v_perm_b32 v37, v111, v107, s68
    v_perm_b32 v38, v119, v115, s68
    v_perm_b32 v39, v127, v123, s68
    v_mfma_f32_16x16x32_bf16 a[0:3], v[32:35], v[44:47], a[0:3]
    s_nop 0
    v_mfma_f32_16x16x32_bf16 a[4:7], v[36:39], v[44:47], a[4:7]
    s_cmp_eq_u32 s34, 0
    s_cbranch_scc1 MLD_Q
    s_mov_b32 s62, 0x40000
    s_waitcnt vmcnt(0)
MLR_Q:
    v_xor_b32 v10, s58, v58
    v_bitop3_b32 v10, v59, s58, v10 bitop3:0xbe
    v_bitop3_b32 v10, v62, s58, v10 bitop3:0xbe
    v_bitop3_b32 v10, v63, s58, v10 bitop3:0xbe
    v_cmp_ne_u32 vcc, 0, v10
    s_cbranch_vccz MLF_Q
    s_mov_b32 s61, 0x20000
    buffer_load_dwordx4 v[56:59], v6, s[12:15], s61 offen offset:0 sc1
    s_mov_b32 s61, 0x20000
    buffer_load_dwordx4 v[60:63], v6, s[12:15], s61 offen offset:1024 sc1
    s_waitcnt vmcnt(0)
    s_sub_u32 s62, s62, 1
    s_cbranch_scc0 MLR_Q
MLF_Q:
    v_max_f32 v58, v56, v60
    s_nop 1
    v_max_f32_dpp v58, v58, v58 row_ror:4 row_mask:0xf bank_mask:0xf
    s_nop 1
    v_max_f32_dpp v58, v58, v58 row_ror:8 row_mask:0xf bank_mask:0xf
    v_mov_b32 v10, v58
    s_nop 1
    v_permlane16_swap_b32 v58, v10
    v_max_f32 v58, v58, v10
    v_mov_b32 v10, v58
    s_nop 1
    v_permlane32_swap_b32 v58, v10
    v_max_f32 v58, v58, v10
    v_sub_f32 v56, v56, v58
    v_sub_f32 v60, v60, v58
    v_sub_f32 v9, v9, v58
    v_mul_f32 v56, s69, v56
    v_mul_f32 v60, s69, v60
    v_mul_f32 v9, s69, v9
    v_exp_f32 v56, v56
    v_exp_f32 v60, v60
    v_exp_f32 v9, v9
    v_mul_f32 v57, v57, v56
    v_fmac_f32 v57, v61, v60
    s_nop 1
    v_add_f32_dpp v57, v57, v57 row_ror:4 row_mask:0xf bank_mask:0xf
    s_nop 1
    v_add_f32_dpp v57, v57, v57 row_ror:8 row_mask:0xf bank_mask:0xf
    v_mov_b32 v10, v57
    s_nop 1
    v_permlane16_swap_b32 v57, v10
    v_add_f32 v57, v57, v10
    v_mov_b32 v10, v57
    s_nop 1
    v_permlane32_swap_b32 v57, v10
    v_add_f32 v57, v57, v10
    v_rcp_f32 v57, v57
    s_nop 0
    v_mul_f32 v9, v9, v57
    v_lshlrev_b32 v10, 4, v1
    s_lshl_b32 s64, s3, 2
    v_add_u32 v10, s64, v10
    s_mov_b64 exec, 0xf
    ds_write_b32 v10, v9 offset:26880
    s_mov_b64 exec, -1
MLD_Q:
    s_nop 3
    ds_write_b128 v8, a[0:3] offset:18688
    s_nop 0
    ds_write_b128 v8, a[4:7] offset:19712
    s_waitcnt lgkmcnt(0)
    s_barrier
    s_cmp_ge_u32 s3, 2
    s_cbranch_scc1 SK2_Q
    ds_read_b128 v[48:51], v15 offset:26880
    ds_read_b128 v[32:35], v2 offset:18688
    ds_read_b128 v[36:39], v2 offset:20736
    ds_read_b128 v[40:43], v2 offset:22784
    ds_read_b128 v[44:47], v2 offset:24832
    s_waitcnt lgkmcnt(2)
    v_pk_mul_f32 v[32:33], v[32:33], v[48:49] op_sel_hi:[1,0]
    v_pk_mul_f32 v[34:35], v[34:35], v[48:49] op_sel_hi:[1,0]
    v_pk_fma_f32 v[32:33], v[36:37], v[48:49], v[32:33] op_sel:[0,1,0] op_sel_hi:[1,1,1]
    v_pk_fma_f32 v[34:35], v[38:39], v[48:49], v[34:35] op_sel:[0,1,0] op_sel_hi:[1,1,1]
    s_waitcnt lgkmcnt(0)
    v_pk_fma_f32 v[32:33], v[40:41], v[50:51], v[32:33] op_sel_hi:[1,0,1]
    v_pk_fma_f32 v[34:35], v[42:43], v[50:51], v[34:35] op_sel_hi:[1,0,1]
    v_pk_fma_f32 v[32:33], v[44:45], v[50:51], v[32:33] op_sel:[0,1,0] op_sel_hi:[1,1,1]
    v_pk_fma_f32 v[34:35], v[46:47], v[50:51], v[34:35] op_sel:[0,1,0] op_sel_hi:[1,1,1]
    v_bfi_b32 v32, s65, v4, v32
    v_bfi_b32 v33, s65, v4, v33
    v_bfi_b32 v34, s65, v4, v34
    v_bfi_b32 v35, s65, v4, v35
    s_mov_b32 s61, 0x80000
    buffer_store_dwordx4 v[32:35], v14, s[12:15], s61 offen offset:0 sc1
SK2_Q:
DONE_Q:
    s_waitcnt vmcnt(0)
    s_endpgm
.p2align 6
CLS_W:
    s_sub_u32 s61, s2, 112
    s_lshr_b32 s61, s61, 3
    s_lshl_b32 s61, s61, 2
    s_add_u32 s61, s61, s3
    s_min_u32 s61, s61, 63
    s_lshl_b32 s61, s61, 3
    v_lshrrev_b32 v10, 3, v1
    v_add_u32 v10, s61, v10
    v_and_b32 v11, 7, v1
    s_and_b32 s64, s2, 7
    s_mul_i32 s61, s64, 768
    s_lshl_b32 s64, s64, 10
    v_min_u32 v12, 5, v11
    v_lshlrev_b32 v12, 7, v12
    v_add_u32 v12, s61, v12
    v_mul_u32_u24 v13, 0x1800, v10
    v_add_u32 v12, v12, v13
    global_load_dword v60, v12, s[52:53] nt
    v_lshlrev_b32 v10, 13, v10
    v_lshl_add_u32 v10, v11, 7, v10
    v_add_u32 v10, s64, v10
    global_load_dword v60, v10, s[38:39] nt
    buffer_load_dwordx4 a[0:3], v2, s[4:7], s59 offen offset:0 nt
    buffer_load_dwordx4 a[4:7], v2, s[4:7], s59 offen offset:128 nt
    buffer_load_dwordx4 a[8:11], v2, s[4:7], s59 offen offset:1024 nt
    buffer_load_dwordx4 a[12:15], v2, s[4:7], s59 offen offset:1152 nt
    buffer_load_dwordx4 a[16:19], v2, s[4:7], s59 offen offset:2048 nt
    buffer_load_dwordx4 a[20:23], v2, s[4:7], s59 offen offset:2176 nt
    buffer_load_dwordx4 a[24:27], v2, s[4:7], s59 offen offset:3072 nt
    buffer_load_dwordx4 a[28:31], v2, s[4:7], s59 offen offset:3200 nt
    s_add_u32 s79, s59, 4096
    s_pack_lh_b32_b16 s59, s79, s59
    s_waitcnt lgkmcnt(0)
    s_add_u32 s58, s58, 0x9e3779b9
    v_mov_b32 v4, s58
    buffer_load_dwordx4 a[32:35], v2, s[4:7], s59 offen offset:0 nt
    buffer_load_dwordx4 a[36:39], v2, s[4:7], s59 offen offset:128 nt
    buffer_load_dwordx4 a[40:43], v2, s[4:7], s59 offen offset:1024 nt
    buffer_load_dwordx4 a[44:47], v2, s[4:7], s59 offen offset:1152 nt
    buffer_load_dwordx4 a[48:51], v2, s[4:7], s59 offen offset:2048 nt
    buffer_load_dwordx4 a[52:55], v2, s[4:7], s59 offen offset:2176 nt
    buffer_load_dwordx4 a[56:59], v2, s[4:7], s59 offen offset:3072 nt
    buffer_load_dwordx4 a[60:63], v2, s[4:7], s59 offen offset:3200 nt
    s_add_u32 s79, s59, 12288
    s_pack_lh_b32_b16 s59, s79, s59
    buffer_load_dwordx4 a[64:67], v2, s[4:7], s59 offen offset:0 nt
    buffer_load_dwordx4 a[68:71], v2, s[4:7], s59 offen offset:128 nt
    buffer_load_dwordx4 a[72:75], v2, s[4:7], s59 offen offset:1024 nt
    buffer_load_dwordx4 a[76:79], v2, s[4:7], s59 offen offset:1152 nt
    buffer_load_dwordx4 a[80:83], v2, s[4:7], s59 offen offset:2048 nt
    buffer_load_dwordx4 a[84:87], v2, s[4:7], s59 offen offset:2176 nt
    buffer_load_dwordx4 a[88:91], v2, s[4:7], s59 offen offset:3072 nt
    buffer_load_dwordx4 a[92:95], v2, s[4:7], s59 offen offset:3200 nt
    s_add_u32 s79, s59, 4096
    s_pack_lh_b32_b16 s59, s79, s59
    buffer_load_dwordx4 a[96:99], v2, s[4:7], s59 offen offset:0 nt
    buffer_load_dwordx4 a[100:103], v2, s[4:7], s59 offen offset:128 nt
    buffer_load_dwordx4 a[104:107], v2, s[4:7], s59 offen offset:1024 nt
    buffer_load_dwordx4 a[108:111], v2, s[4:7], s59 offen offset:1152 nt
    buffer_load_dwordx4 a[112:115], v2, s[4:7], s59 offen offset:2048 nt
    buffer_load_dwordx4 a[116:119], v2, s[4:7], s59 offen offset:2176 nt
    buffer_load_dwordx4 a[120:123], v2, s[4:7], s59 offen offset:3072 nt
    buffer_load_dwordx4 a[124:127], v2, s[4:7], s59 offen offset:3200 nt
    s_add_u32 s79, s59, 12288
    s_pack_lh_b32_b16 s59, s79, s59
    buffer_load_dwordx4 a[128:131], v2, s[4:7], s59 offen offset:0 nt
    buffer_load_dwordx4 a[132:135], v2, s[4:7], s59 offen offset:128 nt
    buffer_load_dwordx4 a[136:139], v2, s[4:7], s59 offen offset:1024 nt
    buffer_load_dwordx4 a[140:143], v2, s[4:7], s59 offen offset:1152 nt
    buffer_load_dwordx4 a[144:147], v2, s[4:7], s59 offen offset:2048 nt
    buffer_load_dwordx4 a[148:151], v2, s[4:7], s59 offen offset:2176 nt
    buffer_load_dwordx4 a[152:155], v2, s[4:7], s59 offen offset:3072 nt
    buffer_load_dwordx4 a[156:159], v2, s[4:7], s59 offen offset:3200 nt
    s_add_u32 s79, s59, 4096
    s_pack_lh_b32_b16 s59, s79, s59
    buffer_load_dwordx4 a[160:163], v2, s[4:7], s59 offen offset:0 nt
    buffer_load_dwordx4 a[164:167], v2, s[4:7], s59 offen offset:128 nt
    buffer_load_dwordx4 a[168:171], v2, s[4:7], s59 offen offset:1024 nt
    buffer_load_dwordx4 a[172:175], v2, s[4:7], s59 offen offset:1152 nt
    buffer_load_dwordx4 a[176:179], v2, s[4:7], s59 offen offset:2048 nt
    buffer_load_dwordx4 a[180:183], v2, s[4:7], s59 offen offset:2176 nt
    buffer_load_dwordx4 a[184:187], v2, s[4:7], s59 offen offset:3072 nt
    buffer_load_dwordx4 a[188:191], v2, s[4:7], s59 offen offset:3200 nt
    s_add_u32 s79, s59, 12288
    s_pack_lh_b32_b16 s59, s79, s59
    buffer_load_dwordx4 a[192:195], v2, s[4:7], s59 offen offset:0 nt
    buffer_load_dwordx4 a[196:199], v2, s[4:7], s59 offen offset:128 nt
    buffer_load_dwordx4 a[200:203], v2, s[4:7], s59 offen offset:1024 nt
    buffer_load_dwordx4 a[204:207], v2, s[4:7], s59 offen offset:1152 nt
    buffer_load_dwordx4 a[208:211], v2, s[4:7], s59 offen offset:2048 nt
    buffer_load_dwordx4 a[212:215], v2, s[4:7], s59 offen offset:2176 nt
    buffer_load_dwordx4 a[216:219], v2, s[4:7], s59 offen offset:3072 nt
    buffer_load_dwordx4 a[220:223], v2, s[4:7], s59 offen offset:3200 nt
    s_add_u32 s79, s59, 4096
    s_pack_lh_b32_b16 s59, s79, s59
    buffer_load_dwordx4 a[224:227], v2, s[4:7], s59 offen offset:0 nt
    buffer_load_dwordx4 a[228:231], v2, s[4:7], s59 offen offset:128 nt
    buffer_load_dwordx4 a[232:235], v2, s[4:7], s59 offen offset:1024 nt
    buffer_load_dwordx4 a[236:239], v2, s[4:7], s59 offen offset:1152 nt
    buffer_load_dwordx4 a[240:243], v2, s[4:7], s59 offen offset:2048 nt
    buffer_load_dwordx4 a[244:247], v2, s[4:7], s59 offen offset:2176 nt
    buffer_load_dwordx4 a[248:251], v2, s[4:7], s59 offen offset:3072 nt
    buffer_load_dwordx4 a[252:255], v2, s[4:7], s59 offen offset:3200 nt
    s_add_u32 s79, s59, 12288
    s_pack_lh_b32_b16 s59, s79, s59
    v_and_b32 v10, 3, v1
    v_lshlrev_b32 v10, 9, v10
    v_lshrrev_b32 v11, 4, v1
    v_lshl_add_u32 v10, v11, 5, v10
    v_bfe_u32 v11, v1, 2, 1
    v_lshl_add_u32 v10, v11, 7, v10
    s_lshr_b32 s61, s2, 3
    s_lshl_b32 s61, s61, 11
    v_add_u32 v6, s61, v10
    s_mov_b32 s61, 0x10000
    buffer_load_dwordx4 v[224:227], v6, s[12:15], s61 offen offset:0 sc1
    s_mov_b32 s61, 0x10000
    buffer_load_dwordx4 v[228:231], v6, s[12:15], s61 offen offset:16 sc1
    s_mov_b32 s61, 0x10000
    buffer_load_dwordx4 v[232:235], v6, s[12:15], s61 offen offset:256 sc1
    s_mov_b32 s61, 0x10000
    buffer_load_dwordx4 v[236:239], v6, s[12:15], s61 offen offset:272 sc1
    buffer_load_dwordx4 v[64:67], v3, s[8:11], s60 offen offset:0 nt
    buffer_load_dwordx4 v[68:71], v3, s[8:11], s60 offen offset:1024 nt
    buffer_load_dwordx4 v[72:75], v3, s[8:11], s60 offen offset:2048 nt
    buffer_load_dwordx4 v[76:79], v3, s[8:11], s60 offen offset:3072 nt
    s_add_u32 s79, s60, 4096
    s_pack_lh_b32_b16 s60, s79, s60
    buffer_load_dwordx4 v[80:83], v3, s[8:11], s60 offen offset:0 nt
    buffer_load_dwordx4 v[84:87], v3, s[8:11], s60 offen offset:1024 nt
    buffer_load_dwordx4 v[88:91], v3, s[8:11], s60 offen offset:2048 nt
    buffer_load_dwordx4 v[92:95], v3, s[8:11], s60 offen offset:3072 nt
    s_add_u32 s79, s60, 4096
    s_pack_lh_b32_b16 s60, s79, s60
    s_mov_b32 s61, 0x10000
    buffer_load_dwordx4 v[224:227], v6, s[12:15], s61 offen offset:0 sc1
    s_mov_b32 s61, 0x10000
    buffer_load_dwordx4 v[228:231], v6, s[12:15], s61 offen offset:16 sc1
    s_mov_b32 s61, 0x10000
    buffer_load_dwordx4 v[232:235], v6, s[12:15], s61 offen offset:256 sc1
    s_mov_b32 s61, 0x10000
    buffer_load_dwordx4 v[236:239], v6, s[12:15], s61 offen offset:272 sc1
    buffer_load_dwordx4 v[96:99], v3, s[8:11], s60 offen offset:0 nt
    buffer_load_dwordx4 v[100:103], v3, s[8:11], s60 offen offset:1024 nt
    buffer_load_dwordx4 v[104:107], v3, s[8:11], s60 offen offset:2048 nt
    buffer_load_dwordx4 v[108:111], v3, s[8:11], s60 offen offset:3072 nt
    s_add_u32 s79, s60, 4096
    s_pack_lh_b32_b16 s60, s79, s60
    buffer_load_dwordx4 v[112:115], v3, s[8:11], s60 offen offset:0 nt
    buffer_load_dwordx4 v[116:119], v3, s[8:11], s60 offen offset:1024 nt
    buffer_load_dwordx4 v[120:123], v3, s[8:11], s60 offen offset:2048 nt
    buffer_load_dwordx4 v[124:127], v3, s[8:11], s60 offen offset:3072 nt
    s_add_u32 s79, s60, 4096
    s_pack_lh_b32_b16 s60, s79, s60
    s_mov_b32 s61, 0x10000
    buffer_load_dwordx4 v[224:227], v6, s[12:15], s61 offen offset:0 sc1
    s_mov_b32 s61, 0x10000
    buffer_load_dwordx4 v[228:231], v6, s[12:15], s61 offen offset:16 sc1
    s_mov_b32 s61, 0x10000
    buffer_load_dwordx4 v[232:235], v6, s[12:15], s61 offen offset:256 sc1
    s_mov_b32 s61, 0x10000
    buffer_load_dwordx4 v[236:239], v6, s[12:15], s61 offen offset:272 sc1
    buffer_load_dwordx4 v[128:131], v3, s[8:11], s60 offen offset:0 nt
    buffer_load_dwordx4 v[132:135], v3, s[8:11], s60 offen offset:1024 nt
    buffer_load_dwordx4 v[136:139], v3, s[8:11], s60 offen offset:2048 nt
    buffer_load_dwordx4 v[140:143], v3, s[8:11], s60 offen offset:3072 nt
    s_add_u32 s79, s60, 4096
    s_pack_lh_b32_b16 s60, s79, s60
    buffer_load_dwordx4 v[144:147], v3, s[8:11], s60 offen offset:0 nt
    buffer_load_dwordx4 v[148:151], v3, s[8:11], s60 offen offset:1024 nt
    buffer_load_dwordx4 v[152:155], v3, s[8:11], s60 offen offset:2048 nt
    buffer_load_dwordx4 v[156:159], v3, s[8:11], s60 offen offset:3072 nt
    s_add_u32 s79, s60, 4096
    s_pack_lh_b32_b16 s60, s79, s60
    s_waitcnt vmcnt(32)
    v_mov_b32 v48, v224
    v_mov_b32 v49, v225
    v_mov_b32 v50, v226
    v_mov_b32 v51, v227
    v_mov_b32 v52, v228
    v_mov_b32 v53, v229
    v_mov_b32 v54, v230
    v_mov_b32 v55, v231
    v_mov_b32 v56, v232
    v_mov_b32 v57, v233
    v_mov_b32 v58, v234
    v_mov_b32 v59, v235
    v_mov_b32 v60, v236
    v_mov_b32 v61, v237
    v_mov_b32 v62, v238
    v_mov_b32 v63, v239
    v_xor_b32 v10, s58, v48
    v_bitop3_b32 v10, v49, s58, v10 bitop3:0xbe
    v_bitop3_b32 v10, v50, s58, v10 bitop3:0xbe
    v_bitop3_b32 v10, v51, s58, v10 bitop3:0xbe
    v_bitop3_b32 v10, v52, s58, v10 bitop3:0xbe
    v_bitop3_b32 v10, v53, s58, v10 bitop3:0xbe
    v_bitop3_b32 v10, v54, s58, v10 bitop3:0xbe
    v_bitop3_b32 v10, v55, s58, v10 bitop3:0xbe
    v_bitop3_b32 v10, v56, s58, v10 bitop3:0xbe
    v_bitop3_b32 v10, v57, s58, v10 bitop3:0xbe
    v_bitop3_b32 v10, v58, s58, v10 bitop3:0xbe
    v_bitop3_b32 v10, v59, s58, v10 bitop3:0xbe
    v_bitop3_b32 v10, v60, s58, v10 bitop3:0xbe
    v_bitop3_b32 v10, v61, s58, v10 bitop3:0xbe
    v_bitop3_b32 v10, v62, s58, v10 bitop3:0xbe
    v_bitop3_b32 v10, v63, s58, v10 bitop3:0xbe
    v_and_b32 v10, 0xff, v10
    v_cmp_ne_u32 vcc, 0, v10
    s_cbranch_vccz QGO_W
    s_waitcnt vmcnt(20)
    v_mov_b32 v48, v224
    v_mov_b32 v49, v225
    v_mov_b32 v50, v226
    v_mov_b32 v51, v227
    v_mov_b32 v52, v228
    v_mov_b32 v53, v229
    v_mov_b32 v54, v230
    v_mov_b32 v55, v231
    v_mov_b32 v56, v232
    v_mov_b32 v57, v233
    v_mov_b32 v58, v234
    v_mov_b32 v59, v235
    v_mov_b32 v60, v236
    v_mov_b32 v61, v237
    v_mov_b32 v62, v238
    v_mov_b32 v63, v239
    v_xor_b32 v10, s58, v48
    v_bitop3_b32 v10, v49, s58, v10 bitop3:0xbe
    v_bitop3_b32 v10, v50, s58, v10 bitop3:0xbe
    v_bitop3_b32 v10, v51, s58, v10 bitop3:0xbe
    v_bitop3_b32 v10, v52, s58, v10 bitop3:0xbe
    v_bitop3_b32 v10, v53, s58, v10 bitop3:0xbe
    v_bitop3_b32 v10, v54, s58, v10 bitop3:0xbe
    v_bitop3_b32 v10, v55, s58, v10 bitop3:0xbe
    v_bitop3_b32 v10, v56, s58, v10 bitop3:0xbe
    v_bitop3_b32 v10, v57, s58, v10 bitop3:0xbe
    v_bitop3_b32 v10, v58, s58, v10 bitop3:0xbe
    v_bitop3_b32 v10, v59, s58, v10 bitop3:0xbe
    v_bitop3_b32 v10, v60, s58, v10 bitop3:0xbe
    v_bitop3_b32 v10, v61, s58, v10 bitop3:0xbe
    v_bitop3_b32 v10, v62, s58, v10 bitop3:0xbe
    v_bitop3_b32 v10, v63, s58, v10 bitop3:0xbe
    v_and_b32 v10, 0xff, v10
    v_cmp_ne_u32 vcc, 0, v10
    s_cbranch_vccz QGO_W
    s_waitcnt vmcnt(8)
    v_mov_b32 v48, v224
    v_mov_b32 v49, v225
    v_mov_b32 v50, v226
    v_mov_b32 v51, v227
    v_mov_b32 v52, v228
    v_mov_b32 v53, v229
    v_mov_b32 v54, v230
    v_mov_b32 v55, v231
    v_mov_b32 v56, v232
    v_mov_b32 v57, v233
    v_mov_b32 v58, v234
    v_mov_b32 v59, v235
    v_mov_b32 v60, v236
    v_mov_b32 v61, v237
    v_mov_b32 v62, v238
    v_mov_b32 v63, v239
    v_xor_b32 v10, s58, v48
    v_bitop3_b32 v10, v49, s58, v10 bitop3:0xbe
    v_bitop3_b32 v10, v50, s58, v10 bitop3:0xbe
    v_bitop3_b32 v10, v51, s58, v10 bitop3:0xbe
    v_bitop3_b32 v10, v52, s58, v10 bitop3:0xbe
    v_bitop3_b32 v10, v53, s58, v10 bitop3:0xbe
    v_bitop3_b32 v10, v54, s58, v10 bitop3:0xbe
    v_bitop3_b32 v10, v55, s58, v10 bitop3:0xbe
    v_bitop3_b32 v10, v56, s58, v10 bitop3:0xbe
    v_bitop3_b32 v10, v57, s58, v10 bitop3:0xbe
    v_bitop3_b32 v10, v58, s58, v10 bitop3:0xbe
    v_bitop3_b32 v10, v59, s58, v10 bitop3:0xbe
    v_bitop3_b32 v10, v60, s58, v10 bitop3:0xbe
    v_bitop3_b32 v10, v61, s58, v10 bitop3:0xbe
    v_bitop3_b32 v10, v62, s58, v10 bitop3:0xbe
    v_bitop3_b32 v10, v63, s58, v10 bitop3:0xbe
    v_and_b32 v10, 0xff, v10
    v_cmp_ne_u32 vcc, 0, v10
    s_cbranch_vccz QGO_W
    s_mov_b32 s62, 0x40000
QRX_W:
    s_mov_b32 s61, 0x10000
    buffer_load_dwordx4 v[224:227], v6, s[12:15], s61 offen offset:0 sc1
    s_mov_b32 s61, 0x10000
    buffer_load_dwordx4 v[228:231], v6, s[12:15], s61 offen offset:16 sc1
    s_mov_b32 s61, 0x10000
    buffer_load_dwordx4 v[232:235], v6, s[12:15], s61 offen offset:256 sc1
    s_mov_b32 s61, 0x10000
    buffer_load_dwordx4 v[236:239], v6, s[12:15], s61 offen offset:272 sc1
    s_waitcnt vmcnt(0)
    v_mov_b32 v48, v224
    v_mov_b32 v49, v225
    v_mov_b32 v50, v226
    v_mov_b32 v51, v227
    v_mov_b32 v52, v228
    v_mov_b32 v53, v229
    v_mov_b32 v54, v230
    v_mov_b32 v55, v231
    v_mov_b32 v56, v232
    v_mov_b32 v57, v233
    v_mov_b32 v58, v234
    v_mov_b32 v59, v235
    v_mov_b32 v60, v236
    v_mov_b32 v61, v237
    v_mov_b32 v62, v238
    v_mov_b32 v63, v239
    v_xor_b32 v10, s58, v48
    v_bitop3_b32 v10, v49, s58, v10 bitop3:0xbe
    v_bitop3_b32 v10, v50, s58, v10 bitop3:0xbe
    v_bitop3_b32 v10, v51, s58, v10 bitop3:0xbe
    v_bitop3_b32 v10, v52, s58, v10 bitop3:0xbe
    v_bitop3_b32 v10, v53, s58, v10 bitop3:0xbe
    v_bitop3_b32 v10, v54, s58, v10 bitop3:0xbe
    v_bitop3_b32 v10, v55, s58, v10 bitop3:0xbe
    v_bitop3_b32 v10, v56, s58, v10 bitop3:0xbe
    v_bitop3_b32 v10, v57, s58, v10 bitop3:0xbe
    v_bitop3_b32 v10, v58, s58, v10 bitop3:0xbe
    v_bitop3_b32 v10, v59, s58, v10 bitop3:0xbe
    v_bitop3_b32 v10, v60, s58, v10 bitop3:0xbe
    v_bitop3_b32 v10, v61, s58, v10 bitop3:0xbe
    v_bitop3_b32 v10, v62, s58, v10 bitop3:0xbe
    v_bitop3_b32 v10, v63, s58, v10 bitop3:0xbe
    v_and_b32 v10, 0xff, v10
    v_cmp_ne_u32 vcc, 0, v10
    s_cbranch_vccz QGO_W
    s_sub_u32 s62, s62, 1
    s_cbranch_scc0 QRX_W
QGO_W:
    buffer_load_dwordx4 v[224:227], v3, s[8:11], s60 offen offset:0 nt
    v_perm_b32 v16, v49, v48, s68
    v_perm_b32 v17, v51, v50, s68
    v_perm_b32 v18, v53, v52, s68
    v_perm_b32 v19, v55, v54, s68
    v_perm_b32 v20, v57, v56, s68
    v_perm_b32 v21, v59, v58, s68
    v_perm_b32 v22, v61, v60, s68
    buffer_load_dwordx4 v[228:231], v3, s[8:11], s60 offen offset:1024 nt
    v_perm_b32 v23, v63, v62, s68
    v_cndmask_b32 v32, 0, v16, s[72:73]
    v_cndmask_b32 v33, 0, v17, s[72:73]
    v_cndmask_b32 v34, 0, v18, s[72:73]
    v_cndmask_b32 v35, 0, v19, s[72:73]
    v_cndmask_b32 v36, 0, v20, s[72:73]
    v_cndmask_b32 v37, 0, v21, s[72:73]
    v_cndmask_b32 v38, 0, v22, s[72:73]
    buffer_load_dwordx4 v[232:235], v3, s[8:11], s60 offen offset:2048 nt
    v_cndmask_b32 v39, 0, v23, s[72:73]
    v_cndmask_b32 v40, 0, v16, s[74:75]
    v_cndmask_b32 v41, 0, v17, s[74:75]
    v_cndmask_b32 v42, 0, v18, s[74:75]
    v_cndmask_b32 v43, 0, v19, s[74:75]
    v_cndmask_b32 v44, 0, v20, s[74:75]
    v_cndmask_b32 v45, 0, v21, s[74:75]
    buffer_load_dwordx4 v[236:239], v3, s[8:11], s60 offen offset:3072 nt
    v_cndmask_b32 v46, 0, v22, s[74:75]
    v_cndmask_b32 v47, 0, v23, s[74:75]
    v_mfma_f32_16x16x32_bf16 v[160:163], a[0:3], v[32:35], 0
    v_mfma_f32_16x16x32_bf16 v[164:167], a[8:11], v[32:35], 0
    v_mfma_f32_16x16x32_bf16 v[168:171], a[16:19], v[32:35], 0
    v_mfma_f32_16x16x32_bf16 v[172:175], a[24:27], v[32:35], 0
    v_mfma_f32_16x16x32_bf16 v[176:179], a[32:35], v[32:35], 0
    v_mfma_f32_16x16x32_bf16 v[180:183], a[40:43], v[32:35], 0
    s_add_u32 s79, s60, 4096
    s_pack_lh_b32_b16 s60, s79, s60
    buffer_load_dwordx4 v[240:243], v3, s[8:11], s60 offen offset:0 nt
    v_mfma_f32_16x16x32_bf16 v[184:187], a[48:51], v[32:35], 0
    v_mfma_f32_16x16x32_bf16 v[188:191], a[56:59], v[32:35], 0
    v_mfma_f32_16x16x32_bf16 v[160:163], a[4:7], v[36:39], v[160:163]
    v_mfma_f32_16x16x32_bf16 v[164:167], a[12:15], v[36:39], v[164:167]
    v_mfma_f32_16x16x32_bf16 v[168:171], a[20:23], v[36:39], v[168:171]
    v_mfma_f32_16x16x32_bf16 v[172:175], a[28:31], v[36:39], v[172:175]
    v_mfma_f32_16x16x32_bf16 v[176:179], a[36:39], v[36:39], v[176:179]
    buffer_load_dwordx4 v[244:247], v3, s[8:11], s60 offen offset:1024 nt
    v_mfma_f32_16x16x32_bf16 v[180:183], a[44:47], v[36:39], v[180:183]
    v_mfma_f32_16x16x32_bf16 v[184:187], a[52:55], v[36:39], v[184:187]
    v_mfma_f32_16x16x32_bf16 v[188:191], a[60:63], v[36:39], v[188:191]
    v_mfma_f32_16x16x32_bf16 v[160:163], a[64:67], v[40:43], v[160:163]
    v_mfma_f32_16x16x32_bf16 v[164:167], a[72:75], v[40:43], v[164:167]
    v_mfma_f32_16x16x32_bf16 v[168:171], a[80:83], v[40:43], v[168:171]
    v_mfma_f32_16x16x32_bf16 v[172:175], a[88:91], v[40:43], v[172:175]
    v_mfma_f32_16x16x32_bf16 v[176:179], a[96:99], v[40:43], v[176:179]
    buffer_load_dwordx4 v[248:251], v3, s[8:11], s60 offen offset:2048 nt
    v_mfma_f32_16x16x32_bf16 v[180:183], a[104:107], v[40:43], v[180:183]
    v_mfma_f32_16x16x32_bf16 v[184:187], a[112:115], v[40:43], v[184:187]
    v_mfma_f32_16x16x32_bf16 v[188:191], a[120:123], v[40:43], v[188:191]
    v_mfma_f32_16x16x32_bf16 v[160:163], a[68:71], v[44:47], v[160:163]
    v_mfma_f32_16x16x32_bf16 v[164:167], a[76:79], v[44:47], v[164:167]
    v_mfma_f32_16x16x32_bf16 v[168:171], a[84:87], v[44:47], v[168:171]
    v_mfma_f32_16x16x32_bf16 v[172:175], a[92:95], v[44:47], v[172:175]
    buffer_load_dwordx4 v[252:255], v3, s[8:11], s60 offen offset:3072 nt
    s_add_u32 s79, s60, 4096
    s_pack_lh_b32_b16 s60, s79, s60
    v_mfma_f32_16x16x32_bf16 v[176:179], a[100:103], v[44:47], v[176:179]
    v_mfma_f32_16x16x32_bf16 v[180:183], a[108:111], v[44:47], v[180:183]
    v_mfma_f32_16x16x32_bf16 v[184:187], a[116:119], v[44:47], v[184:187]
    v_mfma_f32_16x16x32_bf16 v[188:191], a[124:127], v[44:47], v[188:191]
    v_mfma_f32_16x16x32_bf16 v[192:195], a[128:131], v[32:35], 0
    v_mfma_f32_16x16x32_bf16 v[196:199], a[136:139], v[32:35], 0
    v_mfma_f32_16x16x32_bf16 v[200:203], a[144:147], v[32:35], 0
    v_mfma_f32_16x16x32_bf16 v[204:207], a[152:155], v[32:35], 0
    v_mfma_f32_16x16x32_bf16 v[208:211], a[160:163], v[32:35], 0
    v_mfma_f32_16x16x32_bf16 v[212:215], a[168:171], v[32:35], 0
    v_mfma_f32_16x16x32_bf16 v[216:219], a[176:179], v[32:35], 0
    v_mfma_f32_16x16x32_bf16 v[220:223], a[184:187], v[32:35], 0
    v_mfma_f32_16x16x32_bf16 v[192:195], a[132:135], v[36:39], v[192:195]
    v_mfma_f32_16x16x32_bf16 v[196:199], a[140:143], v[36:39], v[196:199]
    v_mfma_f32_16x16x32_bf16 v[200:203], a[148:151], v[36:39], v[200:203]
    v_mfma_f32_16x16x32_bf16 v[204:207], a[156:159], v[36:39], v[204:207]
    v_mfma_f32_16x16x32_bf16 v[208:211], a[164:167], v[36:39], v[208:211]
    v_mfma_f32_16x16x32_bf16 v[212:215], a[172:175], v[36:39], v[212:215]
    v_mfma_f32_16x16x32_bf16 v[216:219], a[180:183], v[36:39], v[216:219]
    v_mfma_f32_16x16x32_bf16 v[220:223], a[188:191], v[36:39], v[220:223]
    v_mfma_f32_16x16x32_bf16 v[192:195], a[192:195], v[40:43], v[192:195]
    v_mfma_f32_16x16x32_bf16 v[196:199], a[200:203], v[40:43], v[196:199]
    v_mfma_f32_16x16x32_bf16 v[200:203], a[208:211], v[40:43], v[200:203]
    v_mfma_f32_16x16x32_bf16 v[204:207], a[216:219], v[40:43], v[204:207]
    v_mfma_f32_16x16x32_bf16 v[208:211], a[224:227], v[40:43], v[208:211]
    v_mfma_f32_16x16x32_bf16 v[212:215], a[232:235], v[40:43], v[212:215]
    v_mfma_f32_16x16x32_bf16 v[216:219], a[240:243], v[40:43], v[216:219]
    v_mfma_f32_16x16x32_bf16 v[220:223], a[248:251], v[40:43], v[220:223]
    v_mfma_f32_16x16x32_bf16 v[192:195], a[196:199], v[44:47], v[192:195]
    v_mfma_f32_16x16x32_bf16 v[196:199], a[204:207], v[44:47], v[196:199]
    v_mfma_f32_16x16x32_bf16 v[200:203], a[212:215], v[44:47], v[200:203]
    v_mfma_f32_16x16x32_bf16 v[204:207], a[220:223], v[44:47], v[204:207]
    v_mfma_f32_16x16x32_bf16 v[208:211], a[228:231], v[44:47], v[208:211]
    v_mfma_f32_16x16x32_bf16 v[212:215], a[236:239], v[44:47], v[212:215]
    v_mfma_f32_16x16x32_bf16 v[216:219], a[244:247], v[44:47], v[216:219]
    v_mfma_f32_16x16x32_bf16 v[220:223], a[252:255], v[44:47], v[220:223]
    v_add_f32_dpp v48, v161, v160 row_shl:4 row_mask:0xf bank_mask:0x5
    v_add_f32_dpp v49, v165, v164 row_shl:4 row_mask:0xf bank_mask:0x5
    v_add_f32_dpp v50, v169, v168 row_shl:4 row_mask:0xf bank_mask:0x5
    v_add_f32_dpp v51, v173, v172 row_shl:4 row_mask:0xf bank_mask:0x5
    v_add_f32_dpp v52, v177, v176 row_shl:4 row_mask:0xf bank_mask:0x5
    v_add_f32_dpp v53, v181, v180 row_shl:4 row_mask:0xf bank_mask:0x5
    v_add_f32_dpp v54, v185, v184 row_shl:4 row_mask:0xf bank_mask:0x5
    v_add_f32_dpp v55, v189, v188 row_shl:4 row_mask:0xf bank_mask:0x5
    v_add_f32_dpp v56, v193, v192 row_shl:4 row_mask:0xf bank_mask:0x5
    v_add_f32_dpp v57, v197, v196 row_shl:4 row_mask:0xf bank_mask:0x5
    v_add_f32_dpp v58, v201, v200 row_shl:4 row_mask:0xf bank_mask:0x5
    v_add_f32_dpp v59, v205, v204 row_shl:4 row_mask:0xf bank_mask:0x5
    v_add_f32_dpp v60, v209, v208 row_shl:4 row_mask:0xf bank_mask:0x5
    v_add_f32_dpp v61, v213, v212 row_shl:4 row_mask:0xf bank_mask:0x5
    v_add_f32_dpp v62, v217, v216 row_shl:4 row_mask:0xf bank_mask:0x5
    v_add_f32_dpp v63, v221, v220 row_shl:4 row_mask:0xf bank_mask:0x5
    v_add_f32_dpp v48, v162, v163 row_shr:4 row_mask:0xf bank_mask:0xa
    v_add_f32_dpp v49, v166, v167 row_shr:4 row_mask:0xf bank_mask:0xa
    v_add_f32_dpp v50, v170, v171 row_shr:4 row_mask:0xf bank_mask:0xa
    v_add_f32_dpp v51, v174, v175 row_shr:4 row_mask:0xf bank_mask:0xa
    v_add_f32_dpp v52, v178, v179 row_shr:4 row_mask:0xf bank_mask:0xa
    v_add_f32_dpp v53, v182, v183 row_shr:4 row_mask:0xf bank_mask:0xa
    v_add_f32_dpp v54, v186, v187 row_shr:4 row_mask:0xf bank_mask:0xa
    v_add_f32_dpp v55, v190, v191 row_shr:4 row_mask:0xf bank_mask:0xa
    v_add_f32_dpp v56, v194, v195 row_shr:4 row_mask:0xf bank_mask:0xa
    v_add_f32_dpp v57, v198, v199 row_shr:4 row_mask:0xf bank_mask:0xa
    v_add_f32_dpp v58, v202, v203 row_shr:4 row_mask:0xf bank_mask:0xa
    v_add_f32_dpp v59, v206, v207 row_shr:4 row_mask:0xf bank_mask:0xa
    v_add_f32_dpp v60, v210, v211 row_shr:4 row_mask:0xf bank_mask:0xa
    v_add_f32_dpp v61, v214, v215 row_shr:4 row_mask:0xf bank_mask:0xa
    v_add_f32_dpp v62, v218, v219 row_shr:4 row_mask:0xf bank_mask:0xa
    v_add_f32_dpp v63, v222, v223 row_shr:4 row_mask:0xf bank_mask:0xa
    buffer_load_dwordx4 v[160:163], v3, s[8:11], s60 offen offset:0 nt
    v_cvt_pk_bf16_f32 v32, v48, v49
    v_cvt_pk_bf16_f32 v33, v50, v51
    v_cvt_pk_bf16_f32 v34, v52, v53
    v_cvt_pk_bf16_f32 v35, v54, v55
    v_cvt_pk_bf16_f32 v36, v56, v57
    v_cvt_pk_bf16_f32 v37, v58, v59
    v_cvt_pk_bf16_f32 v38, v60, v61
    v_cvt_pk_bf16_f32 v39, v62, v63
    v_lshlrev_b32 v48, 16, v32
    buffer_load_dwordx4 v[164:167], v3, s[8:11], s60 offen offset:1024 nt
    v_and_b32 v49, s66, v32
    v_lshlrev_b32 v50, 16, v33
    v_and_b32 v51, s66, v33
    v_lshlrev_b32 v52, 16, v34
    v_and_b32 v53, s66, v34
    v_lshlrev_b32 v54, 16, v35
    v_and_b32 v55, s66, v35
    v_lshlrev_b32 v56, 16, v36
    v_and_b32 v57, s66, v36
    v_lshlrev_b32 v58, 16, v37
    buffer_load_dwordx4 v[168:171], v3, s[8:11], s60 offen offset:2048 nt
    v_and_b32 v59, s66, v37
    v_lshlrev_b32 v60, 16, v38
    v_and_b32 v61, s66, v38
    v_lshlrev_b32 v62, 16, v39
    v_and_b32 v63, s66, v39
    v_mul_f32 v48, s70, v48
    v_mul_f32 v49, s70, v49
    v_mul_f32 v50, s70, v50
    v_mul_f32 v51, s70, v51
    buffer_load_dwordx4 v[172:175], v3, s[8:11], s60 offen offset:3072 nt
    v_mul_f32 v52, s70, v52
    v_mul_f32 v53, s70, v53
    v_mul_f32 v54, s70, v54
    v_mul_f32 v55, s70, v55
    v_mul_f32 v56, s70, v56
    v_mul_f32 v57, s70, v57
    v_mul_f32 v58, s70, v58
    v_mul_f32 v59, s70, v59
    v_mul_f32 v60, s70, v60
    v_mul_f32 v61, s70, v61
    s_add_u32 s79, s60, 4096
    s_pack_lh_b32_b16 s60, s79, s60
    buffer_load_dwordx4 v[176:179], v3, s[8:11], s60 offen offset:0 nt
    v_mul_f32 v62, s70, v62
    v_mul_f32 v63, s70, v63
    v_cvt_pk_bf16_f32 v32, v48, v49
    v_cvt_pk_bf16_f32 v33, v50, v51
    v_cvt_pk_bf16_f32 v34, v52, v53
    v_cvt_pk_bf16_f32 v35, v54, v55
    v_cvt_pk_bf16_f32 v36, v56, v57
    v_cvt_pk_bf16_f32 v37, v58, v59
    v_cvt_pk_bf16_f32 v38, v60, v61
    buffer_load_dwordx4 v[180:183], v3, s[8:11], s60 offen offset:1024 nt
    v_cvt_pk_bf16_f32 v39, v62, v63
    v_lshlrev_b32 v48, 16, v32
    v_and_b32 v49, s66, v32
    v_lshlrev_b32 v50, 16, v33
    v_and_b32 v51, s66, v33
    v_lshlrev_b32 v52, 16, v34
    v_and_b32 v53, s66, v34
    v_lshlrev_b32 v54, 16, v35
    v_and_b32 v55, s66, v35
    v_lshlrev_b32 v56, 16, v36
    buffer_load_dwordx4 v[184:187], v3, s[8:11], s60 offen offset:2048 nt
    v_and_b32 v57, s66, v36
    v_lshlrev_b32 v58, 16, v37
    v_and_b32 v59, s66, v37
    v_lshlrev_b32 v60, 16, v38
    v_and_b32 v61, s66, v38
    v_lshlrev_b32 v62, 16, v39
    v_and_b32 v63, s66, v39
    v_max3_f32 v9, v48, v49, v50
    v_max3_f32 v9, v9, v51, v52
    buffer_load_dwordx4 v[188:191], v3, s[8:11], s60 offen offset:3072 nt
    v_max3_f32 v9, v9, v53, v54
    v_max3_f32 v9, v9, v55, v56
    v_max3_f32 v9, v9, v57, v58
    v_max3_f32 v9, v9, v59, v60
    v_max3_f32 v9, v9, v61, v62
    v_max_f32 v9, v9, v63
    s_nop 1
    v_max_f32_dpp v9, v9, v9 row_ror:4 row_mask:0xf bank_mask:0xf
    s_nop 1
    v_max_f32_dpp v9, v9, v9 row_ror:8 row_mask:0xf bank_mask:0xf
    v_mov_b32 v10, v9
    s_nop 1
    v_permlane16_swap_b32 v9, v10
    s_add_u32 s79, s60, 4096
    s_pack_lh_b32_b16 s60, s79, s60
    buffer_load_dwordx4 v[192:195], v3, s[8:11], s60 offen offset:0 nt
    v_max_f32 v9, v9, v10
    v_mov_b32 v10, v9
    s_nop 1
    v_permlane32_swap_b32 v9, v10
    v_max_f32 v9, v9, v10
    v_mul_f32 v11, s69, v9
    v_fma_f32 v48, v48, s69, -v11
    v_fma_f32 v49, v49, s69, -v11
    v_fma_f32 v50, v50, s69, -v11
    v_fma_f32 v51, v51, s69, -v11
    buffer_load_dwordx4 v[196:199], v3, s[8:11], s60 offen offset:1024 nt
    v_fma_f32 v52, v52, s69, -v11
    v_fma_f32 v53, v53, s69, -v11
    v_fma_f32 v54, v54, s69, -v11
    v_fma_f32 v55, v55, s69, -v11
    v_fma_f32 v56, v56, s69, -v11
    v_fma_f32 v57, v57, s69, -v11
    v_fma_f32 v58, v58, s69, -v11
    v_fma_f32 v59, v59, s69, -v11
    v_fma_f32 v60, v60, s69, -v11
    v_fma_f32 v61, v61, s69, -v11
    buffer_load_dwordx4 v[200:203], v3, s[8:11], s60 offen offset:2048 nt
    v_fma_f32 v62, v62, s69, -v11
    v_fma_f32 v63, v63, s69, -v11
    v_exp_f32 v48, v48
    v_exp_f32 v49, v49
    v_exp_f32 v50, v50
    v_exp_f32 v51, v51
    v_exp_f32 v52, v52
    v_exp_f32 v53, v53
    v_exp_f32 v54, v54
    buffer_load_dwordx4 v[204:207], v3, s[8:11], s60 offen offset:3072 nt
    v_exp_f32 v55, v55
    v_exp_f32 v56, v56
    v_exp_f32 v57, v57
    v_exp_f32 v58, v58
    v_exp_f32 v59, v59
    v_exp_f32 v60, v60
    v_exp_f32 v61, v61
    v_exp_f32 v62, v62
    v_exp_f32 v63, v63
    v_add_f32 v13, v48, v49
    s_add_u32 s79, s60, 4096
    s_pack_lh_b32_b16 s60, s79, s60
    buffer_load_dwordx4 v[208:211], v3, s[8:11], s60 offen offset:0 nt
    v_add_f32 v13, v13, v50
    v_add_f32 v13, v13, v51
    v_add_f32 v13, v13, v52
    v_add_f32 v13, v13, v53
    v_add_f32 v13, v13, v54
    v_add_f32 v13, v13, v55
    v_add_f32 v13, v13, v56
    v_add_f32 v13, v13, v57
    v_add_f32 v13, v13, v58
    buffer_load_dwordx4 v[212:215], v3, s[8:11], s60 offen offset:1024 nt
    v_add_f32 v13, v13, v59
    v_add_f32 v13, v13, v60
    v_add_f32 v13, v13, v61
    v_add_f32 v13, v13, v62
    v_add_f32 v13, v13, v63
    v_cvt_pk_bf16_f32 v16, v48, v49
    v_cvt_pk_bf16_f32 v17, v50, v51
    v_cvt_pk_bf16_f32 v18, v52, v53
    v_cvt_pk_bf16_f32 v19, v54, v55
    v_cvt_pk_bf16_f32 v20, v56, v57
    buffer_load_dwordx4 v[216:219], v3, s[8:11], s60 offen offset:2048 nt
    v_cvt_pk_bf16_f32 v21, v58, v59
    v_cvt_pk_bf16_f32 v22, v60, v61
    v_cvt_pk_bf16_f32 v23, v62, v63
    v_add_f32_dpp v13, v13, v13 row_ror:4 row_mask:0xf bank_mask:0xf
    s_nop 1
    v_add_f32_dpp v13, v13, v13 row_ror:8 row_mask:0xf bank_mask:0xf
    v_mov_b32 v10, v13
    s_nop 1
    v_permlane16_swap_b32 v13, v10
    v_add_f32 v13, v13, v10
    v_mov_b32 v10, v13
    buffer_load_dwordx4 v[220:223], v3, s[8:11], s60 offen offset:3072 nt
    s_add_u32 s79, s60, 4096
    s_pack_lh_b32_b16 s60, s79, s60
    v_permlane32_swap_b32 v13, v10
    v_add_f32 v13, v13, v10
    v_mov_b32 v12, v9
    v_mov_b32 v14, s58
    v_mov_b32 v15, s58
    s_lshl_b32 s64, s2, 8
    s_lshl_b32 s61, s3, 6
    s_add_u32 s64, s64, s61
    v_lshlrev_b32 v10, 4, v1
    v_add_u32 v6, s64, v10
    s_mov_b64 exec, 0xf
    s_mov_b32 s61, 0x20000
    buffer_store_dwordx4 v[12:15], v6, s[12:15], s61 offen offset:0 sc1
    s_mov_b64 exec, -1
    v_mov_b32 v24, 0
    v_mov_b32 v25, 0
    v_mov_b32 v26, 0
    v_mov_b32 v27, 0
    v_mov_b32 v28, 0
    v_mov_b32 v29, 0
    v_mov_b32 v30, 0
    v_mov_b32 v31, 0
    v_mov_b32 v40, 0
    v_mov_b32 v41, 0
    v_mov_b32 v42, 0
    v_mov_b32 v43, 0
    v_mov_b32 v44, 0
    v_mov_b32 v45, 0
    v_mov_b32 v46, 0
    v_mov_b32 v47, 0
    s_lshr_b32 s61, s2, 3
    s_lshl_b32 s61, s61, 11
    v_lshlrev_b32 v10, 4, v1
    v_add_u32 v6, s61, v10
    s_mov_b32 s20, s40
    s_mov_b32 s21, s41
    s_mov_b32 s22, 0x400000
    s_mov_b32 s23, 0x20000
    s_and_b32 s63, s2, 7
    s_lshr_b32 s37, s2, 3
    s_sub_u32 s37, s37, 14
    s_lshl_b32 s64, s37, 7
    s_lshl_b32 s62, s63, 19
    s_add_u32 s64, s64, s62
    v_lshrrev_b32 v10, 4, v1
    v_lshlrev_b32 v10, 5, v10
    s_lshl_b32 s61, s3, 7
    v_add_u32 v10, s61, v10
    s_movk_i32 s61, 1024
    v_mul_lo_u32 v10, v10, s61
    v_and_b32 v11, 3, v1
    v_lshl_add_u32 v10, v11, 4, v10
    v_bfe_u32 v11, v1, 2, 1
    v_lshl_add_u32 v10, v11, 3, v10
    v_bfe_u32 v11, v1, 3, 1
    v_lshl_add_u32 v10, v11, 6, v10
    v_add_u32 v7, s64, v10
    v_lshrrev_b32 v10, 4, v1
    v_add_u32 v10, v10, v1
    v_and_b32 v10, 3, v10
    v_and_b32 v11, 60, v1
    v_or_b32 v10, v10, v11
    v_lshlrev_b32 v10, 4, v10
    s_lshl_b32 s61, s3, 11
    v_add_u32 v8, s61, v10
    v_bfe_u32 v11, v0, 5, 2
    v_lshlrev_b32 v15, 4, v11
    v_bfe_u32 v10, v0, 3, 2
    v_add_u32 v11, v11, v10
    v_and_b32 v11, 3, v11
    v_lshlrev_b32 v11, 4, v11
    v_lshl_add_u32 v11, v10, 8, v11
    v_and_b32 v10, 3, v0
    v_lshl_add_u32 v11, v10, 6, v11
    v_bfe_u32 v10, v0, 2, 1
    v_lshl_add_u32 v2, v10, 10, v11
    v_and_b32 v10, 0x60, v0
    v_bfe_u32 v11, v0, 1, 4
    v_or_b32 v10, v10, v11
    v_and_b32 v11, 1, v0
    v_lshl_or_b32 v10, v11, 4, v10
    v_lshlrev_b32 v10, 4, v10
    s_lshl_b32 s64, s2, 11
    v_add_u32 v14, s64, v10
    v_mov_b32_dpp v24, v16 quad_perm:[0,1,2,3] row_mask:0xf bank_mask:0x1
    v_mov_b32_dpp v25, v17 quad_perm:[0,1,2,3] row_mask:0xf bank_mask:0x1
    v_mov_b32_dpp v26, v18 quad_perm:[0,1,2,3] row_mask:0xf bank_mask:0x1
    v_mov_b32_dpp v27, v19 quad_perm:[0,1,2,3] row_mask:0xf bank_mask:0x1
    v_mov_b32_dpp v28, v16 row_ror:4 row_mask:0xf bank_mask:0x2
    v_mov_b32_dpp v29, v17 row_ror:4 row_mask:0xf bank_mask:0x2
    v_mov_b32_dpp v30, v18 row_ror:4 row_mask:0xf bank_mask:0x2
    v_mov_b32_dpp v31, v19 row_ror:4 row_mask:0xf bank_mask:0x2
    v_mov_b32_dpp v40, v16 row_ror:8 row_mask:0xf bank_mask:0x4
    v_mov_b32_dpp v41, v17 row_ror:8 row_mask:0xf bank_mask:0x4
    v_mov_b32_dpp v42, v18 row_ror:8 row_mask:0xf bank_mask:0x4
    v_mov_b32_dpp v43, v19 row_ror:8 row_mask:0xf bank_mask:0x4
    v_mov_b32_dpp v44, v16 row_ror:12 row_mask:0xf bank_mask:0x8
    v_mov_b32_dpp v45, v17 row_ror:12 row_mask:0xf bank_mask:0x8
    v_mov_b32_dpp v46, v18 row_ror:12 row_mask:0xf bank_mask:0x8
    v_mov_b32_dpp v47, v19 row_ror:12 row_mask:0xf bank_mask:0x8
    s_waitcnt vmcnt(49)
    v_perm_b32 v32, v68, v64, s67
    v_perm_b32 v33, v76, v72, s67
    v_perm_b32 v34, v84, v80, s67
    v_perm_b32 v35, v92, v88, s67
    v_perm_b32 v36, v70, v66, s67
    v_perm_b32 v37, v78, v74, s67
    v_perm_b32 v38, v86, v82, s67
    v_perm_b32 v39, v94, v90, s67
    v_mfma_f32_16x16x32_bf16 a[0:3], v[32:35], v[24:27], 0
    v_perm_b32 v32, v68, v64, s68
    v_perm_b32 v33, v76, v72, s68
    v_perm_b32 v34, v84, v80, s68
    v_perm_b32 v35, v92, v88, s68
    v_mfma_f32_16x16x32_bf16 a[4:7], v[36:39], v[24:27], 0
    v_perm_b32 v36, v70, v66, s68
    v_perm_b32 v37, v78, v74, s68
    v_perm_b32 v38, v86, v82, s68
    v_perm_b32 v39, v94, v90, s68
    v_mfma_f32_16x16x32_bf16 a[0:3], v[32:35], v[28:31], a[0:3]
    v_perm_b32 v32, v69, v65, s67
    v_perm_b32 v33, v77, v73, s67
    v_perm_b32 v34, v85, v81, s67
    v_perm_b32 v35, v93, v89, s67
    v_mfma_f32_16x16x32_bf16 a[4:7], v[36:39], v[28:31], a[4:7]
    v_perm_b32 v36, v71, v67, s67
    v_perm_b32 v37, v79, v75, s67
    v_perm_b32 v38, v87, v83, s67
    v_perm_b32 v39, v95, v91, s67
    v_mfma_f32_16x16x32_bf16 a[0:3], v[32:35], v[40:43], a[0:3]
    v_perm_b32 v32, v69, v65, s68
    v_perm_b32 v33, v77, v73, s68
    v_perm_b32 v34, v85, v81, s68
    v_perm_b32 v35, v93, v89, s68
    v_mfma_f32_16x16x32_bf16 a[4:7], v[36:39], v[40:43], a[4:7]
    v_perm_b32 v36, v71, v67, s68
    v_perm_b32 v37, v79, v75, s68
    v_perm_b32 v38, v87, v83, s68
    v_perm_b32 v39, v95, v91, s68
    v_mfma_f32_16x16x32_bf16 a[0:3], v[32:35], v[44:47], a[0:3]
    s_nop 0
    v_mfma_f32_16x16x32_bf16 a[4:7], v[36:39], v[44:47], a[4:7]
    v_mov_b32_dpp v24, v16 row_ror:12 row_mask:0xf bank_mask:0x1
    v_mov_b32_dpp v25, v17 row_ror:12 row_mask:0xf bank_mask:0x1
    v_mov_b32_dpp v26, v18 row_ror:12 row_mask:0xf bank_mask:0x1
    v_mov_b32_dpp v27, v19 row_ror:12 row_mask:0xf bank_mask:0x1
    v_mov_b32_dpp v28, v16 quad_perm:[0,1,2,3] row_mask:0xf bank_mask:0x2
    v_mov_b32_dpp v29, v17 quad_perm:[0,1,2,3] row_mask:0xf bank_mask:0x2
    v_mov_b32_dpp v30, v18 quad_perm:[0,1,2,3] row_mask:0xf bank_mask:0x2
    v_mov_b32_dpp v31, v19 quad_perm:[0,1,2,3] row_mask:0xf bank_mask:0x2
    v_mov_b32_dpp v40, v16 row_ror:4 row_mask:0xf bank_mask:0x4
    v_mov_b32_dpp v41, v17 row_ror:4 row_mask:0xf bank_mask:0x4
    v_mov_b32_dpp v42, v18 row_ror:4 row_mask:0xf bank_mask:0x4
    v_mov_b32_dpp v43, v19 row_ror:4 row_mask:0xf bank_mask:0x4
    v_mov_b32_dpp v44, v16 row_ror:8 row_mask:0xf bank_mask:0x8
    v_mov_b32_dpp v45, v17 row_ror:8 row_mask:0xf bank_mask:0x8
    v_mov_b32_dpp v46, v18 row_ror:8 row_mask:0xf bank_mask:0x8
    v_mov_b32_dpp v47, v19 row_ror:8 row_mask:0xf bank_mask:0x8
    s_waitcnt vmcnt(37)
    buffer_load_dwordx4 v[64:67], v3, s[8:11], s60 offen offset:0 nt
    v_perm_b32 v32, v100, v96, s67
    v_perm_b32 v33, v108, v104, s67
    v_perm_b32 v34, v116, v112, s67
    v_perm_b32 v35, v124, v120, s67
    v_perm_b32 v36, v102, v98, s67
    buffer_load_dwordx4 v[68:71], v3, s[8:11], s60 offen offset:1024 nt
    v_perm_b32 v37, v110, v106, s67
    v_perm_b32 v38, v118, v114, s67
    v_perm_b32 v39, v126, v122, s67
    v_mfma_f32_16x16x32_bf16 a[0:3], v[32:35], v[24:27], a[0:3]
    v_perm_b32 v32, v100, v96, s68
    buffer_load_dwordx4 v[72:75], v3, s[8:11], s60 offen offset:2048 nt
    v_perm_b32 v33, v108, v104, s68
    v_perm_b32 v34, v116, v112, s68
    v_perm_b32 v35, v124, v120, s68
    v_mfma_f32_16x16x32_bf16 a[4:7], v[36:39], v[24:27], a[4:7]
    v_perm_b32 v36, v102, v98, s68
    buffer_load_dwordx4 v[76:79], v3, s[8:11], s60 offen offset:3072 nt
    v_perm_b32 v37, v110, v106, s68
    v_perm_b32 v38, v118, v114, s68
    v_perm_b32 v39, v126, v122, s68
    v_mfma_f32_16x16x32_bf16 a[0:3], v[32:35], v[28:31], a[0:3]
    v_perm_b32 v32, v101, v97, s67
    s_add_u32 s79, s60, 4096
    s_pack_lh_b32_b16 s60, s79, s60
    buffer_load_dwordx4 v[80:83], v3, s[8:11], s60 offen offset:0 nt
    v_perm_b32 v33, v109, v105, s67
    v_perm_b32 v34, v117, v113, s67
    v_perm_b32 v35, v125, v121, s67
    v_mfma_f32_16x16x32_bf16 a[4:7], v[36:39], v[28:31], a[4:7]
    v_perm_b32 v36, v103, v99, s67
    buffer_load_dwordx4 v[84:87], v3, s[8:11], s60 offen offset:1024 nt
    v_perm_b32 v37, v111, v107, s67
    v_perm_b32 v38, v119, v115, s67
    v_perm_b32 v39, v127, v123, s67
    v_mfma_f32_16x16x32_bf16 a[0:3], v[32:35], v[40:43], a[0:3]
    v_perm_b32 v32, v101, v97, s68
    buffer_load_dwordx4 v[88:91], v3, s[8:11], s60 offen offset:2048 nt
    v_perm_b32 v33, v109, v105, s68
    v_perm_b32 v34, v117, v113, s68
    v_perm_b32 v35, v125, v121, s68
    v_mfma_f32_16x16x32_bf16 a[4:7], v[36:39], v[40:43], a[4:7]
    v_perm_b32 v36, v103, v99, s68
    buffer_load_dwordx4 v[92:95], v3, s[8:11], s60 offen offset:3072 nt
    s_add_u32 s79, s60, 4096
    s_pack_lh_b32_b16 s60, s79, s60
    v_perm_b32 v37, v111, v107, s68
    v_perm_b32 v38, v119, v115, s68
    v_perm_b32 v39, v127, v123, s68
    v_mfma_f32_16x16x32_bf16 a[0:3], v[32:35], v[44:47], a[0:3]
    s_nop 0
    v_mfma_f32_16x16x32_bf16 a[4:7], v[36:39], v[44:47], a[4:7]
    v_mov_b32_dpp v24, v16 row_ror:8 row_mask:0xf bank_mask:0x1
    v_mov_b32_dpp v25, v17 row_ror:8 row_mask:0xf bank_mask:0x1
    v_mov_b32_dpp v26, v18 row_ror:8 row_mask:0xf bank_mask:0x1
    v_mov_b32_dpp v27, v19 row_ror:8 row_mask:0xf bank_mask:0x1
    v_mov_b32_dpp v28, v16 row_ror:12 row_mask:0xf bank_mask:0x2
    v_mov_b32_dpp v29, v17 row_ror:12 row_mask:0xf bank_mask:0x2
    v_mov_b32_dpp v30, v18 row_ror:12 row_mask:0xf bank_mask:0x2
    v_mov_b32_dpp v31, v19 row_ror:12 row_mask:0xf bank_mask:0x2
    v_mov_b32_dpp v40, v16 quad_perm:[0,1,2,3] row_mask:0xf bank_mask:0x4
    v_mov_b32_dpp v41, v17 quad_perm:[0,1,2,3] row_mask:0xf bank_mask:0x4
    v_mov_b32_dpp v42, v18 quad_perm:[0,1,2,3] row_mask:0xf bank_mask:0x4
    v_mov_b32_dpp v43, v19 quad_perm:[0,1,2,3] row_mask:0xf bank_mask:0x4
    v_mov_b32_dpp v44, v16 row_ror:4 row_mask:0xf bank_mask:0x8
    v_mov_b32_dpp v45, v17 row_ror:4 row_mask:0xf bank_mask:0x8
    v_mov_b32_dpp v46, v18 row_ror:4 row_mask:0xf bank_mask:0x8
    v_mov_b32_dpp v47, v19 row_ror:4 row_mask:0xf bank_mask:0x8
    s_waitcnt vmcnt(33)
    v_perm_b32 v32, v132, v128, s67
    v_perm_b32 v33, v140, v136, s67
    v_perm_b32 v34, v148, v144, s67
    v_perm_b32 v35, v156, v152, s67
    v_perm_b32 v36, v134, v130, s67
    v_perm_b32 v37, v142, v138, s67
    v_perm_b32 v38, v150, v146, s67
    v_perm_b32 v39, v158, v154, s67
    v_mfma_f32_16x16x32_bf16 a[0:3], v[32:35], v[24:27], a[0:3]
    v_perm_b32 v32, v132, v128, s68
    v_perm_b32 v33, v140, v136, s68
    v_perm_b32 v34, v148, v144, s68
    v_perm_b32 v35, v156, v152, s68
    v_mfma_f32_16x16x32_bf16 a[4:7], v[36:39], v[24:27], a[4:7]
    v_perm_b32 v36, v134, v130, s68
    v_perm_b32 v37, v142, v138, s68
    v_perm_b32 v38, v150, v146, s68
    v_perm_b32 v39, v158, v154, s68
    v_mfma_f32_16x16x32_bf16 a[0:3], v[32:35], v[28:31], a[0:3]
    v_perm_b32 v32, v133, v129, s67
    v_perm_b32 v33, v141, v137, s67
    v_perm_b32 v34, v149, v145, s67
    v_perm_b32 v35, v157, v153, s67
    v_mfma_f32_16x16x32_bf16 a[4:7], v[36:39], v[28:31], a[4:7]
    v_perm_b32 v36, v135, v131, s67
    v_perm_b32 v37, v143, v139, s67
    v_perm_b32 v38, v151, v147, s67
    v_perm_b32 v39, v159, v155, s67
    v_mfma_f32_16x16x32_bf16 a[0:3], v[32:35], v[40:43], a[0:3]
    v_perm_b32 v32, v133, v129, s68
    v_perm_b32 v33, v141, v137, s68
    v_perm_b32 v34, v149, v145, s68
    v_perm_b32 v35, v157, v153, s68
    v_mfma_f32_16x16x32_bf16 a[4:7], v[36:39], v[40:43], a[4:7]
    v_perm_b32 v36, v135, v131, s68
    v_perm_b32 v37, v143, v139, s68
    v_perm_b32 v38, v151, v147, s68
    v_perm_b32 v39, v159, v155, s68
    v_mfma_f32_16x16x32_bf16 a[0:3], v[32:35], v[44:47], a[0:3]
    s_nop 0
    v_mfma_f32_16x16x32_bf16 a[4:7], v[36:39], v[44:47], a[4:7]
    v_mov_b32_dpp v24, v16 row_ror:4 row_mask:0xf bank_mask:0x1
    v_mov_b32_dpp v25, v17 row_ror:4 row_mask:0xf bank_mask:0x1
    v_mov_b32_dpp v26, v18 row_ror:4 row_mask:0xf bank_mask:0x1
    v_mov_b32_dpp v27, v19 row_ror:4 row_mask:0xf bank_mask:0x1
    v_mov_b32_dpp v28, v16 row_ror:8 row_mask:0xf bank_mask:0x2
    v_mov_b32_dpp v29, v17 row_ror:8 row_mask:0xf bank_mask:0x2
    v_mov_b32_dpp v30, v18 row_ror:8 row_mask:0xf bank_mask:0x2
    v_mov_b32_dpp v31, v19 row_ror:8 row_mask:0xf bank_mask:0x2
    v_mov_b32_dpp v40, v16 row_ror:12 row_mask:0xf bank_mask:0x4
    v_mov_b32_dpp v41, v17 row_ror:12 row_mask:0xf bank_mask:0x4
    v_mov_b32_dpp v42, v18 row_ror:12 row_mask:0xf bank_mask:0x4
    v_mov_b32_dpp v43, v19 row_ror:12 row_mask:0xf bank_mask:0x4
    v_mov_b32_dpp v44, v16 quad_perm:[0,1,2,3] row_mask:0xf bank_mask:0x8
    v_mov_b32_dpp v45, v17 quad_perm:[0,1,2,3] row_mask:0xf bank_mask:0x8
    v_mov_b32_dpp v46, v18 quad_perm:[0,1,2,3] row_mask:0xf bank_mask:0x8
    v_mov_b32_dpp v47, v19 quad_perm:[0,1,2,3] row_mask:0xf bank_mask:0x8
    s_waitcnt vmcnt(25)
    s_mov_b32 s61, 0x20000
    buffer_load_dwordx4 v[48:51], v6, s[12:15], s61 offen offset:0 sc1
    v_perm_b32 v32, v228, v224, s67
    v_perm_b32 v33, v236, v232, s67
    v_perm_b32 v34, v244, v240, s67
    v_perm_b32 v35, v252, v248, s67
    s_mov_b32 s61, 0x20000
    buffer_load_dwordx4 v[52:55], v6, s[12:15], s61 offen offset:1024 sc1
    v_perm_b32 v36, v230, v226, s67
    v_perm_b32 v37, v238, v234, s67
    v_perm_b32 v38, v246, v242, s67
    v_perm_b32 v39, v254, v250, s67
    buffer_load_dwordx4 v[96:99], v3, s[8:11], s60 offen offset:0 nt
    v_mfma_f32_16x16x32_bf16 a[0:3], v[32:35], v[24:27], a[0:3]
    v_perm_b32 v32, v228, v224, s68
    v_perm_b32 v33, v236, v232, s68
    v_perm_b32 v34, v244, v240, s68
    buffer_load_dwordx4 v[100:103], v3, s[8:11], s60 offen offset:1024 nt
    v_perm_b32 v35, v252, v248, s68
    v_mfma_f32_16x16x32_bf16 a[4:7], v[36:39], v[24:27], a[4:7]
    v_perm_b32 v36, v230, v226, s68
    v_perm_b32 v37, v238, v234, s68
    buffer_load_dwordx4 v[104:107], v3, s[8:11], s60 offen offset:2048 nt
    v_perm_b32 v38, v246, v242, s68
    v_perm_b32 v39, v254, v250, s68
    v_mfma_f32_16x16x32_bf16 a[0:3], v[32:35], v[28:31], a[0:3]
    v_perm_b32 v32, v229, v225, s67
    buffer_load_dwordx4 v[108:111], v3, s[8:11], s60 offen offset:3072 nt
    v_perm_b32 v33, v237, v233, s67
    v_perm_b32 v34, v245, v241, s67
    v_perm_b32 v35, v253, v249, s67
    v_mfma_f32_16x16x32_bf16 a[4:7], v[36:39], v[28:31], a[4:7]
    s_add_u32 s79, s60, 4096
    s_pack_lh_b32_b16 s60, s79, s60
    buffer_load_dwordx4 v[112:115], v3, s[8:11], s60 offen offset:0 nt
    v_perm_b32 v36, v231, v227, s67
    v_perm_b32 v37, v239, v235, s67
    v_perm_b32 v38, v247, v243, s67
    v_perm_b32 v39, v255, v251, s67
    buffer_load_dwordx4 v[116:119], v3, s[8:11], s60 offen offset:1024 nt
    v_mfma_f32_16x16x32_bf16 a[0:3], v[32:35], v[40:43], a[0:3]
    v_perm_b32 v32, v229, v225, s68
    v_perm_b32 v33, v237, v233, s68
    v_perm_b32 v34, v245, v241, s68
    buffer_load_dwordx4 v[120:123], v3, s[8:11], s60 offen offset:2048 nt
    v_perm_b32 v35, v253, v249, s68
    v_mfma_f32_16x16x32_bf16 a[4:7], v[36:39], v[40:43], a[4:7]
    v_perm_b32 v36, v231, v227, s68
    v_perm_b32 v37, v239, v235, s68
    buffer_load_dwordx4 v[124:127], v3, s[8:11], s60 offen offset:3072 nt
    s_add_u32 s79, s60, 4096
    s_pack_lh_b32_b16 s60, s79, s60
    v_perm_b32 v38, v247, v243, s68
    v_perm_b32 v39, v255, v251, s68
    v_mfma_f32_16x16x32_bf16 a[0:3], v[32:35], v[44:47], a[0:3]
    s_nop 0
    v_mfma_f32_16x16x32_bf16 a[4:7], v[36:39], v[44:47], a[4:7]
    v_mov_b32_dpp v24, v20 quad_perm:[0,1,2,3] row_mask:0xf bank_mask:0x1
    v_mov_b32_dpp v25, v21 quad_perm:[0,1,2,3] row_mask:0xf bank_mask:0x1
    v_mov_b32_dpp v26, v22 quad_perm:[0,1,2,3] row_mask:0xf bank_mask:0x1
    v_mov_b32_dpp v27, v23 quad_perm:[0,1,2,3] row_mask:0xf bank_mask:0x1
    v_mov_b32_dpp v28, v20 row_ror:4 row_mask:0xf bank_mask:0x2
    v_mov_b32_dpp v29, v21 row_ror:4 row_mask:0xf bank_mask:0x2
    v_mov_b32_dpp v30, v22 row_ror:4 row_mask:0xf bank_mask:0x2
    v_mov_b32_dpp v31, v23 row_ror:4 row_mask:0xf bank_mask:0x2
    v_mov_b32_dpp v40, v20 row_ror:8 row_mask:0xf bank_mask:0x4
    v_mov_b32_dpp v41, v21 row_ror:8 row_mask:0xf bank_mask:0x4
    v_mov_b32_dpp v42, v22 row_ror:8 row_mask:0xf bank_mask:0x4
    v_mov_b32_dpp v43, v23 row_ror:8 row_mask:0xf bank_mask:0x4
    v_mov_b32_dpp v44, v20 row_ror:12 row_mask:0xf bank_mask:0x8
    v_mov_b32_dpp v45, v21 row_ror:12 row_mask:0xf bank_mask:0x8
    v_mov_b32_dpp v46, v22 row_ror:12 row_mask:0xf bank_mask:0x8
    v_mov_b32_dpp v47, v23 row_ror:12 row_mask:0xf bank_mask:0x8
    s_waitcnt vmcnt(27)
    v_perm_b32 v32, v164, v160, s67
    v_perm_b32 v33, v172, v168, s67
    v_perm_b32 v34, v180, v176, s67
    v_perm_b32 v35, v188, v184, s67
    v_perm_b32 v36, v166, v162, s67
    v_perm_b32 v37, v174, v170, s67
    v_perm_b32 v38, v182, v178, s67
    v_perm_b32 v39, v190, v186, s67
    v_mfma_f32_16x16x32_bf16 a[0:3], v[32:35], v[24:27], a[0:3]
    v_perm_b32 v32, v164, v160, s68
    v_perm_b32 v33, v172, v168, s68
    v_perm_b32 v34, v180, v176, s68
    v_perm_b32 v35, v188, v184, s68
    v_mfma_f32_16x16x32_bf16 a[4:7], v[36:39], v[24:27], a[4:7]
    v_perm_b32 v36, v166, v162, s68
    v_perm_b32 v37, v174, v170, s68
    v_perm_b32 v38, v182, v178, s68
    v_perm_b32 v39, v190, v186, s68
    v_mfma_f32_16x16x32_bf16 a[0:3], v[32:35], v[28:31], a[0:3]
    v_perm_b32 v32, v165, v161, s67
    v_perm_b32 v33, v173, v169, s67
    v_perm_b32 v34, v181, v177, s67
    v_perm_b32 v35, v189, v185, s67
    v_mfma_f32_16x16x32_bf16 a[4:7], v[36:39], v[28:31], a[4:7]
    v_perm_b32 v36, v167, v163, s67
    v_perm_b32 v37, v175, v171, s67
    v_perm_b32 v38, v183, v179, s67
    v_perm_b32 v39, v191, v187, s67
    v_mfma_f32_16x16x32_bf16 a[0:3], v[32:35], v[40:43], a[0:3]
    v_perm_b32 v32, v165, v161, s68
    v_perm_b32 v33, v173, v169, s68
    v_perm_b32 v34, v181, v177, s68
    v_perm_b32 v35, v189, v185, s68
    v_mfma_f32_16x16x32_bf16 a[4:7], v[36:39], v[40:43], a[4:7]
    v_perm_b32 v36, v167, v163, s68
    v_perm_b32 v37, v175, v171, s68
    v_perm_b32 v38, v183, v179, s68
    v_perm_b32 v39, v191, v187, s68
    v_mfma_f32_16x16x32_bf16 a[0:3], v[32:35], v[44:47], a[0:3]
    s_nop 0
    v_mfma_f32_16x16x32_bf16 a[4:7], v[36:39], v[44:47], a[4:7]
    v_mov_b32_dpp v24, v20 row_ror:12 row_mask:0xf bank_mask:0x1
    v_mov_b32_dpp v25, v21 row_ror:12 row_mask:0xf bank_mask:0x1
    v_mov_b32_dpp v26, v22 row_ror:12 row_mask:0xf bank_mask:0x1
    v_mov_b32_dpp v27, v23 row_ror:12 row_mask:0xf bank_mask:0x1
    v_mov_b32_dpp v28, v20 quad_perm:[0,1,2,3] row_mask:0xf bank_mask:0x2
    v_mov_b32_dpp v29, v21 quad_perm:[0,1,2,3] row_mask:0xf bank_mask:0x2
    v_mov_b32_dpp v30, v22 quad_perm:[0,1,2,3] row_mask:0xf bank_mask:0x2
    v_mov_b32_dpp v31, v23 quad_perm:[0,1,2,3] row_mask:0xf bank_mask:0x2
    v_mov_b32_dpp v40, v20 row_ror:4 row_mask:0xf bank_mask:0x4
    v_mov_b32_dpp v41, v21 row_ror:4 row_mask:0xf bank_mask:0x4
    v_mov_b32_dpp v42, v22 row_ror:4 row_mask:0xf bank_mask:0x4
    v_mov_b32_dpp v43, v23 row_ror:4 row_mask:0xf bank_mask:0x4
    v_mov_b32_dpp v44, v20 row_ror:8 row_mask:0xf bank_mask:0x8
    v_mov_b32_dpp v45, v21 row_ror:8 row_mask:0xf bank_mask:0x8
    v_mov_b32_dpp v46, v22 row_ror:8 row_mask:0xf bank_mask:0x8
    v_mov_b32_dpp v47, v23 row_ror:8 row_mask:0xf bank_mask:0x8
    s_waitcnt vmcnt(19)
    v_perm_b32 v32, v196, v192, s67
    v_perm_b32 v33, v204, v200, s67
    v_perm_b32 v34, v212, v208, s67
    v_perm_b32 v35, v220, v216, s67
    v_perm_b32 v36, v198, v194, s67
    v_perm_b32 v37, v206, v202, s67
    v_perm_b32 v38, v214, v210, s67
    v_perm_b32 v39, v222, v218, s67
    v_mfma_f32_16x16x32_bf16 a[0:3], v[32:35], v[24:27], a[0:3]
    v_perm_b32 v32, v196, v192, s68
    v_perm_b32 v33, v204, v200, s68
    v_perm_b32 v34, v212, v208, s68
    v_perm_b32 v35, v220, v216, s68
    v_mfma_f32_16x16x32_bf16 a[4:7], v[36:39], v[24:27], a[4:7]
    v_perm_b32 v36, v198, v194, s68
    v_perm_b32 v37, v206, v202, s68
    v_perm_b32 v38, v214, v210, s68
    v_perm_b32 v39, v222, v218, s68
    v_mfma_f32_16x16x32_bf16 a[0:3], v[32:35], v[28:31], a[0:3]
    v_perm_b32 v32, v197, v193, s67
    v_perm_b32 v33, v205, v201, s67
    v_perm_b32 v34, v213, v209, s67
    v_perm_b32 v35, v221, v217, s67
    v_mfma_f32_16x16x32_bf16 a[4:7], v[36:39], v[28:31], a[4:7]
    v_perm_b32 v36, v199, v195, s67
    v_perm_b32 v37, v207, v203, s67
    v_perm_b32 v38, v215, v211, s67
    v_perm_b32 v39, v223, v219, s67
    v_mfma_f32_16x16x32_bf16 a[0:3], v[32:35], v[40:43], a[0:3]
    v_perm_b32 v32, v197, v193, s68
    v_perm_b32 v33, v205, v201, s68
    v_perm_b32 v34, v213, v209, s68
    v_perm_b32 v35, v221, v217, s68
    v_mfma_f32_16x16x32_bf16 a[4:7], v[36:39], v[40:43], a[4:7]
    v_perm_b32 v36, v199, v195, s68
    v_perm_b32 v37, v207, v203, s68
    v_perm_b32 v38, v215, v211, s68
    v_perm_b32 v39, v223, v219, s68
    v_mfma_f32_16x16x32_bf16 a[0:3], v[32:35], v[44:47], a[0:3]
    s_nop 0
    v_mfma_f32_16x16x32_bf16 a[4:7], v[36:39], v[44:47], a[4:7]
    s_mov_b32 s61, 0x20000
    buffer_load_dwordx4 v[56:59], v6, s[12:15], s61 offen offset:0 sc1
    s_mov_b32 s61, 0x20000
    buffer_load_dwordx4 v[60:63], v6, s[12:15], s61 offen offset:1024 sc1
    v_mov_b32_dpp v24, v20 row_ror:8 row_mask:0xf bank_mask:0x1
    v_mov_b32_dpp v25, v21 row_ror:8 row_mask:0xf bank_mask:0x1
    v_mov_b32_dpp v26, v22 row_ror:8 row_mask:0xf bank_mask:0x1
    v_mov_b32_dpp v27, v23 row_ror:8 row_mask:0xf bank_mask:0x1
    v_mov_b32_dpp v28, v20 row_ror:12 row_mask:0xf bank_mask:0x2
    v_mov_b32_dpp v29, v21 row_ror:12 row_mask:0xf bank_mask:0x2
    v_mov_b32_dpp v30, v22 row_ror:12 row_mask:0xf bank_mask:0x2
    v_mov_b32_dpp v31, v23 row_ror:12 row_mask:0xf bank_mask:0x2
    v_mov_b32_dpp v40, v20 quad_perm:[0,1,2,3] row_mask:0xf bank_mask:0x4
    v_mov_b32_dpp v41, v21 quad_perm:[0,1,2,3] row_mask:0xf bank_mask:0x4
    v_mov_b32_dpp v42, v22 quad_perm:[0,1,2,3] row_mask:0xf bank_mask:0x4
    v_mov_b32_dpp v43, v23 quad_perm:[0,1,2,3] row_mask:0xf bank_mask:0x4
    v_mov_b32_dpp v44, v20 row_ror:4 row_mask:0xf bank_mask:0x8
    v_mov_b32_dpp v45, v21 row_ror:4 row_mask:0xf bank_mask:0x8
    v_mov_b32_dpp v46, v22 row_ror:4 row_mask:0xf bank_mask:0x8
    v_mov_b32_dpp v47, v23 row_ror:4 row_mask:0xf bank_mask:0x8
    s_waitcnt vmcnt(12)
    v_perm_b32 v32, v68, v64, s67
    v_perm_b32 v33, v76, v72, s67
    v_perm_b32 v34, v84, v80, s67
    v_perm_b32 v35, v92, v88, s67
    v_perm_b32 v36, v70, v66, s67
    v_perm_b32 v37, v78, v74, s67
    v_perm_b32 v38, v86, v82, s67
    v_perm_b32 v39, v94, v90, s67
    v_mfma_f32_16x16x32_bf16 a[0:3], v[32:35], v[24:27], a[0:3]
    v_perm_b32 v32, v68, v64, s68
    v_perm_b32 v33, v76, v72, s68
    v_perm_b32 v34, v84, v80, s68
    v_perm_b32 v35, v92, v88, s68
    v_mfma_f32_16x16x32_bf16 a[4:7], v[36:39], v[24:27], a[4:7]
    v_perm_b32 v36, v70, v66, s68
    v_perm_b32 v37, v78, v74, s68
    v_perm_b32 v38, v86, v82, s68
    v_perm_b32 v39, v94, v90, s68
    v_mfma_f32_16x16x32_bf16 a[0:3], v[32:35], v[28:31], a[0:3]
    v_perm_b32 v32, v69, v65, s67
    v_perm_b32 v33, v77, v73, s67
    v_perm_b32 v34, v85, v81, s67
    v_perm_b32 v35, v93, v89, s67
    v_mfma_f32_16x16x32_bf16 a[4:7], v[36:39], v[28:31], a[4:7]
    v_perm_b32 v36, v71, v67, s67
    v_perm_b32 v37, v79, v75, s67
    v_perm_b32 v38, v87, v83, s67
    v_perm_b32 v39, v95, v91, s67
    v_mfma_f32_16x16x32_bf16 a[0:3], v[32:35], v[40:43], a[0:3]
    v_perm_b32 v32, v69, v65, s68
    v_perm_b32 v33, v77, v73, s68
    v_perm_b32 v34, v85, v81, s68
    v_perm_b32 v35, v93, v89, s68
    v_mfma_f32_16x16x32_bf16 a[4:7], v[36:39], v[40:43], a[4:7]
    v_perm_b32 v36, v71, v67, s68
    v_perm_b32 v37, v79, v75, s68
    v_perm_b32 v38, v87, v83, s68
    v_perm_b32 v39, v95, v91, s68
    v_mfma_f32_16x16x32_bf16 a[0:3], v[32:35], v[44:47], a[0:3]
    s_nop 0
    v_mfma_f32_16x16x32_bf16 a[4:7], v[36:39], v[44:47], a[4:7]
    s_waitcnt vmcnt(10)
    v_xor_b32 v10, s58, v50
    v_bitop3_b32 v10, v51, s58, v10 bitop3:0xbe
    v_bitop3_b32 v10, v54, s58, v10 bitop3:0xbe
    v_bitop3_b32 v10, v55, s58, v10 bitop3:0xbe
    v_cmp_ne_u32 vcc, 0, v10
    s_mov_b32 s34, 1
    s_cbranch_vccnz MLS_W
    v_max_f32 v50, v48, v52
    s_nop 1
    v_max_f32_dpp v50, v50, v50 row_ror:4 row_mask:0xf bank_mask:0xf
    s_nop 1
    v_max_f32_dpp v50, v50, v50 row_ror:8 row_mask:0xf bank_mask:0xf
    v_mov_b32 v10, v50
    s_nop 1
    v_permlane16_swap_b32 v50, v10
    v_max_f32 v50, v50, v10
    v_mov_b32 v10, v50
    s_nop 1
    v_permlane32_swap_b32 v50, v10
    v_max_f32 v50, v50, v10
    v_sub_f32 v48, v48, v50
    v_sub_f32 v52, v52, v50
    v_sub_f32 v9, v9, v50
    v_mul_f32 v48, s69, v48
    v_mul_f32 v52, s69, v52
    v_mul_f32 v9, s69, v9
    v_exp_f32 v48, v48
    v_exp_f32 v52, v52
    v_exp_f32 v9, v9
    v_mul_f32 v49, v49, v48
    v_fmac_f32 v49, v53, v52
    s_nop 1
    v_add_f32_dpp v49, v49, v49 row_ror:4 row_mask:0xf bank_mask:0xf
    s_nop 1
    v_add_f32_dpp v49, v49, v49 row_ror:8 row_mask:0xf bank_mask:0xf
    v_mov_b32 v10, v49
    s_nop 1
    v_permlane16_swap_b32 v49, v10
    v_add_f32 v49, v49, v10
    v_mov_b32 v10, v49
    s_nop 1
    v_permlane32_swap_b32 v49, v10
    v_add_f32 v49, v49, v10
    v_rcp_f32 v49, v49
    s_nop 0
    v_mul_f32 v9, v9, v49
    v_lshlrev_b32 v10, 4, v1
    s_lshl_b32 s64, s3, 2
    v_add_u32 v10, s64, v10
    s_mov_b64 exec, 0xf
    ds_write_b32 v10, v9 offset:26880
    s_mov_b64 exec, -1
    s_mov_b32 s34, 0
MLS_W:
    v_mov_b32_dpp v24, v20 row_ror:4 row_mask:0xf bank_mask:0x1
    v_mov_b32_dpp v25, v21 row_ror:4 row_mask:0xf bank_mask:0x1
    v_mov_b32_dpp v26, v22 row_ror:4 row_mask:0xf bank_mask:0x1
    v_mov_b32_dpp v27, v23 row_ror:4 row_mask:0xf bank_mask:0x1
    v_mov_b32_dpp v28, v20 row_ror:8 row_mask:0xf bank_mask:0x2
    v_mov_b32_dpp v29, v21 row_ror:8 row_mask:0xf bank_mask:0x2
    v_mov_b32_dpp v30, v22 row_ror:8 row_mask:0xf bank_mask:0x2
    v_mov_b32_dpp v31, v23 row_ror:8 row_mask:0xf bank_mask:0x2
    v_mov_b32_dpp v40, v20 row_ror:12 row_mask:0xf bank_mask:0x4
    v_mov_b32_dpp v41, v21 row_ror:12 row_mask:0xf bank_mask:0x4
    v_mov_b32_dpp v42, v22 row_ror:12 row_mask:0xf bank_mask:0x4
    v_mov_b32_dpp v43, v23 row_ror:12 row_mask:0xf bank_mask:0x4
    v_mov_b32_dpp v44, v20 quad_perm:[0,1,2,3] row_mask:0xf bank_mask:0x8
    v_mov_b32_dpp v45, v21 quad_perm:[0,1,2,3] row_mask:0xf bank_mask:0x8
    v_mov_b32_dpp v46, v22 quad_perm:[0,1,2,3] row_mask:0xf bank_mask:0x8
    v_mov_b32_dpp v47, v23 quad_perm:[0,1,2,3] row_mask:0xf bank_mask:0x8
    s_waitcnt vmcnt(2)
    buffer_load_dwordx2 v[128:129], v7, s[20:23], 0 offen offset:0
    v_perm_b32 v32, v100, v96, s67
    buffer_load_dwordx2 v[130:131], v7, s[20:23], 0 offen offset:1024
    v_perm_b32 v33, v108, v104, s67
    buffer_load_dwordx2 v[144:145], v7, s[20:23], 0 offen offset:2048
    v_perm_b32 v34, v116, v112, s67
    buffer_load_dwordx2 v[146:147], v7, s[20:23], 0 offen offset:3072
    v_perm_b32 v35, v124, v120, s67
    v_perm_b32 v36, v102, v98, s67
    s_mov_b32 s61, 0x1000
    buffer_load_dwordx2 v[224:225], v7, s[20:23], s61 offen offset:0
    v_perm_b32 v37, v110, v106, s67
    s_mov_b32 s61, 0x1000
    buffer_load_dwordx2 v[226:227], v7, s[20:23], s61 offen offset:1024
    v_perm_b32 v38, v118, v114, s67
    s_mov_b32 s61, 0x1000
    buffer_load_dwordx2 v[240:241], v7, s[20:23], s61 offen offset:2048
    v_perm_b32 v39, v126, v122, s67
    s_mov_b32 s61, 0x1000
    buffer_load_dwordx2 v[242:243], v7, s[20:23], s61 offen offset:3072
    v_mfma_f32_16x16x32_bf16 a[0:3], v[32:35], v[24:27], a[0:3]
    v_perm_b32 v32, v100, v96, s68
    s_mov_b32 s61, 0x2000
    buffer_load_dwordx2 v[132:133], v7, s[20:23], s61 offen offset:0
    v_perm_b32 v33, v108, v104, s68
    s_mov_b32 s61, 0x2000
    buffer_load_dwordx2 v[134:135], v7, s[20:23], s61 offen offset:1024
    v_perm_b32 v34, v116, v112, s68
    s_mov_b32 s61, 0x2000
    buffer_load_dwordx2 v[148:149], v7, s[20:23], s61 offen offset:2048
    v_perm_b32 v35, v124, v120, s68
    s_mov_b32 s61, 0x2000
    buffer_load_dwordx2 v[150:151], v7, s[20:23], s61 offen offset:3072
    v_mfma_f32_16x16x32_bf16 a[4:7], v[36:39], v[24:27], a[4:7]
    v_perm_b32 v36, v102, v98, s68
    s_mov_b32 s61, 0x3000
    buffer_load_dwordx2 v[228:229], v7, s[20:23], s61 offen offset:0
    v_perm_b32 v37, v110, v106, s68
    s_mov_b32 s61, 0x3000
    buffer_load_dwordx2 v[230:231], v7, s[20:23], s61 offen offset:1024
    v_perm_b32 v38, v118, v114, s68
    s_mov_b32 s61, 0x3000
    buffer_load_dwordx2 v[244:245], v7, s[20:23], s61 offen offset:2048
    v_perm_b32 v39, v126, v122, s68
    s_mov_b32 s61, 0x3000
    buffer_load_dwordx2 v[246:247], v7, s[20:23], s61 offen offset:3072
    v_mfma_f32_16x16x32_bf16 a[0:3], v[32:35], v[28:31], a[0:3]
    v_perm_b32 v32, v101, v97, s67
    s_mov_b32 s61, 0x4000
    buffer_load_dwordx2 v[136:137], v7, s[20:23], s61 offen offset:0
    v_perm_b32 v33, v109, v105, s67
    s_mov_b32 s61, 0x4000
    buffer_load_dwordx2 v[138:139], v7, s[20:23], s61 offen offset:1024
    v_perm_b32 v34, v117, v113, s67
    s_mov_b32 s61, 0x4000
    buffer_load_dwordx2 v[152:153], v7, s[20:23], s61 offen offset:2048
    v_perm_b32 v35, v125, v121, s67
    s_mov_b32 s61, 0x4000
    buffer_load_dwordx2 v[154:155], v7, s[20:23], s61 offen offset:3072
    v_mfma_f32_16x16x32_bf16 a[4:7], v[36:39], v[28:31], a[4:7]
    v_perm_b32 v36, v103, v99, s67
    s_mov_b32 s61, 0x5000
    buffer_load_dwordx2 v[232:233], v7, s[20:23], s61 offen offset:0
    v_perm_b32 v37, v111, v107, s67
    s_mov_b32 s61, 0x5000
    buffer_load_dwordx2 v[234:235], v7, s[20:23], s61 offen offset:1024
    v_perm_b32 v38, v119, v115, s67
    s_mov_b32 s61, 0x5000
    buffer_load_dwordx2 v[248:249], v7, s[20:23], s61 offen offset:2048
    v_perm_b32 v39, v127, v123, s67
    s_mov_b32 s61, 0x5000
    buffer_load_dwordx2 v[250:251], v7, s[20:23], s61 offen offset:3072
    v_mfma_f32_16x16x32_bf16 a[0:3], v[32:35], v[40:43], a[0:3]
    v_perm_b32 v32, v101, v97, s68
    s_mov_b32 s61, 0x6000
    buffer_load_dwordx2 v[140:141], v7, s[20:23], s61 offen offset:0
    v_perm_b32 v33, v109, v105, s68
    s_mov_b32 s61, 0x6000
    buffer_load_dwordx2 v[142:143], v7, s[20:23], s61 offen offset:1024
    v_perm_b32 v34, v117, v113, s68
    s_mov_b32 s61, 0x6000
    buffer_load_dwordx2 v[156:157], v7, s[20:23], s61 offen offset:2048
    v_perm_b32 v35, v125, v121, s68
    s_mov_b32 s61, 0x6000
    buffer_load_dwordx2 v[158:159], v7, s[20:23], s61 offen offset:3072
    v_mfma_f32_16x16x32_bf16 a[4:7], v[36:39], v[40:43], a[4:7]
    v_perm_b32 v36, v103, v99, s68
    s_mov_b32 s61, 0x7000
    buffer_load_dwordx2 v[236:237], v7, s[20:23], s61 offen offset:0
    v_perm_b32 v37, v111, v107, s68
    s_mov_b32 s61, 0x7000
    buffer_load_dwordx2 v[238:239], v7, s[20:23], s61 offen offset:1024
    v_perm_b32 v38, v119, v115, s68
    s_mov_b32 s61, 0x7000
    buffer_load_dwordx2 v[252:253], v7, s[20:23], s61 offen offset:2048
    v_perm_b32 v39, v127, v123, s68
    s_mov_b32 s61, 0x7000
    buffer_load_dwordx2 v[254:255], v7, s[20:23], s61 offen offset:3072
    v_mfma_f32_16x16x32_bf16 a[0:3], v[32:35], v[44:47], a[0:3]
    v_mfma_f32_16x16x32_bf16 a[4:7], v[36:39], v[44:47], a[4:7]
    s_cmp_eq_u32 s34, 0
    s_cbranch_scc1 MLD_W
    s_mov_b32 s62, 0x40000
    s_waitcnt vmcnt(32)
MLR_W:
    v_xor_b32 v10, s58, v58
    v_bitop3_b32 v10, v59, s58, v10 bitop3:0xbe
    v_bitop3_b32 v10, v62, s58, v10 bitop3:0xbe
    v_bitop3_b32 v10, v63, s58, v10 bitop3:0xbe
    v_cmp_ne_u32 vcc, 0, v10
    s_cbranch_vccz MLF_W
    s_mov_b32 s61, 0x20000
    buffer_load_dwordx4 v[56:59], v6, s[12:15], s61 offen offset:0 sc1
    s_mov_b32 s61, 0x20000
    buffer_load_dwordx4 v[60:63], v6, s[12:15], s61 offen offset:1024 sc1
    s_waitcnt vmcnt(0)
    s_sub_u32 s62, s62, 1
    s_cbranch_scc0 MLR_W
MLF_W:
    v_max_f32 v58, v56, v60
    s_nop 1
    v_max_f32_dpp v58, v58, v58 row_ror:4 row_mask:0xf bank_mask:0xf
    s_nop 1
    v_max_f32_dpp v58, v58, v58 row_ror:8 row_mask:0xf bank_mask:0xf
    v_mov_b32 v10, v58
    s_nop 1
    v_permlane16_swap_b32 v58, v10
    v_max_f32 v58, v58, v10
    v_mov_b32 v10, v58
    s_nop 1
    v_permlane32_swap_b32 v58, v10
    v_max_f32 v58, v58, v10
    v_sub_f32 v56, v56, v58
    v_sub_f32 v60, v60, v58
    v_sub_f32 v9, v9, v58
    v_mul_f32 v56, s69, v56
    v_mul_f32 v60, s69, v60
    v_mul_f32 v9, s69, v9
    v_exp_f32 v56, v56
    v_exp_f32 v60, v60
    v_exp_f32 v9, v9
    v_mul_f32 v57, v57, v56
    v_fmac_f32 v57, v61, v60
    s_nop 1
    v_add_f32_dpp v57, v57, v57 row_ror:4 row_mask:0xf bank_mask:0xf
    s_nop 1
    v_add_f32_dpp v57, v57, v57 row_ror:8 row_mask:0xf bank_mask:0xf
    v_mov_b32 v10, v57
    s_nop 1
    v_permlane16_swap_b32 v57, v10
    v_add_f32 v57, v57, v10
    v_mov_b32 v10, v57
    s_nop 1
    v_permlane32_swap_b32 v57, v10
    v_add_f32 v57, v57, v10
    v_rcp_f32 v57, v57
    s_nop 0
    v_mul_f32 v9, v9, v57
    v_lshlrev_b32 v10, 4, v1
    s_lshl_b32 s64, s3, 2
    v_add_u32 v10, s64, v10
    s_mov_b64 exec, 0xf
    ds_write_b32 v10, v9 offset:26880
    s_mov_b64 exec, -1
MLD_W:
    s_nop 4
    ds_write_b128 v8, a[0:3] offset:18688
    ds_write_b128 v8, a[4:7] offset:19712
    s_waitcnt lgkmcnt(0)
    s_barrier
    s_cmp_ge_u32 s3, 2
    s_cbranch_scc1 SK2_W
    ds_read_b128 v[48:51], v15 offset:26880
    ds_read_b128 v[32:35], v2 offset:18688
    ds_read_b128 v[36:39], v2 offset:20736
    ds_read_b128 v[40:43], v2 offset:22784
    ds_read_b128 v[44:47], v2 offset:24832
    s_waitcnt lgkmcnt(2)
    v_pk_mul_f32 v[32:33], v[32:33], v[48:49] op_sel_hi:[1,0]
    v_pk_mul_f32 v[34:35], v[34:35], v[48:49] op_sel_hi:[1,0]
    v_pk_fma_f32 v[32:33], v[36:37], v[48:49], v[32:33] op_sel:[0,1,0] op_sel_hi:[1,1,1]
    v_pk_fma_f32 v[34:35], v[38:39], v[48:49], v[34:35] op_sel:[0,1,0] op_sel_hi:[1,1,1]
    s_waitcnt lgkmcnt(0)
    v_pk_fma_f32 v[32:33], v[40:41], v[50:51], v[32:33] op_sel_hi:[1,0,1]
    v_pk_fma_f32 v[34:35], v[42:43], v[50:51], v[34:35] op_sel_hi:[1,0,1]
    v_pk_fma_f32 v[32:33], v[44:45], v[50:51], v[32:33] op_sel:[0,1,0] op_sel_hi:[1,1,1]
    v_pk_fma_f32 v[34:35], v[46:47], v[50:51], v[34:35] op_sel:[0,1,0] op_sel_hi:[1,1,1]
    v_bfi_b32 v32, s65, v4, v32
    v_bfi_b32 v33, s65, v4, v33
    v_bfi_b32 v34, s65, v4, v34
    v_bfi_b32 v35, s65, v4, v35
    s_mov_b32 s61, 0x80000
    buffer_store_dwordx4 v[32:35], v14, s[12:15], s61 offen offset:0 sc1
SK2_W:
    s_barrier
    s_mov_b32 s28, s54
    s_mov_b32 s29, s55
    s_mov_b32 s30, 0x1000
    s_mov_b32 s31, 0x20000
    s_sub_u32 s32, s2, 112
    s_lshl_b32 s32, s32, 1
    s_and_b32 s61, s3, 1
    s_add_u32 s32, s32, s61
    v_and_b32 v10, 3, v1
    v_mul_u32_u24 v11, 0x3000, v10
    s_and_b32 s35, s32, 0x60
    s_bfe_u32 s61, s32, 0x40001
    s_or_b32 s35, s35, s61
    s_and_b32 s61, s32, 1
    s_lshl_b32 s61, s61, 4
    s_or_b32 s35, s35, s61
    s_lshl_b32 s35, s35, 4
    v_add_u32 v7, s35, v11
    s_mov_b32 s61, 0x2000
    buffer_load_dwordx4 v[40:43], v7, s[12:15], s61 offen offset:0 sc1
    s_mov_b32 s61, 0x3000
    buffer_load_dwordx4 v[44:47], v7, s[12:15], s61 offen offset:2048 sc1
    s_lshr_b32 s64, s32, 3
    s_lshl_b32 s64, s64, 6
    s_and_b32 s61, s32, 7
    s_lshl_b32 s61, s61, 1
    s_add_u32 s64, s64, s61
    v_lshlrev_b32 v10, 10, v10
    v_add_u32 v36, s64, v10
    buffer_load_ushort v32, v36, s[24:27], 0 offen offset:0
    buffer_load_ushort v33, v36, s[24:27], 0 offen offset:16
    buffer_load_ushort v34, v36, s[24:27], 0 offen offset:32
    buffer_load_ushort v35, v36, s[24:27], 0 offen offset:48
    v_and_b32 v10, 3, v1
    v_lshlrev_b32 v10, 17, v10
    v_add_u32 v10, v10, v5
    s_lshl_b32 s64, s63, 14
    v_add_u32 v6, s64, v10
    v_mov_b32 v16, 0
    v_mov_b32 v17, 0
    v_mov_b32 v18, 0
    v_mov_b32 v19, 0
    v_mov_b32 v20, 0
    v_mov_b32 v21, 0
    v_mov_b32 v22, 0
    v_mov_b32 v23, 0
    v_mov_b32 v9, 0xffff
    v_mov_b32 v3, 0
    s_mov_b32 s74, 0xfffffeff
    s_mov_b32 s75, 0x80000
    s_mov_b32 s62, 0x40000
    s_mov_b32 exec_lo, 0xcccccccc
    s_mov_b32 exec_hi, 0xcccccccc
    v_mov_b32 v9, 0
    s_mov_b32 exec_lo, 0x33333333
    s_mov_b32 exec_hi, 0x33333333
    buffer_load_dwordx4 v[160:163], v6, s[12:15], s75 offen offset:0 sc1
    buffer_load_dwordx4 v[164:167], v6, s[12:15], s75 offen offset:256 sc1
    buffer_load_dwordx4 v[168:171], v6, s[12:15], s75 offen offset:2048 sc1
    buffer_load_dwordx4 v[172:175], v6, s[12:15], s75 offen offset:2304 sc1
    s_add_u32 s61, s75, 0x1000
    buffer_load_dwordx4 v[176:179], v6, s[12:15], s61 offen offset:0 sc1
    buffer_load_dwordx4 v[180:183], v6, s[12:15], s61 offen offset:256 sc1
    s_add_u32 s61, s75, 0x1000
    buffer_load_dwordx4 v[184:187], v6, s[12:15], s61 offen offset:2048 sc1
    buffer_load_dwordx4 v[188:191], v6, s[12:15], s61 offen offset:2304 sc1
    s_add_u32 s61, s75, 0x2000
    buffer_load_dwordx4 v[192:195], v6, s[12:15], s61 offen offset:0 sc1
    buffer_load_dwordx4 v[196:199], v6, s[12:15], s61 offen offset:256 sc1
    s_add_u32 s61, s75, 0x2000
    buffer_load_dwordx4 v[200:203], v6, s[12:15], s61 offen offset:2048 sc1
    buffer_load_dwordx4 v[204:207], v6, s[12:15], s61 offen offset:2304 sc1
    s_add_u32 s61, s75, 0x3000
    buffer_load_dwordx4 v[208:211], v6, s[12:15], s61 offen offset:0 sc1
    buffer_load_dwordx4 v[212:215], v6, s[12:15], s61 offen offset:256 sc1
    s_add_u32 s61, s75, 0x3000
    buffer_load_dwordx4 v[216:219], v6, s[12:15], s61 offen offset:2048 sc1
    buffer_load_dwordx4 v[220:223], v6, s[12:15], s61 offen offset:2304 sc1
    s_mov_b64 exec, -1
    v_lshrrev_b32 v10, 4, v1
    v_add_u32 v10, v10, v1
    v_and_b32 v10, 3, v10
    v_and_b32 v11, 60, v1
    v_or_b32 v10, v10, v11
    v_lshlrev_b32 v10, 4, v10
    s_lshl_b32 s61, s3, 10
    v_add_u32 v8, s61, v10
    v_lshrrev_b32 v10, 4, v1
    v_bfe_u32 v11, v1, 2, 2
    v_add_u32 v10, v10, v11
    v_and_b32 v10, 3, v10
    v_and_b32 v11, 15, v1
    v_lshl_or_b32 v10, v11, 2, v10
    v_lshlrev_b32 v14, 4, v10
    s_lshl_b32 s64, s63, 13
    s_lshr_b32 s61, s37, 1
    s_lshl_b32 s61, s61, 9
    s_add_u32 s64, s64, s61
    s_and_b32 s61, s37, 1
    s_lshl_b32 s61, s61, 7
    s_add_u32 s64, s64, s61
    v_lshrrev_b32 v10, 4, v1
    v_mul_u32_u24 v10, 0x800, v10
    v_and_b32 v11, 1, v1
    v_lshl_add_u32 v10, v11, 8, v10
    v_bfe_u32 v11, v1, 1, 3
    v_lshl_add_u32 v10, v11, 4, v10
    v_add_u32 v15, s64, v10
    s_mul_i32 s36, s3, 0x0
    s_add_u32 s36, s36, 0x200000
    s_waitcnt vmcnt(22)
    v_perm_b32 v64, v130, v128, s67
    v_perm_b32 v65, v134, v132, s67
    v_perm_b32 v66, v138, v136, s67
    v_perm_b32 v67, v142, v140, s67
    v_perm_b32 v68, v130, v128, s68
    v_perm_b32 v69, v134, v132, s68
    v_perm_b32 v70, v138, v136, s68
    v_perm_b32 v71, v142, v140, s68
    v_perm_b32 v72, v131, v129, s67
    v_perm_b32 v73, v135, v133, s67
    v_perm_b32 v74, v139, v137, s67
    v_perm_b32 v75, v143, v141, s67
    v_perm_b32 v76, v131, v129, s68
    v_perm_b32 v77, v135, v133, s68
    v_perm_b32 v78, v139, v137, s68
    v_perm_b32 v79, v143, v141, s68
    v_perm_b32 v80, v146, v144, s67
    v_perm_b32 v81, v150, v148, s67
    v_perm_b32 v82, v154, v152, s67
    v_perm_b32 v83, v158, v156, s67
    v_perm_b32 v84, v146, v144, s68
    v_perm_b32 v85, v150, v148, s68
    v_perm_b32 v86, v154, v152, s68
    v_perm_b32 v87, v158, v156, s68
    v_perm_b32 v88, v147, v145, s67
    v_perm_b32 v89, v151, v149, s67
    v_perm_b32 v90, v155, v153, s67
    v_perm_b32 v91, v159, v157, s67
    v_perm_b32 v92, v147, v145, s68
    v_perm_b32 v93, v151, v149, s68
    v_perm_b32 v94, v155, v153, s68
    v_perm_b32 v95, v159, v157, s68
    v_perm_b32 v96, v226, v224, s67
    v_perm_b32 v97, v230, v228, s67
    v_perm_b32 v98, v234, v232, s67
    v_perm_b32 v99, v238, v236, s67
    v_perm_b32 v100, v226, v224, s68
    v_perm_b32 v101, v230, v228, s68
    v_perm_b32 v102, v234, v232, s68
    v_perm_b32 v103, v238, v236, s68
    v_perm_b32 v104, v227, v225, s67
    v_perm_b32 v105, v231, v229, s67
    v_perm_b32 v106, v235, v233, s67
    v_perm_b32 v107, v239, v237, s67
    v_perm_b32 v108, v227, v225, s68
    v_perm_b32 v109, v231, v229, s68
    v_perm_b32 v110, v235, v233, s68
    v_perm_b32 v111, v239, v237, s68
    v_perm_b32 v112, v242, v240, s67
    v_perm_b32 v113, v246, v244, s67
    v_perm_b32 v114, v250, v248, s67
    v_perm_b32 v115, v254, v252, s67
    v_perm_b32 v116, v242, v240, s68
    v_perm_b32 v117, v246, v244, s68
    v_perm_b32 v118, v250, v248, s68
    v_perm_b32 v119, v254, v252, s68
    v_perm_b32 v120, v243, v241, s67
    v_perm_b32 v121, v247, v245, s67
    v_perm_b32 v122, v251, v249, s67
    v_perm_b32 v123, v255, v253, s67
    v_perm_b32 v124, v243, v241, s68
    v_perm_b32 v125, v247, v245, s68
    v_perm_b32 v126, v251, v249, s68
    v_perm_b32 v127, v255, v253, s68
    v_mov_b32 v48, 0
    v_mov_b32 v49, 0
    v_mov_b32 v50, 0
    v_mov_b32 v51, 0
    v_mov_b32 v52, 0
    v_mov_b32 v53, 0
    v_mov_b32 v54, 0
    v_mov_b32 v55, 0
    v_mov_b32 v56, 0
    v_mov_b32 v57, 0
    v_mov_b32 v58, 0
    v_mov_b32 v59, 0
    v_mov_b32 v60, 0
    v_mov_b32 v61, 0
    v_mov_b32 v62, 0
    v_mov_b32 v63, 0
    s_waitcnt vmcnt(14)
    v_xor_b32 v10, s58, v160
    v_bitop3_b32 v10, v161, s58, v10 bitop3:0xbe
    v_bitop3_b32 v10, v162, s58, v10 bitop3:0xbe
    v_bitop3_b32 v10, v163, s58, v10 bitop3:0xbe
    v_bitop3_b32 v10, v164, s58, v10 bitop3:0xbe
    v_bitop3_b32 v10, v165, s58, v10 bitop3:0xbe
    v_bitop3_b32 v10, v166, s58, v10 bitop3:0xbe
    v_bitop3_b32 v10, v167, s58, v10 bitop3:0xbe
    v_and_b32 v10, 0xff, v10
    v_cmp_eq_u32 vcc, 0, v10
    s_and_b32 exec_lo, vcc_lo, 0x33333333
    s_and_b32 exec_hi, vcc_hi, 0x33333333
    v_pk_add_f32 v[16:17], v[16:17], v[160:161]
    v_pk_add_f32 v[18:19], v[18:19], v[162:163]
    v_pk_add_f32 v[20:21], v[20:21], v[164:165]
    v_pk_add_f32 v[22:23], v[22:23], v[166:167]
    v_xor_b32 v9, 0x101, v9
    s_mov_b64 exec, -1
    s_waitcnt vmcnt(12)
    v_xor_b32 v10, s58, v168
    v_bitop3_b32 v10, v169, s58, v10 bitop3:0xbe
    v_bitop3_b32 v10, v170, s58, v10 bitop3:0xbe
    v_bitop3_b32 v10, v171, s58, v10 bitop3:0xbe
    v_bitop3_b32 v10, v172, s58, v10 bitop3:0xbe
    v_bitop3_b32 v10, v173, s58, v10 bitop3:0xbe
    v_bitop3_b32 v10, v174, s58, v10 bitop3:0xbe
    v_bitop3_b32 v10, v175, s58, v10 bitop3:0xbe
    v_and_b32 v10, 0xff, v10
    v_cmp_eq_u32 vcc, 0, v10
    s_and_b32 exec_lo, vcc_lo, 0x33333333
    s_and_b32 exec_hi, vcc_hi, 0x33333333
    v_pk_add_f32 v[16:17], v[16:17], v[168:169]
    v_pk_add_f32 v[18:19], v[18:19], v[170:171]
    v_pk_add_f32 v[20:21], v[20:21], v[172:173]
    v_pk_add_f32 v[22:23], v[22:23], v[174:175]
    v_xor_b32 v9, 0x202, v9
    s_mov_b64 exec, -1
    s_waitcnt vmcnt(10)
    v_xor_b32 v10, s58, v176
    v_bitop3_b32 v10, v177, s58, v10 bitop3:0xbe
    v_bitop3_b32 v10, v178, s58, v10 bitop3:0xbe
    v_bitop3_b32 v10, v179, s58, v10 bitop3:0xbe
    v_bitop3_b32 v10, v180, s58, v10 bitop3:0xbe
    v_bitop3_b32 v10, v181, s58, v10 bitop3:0xbe
    v_bitop3_b32 v10, v182, s58, v10 bitop3:0xbe
    v_bitop3_b32 v10, v183, s58, v10 bitop3:0xbe
    v_and_b32 v10, 0xff, v10
    v_cmp_eq_u32 vcc, 0, v10
    s_and_b32 exec_lo, vcc_lo, 0x33333333
    s_and_b32 exec_hi, vcc_hi, 0x33333333
    v_pk_add_f32 v[16:17], v[16:17], v[176:177]
    v_pk_add_f32 v[18:19], v[18:19], v[178:179]
    v_pk_add_f32 v[20:21], v[20:21], v[180:181]
    v_pk_add_f32 v[22:23], v[22:23], v[182:183]
    v_xor_b32 v9, 0x404, v9
    s_mov_b64 exec, -1
    s_waitcnt vmcnt(8)
    v_xor_b32 v10, s58, v184
    v_bitop3_b32 v10, v185, s58, v10 bitop3:0xbe
    v_bitop3_b32 v10, v186, s58, v10 bitop3:0xbe
    v_bitop3_b32 v10, v187, s58, v10 bitop3:0xbe
    v_bitop3_b32 v10, v188, s58, v10 bitop3:0xbe
    v_bitop3_b32 v10, v189, s58, v10 bitop3:0xbe
    v_bitop3_b32 v10, v190, s58, v10 bitop3:0xbe
    v_bitop3_b32 v10, v191, s58, v10 bitop3:0xbe
    v_and_b32 v10, 0xff, v10
    v_cmp_eq_u32 vcc, 0, v10
    s_and_b32 exec_lo, vcc_lo, 0x33333333
    s_and_b32 exec_hi, vcc_hi, 0x33333333
    v_pk_add_f32 v[16:17], v[16:17], v[184:185]
    v_pk_add_f32 v[18:19], v[18:19], v[186:187]
    v_pk_add_f32 v[20:21], v[20:21], v[188:189]
    v_pk_add_f32 v[22:23], v[22:23], v[190:191]
    v_xor_b32 v9, 0x808, v9
    s_mov_b64 exec, -1
    s_waitcnt vmcnt(6)
    v_xor_b32 v10, s58, v192
    v_bitop3_b32 v10, v193, s58, v10 bitop3:0xbe
    v_bitop3_b32 v10, v194, s58, v10 bitop3:0xbe
    v_bitop3_b32 v10, v195, s58, v10 bitop3:0xbe
    v_bitop3_b32 v10, v196, s58, v10 bitop3:0xbe
    v_bitop3_b32 v10, v197, s58, v10 bitop3:0xbe
    v_bitop3_b32 v10, v198, s58, v10 bitop3:0xbe
    v_bitop3_b32 v10, v199, s58, v10 bitop3:0xbe
    v_and_b32 v10, 0xff, v10
    v_cmp_eq_u32 vcc, 0, v10
    s_and_b32 exec_lo, vcc_lo, 0x33333333
    s_and_b32 exec_hi, vcc_hi, 0x33333333
    v_pk_add_f32 v[16:17], v[16:17], v[192:193]
    v_pk_add_f32 v[18:19], v[18:19], v[194:195]
    v_pk_add_f32 v[20:21], v[20:21], v[196:197]
    v_pk_add_f32 v[22:23], v[22:23], v[198:199]
    v_xor_b32 v9, 0x1010, v9
    s_mov_b64 exec, -1
    s_waitcnt vmcnt(4)
    v_xor_b32 v10, s58, v200
    v_bitop3_b32 v10, v201, s58, v10 bitop3:0xbe
    v_bitop3_b32 v10, v202, s58, v10 bitop3:0xbe
    v_bitop3_b32 v10, v203, s58, v10 bitop3:0xbe
    v_bitop3_b32 v10, v204, s58, v10 bitop3:0xbe
    v_bitop3_b32 v10, v205, s58, v10 bitop3:0xbe
    v_bitop3_b32 v10, v206, s58, v10 bitop3:0xbe
    v_bitop3_b32 v10, v207, s58, v10 bitop3:0xbe
    v_and_b32 v10, 0xff, v10
    v_cmp_eq_u32 vcc, 0, v10
    s_and_b32 exec_lo, vcc_lo, 0x33333333
    s_and_b32 exec_hi, vcc_hi, 0x33333333
    v_pk_add_f32 v[16:17], v[16:17], v[200:201]
    v_pk_add_f32 v[18:19], v[18:19], v[202:203]
    v_pk_add_f32 v[20:21], v[20:21], v[204:205]
    v_pk_add_f32 v[22:23], v[22:23], v[206:207]
    v_xor_b32 v9, 0x2020, v9
    s_mov_b64 exec, -1
    s_waitcnt vmcnt(2)
    v_xor_b32 v10, s58, v208
    v_bitop3_b32 v10, v209, s58, v10 bitop3:0xbe
    v_bitop3_b32 v10, v210, s58, v10 bitop3:0xbe
    v_bitop3_b32 v10, v211, s58, v10 bitop3:0xbe
    v_bitop3_b32 v10, v212, s58, v10 bitop3:0xbe
    v_bitop3_b32 v10, v213, s58, v10 bitop3:0xbe
    v_bitop3_b32 v10, v214, s58, v10 bitop3:0xbe
    v_bitop3_b32 v10, v215, s58, v10 bitop3:0xbe
    v_and_b32 v10, 0xff, v10
    v_cmp_eq_u32 vcc, 0, v10
    s_and_b32 exec_lo, vcc_lo, 0x33333333
    s_and_b32 exec_hi, vcc_hi, 0x33333333
    v_pk_add_f32 v[16:17], v[16:17], v[208:209]
    v_pk_add_f32 v[18:19], v[18:19], v[210:211]
    v_pk_add_f32 v[20:21], v[20:21], v[212:213]
    v_pk_add_f32 v[22:23], v[22:23], v[214:215]
    v_xor_b32 v9, 0x4040, v9
    s_mov_b64 exec, -1
    s_waitcnt vmcnt(0)
    v_xor_b32 v10, s58, v216
    v_bitop3_b32 v10, v217, s58, v10 bitop3:0xbe
    v_bitop3_b32 v10, v218, s58, v10 bitop3:0xbe
    v_bitop3_b32 v10, v219, s58, v10 bitop3:0xbe
    v_bitop3_b32 v10, v220, s58, v10 bitop3:0xbe
    v_bitop3_b32 v10, v221, s58, v10 bitop3:0xbe
    v_bitop3_b32 v10, v222, s58, v10 bitop3:0xbe
    v_bitop3_b32 v10, v223, s58, v10 bitop3:0xbe
    v_and_b32 v10, 0xff, v10
    v_cmp_eq_u32 vcc, 0, v10
    s_and_b32 exec_lo, vcc_lo, 0x33333333
    s_and_b32 exec_hi, vcc_hi, 0x33333333
    v_pk_add_f32 v[16:17], v[16:17], v[216:217]
    v_pk_add_f32 v[18:19], v[18:19], v[218:219]
    v_pk_add_f32 v[20:21], v[20:21], v[220:221]
    v_pk_add_f32 v[22:23], v[22:23], v[222:223]
    v_xor_b32 v9, 0x8080, v9
    s_mov_b64 exec, -1
    v_cmp_ne_u32 vcc, 0, v9
    s_mov_b64 exec, vcc
    s_cbranch_execz RD_Wm1
    v_lshrrev_b32 v11, v3, v9
    v_ffbl_b32 v11, v11
    v_add_u32 v11, v11, v3
    v_and_b32 v24, 7, v11
    v_add_u32 v3, 1, v24
    v_lshl_add_u32 v11, v24, 11, v6
    buffer_load_dwordx4 v[160:163], v11, s[12:15], s75 offen offset:0 sc1
    buffer_load_dwordx4 v[164:167], v11, s[12:15], s75 offen offset:256 sc1
    v_lshrrev_b32 v11, v3, v9
    v_ffbl_b32 v11, v11
    v_add_u32 v11, v11, v3
    v_and_b32 v25, 7, v11
    v_add_u32 v3, 1, v25
    v_lshl_add_u32 v11, v25, 11, v6
    buffer_load_dwordx4 v[168:171], v11, s[12:15], s75 offen offset:0 sc1
    buffer_load_dwordx4 v[172:175], v11, s[12:15], s75 offen offset:256 sc1
    v_lshrrev_b32 v11, v3, v9
    v_ffbl_b32 v11, v11
    v_add_u32 v11, v11, v3
    v_and_b32 v26, 7, v11
    v_add_u32 v3, 1, v26
    v_lshl_add_u32 v11, v26, 11, v6
    buffer_load_dwordx4 v[176:179], v11, s[12:15], s75 offen offset:0 sc1
    buffer_load_dwordx4 v[180:183], v11, s[12:15], s75 offen offset:256 sc1
RL_Wm1:
    v_lshrrev_b32 v11, v3, v9
    v_ffbl_b32 v11, v11
    v_add_u32 v11, v11, v3
    v_and_b32 v27, 7, v11
    v_add_u32 v3, 1, v27
    v_lshl_add_u32 v11, v27, 11, v6
    buffer_load_dwordx4 v[184:187], v11, s[12:15], s75 offen offset:0 sc1
    buffer_load_dwordx4 v[188:191], v11, s[12:15], s75 offen offset:256 sc1
    v_bfe_u32 v12, v9, v24, 1
    s_waitcnt vmcnt(6)
    v_xor_b32 v10, s58, v160
    v_bitop3_b32 v10, v161, s58, v10 bitop3:0xbe
    v_bitop3_b32 v10, v162, s58, v10 bitop3:0xbe
    v_bitop3_b32 v10, v163, s58, v10 bitop3:0xbe
    v_bitop3_b32 v10, v164, s58, v10 bitop3:0xbe
    v_bitop3_b32 v10, v165, s58, v10 bitop3:0xbe
    v_bitop3_b32 v10, v166, s58, v10 bitop3:0xbe
    v_bitop3_b32 v10, v167, s58, v10 bitop3:0xbe
    v_and_b32 v10, 0xff, v10
    v_cmp_lt_u32 vcc, v10, v12
    s_and_saveexec_b64 s[72:73], vcc
    v_pk_add_f32 v[16:17], v[16:17], v[160:161]
    v_pk_add_f32 v[18:19], v[18:19], v[162:163]
    v_pk_add_f32 v[20:21], v[20:21], v[164:165]
    v_pk_add_f32 v[22:23], v[22:23], v[166:167]
    v_lshl_add_u32 v9, s74, v24, v9
    s_mov_b64 exec, s[72:73]
    v_cmp_ne_u32 vcc, 0, v9
    s_mov_b64 exec, vcc
    s_cbranch_execz RD_Wm1
    v_lshrrev_b32 v11, v3, v9
    v_ffbl_b32 v11, v11
    v_add_u32 v11, v11, v3
    v_and_b32 v24, 7, v11
    v_add_u32 v3, 1, v24
    v_lshl_add_u32 v11, v24, 11, v6
    buffer_load_dwordx4 v[160:163], v11, s[12:15], s75 offen offset:0 sc1
    buffer_load_dwordx4 v[164:167], v11, s[12:15], s75 offen offset:256 sc1
    v_bfe_u32 v12, v9, v25, 1
    s_waitcnt vmcnt(6)
    v_xor_b32 v10, s58, v168
    v_bitop3_b32 v10, v169, s58, v10 bitop3:0xbe
    v_bitop3_b32 v10, v170, s58, v10 bitop3:0xbe
    v_bitop3_b32 v10, v171, s58, v10 bitop3:0xbe
    v_bitop3_b32 v10, v172, s58, v10 bitop3:0xbe
    v_bitop3_b32 v10, v173, s58, v10 bitop3:0xbe
    v_bitop3_b32 v10, v174, s58, v10 bitop3:0xbe
    v_bitop3_b32 v10, v175, s58, v10 bitop3:0xbe
    v_and_b32 v10, 0xff, v10
    v_cmp_lt_u32 vcc, v10, v12
    s_and_saveexec_b64 s[72:73], vcc
    v_pk_add_f32 v[16:17], v[16:17], v[168:169]
    v_pk_add_f32 v[18:19], v[18:19], v[170:171]
    v_pk_add_f32 v[20:21], v[20:21], v[172:173]
    v_pk_add_f32 v[22:23], v[22:23], v[174:175]
    v_lshl_add_u32 v9, s74, v25, v9
    s_mov_b64 exec, s[72:73]
    v_cmp_ne_u32 vcc, 0, v9
    s_mov_b64 exec, vcc
    s_cbranch_execz RD_Wm1
    v_lshrrev_b32 v11, v3, v9
    v_ffbl_b32 v11, v11
    v_add_u32 v11, v11, v3
    v_and_b32 v25, 7, v11
    v_add_u32 v3, 1, v25
    v_lshl_add_u32 v11, v25, 11, v6
    buffer_load_dwordx4 v[168:171], v11, s[12:15], s75 offen offset:0 sc1
    buffer_load_dwordx4 v[172:175], v11, s[12:15], s75 offen offset:256 sc1
    v_bfe_u32 v12, v9, v26, 1
    s_waitcnt vmcnt(6)
    v_xor_b32 v10, s58, v176
    v_bitop3_b32 v10, v177, s58, v10 bitop3:0xbe
    v_bitop3_b32 v10, v178, s58, v10 bitop3:0xbe
    v_bitop3_b32 v10, v179, s58, v10 bitop3:0xbe
    v_bitop3_b32 v10, v180, s58, v10 bitop3:0xbe
    v_bitop3_b32 v10, v181, s58, v10 bitop3:0xbe
    v_bitop3_b32 v10, v182, s58, v10 bitop3:0xbe
    v_bitop3_b32 v10, v183, s58, v10 bitop3:0xbe
    v_and_b32 v10, 0xff, v10
    v_cmp_lt_u32 vcc, v10, v12
    s_and_saveexec_b64 s[72:73], vcc
    v_pk_add_f32 v[16:17], v[16:17], v[176:177]
    v_pk_add_f32 v[18:19], v[18:19], v[178:179]
    v_pk_add_f32 v[20:21], v[20:21], v[180:181]
    v_pk_add_f32 v[22:23], v[22:23], v[182:183]
    v_lshl_add_u32 v9, s74, v26, v9
    s_mov_b64 exec, s[72:73]
    v_cmp_ne_u32 vcc, 0, v9
    s_mov_b64 exec, vcc
    s_cbranch_execz RD_Wm1
    v_lshrrev_b32 v11, v3, v9
    v_ffbl_b32 v11, v11
    v_add_u32 v11, v11, v3
    v_and_b32 v26, 7, v11
    v_add_u32 v3, 1, v26
    v_lshl_add_u32 v11, v26, 11, v6
    buffer_load_dwordx4 v[176:179], v11, s[12:15], s75 offen offset:0 sc1
    buffer_load_dwordx4 v[180:183], v11, s[12:15], s75 offen offset:256 sc1
    v_bfe_u32 v12, v9, v27, 1
    s_waitcnt vmcnt(6)
    v_xor_b32 v10, s58, v184
    v_bitop3_b32 v10, v185, s58, v10 bitop3:0xbe
    v_bitop3_b32 v10, v186, s58, v10 bitop3:0xbe
    v_bitop3_b32 v10, v187, s58, v10 bitop3:0xbe
    v_bitop3_b32 v10, v188, s58, v10 bitop3:0xbe
    v_bitop3_b32 v10, v189, s58, v10 bitop3:0xbe
    v_bitop3_b32 v10, v190, s58, v10 bitop3:0xbe
    v_bitop3_b32 v10, v191, s58, v10 bitop3:0xbe
    v_and_b32 v10, 0xff, v10
    v_cmp_lt_u32 vcc, v10, v12
    s_and_saveexec_b64 s[72:73], vcc
    v_pk_add_f32 v[16:17], v[16:17], v[184:185]
    v_pk_add_f32 v[18:19], v[18:19], v[186:187]
    v_pk_add_f32 v[20:21], v[20:21], v[188:189]
    v_pk_add_f32 v[22:23], v[22:23], v[190:191]
    v_lshl_add_u32 v9, s74, v27, v9
    s_mov_b64 exec, s[72:73]
    v_cmp_ne_u32 vcc, 0, v9
    s_mov_b64 exec, vcc
    s_cbranch_execz RD_Wm1
    s_sub_u32 s62, s62, 1
    s_cbranch_scc0 RL_Wm1
RD_Wm1:
    s_mov_b64 exec, -1
    v_cvt_pk_bf16_f32 v24, v16, v20
    v_cvt_pk_bf16_f32 v25, v17, v21
    v_cvt_pk_bf16_f32 v26, v18, v22
    v_cvt_pk_bf16_f32 v27, v19, v23
    v_mov_b32_dpp v48, v24 quad_perm:[0,1,2,3] row_mask:0xf bank_mask:0x1
    v_mov_b32_dpp v49, v25 quad_perm:[0,1,2,3] row_mask:0xf bank_mask:0x1
    v_mov_b32_dpp v50, v26 quad_perm:[0,1,2,3] row_mask:0xf bank_mask:0x1
    v_mov_b32_dpp v51, v27 quad_perm:[0,1,2,3] row_mask:0xf bank_mask:0x1
    s_nop 1
    v_mfma_f32_16x16x32_bf16 v[128:131], v[64:67], v[48:51], 0
    v_mov_b32_dpp v52, v24 quad_perm:[0,1,2,3] row_mask:0xf bank_mask:0x2
    v_mov_b32_dpp v53, v25 quad_perm:[0,1,2,3] row_mask:0xf bank_mask:0x2
    v_mfma_f32_16x16x32_bf16 v[132:135], v[68:71], v[48:51], 0
    v_mov_b32_dpp v54, v26 quad_perm:[0,1,2,3] row_mask:0xf bank_mask:0x2
    v_mov_b32_dpp v55, v27 quad_perm:[0,1,2,3] row_mask:0xf bank_mask:0x2
    s_nop 1
    v_mfma_f32_16x16x32_bf16 v[128:131], v[80:83], v[52:55], v[128:131]
    v_mov_b32_dpp v56, v24 quad_perm:[0,1,2,3] row_mask:0xf bank_mask:0x4
    v_mov_b32_dpp v57, v25 quad_perm:[0,1,2,3] row_mask:0xf bank_mask:0x4
    v_mfma_f32_16x16x32_bf16 v[132:135], v[84:87], v[52:55], v[132:135]
    v_mov_b32_dpp v58, v26 quad_perm:[0,1,2,3] row_mask:0xf bank_mask:0x4
    v_mov_b32_dpp v59, v27 quad_perm:[0,1,2,3] row_mask:0xf bank_mask:0x4
    s_nop 1
    v_mfma_f32_16x16x32_bf16 v[128:131], v[96:99], v[56:59], v[128:131]
    v_mov_b32_dpp v60, v24 quad_perm:[0,1,2,3] row_mask:0xf bank_mask:0x8
    v_mov_b32_dpp v61, v25 quad_perm:[0,1,2,3] row_mask:0xf bank_mask:0x8
    v_mfma_f32_16x16x32_bf16 v[132:135], v[100:103], v[56:59], v[132:135]
    v_mov_b32_dpp v62, v26 quad_perm:[0,1,2,3] row_mask:0xf bank_mask:0x8
    v_mov_b32_dpp v63, v27 quad_perm:[0,1,2,3] row_mask:0xf bank_mask:0x8
    s_nop 1
    v_mfma_f32_16x16x32_bf16 v[128:131], v[112:115], v[60:63], v[128:131]
    v_mfma_f32_16x16x32_bf16 v[132:135], v[116:119], v[60:63], v[132:135]
    v_mfma_f32_16x16x32_bf16 v[136:139], v[72:75], v[48:51], 0
    v_mfma_f32_16x16x32_bf16 v[140:143], v[76:79], v[48:51], 0
    v_mfma_f32_16x16x32_bf16 v[136:139], v[88:91], v[52:55], v[136:139]
    v_mfma_f32_16x16x32_bf16 v[140:143], v[92:95], v[52:55], v[140:143]
    s_nop 2
    v_add_f32_dpp v144, v128, v128 row_shl:4 row_mask:0xf bank_mask:0x5
    v_add_f32_dpp v146, v129, v129 row_shl:4 row_mask:0xf bank_mask:0x5
    v_mfma_f32_16x16x32_bf16 v[136:139], v[104:107], v[56:59], v[136:139]
    v_add_f32_dpp v148, v130, v130 row_shl:4 row_mask:0xf bank_mask:0x5
    v_add_f32_dpp v150, v131, v131 row_shl:4 row_mask:0xf bank_mask:0x5
    v_mfma_f32_16x16x32_bf16 v[140:143], v[108:111], v[56:59], v[140:143]
    v_add_f32_dpp v144, v132, v132 row_shr:4 row_mask:0xf bank_mask:0xa
    v_add_f32_dpp v146, v133, v133 row_shr:4 row_mask:0xf bank_mask:0xa
    v_mfma_f32_16x16x32_bf16 v[136:139], v[120:123], v[60:63], v[136:139]
    v_add_f32_dpp v148, v134, v134 row_shr:4 row_mask:0xf bank_mask:0xa
    v_add_f32_dpp v150, v135, v135 row_shr:4 row_mask:0xf bank_mask:0xa
    v_mfma_f32_16x16x32_bf16 v[140:143], v[124:127], v[60:63], v[140:143]
    s_nop 4
    v_add_f32_dpp v145, v136, v136 row_shl:4 row_mask:0xf bank_mask:0x5
    v_add_f32_dpp v147, v137, v137 row_shl:4 row_mask:0xf bank_mask:0x5
    v_add_f32_dpp v149, v138, v138 row_shl:4 row_mask:0xf bank_mask:0x5
    v_add_f32_dpp v151, v139, v139 row_shl:4 row_mask:0xf bank_mask:0x5
    v_add_f32_dpp v145, v140, v140 row_shr:4 row_mask:0xf bank_mask:0xa
    v_add_f32_dpp v147, v141, v141 row_shr:4 row_mask:0xf bank_mask:0xa
    v_add_f32_dpp v149, v142, v142 row_shr:4 row_mask:0xf bank_mask:0xa
    v_add_f32_dpp v151, v143, v143 row_shr:4 row_mask:0xf bank_mask:0xa
    v_add_f32_dpp v152, v144, v144 row_shl:8 row_mask:0xf bank_mask:0x3
    v_add_f32_dpp v153, v146, v146 row_shl:8 row_mask:0xf bank_mask:0x3
    v_add_f32_dpp v154, v148, v148 row_shl:8 row_mask:0xf bank_mask:0x3
    v_add_f32_dpp v155, v150, v150 row_shl:8 row_mask:0xf bank_mask:0x3
    v_add_f32_dpp v152, v145, v145 row_shr:8 row_mask:0xf bank_mask:0xc
    v_add_f32_dpp v153, v147, v147 row_shr:8 row_mask:0xf bank_mask:0xc
    v_add_f32_dpp v154, v149, v149 row_shr:8 row_mask:0xf bank_mask:0xc
    v_add_f32_dpp v155, v151, v151 row_shr:8 row_mask:0xf bank_mask:0xc
    ds_write_b128 v8, v[152:155] offset:0
    s_waitcnt lgkmcnt(0)
    s_barrier
    s_cmp_lg_u32 s3, 0
    s_cbranch_scc1 WS_W
    ds_read_b128 v[16:19], v14 offset:0
    ds_read_b128 v[20:23], v14 offset:1024
    ds_read_b128 v[24:27], v14 offset:2048
    ds_read_b128 v[28:31], v14 offset:3072
    s_waitcnt lgkmcnt(2)
    v_pk_add_f32 v[16:17], v[16:17], v[20:21]
    v_pk_add_f32 v[18:19], v[18:19], v[22:23]
    s_waitcnt lgkmcnt(0)
    v_pk_add_f32 v[24:25], v[24:25], v[28:29]
    v_pk_add_f32 v[26:27], v[26:27], v[30:31]
    v_pk_add_f32 v[16:17], v[16:17], v[24:25]
    v_pk_add_f32 v[18:19], v[18:19], v[26:27]
    v_bfi_b32 v16, s65, v4, v16
    v_bfi_b32 v17, s65, v4, v17
    v_bfi_b32 v18, s65, v4, v18
    v_bfi_b32 v19, s65, v4, v19
    s_mov_b32 exec_hi, 0
    buffer_store_dwordx4 v[16:19], v15, s[12:15], s36 offen sc1
    s_mov_b64 exec, -1
WS_W:
    s_cmp_ge_u32 s3, 2
    s_cbranch_scc1 DONE_W
    s_mov_b32 s62, 0x40000
CW_fg:
    v_xor_b32 v10, s58, v40
    v_bitop3_b32 v10, v41, s58, v10 bitop3:0xbe
    v_bitop3_b32 v10, v42, s58, v10 bitop3:0xbe
    v_bitop3_b32 v10, v43, s58, v10 bitop3:0xbe
    v_bitop3_b32 v10, v44, s58, v10 bitop3:0xbe
    v_bitop3_b32 v10, v45, s58, v10 bitop3:0xbe
    v_bitop3_b32 v10, v46, s58, v10 bitop3:0xbe
    v_bitop3_b32 v10, v47, s58, v10 bitop3:0xbe
    v_and_b32 v10, 0xff, v10
    v_cmp_ne_u32 vcc, 0, v10
    s_cbranch_vccnz RW_fg
KW_fg:
    v_and_b32 v40, s66, v40
    v_and_b32 v41, s66, v41
    v_and_b32 v42, s66, v42
    v_and_b32 v43, s66, v43
    v_and_b32 v44, s66, v44
    v_and_b32 v45, s66, v45
    v_and_b32 v46, s66, v46
    v_and_b32 v47, s66, v47
    v_lshlrev_b32 v32, 16, v32
    v_lshlrev_b32 v33, 16, v33
    v_lshlrev_b32 v34, 16, v34
    v_lshlrev_b32 v35, 16, v35
    v_and_b32 v10, 31, v1
    v_lshlrev_b32 v10, 11, v10
    v_add_u32 v6, s35, v10
    s_and_b32 s64, s32, 0
    s_lshl_b32 s64, s64, 16
    v_add_u32 v6, s64, v6
    s_mov_b32 s61, 0x200000
    buffer_load_dwordx4 v[224:227], v6, s[12:15], s61 offen offset:0 sc1
    s_waitcnt vmcnt(0)
    s_mov_b32 s62, 0x40000
CW_f2:
    v_xor_b32 v10, s58, v224
    v_bitop3_b32 v10, v225, s58, v10 bitop3:0xbe
    v_bitop3_b32 v10, v226, s58, v10 bitop3:0xbe
    v_bitop3_b32 v10, v227, s58, v10 bitop3:0xbe
    v_and_b32 v10, 0xff, v10
    v_cmp_ne_u32 vcc, 0, v10
    s_cbranch_vccnz RW_f2
KW_f2:
    v_add_f32_dpp v224, v224, v224 row_ror:4 row_mask:0xf bank_mask:0xf
    v_add_f32_dpp v225, v225, v225 row_ror:4 row_mask:0xf bank_mask:0xf
    v_add_f32_dpp v226, v226, v226 row_ror:4 row_mask:0xf bank_mask:0xf
    v_add_f32_dpp v227, v227, v227 row_ror:4 row_mask:0xf bank_mask:0xf
    v_add_f32_dpp v224, v224, v224 row_ror:8 row_mask:0xf bank_mask:0xf
    v_add_f32_dpp v225, v225, v225 row_ror:8 row_mask:0xf bank_mask:0xf
    v_add_f32_dpp v226, v226, v226 row_ror:8 row_mask:0xf bank_mask:0xf
    v_add_f32_dpp v227, v227, v227 row_ror:8 row_mask:0xf bank_mask:0xf
    v_mov_b32 v228, v224
    v_mov_b32 v229, v225
    v_mov_b32 v230, v226
    v_mov_b32 v231, v227
    v_permlane16_swap_b32 v224, v228
    v_permlane16_swap_b32 v225, v229
    v_permlane16_swap_b32 v226, v230
    v_permlane16_swap_b32 v227, v231
    v_add_f32 v224, v224, v228
    v_add_f32 v225, v225, v229
    v_add_f32 v226, v226, v230
    v_add_f32 v227, v227, v231
    v_cvt_pk_bf16_f32 v228, v224, v225
    v_cvt_pk_bf16_f32 v229, v226, v227
    v_lshlrev_b32 v224, 16, v228
    v_and_b32 v225, s66, v228
    v_lshlrev_b32 v226, 16, v229
    v_and_b32 v227, s66, v229
    v_mul_f32 v224, v224, v40
    v_mul_f32 v225, v225, v41
    v_mul_f32 v226, v226, v42
    v_mul_f32 v227, v227, v43
    v_cvt_pk_bf16_f32 v228, v224, v225
    v_cvt_pk_bf16_f32 v229, v226, v227
    v_lshlrev_b32 v224, 16, v228
    v_and_b32 v225, s66, v228
    v_lshlrev_b32 v226, 16, v229
    v_and_b32 v227, s66, v229
    v_add_f32 v224, v224, v32
    v_add_f32 v225, v225, v33
    v_add_f32 v226, v226, v34
    v_add_f32 v227, v227, v35
    v_cvt_pk_bf16_f32 v228, v224, v225
    v_cvt_pk_bf16_f32 v229, v226, v227
    v_lshlrev_b32 v224, 16, v228
    v_and_b32 v225, s66, v228
    v_lshlrev_b32 v226, 16, v229
    v_and_b32 v227, s66, v229
    v_bfe_u32 v11, v1, 2, 2
    v_lshl_add_u32 v7, v11, 4, v36
    v_cmp_eq_u32 vcc, 1, v11
    s_nop 1
    v_cndmask_b32 v44, v44, v45, vcc
    v_cndmask_b32 v224, v224, v225, vcc
    v_cmp_eq_u32 vcc, 2, v11
    s_nop 1
    v_cndmask_b32 v44, v44, v46, vcc
    v_cndmask_b32 v224, v224, v226, vcc
    v_cmp_eq_u32 vcc, 3, v11
    s_nop 1
    v_cndmask_b32 v44, v44, v47, vcc
    v_cndmask_b32 v224, v224, v227, vcc
    v_lshrrev_b32 v44, 16, v44
    s_mul_i32 s64, s32, 3584
    v_lshlrev_b32 v10, 4, v1
    v_add_u32 v6, s64, v10
    v_mov_b32 v16, 0
    v_mov_b32 v17, 0
    v_mov_b32 v18, 0
    v_mov_b32 v19, 0
    v_mov_b32 v9, 0xff
    s_mov_b32 exec_lo, 0x0
    s_mov_b32 exec_hi, 0xffffffff
    v_mov_b32 v9, 0x77
    s_mov_b64 exec, -1
    v_mov_b32 v3, 0
    s_mov_b32 s74, 0xffffffef
    s_mov_b32 s75, 0x100000
    s_mov_b32 s62, 0x40000
    buffer_load_dwordx4 v[160:163], v6, s[12:15], s75 offen offset:0 sc1
    buffer_load_dwordx4 v[164:167], v6, s[12:15], s75 offen offset:1024 sc1
    buffer_load_dwordx4 v[168:171], v6, s[12:15], s75 offen offset:2048 sc1
    buffer_load_dwordx4 v[172:175], v6, s[12:15], s75 offen offset:3072 sc1
    s_waitcnt vmcnt(3)
    v_xor_b32 v10, s58, v160
    v_bitop3_b32 v10, v161, s58, v10 bitop3:0xbe
    v_bitop3_b32 v10, v162, s58, v10 bitop3:0xbe
    v_bitop3_b32 v10, v163, s58, v10 bitop3:0xbe
    v_and_b32 v10, 0xff, v10
    v_cmp_eq_u32 vcc, 0, v10
    s_mov_b64 exec, vcc
    v_pk_add_f32 v[16:17], v[16:17], v[160:161]
    v_pk_add_f32 v[18:19], v[18:19], v[162:163]
    v_xor_b32 v9, 0x11, v9
    s_mov_b64 exec, -1
    s_waitcnt vmcnt(2)
    v_xor_b32 v10, s58, v164
    v_bitop3_b32 v10, v165, s58, v10 bitop3:0xbe
    v_bitop3_b32 v10, v166, s58, v10 bitop3:0xbe
    v_bitop3_b32 v10, v167, s58, v10 bitop3:0xbe
    v_and_b32 v10, 0xff, v10
    v_cmp_eq_u32 vcc, 0, v10
    s_mov_b64 exec, vcc
    v_pk_add_f32 v[16:17], v[16:17], v[164:165]
    v_pk_add_f32 v[18:19], v[18:19], v[166:167]
    v_xor_b32 v9, 0x22, v9
    s_mov_b64 exec, -1
    s_waitcnt vmcnt(1)
    v_xor_b32 v10, s58, v168
    v_bitop3_b32 v10, v169, s58, v10 bitop3:0xbe
    v_bitop3_b32 v10, v170, s58, v10 bitop3:0xbe
    v_bitop3_b32 v10, v171, s58, v10 bitop3:0xbe
    v_and_b32 v10, 0xff, v10
    v_cmp_eq_u32 vcc, 0, v10
    s_mov_b64 exec, vcc
    v_pk_add_f32 v[16:17], v[16:17], v[168:169]
    v_pk_add_f32 v[18:19], v[18:19], v[170:171]
    v_xor_b32 v9, 0x44, v9
    s_mov_b64 exec, -1
    s_waitcnt vmcnt(0)
    v_xor_b32 v10, s58, v172
    v_bitop3_b32 v10, v173, s58, v10 bitop3:0xbe
    v_bitop3_b32 v10, v174, s58, v10 bitop3:0xbe
    v_bitop3_b32 v10, v175, s58, v10 bitop3:0xbe
    v_and_b32 v10, 0xff, v10
    v_cmp_eq_u32 vcc, 0, v10
    s_mov_b32 exec_lo, vcc_lo
    s_mov_b32 exec_hi, 0
    v_pk_add_f32 v[16:17], v[16:17], v[172:173]
    v_pk_add_f32 v[18:19], v[18:19], v[174:175]
    v_xor_b32 v9, 0x88, v9
    s_mov_b64 exec, -1
    v_cmp_ne_u32 vcc, 0, v9
    s_mov_b64 exec, vcc
    s_cbranch_execz RD_Wm3
    v_lshrrev_b32 v11, v3, v9
    v_ffbl_b32 v11, v11
    v_add_u32 v11, v11, v3
    v_and_b32 v24, 3, v11
    v_add_u32 v3, 1, v24
    v_lshl_add_u32 v11, v24, 10, v6
    buffer_load_dwordx4 v[160:163], v11, s[12:15], s75 offen offset:0 sc1
    v_lshrrev_b32 v11, v3, v9
    v_ffbl_b32 v11, v11
    v_add_u32 v11, v11, v3
    v_and_b32 v25, 3, v11
    v_add_u32 v3, 1, v25
    v_lshl_add_u32 v11, v25, 10, v6
    buffer_load_dwordx4 v[164:167], v11, s[12:15], s75 offen offset:0 sc1
    v_lshrrev_b32 v11, v3, v9
    v_ffbl_b32 v11, v11
    v_add_u32 v11, v11, v3
    v_and_b32 v26, 3, v11
    v_add_u32 v3, 1, v26
    v_lshl_add_u32 v11, v26, 10, v6
    buffer_load_dwordx4 v[168:171], v11, s[12:15], s75 offen offset:0 sc1
RL_Wm3:
    v_lshrrev_b32 v11, v3, v9
    v_ffbl_b32 v11, v11
    v_add_u32 v11, v11, v3
    v_and_b32 v27, 3, v11
    v_add_u32 v3, 1, v27
    v_lshl_add_u32 v11, v27, 10, v6
    buffer_load_dwordx4 v[172:175], v11, s[12:15], s75 offen offset:0 sc1
    v_bfe_u32 v12, v9, v24, 1
    s_waitcnt vmcnt(3)
    v_xor_b32 v10, s58, v160
    v_bitop3_b32 v10, v161, s58, v10 bitop3:0xbe
    v_bitop3_b32 v10, v162, s58, v10 bitop3:0xbe
    v_bitop3_b32 v10, v163, s58, v10 bitop3:0xbe
    v_and_b32 v10, 0xff, v10
    v_cmp_lt_u32 vcc, v10, v12
    s_and_saveexec_b64 s[72:73], vcc
    v_pk_add_f32 v[16:17], v[16:17], v[160:161]
    v_pk_add_f32 v[18:19], v[18:19], v[162:163]
    v_lshl_add_u32 v9, s74, v24, v9
    s_mov_b64 exec, s[72:73]
    v_cmp_ne_u32 vcc, 0, v9
    s_mov_b64 exec, vcc
    s_cbranch_execz RD_Wm3
    v_lshrrev_b32 v11, v3, v9
    v_ffbl_b32 v11, v11
    v_add_u32 v11, v11, v3
    v_and_b32 v24, 3, v11
    v_add_u32 v3, 1, v24
    v_lshl_add_u32 v11, v24, 10, v6
    buffer_load_dwordx4 v[160:163], v11, s[12:15], s75 offen offset:0 sc1
    v_bfe_u32 v12, v9, v25, 1
    s_waitcnt vmcnt(3)
    v_xor_b32 v10, s58, v164
    v_bitop3_b32 v10, v165, s58, v10 bitop3:0xbe
    v_bitop3_b32 v10, v166, s58, v10 bitop3:0xbe
    v_bitop3_b32 v10, v167, s58, v10 bitop3:0xbe
    v_and_b32 v10, 0xff, v10
    v_cmp_lt_u32 vcc, v10, v12
    s_and_saveexec_b64 s[72:73], vcc
    v_pk_add_f32 v[16:17], v[16:17], v[164:165]
    v_pk_add_f32 v[18:19], v[18:19], v[166:167]
    v_lshl_add_u32 v9, s74, v25, v9
    s_mov_b64 exec, s[72:73]
    v_cmp_ne_u32 vcc, 0, v9
    s_mov_b64 exec, vcc
    s_cbranch_execz RD_Wm3
    v_lshrrev_b32 v11, v3, v9
    v_ffbl_b32 v11, v11
    v_add_u32 v11, v11, v3
    v_and_b32 v25, 3, v11
    v_add_u32 v3, 1, v25
    v_lshl_add_u32 v11, v25, 10, v6
    buffer_load_dwordx4 v[164:167], v11, s[12:15], s75 offen offset:0 sc1
    v_bfe_u32 v12, v9, v26, 1
    s_waitcnt vmcnt(3)
    v_xor_b32 v10, s58, v168
    v_bitop3_b32 v10, v169, s58, v10 bitop3:0xbe
    v_bitop3_b32 v10, v170, s58, v10 bitop3:0xbe
    v_bitop3_b32 v10, v171, s58, v10 bitop3:0xbe
    v_and_b32 v10, 0xff, v10
    v_cmp_lt_u32 vcc, v10, v12
    s_and_saveexec_b64 s[72:73], vcc
    v_pk_add_f32 v[16:17], v[16:17], v[168:169]
    v_pk_add_f32 v[18:19], v[18:19], v[170:171]
    v_lshl_add_u32 v9, s74, v26, v9
    s_mov_b64 exec, s[72:73]
    v_cmp_ne_u32 vcc, 0, v9
    s_mov_b64 exec, vcc
    s_cbranch_execz RD_Wm3
    v_lshrrev_b32 v11, v3, v9
    v_ffbl_b32 v11, v11
    v_add_u32 v11, v11, v3
    v_and_b32 v26, 3, v11
    v_add_u32 v3, 1, v26
    v_lshl_add_u32 v11, v26, 10, v6
    buffer_load_dwordx4 v[168:171], v11, s[12:15], s75 offen offset:0 sc1
    v_bfe_u32 v12, v9, v27, 1
    s_waitcnt vmcnt(3)
    v_xor_b32 v10, s58, v172
    v_bitop3_b32 v10, v173, s58, v10 bitop3:0xbe
    v_bitop3_b32 v10, v174, s58, v10 bitop3:0xbe
    v_bitop3_b32 v10, v175, s58, v10 bitop3:0xbe
    v_and_b32 v10, 0xff, v10
    v_cmp_lt_u32 vcc, v10, v12
    s_and_saveexec_b64 s[72:73], vcc
    v_pk_add_f32 v[16:17], v[16:17], v[172:173]
    v_pk_add_f32 v[18:19], v[18:19], v[174:175]
    v_lshl_add_u32 v9, s74, v27, v9
    s_mov_b64 exec, s[72:73]
    v_cmp_ne_u32 vcc, 0, v9
    s_mov_b64 exec, vcc
    s_cbranch_execz RD_Wm3
    s_sub_u32 s62, s62, 1
    s_cbranch_scc0 RL_Wm3
RD_Wm3:
    s_mov_b64 exec, -1
    v_add_f32_dpp v20, v16, v16 row_shl:4 row_mask:0xf bank_mask:0x5
    v_add_f32_dpp v21, v18, v18 row_shl:4 row_mask:0xf bank_mask:0x5
    s_nop 0
    v_add_f32_dpp v20, v17, v17 row_shr:4 row_mask:0xf bank_mask:0xa
    v_add_f32_dpp v21, v19, v19 row_shr:4 row_mask:0xf bank_mask:0xa
    s_nop 0
    v_add_f32_dpp v22, v20, v20 row_shl:8 row_mask:0xf bank_mask:0x3
    s_nop 1
    v_add_f32_dpp v22, v21, v21 row_shr:8 row_mask:0xf bank_mask:0xc
    v_mov_b32 v23, v22
    s_nop 1
    v_permlane16_swap_b32 v22, v23
    v_add_f32 v22, v22, v23
    v_mov_b32 v23, v22
    s_nop 1
    v_permlane32_swap_b32 v22, v23
    v_add_f32 v22, v22, v23
    v_cvt_pk_bf16_f32 v20, v22, v22
    v_dot2_f32_bf16 v20, v20, v44, 0
    s_nop 2
    v_cvt_pk_bf16_f32 v20, v20, v20
    v_dot2_f32_bf16 v20, v20, s76, v224
    s_nop 2
    v_cvt_pk_bf16_f32 v20, v20, v20
    s_mov_b64 exec, 0xffff
    buffer_store_short v20, v7, s[28:31], 0 offen
    s_cmp_lg_u32 s32, 0
    s_cbranch_scc1 DONE_W
    s_mov_b64 exec, 0x1
    v_mov_b32 v10, 0
    buffer_store_dword v4, v10, s[12:15], 0 offen sc1
DONE_W:
    s_waitcnt vmcnt(0)
    s_endpgm
RW_fg:
    s_sub_u32 s62, s62, 1
    s_cbranch_scc1 KW_fg
    s_mov_b32 s61, 0x2000
    buffer_load_dwordx4 v[40:43], v7, s[12:15], s61 offen offset:0 sc1
    s_mov_b32 s61, 0x3000
    buffer_load_dwordx4 v[44:47], v7, s[12:15], s61 offen offset:2048 sc1
    s_waitcnt vmcnt(0)
    s_branch CW_fg
RW_f2:
    s_sub_u32 s62, s62, 1
    s_cbranch_scc1 KW_f2
    s_mov_b32 s61, 0x200000
    buffer_load_dwordx4 v[224:227], v6, s[12:15], s61 offen offset:0 sc1
    s_waitcnt vmcnt(0)
    s_branch CW_f2
.p2align 6
CLS_F:
    s_sub_u32 s61, s2, 112
    s_lshr_b32 s61, s61, 3
    s_lshl_b32 s61, s61, 2
    s_add_u32 s61, s61, s3
    s_min_u32 s61, s61, 63
    s_lshl_b32 s61, s61, 3
    v_lshrrev_b32 v10, 3, v1
    v_add_u32 v10, s61, v10
    v_and_b32 v11, 7, v1
    s_and_b32 s64, s2, 7
    s_mul_i32 s61, s64, 768
    s_lshl_b32 s64, s64, 10
    v_min_u32 v12, 5, v11
    v_lshlrev_b32 v12, 7, v12
    v_add_u32 v12, s61, v12
    v_mul_u32_u24 v13, 0x1800, v10
    v_add_u32 v12, v12, v13
    global_load_dword v60, v12, s[52:53] nt
    v_lshlrev_b32 v10, 13, v10
    v_lshl_add_u32 v10, v11, 7, v10
    v_add_u32 v10, s64, v10
    global_load_dword v60, v10, s[38:39] nt
    buffer_load_dwordx4 a[0:3], v2, s[4:7], s59 offen offset:0 nt
    buffer_load_dwordx4 a[4:7], v2, s[4:7], s59 offen offset:128 nt
    buffer_load_dwordx4 a[8:11], v2, s[4:7], s59 offen offset:1024 nt
    buffer_load_dwordx4 a[12:15], v2, s[4:7], s59 offen offset:1152 nt
    buffer_load_dwordx4 a[16:19], v2, s[4:7], s59 offen offset:2048 nt
    buffer_load_dwordx4 a[20:23], v2, s[4:7], s59 offen offset:2176 nt
    buffer_load_dwordx4 a[24:27], v2, s[4:7], s59 offen offset:3072 nt
    buffer_load_dwordx4 a[28:31], v2, s[4:7], s59 offen offset:3200 nt
    s_add_u32 s79, s59, 4096
    s_pack_lh_b32_b16 s59, s79, s59
    s_waitcnt lgkmcnt(0)
    s_add_u32 s58, s58, 0x9e3779b9
    v_mov_b32 v4, s58
    buffer_load_dwordx4 a[32:35], v2, s[4:7], s59 offen offset:0 nt
    buffer_load_dwordx4 a[36:39], v2, s[4:7], s59 offen offset:128 nt
    buffer_load_dwordx4 a[40:43], v2, s[4:7], s59 offen offset:1024 nt
    buffer_load_dwordx4 a[44:47], v2, s[4:7], s59 offen offset:1152 nt
    buffer_load_dwordx4 a[48:51], v2, s[4:7], s59 offen offset:2048 nt
    buffer_load_dwordx4 a[52:55], v2, s[4:7], s59 offen offset:2176 nt
    buffer_load_dwordx4 a[56:59], v2, s[4:7], s59 offen offset:3072 nt
    buffer_load_dwordx4 a[60:63], v2, s[4:7], s59 offen offset:3200 nt
    s_add_u32 s79, s59, 12288
    s_pack_lh_b32_b16 s59, s79, s59
    buffer_load_dwordx4 a[64:67], v2, s[4:7], s59 offen offset:0 nt
    buffer_load_dwordx4 a[68:71], v2, s[4:7], s59 offen offset:128 nt
    buffer_load_dwordx4 a[72:75], v2, s[4:7], s59 offen offset:1024 nt
    buffer_load_dwordx4 a[76:79], v2, s[4:7], s59 offen offset:1152 nt
    buffer_load_dwordx4 a[80:83], v2, s[4:7], s59 offen offset:2048 nt
    buffer_load_dwordx4 a[84:87], v2, s[4:7], s59 offen offset:2176 nt
    buffer_load_dwordx4 a[88:91], v2, s[4:7], s59 offen offset:3072 nt
    buffer_load_dwordx4 a[92:95], v2, s[4:7], s59 offen offset:3200 nt
    s_add_u32 s79, s59, 4096
    s_pack_lh_b32_b16 s59, s79, s59
    buffer_load_dwordx4 a[96:99], v2, s[4:7], s59 offen offset:0 nt
    buffer_load_dwordx4 a[100:103], v2, s[4:7], s59 offen offset:128 nt
    buffer_load_dwordx4 a[104:107], v2, s[4:7], s59 offen offset:1024 nt
    buffer_load_dwordx4 a[108:111], v2, s[4:7], s59 offen offset:1152 nt
    buffer_load_dwordx4 a[112:115], v2, s[4:7], s59 offen offset:2048 nt
    buffer_load_dwordx4 a[116:119], v2, s[4:7], s59 offen offset:2176 nt
    buffer_load_dwordx4 a[120:123], v2, s[4:7], s59 offen offset:3072 nt
    buffer_load_dwordx4 a[124:127], v2, s[4:7], s59 offen offset:3200 nt
    s_add_u32 s79, s59, 12288
    s_pack_lh_b32_b16 s59, s79, s59
    buffer_load_dwordx4 a[128:131], v2, s[4:7], s59 offen offset:0 nt
    buffer_load_dwordx4 a[132:135], v2, s[4:7], s59 offen offset:128 nt
    buffer_load_dwordx4 a[136:139], v2, s[4:7], s59 offen offset:1024 nt
    buffer_load_dwordx4 a[140:143], v2, s[4:7], s59 offen offset:1152 nt
    buffer_load_dwordx4 a[144:147], v2, s[4:7], s59 offen offset:2048 nt
    buffer_load_dwordx4 a[148:151], v2, s[4:7], s59 offen offset:2176 nt
    buffer_load_dwordx4 a[152:155], v2, s[4:7], s59 offen offset:3072 nt
    buffer_load_dwordx4 a[156:159], v2, s[4:7], s59 offen offset:3200 nt
    s_add_u32 s79, s59, 4096
    s_pack_lh_b32_b16 s59, s79, s59
    buffer_load_dwordx4 a[160:163], v2, s[4:7], s59 offen offset:0 nt
    buffer_load_dwordx4 a[164:167], v2, s[4:7], s59 offen offset:128 nt
    buffer_load_dwordx4 a[168:171], v2, s[4:7], s59 offen offset:1024 nt
    buffer_load_dwordx4 a[172:175], v2, s[4:7], s59 offen offset:1152 nt
    buffer_load_dwordx4 a[176:179], v2, s[4:7], s59 offen offset:2048 nt
    buffer_load_dwordx4 a[180:183], v2, s[4:7], s59 offen offset:2176 nt
    buffer_load_dwordx4 a[184:187], v2, s[4:7], s59 offen offset:3072 nt
    buffer_load_dwordx4 a[188:191], v2, s[4:7], s59 offen offset:3200 nt
    s_add_u32 s79, s59, 12288
    s_pack_lh_b32_b16 s59, s79, s59
    buffer_load_dwordx4 a[192:195], v2, s[4:7], s59 offen offset:0 nt
    buffer_load_dwordx4 a[196:199], v2, s[4:7], s59 offen offset:128 nt
    buffer_load_dwordx4 a[200:203], v2, s[4:7], s59 offen offset:1024 nt
    buffer_load_dwordx4 a[204:207], v2, s[4:7], s59 offen offset:1152 nt
    buffer_load_dwordx4 a[208:211], v2, s[4:7], s59 offen offset:2048 nt
    buffer_load_dwordx4 a[212:215], v2, s[4:7], s59 offen offset:2176 nt
    buffer_load_dwordx4 a[216:219], v2, s[4:7], s59 offen offset:3072 nt
    buffer_load_dwordx4 a[220:223], v2, s[4:7], s59 offen offset:3200 nt
    s_add_u32 s79, s59, 4096
    s_pack_lh_b32_b16 s59, s79, s59
    buffer_load_dwordx4 a[224:227], v2, s[4:7], s59 offen offset:0 nt
    buffer_load_dwordx4 a[228:231], v2, s[4:7], s59 offen offset:128 nt
    buffer_load_dwordx4 a[232:235], v2, s[4:7], s59 offen offset:1024 nt
    buffer_load_dwordx4 a[236:239], v2, s[4:7], s59 offen offset:1152 nt
    buffer_load_dwordx4 a[240:243], v2, s[4:7], s59 offen offset:2048 nt
    buffer_load_dwordx4 a[244:247], v2, s[4:7], s59 offen offset:2176 nt
    buffer_load_dwordx4 a[248:251], v2, s[4:7], s59 offen offset:3072 nt
    buffer_load_dwordx4 a[252:255], v2, s[4:7], s59 offen offset:3200 nt
    s_add_u32 s79, s59, 12288
    s_pack_lh_b32_b16 s59, s79, s59
    v_and_b32 v10, 3, v1
    v_lshlrev_b32 v10, 9, v10
    v_lshrrev_b32 v11, 4, v1
    v_lshl_add_u32 v10, v11, 5, v10
    v_bfe_u32 v11, v1, 2, 1
    v_lshl_add_u32 v10, v11, 7, v10
    s_lshr_b32 s61, s2, 3
    s_lshl_b32 s61, s61, 11
    v_add_u32 v6, s61, v10
    s_mov_b32 s61, 0x10000
    buffer_load_dwordx4 v[224:227], v6, s[12:15], s61 offen offset:0 sc1
    s_mov_b32 s61, 0x10000
    buffer_load_dwordx4 v[228:231], v6, s[12:15], s61 offen offset:16 sc1
    s_mov_b32 s61, 0x10000
    buffer_load_dwordx4 v[232:235], v6, s[12:15], s61 offen offset:256 sc1
    s_mov_b32 s61, 0x10000
    buffer_load_dwordx4 v[236:239], v6, s[12:15], s61 offen offset:272 sc1
    buffer_load_dwordx4 v[64:67], v3, s[8:11], s60 offen offset:0 nt
    buffer_load_dwordx4 v[68:71], v3, s[8:11], s60 offen offset:1024 nt
    buffer_load_dwordx4 v[72:75], v3, s[8:11], s60 offen offset:2048 nt
    buffer_load_dwordx4 v[76:79], v3, s[8:11], s60 offen offset:3072 nt
    s_add_u32 s79, s60, 4096
    s_pack_lh_b32_b16 s60, s79, s60
    buffer_load_dwordx4 v[80:83], v3, s[8:11], s60 offen offset:0 nt
    buffer_load_dwordx4 v[84:87], v3, s[8:11], s60 offen offset:1024 nt
    buffer_load_dwordx4 v[88:91], v3, s[8:11], s60 offen offset:2048 nt
    buffer_load_dwordx4 v[92:95], v3, s[8:11], s60 offen offset:3072 nt
    s_add_u32 s79, s60, 4096
    s_pack_lh_b32_b16 s60, s79, s60
    s_mov_b32 s61, 0x10000
    buffer_load_dwordx4 v[224:227], v6, s[12:15], s61 offen offset:0 sc1
    s_mov_b32 s61, 0x10000
    buffer_load_dwordx4 v[228:231], v6, s[12:15], s61 offen offset:16 sc1
    s_mov_b32 s61, 0x10000
    buffer_load_dwordx4 v[232:235], v6, s[12:15], s61 offen offset:256 sc1
    s_mov_b32 s61, 0x10000
    buffer_load_dwordx4 v[236:239], v6, s[12:15], s61 offen offset:272 sc1
    buffer_load_dwordx4 v[96:99], v3, s[8:11], s60 offen offset:0 nt
    buffer_load_dwordx4 v[100:103], v3, s[8:11], s60 offen offset:1024 nt
    buffer_load_dwordx4 v[104:107], v3, s[8:11], s60 offen offset:2048 nt
    buffer_load_dwordx4 v[108:111], v3, s[8:11], s60 offen offset:3072 nt
    s_add_u32 s79, s60, 4096
    s_pack_lh_b32_b16 s60, s79, s60
    buffer_load_dwordx4 v[112:115], v3, s[8:11], s60 offen offset:0 nt
    buffer_load_dwordx4 v[116:119], v3, s[8:11], s60 offen offset:1024 nt
    buffer_load_dwordx4 v[120:123], v3, s[8:11], s60 offen offset:2048 nt
    buffer_load_dwordx4 v[124:127], v3, s[8:11], s60 offen offset:3072 nt
    s_add_u32 s79, s60, 4096
    s_pack_lh_b32_b16 s60, s79, s60
    s_mov_b32 s61, 0x10000
    buffer_load_dwordx4 v[224:227], v6, s[12:15], s61 offen offset:0 sc1
    s_mov_b32 s61, 0x10000
    buffer_load_dwordx4 v[228:231], v6, s[12:15], s61 offen offset:16 sc1
    s_mov_b32 s61, 0x10000
    buffer_load_dwordx4 v[232:235], v6, s[12:15], s61 offen offset:256 sc1
    s_mov_b32 s61, 0x10000
    buffer_load_dwordx4 v[236:239], v6, s[12:15], s61 offen offset:272 sc1
    buffer_load_dwordx4 v[128:131], v3, s[8:11], s60 offen offset:0 nt
    buffer_load_dwordx4 v[132:135], v3, s[8:11], s60 offen offset:1024 nt
    buffer_load_dwordx4 v[136:139], v3, s[8:11], s60 offen offset:2048 nt
    buffer_load_dwordx4 v[140:143], v3, s[8:11], s60 offen offset:3072 nt
    s_add_u32 s79, s60, 4096
    s_pack_lh_b32_b16 s60, s79, s60
    buffer_load_dwordx4 v[144:147], v3, s[8:11], s60 offen offset:0 nt
    buffer_load_dwordx4 v[148:151], v3, s[8:11], s60 offen offset:1024 nt
    buffer_load_dwordx4 v[152:155], v3, s[8:11], s60 offen offset:2048 nt
    buffer_load_dwordx4 v[156:159], v3, s[8:11], s60 offen offset:3072 nt
    s_add_u32 s79, s60, 4096
    s_pack_lh_b32_b16 s60, s79, s60
    s_waitcnt vmcnt(32)
    v_mov_b32 v48, v224
    v_mov_b32 v49, v225
    v_mov_b32 v50, v226
    v_mov_b32 v51, v227
    v_mov_b32 v52, v228
    v_mov_b32 v53, v229
    v_mov_b32 v54, v230
    v_mov_b32 v55, v231
    v_mov_b32 v56, v232
    v_mov_b32 v57, v233
    v_mov_b32 v58, v234
    v_mov_b32 v59, v235
    v_mov_b32 v60, v236
    v_mov_b32 v61, v237
    v_mov_b32 v62, v238
    v_mov_b32 v63, v239
    v_xor_b32 v10, s58, v48
    v_bitop3_b32 v10, v49, s58, v10 bitop3:0xbe
    v_bitop3_b32 v10, v50, s58, v10 bitop3:0xbe
    v_bitop3_b32 v10, v51, s58, v10 bitop3:0xbe
    v_bitop3_b32 v10, v52, s58, v10 bitop3:0xbe
    v_bitop3_b32 v10, v53, s58, v10 bitop3:0xbe
    v_bitop3_b32 v10, v54, s58, v10 bitop3:0xbe
    v_bitop3_b32 v10, v55, s58, v10 bitop3:0xbe
    v_bitop3_b32 v10, v56, s58, v10 bitop3:0xbe
    v_bitop3_b32 v10, v57, s58, v10 bitop3:0xbe
    v_bitop3_b32 v10, v58, s58, v10 bitop3:0xbe
    v_bitop3_b32 v10, v59, s58, v10 bitop3:0xbe
    v_bitop3_b32 v10, v60, s58, v10 bitop3:0xbe
    v_bitop3_b32 v10, v61, s58, v10 bitop3:0xbe
    v_bitop3_b32 v10, v62, s58, v10 bitop3:0xbe
    v_bitop3_b32 v10, v63, s58, v10 bitop3:0xbe
    v_and_b32 v10, 0xff, v10
    v_cmp_ne_u32 vcc, 0, v10
    s_cbranch_vccz QGO_F
    s_waitcnt vmcnt(20)
    v_mov_b32 v48, v224
    v_mov_b32 v49, v225
    v_mov_b32 v50, v226
    v_mov_b32 v51, v227
    v_mov_b32 v52, v228
    v_mov_b32 v53, v229
    v_mov_b32 v54, v230
    v_mov_b32 v55, v231
    v_mov_b32 v56, v232
    v_mov_b32 v57, v233
    v_mov_b32 v58, v234
    v_mov_b32 v59, v235
    v_mov_b32 v60, v236
    v_mov_b32 v61, v237
    v_mov_b32 v62, v238
    v_mov_b32 v63, v239
    v_xor_b32 v10, s58, v48
    v_bitop3_b32 v10, v49, s58, v10 bitop3:0xbe
    v_bitop3_b32 v10, v50, s58, v10 bitop3:0xbe
    v_bitop3_b32 v10, v51, s58, v10 bitop3:0xbe
    v_bitop3_b32 v10, v52, s58, v10 bitop3:0xbe
    v_bitop3_b32 v10, v53, s58, v10 bitop3:0xbe
    v_bitop3_b32 v10, v54, s58, v10 bitop3:0xbe
    v_bitop3_b32 v10, v55, s58, v10 bitop3:0xbe
    v_bitop3_b32 v10, v56, s58, v10 bitop3:0xbe
    v_bitop3_b32 v10, v57, s58, v10 bitop3:0xbe
    v_bitop3_b32 v10, v58, s58, v10 bitop3:0xbe
    v_bitop3_b32 v10, v59, s58, v10 bitop3:0xbe
    v_bitop3_b32 v10, v60, s58, v10 bitop3:0xbe
    v_bitop3_b32 v10, v61, s58, v10 bitop3:0xbe
    v_bitop3_b32 v10, v62, s58, v10 bitop3:0xbe
    v_bitop3_b32 v10, v63, s58, v10 bitop3:0xbe
    v_and_b32 v10, 0xff, v10
    v_cmp_ne_u32 vcc, 0, v10
    s_cbranch_vccz QGO_F
    s_waitcnt vmcnt(8)
    v_mov_b32 v48, v224
    v_mov_b32 v49, v225
    v_mov_b32 v50, v226
    v_mov_b32 v51, v227
    v_mov_b32 v52, v228
    v_mov_b32 v53, v229
    v_mov_b32 v54, v230
    v_mov_b32 v55, v231
    v_mov_b32 v56, v232
    v_mov_b32 v57, v233
    v_mov_b32 v58, v234
    v_mov_b32 v59, v235
    v_mov_b32 v60, v236
    v_mov_b32 v61, v237
    v_mov_b32 v62, v238
    v_mov_b32 v63, v239
    v_xor_b32 v10, s58, v48
    v_bitop3_b32 v10, v49, s58, v10 bitop3:0xbe
    v_bitop3_b32 v10, v50, s58, v10 bitop3:0xbe
    v_bitop3_b32 v10, v51, s58, v10 bitop3:0xbe
    v_bitop3_b32 v10, v52, s58, v10 bitop3:0xbe
    v_bitop3_b32 v10, v53, s58, v10 bitop3:0xbe
    v_bitop3_b32 v10, v54, s58, v10 bitop3:0xbe
    v_bitop3_b32 v10, v55, s58, v10 bitop3:0xbe
    v_bitop3_b32 v10, v56, s58, v10 bitop3:0xbe
    v_bitop3_b32 v10, v57, s58, v10 bitop3:0xbe
    v_bitop3_b32 v10, v58, s58, v10 bitop3:0xbe
    v_bitop3_b32 v10, v59, s58, v10 bitop3:0xbe
    v_bitop3_b32 v10, v60, s58, v10 bitop3:0xbe
    v_bitop3_b32 v10, v61, s58, v10 bitop3:0xbe
    v_bitop3_b32 v10, v62, s58, v10 bitop3:0xbe
    v_bitop3_b32 v10, v63, s58, v10 bitop3:0xbe
    v_and_b32 v10, 0xff, v10
    v_cmp_ne_u32 vcc, 0, v10
    s_cbranch_vccz QGO_F
    s_mov_b32 s62, 0x40000
QRX_F:
    s_mov_b32 s61, 0x10000
    buffer_load_dwordx4 v[224:227], v6, s[12:15], s61 offen offset:0 sc1
    s_mov_b32 s61, 0x10000
    buffer_load_dwordx4 v[228:231], v6, s[12:15], s61 offen offset:16 sc1
    s_mov_b32 s61, 0x10000
    buffer_load_dwordx4 v[232:235], v6, s[12:15], s61 offen offset:256 sc1
    s_mov_b32 s61, 0x10000
    buffer_load_dwordx4 v[236:239], v6, s[12:15], s61 offen offset:272 sc1
    s_waitcnt vmcnt(0)
    v_mov_b32 v48, v224
    v_mov_b32 v49, v225
    v_mov_b32 v50, v226
    v_mov_b32 v51, v227
    v_mov_b32 v52, v228
    v_mov_b32 v53, v229
    v_mov_b32 v54, v230
    v_mov_b32 v55, v231
    v_mov_b32 v56, v232
    v_mov_b32 v57, v233
    v_mov_b32 v58, v234
    v_mov_b32 v59, v235
    v_mov_b32 v60, v236
    v_mov_b32 v61, v237
    v_mov_b32 v62, v238
    v_mov_b32 v63, v239
    v_xor_b32 v10, s58, v48
    v_bitop3_b32 v10, v49, s58, v10 bitop3:0xbe
    v_bitop3_b32 v10, v50, s58, v10 bitop3:0xbe
    v_bitop3_b32 v10, v51, s58, v10 bitop3:0xbe
    v_bitop3_b32 v10, v52, s58, v10 bitop3:0xbe
    v_bitop3_b32 v10, v53, s58, v10 bitop3:0xbe
    v_bitop3_b32 v10, v54, s58, v10 bitop3:0xbe
    v_bitop3_b32 v10, v55, s58, v10 bitop3:0xbe
    v_bitop3_b32 v10, v56, s58, v10 bitop3:0xbe
    v_bitop3_b32 v10, v57, s58, v10 bitop3:0xbe
    v_bitop3_b32 v10, v58, s58, v10 bitop3:0xbe
    v_bitop3_b32 v10, v59, s58, v10 bitop3:0xbe
    v_bitop3_b32 v10, v60, s58, v10 bitop3:0xbe
    v_bitop3_b32 v10, v61, s58, v10 bitop3:0xbe
    v_bitop3_b32 v10, v62, s58, v10 bitop3:0xbe
    v_bitop3_b32 v10, v63, s58, v10 bitop3:0xbe
    v_and_b32 v10, 0xff, v10
    v_cmp_ne_u32 vcc, 0, v10
    s_cbranch_vccz QGO_F
    s_sub_u32 s62, s62, 1
    s_cbranch_scc0 QRX_F
QGO_F:
    buffer_load_dwordx4 v[224:227], v3, s[8:11], s60 offen offset:0 nt
    v_perm_b32 v16, v49, v48, s68
    v_perm_b32 v17, v51, v50, s68
    v_perm_b32 v18, v53, v52, s68
    v_perm_b32 v19, v55, v54, s68
    v_perm_b32 v20, v57, v56, s68
    v_perm_b32 v21, v59, v58, s68
    v_perm_b32 v22, v61, v60, s68
    buffer_load_dwordx4 v[228:231], v3, s[8:11], s60 offen offset:1024 nt
    v_perm_b32 v23, v63, v62, s68
    v_cndmask_b32 v32, 0, v16, s[72:73]
    v_cndmask_b32 v33, 0, v17, s[72:73]
    v_cndmask_b32 v34, 0, v18, s[72:73]
    v_cndmask_b32 v35, 0, v19, s[72:73]
    v_cndmask_b32 v36, 0, v20, s[72:73]
    v_cndmask_b32 v37, 0, v21, s[72:73]
    v_cndmask_b32 v38, 0, v22, s[72:73]
    buffer_load_dwordx4 v[232:235], v3, s[8:11], s60 offen offset:2048 nt
    v_cndmask_b32 v39, 0, v23, s[72:73]
    v_cndmask_b32 v40, 0, v16, s[74:75]
    v_cndmask_b32 v41, 0, v17, s[74:75]
    v_cndmask_b32 v42, 0, v18, s[74:75]
    v_cndmask_b32 v43, 0, v19, s[74:75]
    v_cndmask_b32 v44, 0, v20, s[74:75]
    v_cndmask_b32 v45, 0, v21, s[74:75]
    buffer_load_dwordx4 v[236:239], v3, s[8:11], s60 offen offset:3072 nt
    v_cndmask_b32 v46, 0, v22, s[74:75]
    v_cndmask_b32 v47, 0, v23, s[74:75]
    v_mfma_f32_16x16x32_bf16 v[160:163], a[0:3], v[32:35], 0
    v_mfma_f32_16x16x32_bf16 v[164:167], a[8:11], v[32:35], 0
    v_mfma_f32_16x16x32_bf16 v[168:171], a[16:19], v[32:35], 0
    v_mfma_f32_16x16x32_bf16 v[172:175], a[24:27], v[32:35], 0
    v_mfma_f32_16x16x32_bf16 v[176:179], a[32:35], v[32:35], 0
    v_mfma_f32_16x16x32_bf16 v[180:183], a[40:43], v[32:35], 0
    s_add_u32 s79, s60, 4096
    s_pack_lh_b32_b16 s60, s79, s60
    buffer_load_dwordx4 v[240:243], v3, s[8:11], s60 offen offset:0 nt
    v_mfma_f32_16x16x32_bf16 v[184:187], a[48:51], v[32:35], 0
    v_mfma_f32_16x16x32_bf16 v[188:191], a[56:59], v[32:35], 0
    v_mfma_f32_16x16x32_bf16 v[160:163], a[4:7], v[36:39], v[160:163]
    v_mfma_f32_16x16x32_bf16 v[164:167], a[12:15], v[36:39], v[164:167]
    v_mfma_f32_16x16x32_bf16 v[168:171], a[20:23], v[36:39], v[168:171]
    v_mfma_f32_16x16x32_bf16 v[172:175], a[28:31], v[36:39], v[172:175]
    v_mfma_f32_16x16x32_bf16 v[176:179], a[36:39], v[36:39], v[176:179]
    buffer_load_dwordx4 v[244:247], v3, s[8:11], s60 offen offset:1024 nt
    v_mfma_f32_16x16x32_bf16 v[180:183], a[44:47], v[36:39], v[180:183]
    v_mfma_f32_16x16x32_bf16 v[184:187], a[52:55], v[36:39], v[184:187]
    v_mfma_f32_16x16x32_bf16 v[188:191], a[60:63], v[36:39], v[188:191]
    v_mfma_f32_16x16x32_bf16 v[160:163], a[64:67], v[40:43], v[160:163]
    v_mfma_f32_16x16x32_bf16 v[164:167], a[72:75], v[40:43], v[164:167]
    v_mfma_f32_16x16x32_bf16 v[168:171], a[80:83], v[40:43], v[168:171]
    v_mfma_f32_16x16x32_bf16 v[172:175], a[88:91], v[40:43], v[172:175]
    v_mfma_f32_16x16x32_bf16 v[176:179], a[96:99], v[40:43], v[176:179]
    buffer_load_dwordx4 v[248:251], v3, s[8:11], s60 offen offset:2048 nt
    v_mfma_f32_16x16x32_bf16 v[180:183], a[104:107], v[40:43], v[180:183]
    v_mfma_f32_16x16x32_bf16 v[184:187], a[112:115], v[40:43], v[184:187]
    v_mfma_f32_16x16x32_bf16 v[188:191], a[120:123], v[40:43], v[188:191]
    v_mfma_f32_16x16x32_bf16 v[160:163], a[68:71], v[44:47], v[160:163]
    v_mfma_f32_16x16x32_bf16 v[164:167], a[76:79], v[44:47], v[164:167]
    v_mfma_f32_16x16x32_bf16 v[168:171], a[84:87], v[44:47], v[168:171]
    v_mfma_f32_16x16x32_bf16 v[172:175], a[92:95], v[44:47], v[172:175]
    buffer_load_dwordx4 v[252:255], v3, s[8:11], s60 offen offset:3072 nt
    s_add_u32 s79, s60, 4096
    s_pack_lh_b32_b16 s60, s79, s60
    v_mfma_f32_16x16x32_bf16 v[176:179], a[100:103], v[44:47], v[176:179]
    v_mfma_f32_16x16x32_bf16 v[180:183], a[108:111], v[44:47], v[180:183]
    v_mfma_f32_16x16x32_bf16 v[184:187], a[116:119], v[44:47], v[184:187]
    v_mfma_f32_16x16x32_bf16 v[188:191], a[124:127], v[44:47], v[188:191]
    v_mfma_f32_16x16x32_bf16 v[192:195], a[128:131], v[32:35], 0
    v_mfma_f32_16x16x32_bf16 v[196:199], a[136:139], v[32:35], 0
    v_mfma_f32_16x16x32_bf16 v[200:203], a[144:147], v[32:35], 0
    v_mfma_f32_16x16x32_bf16 v[204:207], a[152:155], v[32:35], 0
    v_mfma_f32_16x16x32_bf16 v[208:211], a[160:163], v[32:35], 0
    v_mfma_f32_16x16x32_bf16 v[212:215], a[168:171], v[32:35], 0
    v_mfma_f32_16x16x32_bf16 v[216:219], a[176:179], v[32:35], 0
    v_mfma_f32_16x16x32_bf16 v[220:223], a[184:187], v[32:35], 0
    v_mfma_f32_16x16x32_bf16 v[192:195], a[132:135], v[36:39], v[192:195]
    v_mfma_f32_16x16x32_bf16 v[196:199], a[140:143], v[36:39], v[196:199]
    v_mfma_f32_16x16x32_bf16 v[200:203], a[148:151], v[36:39], v[200:203]
    v_mfma_f32_16x16x32_bf16 v[204:207], a[156:159], v[36:39], v[204:207]
    v_mfma_f32_16x16x32_bf16 v[208:211], a[164:167], v[36:39], v[208:211]
    v_mfma_f32_16x16x32_bf16 v[212:215], a[172:175], v[36:39], v[212:215]
    v_mfma_f32_16x16x32_bf16 v[216:219], a[180:183], v[36:39], v[216:219]
    v_mfma_f32_16x16x32_bf16 v[220:223], a[188:191], v[36:39], v[220:223]
    v_mfma_f32_16x16x32_bf16 v[192:195], a[192:195], v[40:43], v[192:195]
    v_mfma_f32_16x16x32_bf16 v[196:199], a[200:203], v[40:43], v[196:199]
    v_mfma_f32_16x16x32_bf16 v[200:203], a[208:211], v[40:43], v[200:203]
    v_mfma_f32_16x16x32_bf16 v[204:207], a[216:219], v[40:43], v[204:207]
    v_mfma_f32_16x16x32_bf16 v[208:211], a[224:227], v[40:43], v[208:211]
    v_mfma_f32_16x16x32_bf16 v[212:215], a[232:235], v[40:43], v[212:215]
    v_mfma_f32_16x16x32_bf16 v[216:219], a[240:243], v[40:43], v[216:219]
    v_mfma_f32_16x16x32_bf16 v[220:223], a[248:251], v[40:43], v[220:223]
    v_mfma_f32_16x16x32_bf16 v[192:195], a[196:199], v[44:47], v[192:195]
    v_mfma_f32_16x16x32_bf16 v[196:199], a[204:207], v[44:47], v[196:199]
    v_mfma_f32_16x16x32_bf16 v[200:203], a[212:215], v[44:47], v[200:203]
    v_mfma_f32_16x16x32_bf16 v[204:207], a[220:223], v[44:47], v[204:207]
    v_mfma_f32_16x16x32_bf16 v[208:211], a[228:231], v[44:47], v[208:211]
    v_mfma_f32_16x16x32_bf16 v[212:215], a[236:239], v[44:47], v[212:215]
    v_mfma_f32_16x16x32_bf16 v[216:219], a[244:247], v[44:47], v[216:219]
    v_mfma_f32_16x16x32_bf16 v[220:223], a[252:255], v[44:47], v[220:223]
    v_add_f32_dpp v48, v161, v160 row_shl:4 row_mask:0xf bank_mask:0x5
    v_add_f32_dpp v49, v165, v164 row_shl:4 row_mask:0xf bank_mask:0x5
    v_add_f32_dpp v50, v169, v168 row_shl:4 row_mask:0xf bank_mask:0x5
    v_add_f32_dpp v51, v173, v172 row_shl:4 row_mask:0xf bank_mask:0x5
    v_add_f32_dpp v52, v177, v176 row_shl:4 row_mask:0xf bank_mask:0x5
    v_add_f32_dpp v53, v181, v180 row_shl:4 row_mask:0xf bank_mask:0x5
    v_add_f32_dpp v54, v185, v184 row_shl:4 row_mask:0xf bank_mask:0x5
    v_add_f32_dpp v55, v189, v188 row_shl:4 row_mask:0xf bank_mask:0x5
    v_add_f32_dpp v56, v193, v192 row_shl:4 row_mask:0xf bank_mask:0x5
    v_add_f32_dpp v57, v197, v196 row_shl:4 row_mask:0xf bank_mask:0x5
    v_add_f32_dpp v58, v201, v200 row_shl:4 row_mask:0xf bank_mask:0x5
    v_add_f32_dpp v59, v205, v204 row_shl:4 row_mask:0xf bank_mask:0x5
    v_add_f32_dpp v60, v209, v208 row_shl:4 row_mask:0xf bank_mask:0x5
    v_add_f32_dpp v61, v213, v212 row_shl:4 row_mask:0xf bank_mask:0x5
    v_add_f32_dpp v62, v217, v216 row_shl:4 row_mask:0xf bank_mask:0x5
    v_add_f32_dpp v63, v221, v220 row_shl:4 row_mask:0xf bank_mask:0x5
    v_add_f32_dpp v48, v162, v163 row_shr:4 row_mask:0xf bank_mask:0xa
    v_add_f32_dpp v49, v166, v167 row_shr:4 row_mask:0xf bank_mask:0xa
    v_add_f32_dpp v50, v170, v171 row_shr:4 row_mask:0xf bank_mask:0xa
    v_add_f32_dpp v51, v174, v175 row_shr:4 row_mask:0xf bank_mask:0xa
    v_add_f32_dpp v52, v178, v179 row_shr:4 row_mask:0xf bank_mask:0xa
    v_add_f32_dpp v53, v182, v183 row_shr:4 row_mask:0xf bank_mask:0xa
    v_add_f32_dpp v54, v186, v187 row_shr:4 row_mask:0xf bank_mask:0xa
    v_add_f32_dpp v55, v190, v191 row_shr:4 row_mask:0xf bank_mask:0xa
    v_add_f32_dpp v56, v194, v195 row_shr:4 row_mask:0xf bank_mask:0xa
    v_add_f32_dpp v57, v198, v199 row_shr:4 row_mask:0xf bank_mask:0xa
    v_add_f32_dpp v58, v202, v203 row_shr:4 row_mask:0xf bank_mask:0xa
    v_add_f32_dpp v59, v206, v207 row_shr:4 row_mask:0xf bank_mask:0xa
    v_add_f32_dpp v60, v210, v211 row_shr:4 row_mask:0xf bank_mask:0xa
    v_add_f32_dpp v61, v214, v215 row_shr:4 row_mask:0xf bank_mask:0xa
    v_add_f32_dpp v62, v218, v219 row_shr:4 row_mask:0xf bank_mask:0xa
    v_add_f32_dpp v63, v222, v223 row_shr:4 row_mask:0xf bank_mask:0xa
    buffer_load_dwordx4 v[160:163], v3, s[8:11], s60 offen offset:0 nt
    v_cvt_pk_bf16_f32 v32, v48, v49
    v_cvt_pk_bf16_f32 v33, v50, v51
    v_cvt_pk_bf16_f32 v34, v52, v53
    v_cvt_pk_bf16_f32 v35, v54, v55
    v_cvt_pk_bf16_f32 v36, v56, v57
    v_cvt_pk_bf16_f32 v37, v58, v59
    v_cvt_pk_bf16_f32 v38, v60, v61
    v_cvt_pk_bf16_f32 v39, v62, v63
    v_lshlrev_b32 v48, 16, v32
    buffer_load_dwordx4 v[164:167], v3, s[8:11], s60 offen offset:1024 nt
    v_and_b32 v49, s66, v32
    v_lshlrev_b32 v50, 16, v33
    v_and_b32 v51, s66, v33
    v_lshlrev_b32 v52, 16, v34
    v_and_b32 v53, s66, v34
    v_lshlrev_b32 v54, 16, v35
    v_and_b32 v55, s66, v35
    v_lshlrev_b32 v56, 16, v36
    v_and_b32 v57, s66, v36
    v_lshlrev_b32 v58, 16, v37
    buffer_load_dwordx4 v[168:171], v3, s[8:11], s60 offen offset:2048 nt
    v_and_b32 v59, s66, v37
    v_lshlrev_b32 v60, 16, v38
    v_and_b32 v61, s66, v38
    v_lshlrev_b32 v62, 16, v39
    v_and_b32 v63, s66, v39
    v_mul_f32 v48, s70, v48
    v_mul_f32 v49, s70, v49
    v_mul_f32 v50, s70, v50
    v_mul_f32 v51, s70, v51
    buffer_load_dwordx4 v[172:175], v3, s[8:11], s60 offen offset:3072 nt
    v_mul_f32 v52, s70, v52
    v_mul_f32 v53, s70, v53
    v_mul_f32 v54, s70, v54
    v_mul_f32 v55, s70, v55
    v_mul_f32 v56, s70, v56
    v_mul_f32 v57, s70, v57
    v_mul_f32 v58, s70, v58
    v_mul_f32 v59, s70, v59
    v_mul_f32 v60, s70, v60
    v_mul_f32 v61, s70, v61
    s_add_u32 s79, s60, 4096
    s_pack_lh_b32_b16 s60, s79, s60
    buffer_load_dwordx4 v[176:179], v3, s[8:11], s60 offen offset:0 nt
    v_mul_f32 v62, s70, v62
    v_mul_f32 v63, s70, v63
    v_cvt_pk_bf16_f32 v32, v48, v49
    v_cvt_pk_bf16_f32 v33, v50, v51
    v_cvt_pk_bf16_f32 v34, v52, v53
    v_cvt_pk_bf16_f32 v35, v54, v55
    v_cvt_pk_bf16_f32 v36, v56, v57
    v_cvt_pk_bf16_f32 v37, v58, v59
    v_cvt_pk_bf16_f32 v38, v60, v61
    buffer_load_dwordx4 v[180:183], v3, s[8:11], s60 offen offset:1024 nt
    v_cvt_pk_bf16_f32 v39, v62, v63
    v_lshlrev_b32 v48, 16, v32
    v_and_b32 v49, s66, v32
    v_lshlrev_b32 v50, 16, v33
    v_and_b32 v51, s66, v33
    v_lshlrev_b32 v52, 16, v34
    v_and_b32 v53, s66, v34
    v_lshlrev_b32 v54, 16, v35
    v_and_b32 v55, s66, v35
    v_lshlrev_b32 v56, 16, v36
    buffer_load_dwordx4 v[184:187], v3, s[8:11], s60 offen offset:2048 nt
    v_and_b32 v57, s66, v36
    v_lshlrev_b32 v58, 16, v37
    v_and_b32 v59, s66, v37
    v_lshlrev_b32 v60, 16, v38
    v_and_b32 v61, s66, v38
    v_lshlrev_b32 v62, 16, v39
    v_and_b32 v63, s66, v39
    v_max3_f32 v9, v48, v49, v50
    v_max3_f32 v9, v9, v51, v52
    buffer_load_dwordx4 v[188:191], v3, s[8:11], s60 offen offset:3072 nt
    v_max3_f32 v9, v9, v53, v54
    v_max3_f32 v9, v9, v55, v56
    v_max3_f32 v9, v9, v57, v58
    v_max3_f32 v9, v9, v59, v60
    v_max3_f32 v9, v9, v61, v62
    v_max_f32 v9, v9, v63
    s_nop 1
    v_max_f32_dpp v9, v9, v9 row_ror:4 row_mask:0xf bank_mask:0xf
    s_nop 1
    v_max_f32_dpp v9, v9, v9 row_ror:8 row_mask:0xf bank_mask:0xf
    v_mov_b32 v10, v9
    s_nop 1
    v_permlane16_swap_b32 v9, v10
    s_add_u32 s79, s60, 4096
    s_pack_lh_b32_b16 s60, s79, s60
    buffer_load_dwordx4 v[192:195], v3, s[8:11], s60 offen offset:0 nt
    v_max_f32 v9, v9, v10
    v_mov_b32 v10, v9
    s_nop 1
    v_permlane32_swap_b32 v9, v10
    v_max_f32 v9, v9, v10
    v_mul_f32 v11, s69, v9
    v_fma_f32 v48, v48, s69, -v11
    v_fma_f32 v49, v49, s69, -v11
    v_fma_f32 v50, v50, s69, -v11
    v_fma_f32 v51, v51, s69, -v11
    buffer_load_dwordx4 v[196:199], v3, s[8:11], s60 offen offset:1024 nt
    v_fma_f32 v52, v52, s69, -v11
    v_fma_f32 v53, v53, s69, -v11
    v_fma_f32 v54, v54, s69, -v11
    v_fma_f32 v55, v55, s69, -v11
    v_fma_f32 v56, v56, s69, -v11
    v_fma_f32 v57, v57, s69, -v11
    v_fma_f32 v58, v58, s69, -v11
    v_fma_f32 v59, v59, s69, -v11
    v_fma_f32 v60, v60, s69, -v11
    v_fma_f32 v61, v61, s69, -v11
    buffer_load_dwordx4 v[200:203], v3, s[8:11], s60 offen offset:2048 nt
    v_fma_f32 v62, v62, s69, -v11
    v_fma_f32 v63, v63, s69, -v11
    v_exp_f32 v48, v48
    v_exp_f32 v49, v49
    v_exp_f32 v50, v50
    v_exp_f32 v51, v51
    v_exp_f32 v52, v52
    v_exp_f32 v53, v53
    v_exp_f32 v54, v54
    buffer_load_dwordx4 v[204:207], v3, s[8:11], s60 offen offset:3072 nt
    v_exp_f32 v55, v55
    v_exp_f32 v56, v56
    v_exp_f32 v57, v57
    v_exp_f32 v58, v58
    v_exp_f32 v59, v59
    v_exp_f32 v60, v60
    v_exp_f32 v61, v61
    v_exp_f32 v62, v62
    v_exp_f32 v63, v63
    v_add_f32 v13, v48, v49
    s_add_u32 s79, s60, 4096
    s_pack_lh_b32_b16 s60, s79, s60
    buffer_load_dwordx4 v[208:211], v3, s[8:11], s60 offen offset:0 nt
    v_add_f32 v13, v13, v50
    v_add_f32 v13, v13, v51
    v_add_f32 v13, v13, v52
    v_add_f32 v13, v13, v53
    v_add_f32 v13, v13, v54
    v_add_f32 v13, v13, v55
    v_add_f32 v13, v13, v56
    v_add_f32 v13, v13, v57
    v_add_f32 v13, v13, v58
    buffer_load_dwordx4 v[212:215], v3, s[8:11], s60 offen offset:1024 nt
    v_add_f32 v13, v13, v59
    v_add_f32 v13, v13, v60
    v_add_f32 v13, v13, v61
    v_add_f32 v13, v13, v62
    v_add_f32 v13, v13, v63
    v_cvt_pk_bf16_f32 v16, v48, v49
    v_cvt_pk_bf16_f32 v17, v50, v51
    v_cvt_pk_bf16_f32 v18, v52, v53
    v_cvt_pk_bf16_f32 v19, v54, v55
    v_cvt_pk_bf16_f32 v20, v56, v57
    buffer_load_dwordx4 v[216:219], v3, s[8:11], s60 offen offset:2048 nt
    v_cvt_pk_bf16_f32 v21, v58, v59
    v_cvt_pk_bf16_f32 v22, v60, v61
    v_cvt_pk_bf16_f32 v23, v62, v63
    v_add_f32_dpp v13, v13, v13 row_ror:4 row_mask:0xf bank_mask:0xf
    s_nop 1
    v_add_f32_dpp v13, v13, v13 row_ror:8 row_mask:0xf bank_mask:0xf
    v_mov_b32 v10, v13
    s_nop 1
    v_permlane16_swap_b32 v13, v10
    v_add_f32 v13, v13, v10
    v_mov_b32 v10, v13
    buffer_load_dwordx4 v[220:223], v3, s[8:11], s60 offen offset:3072 nt
    s_add_u32 s79, s60, 4096
    s_pack_lh_b32_b16 s60, s79, s60
    v_permlane32_swap_b32 v13, v10
    v_add_f32 v13, v13, v10
    v_mov_b32 v12, v9
    v_mov_b32 v14, s58
    v_mov_b32 v15, s58
    s_lshl_b32 s64, s2, 8
    s_lshl_b32 s61, s3, 6
    s_add_u32 s64, s64, s61
    v_lshlrev_b32 v10, 4, v1
    v_add_u32 v6, s64, v10
    s_mov_b64 exec, 0xf
    s_mov_b32 s61, 0x20000
    buffer_store_dwordx4 v[12:15], v6, s[12:15], s61 offen offset:0 sc1
    s_mov_b64 exec, -1
    v_mov_b32 v24, 0
    v_mov_b32 v25, 0
    v_mov_b32 v26, 0
    v_mov_b32 v27, 0
    v_mov_b32 v28, 0
    v_mov_b32 v29, 0
    v_mov_b32 v30, 0
    v_mov_b32 v31, 0
    v_mov_b32 v40, 0
    v_mov_b32 v41, 0
    v_mov_b32 v42, 0
    v_mov_b32 v43, 0
    v_mov_b32 v44, 0
    v_mov_b32 v45, 0
    v_mov_b32 v46, 0
    v_mov_b32 v47, 0
    s_lshr_b32 s61, s2, 3
    s_lshl_b32 s61, s61, 11
    v_lshlrev_b32 v10, 4, v1
    v_add_u32 v6, s61, v10
    v_lshrrev_b32 v10, 4, v1
    v_add_u32 v10, v10, v1
    v_and_b32 v10, 3, v10
    v_and_b32 v11, 60, v1
    v_or_b32 v10, v10, v11
    v_lshlrev_b32 v10, 4, v10
    s_lshl_b32 s61, s3, 11
    v_add_u32 v8, s61, v10
    v_bfe_u32 v11, v0, 5, 2
    v_lshlrev_b32 v15, 4, v11
    v_bfe_u32 v10, v0, 3, 2
    v_add_u32 v11, v11, v10
    v_and_b32 v11, 3, v11
    v_lshlrev_b32 v11, 4, v11
    v_lshl_add_u32 v11, v10, 8, v11
    v_and_b32 v10, 3, v0
    v_lshl_add_u32 v11, v10, 6, v11
    v_bfe_u32 v10, v0, 2, 1
    v_lshl_add_u32 v2, v10, 10, v11
    v_and_b32 v10, 0x60, v0
    v_bfe_u32 v11, v0, 1, 4
    v_or_b32 v10, v10, v11
    v_and_b32 v11, 1, v0
    v_lshl_or_b32 v10, v11, 4, v10
    v_lshlrev_b32 v10, 4, v10
    s_lshl_b32 s64, s2, 11
    v_add_u32 v14, s64, v10
    v_mov_b32_dpp v24, v16 quad_perm:[0,1,2,3] row_mask:0xf bank_mask:0x1
    v_mov_b32_dpp v25, v17 quad_perm:[0,1,2,3] row_mask:0xf bank_mask:0x1
    v_mov_b32_dpp v26, v18 quad_perm:[0,1,2,3] row_mask:0xf bank_mask:0x1
    v_mov_b32_dpp v27, v19 quad_perm:[0,1,2,3] row_mask:0xf bank_mask:0x1
    v_mov_b32_dpp v28, v16 row_ror:4 row_mask:0xf bank_mask:0x2
    v_mov_b32_dpp v29, v17 row_ror:4 row_mask:0xf bank_mask:0x2
    v_mov_b32_dpp v30, v18 row_ror:4 row_mask:0xf bank_mask:0x2
    v_mov_b32_dpp v31, v19 row_ror:4 row_mask:0xf bank_mask:0x2
    v_mov_b32_dpp v40, v16 row_ror:8 row_mask:0xf bank_mask:0x4
    v_mov_b32_dpp v41, v17 row_ror:8 row_mask:0xf bank_mask:0x4
    v_mov_b32_dpp v42, v18 row_ror:8 row_mask:0xf bank_mask:0x4
    v_mov_b32_dpp v43, v19 row_ror:8 row_mask:0xf bank_mask:0x4
    v_mov_b32_dpp v44, v16 row_ror:12 row_mask:0xf bank_mask:0x8
    v_mov_b32_dpp v45, v17 row_ror:12 row_mask:0xf bank_mask:0x8
    v_mov_b32_dpp v46, v18 row_ror:12 row_mask:0xf bank_mask:0x8
    v_mov_b32_dpp v47, v19 row_ror:12 row_mask:0xf bank_mask:0x8
    s_waitcnt vmcnt(49)
    v_perm_b32 v32, v68, v64, s67
    v_perm_b32 v33, v76, v72, s67
    v_perm_b32 v34, v84, v80, s67
    v_perm_b32 v35, v92, v88, s67
    v_perm_b32 v36, v70, v66, s67
    v_perm_b32 v37, v78, v74, s67
    v_perm_b32 v38, v86, v82, s67
    v_perm_b32 v39, v94, v90, s67
    v_mfma_f32_16x16x32_bf16 a[0:3], v[32:35], v[24:27], 0
    v_perm_b32 v32, v68, v64, s68
    v_perm_b32 v33, v76, v72, s68
    v_perm_b32 v34, v84, v80, s68
    v_perm_b32 v35, v92, v88, s68
    v_mfma_f32_16x16x32_bf16 a[4:7], v[36:39], v[24:27], 0
    v_perm_b32 v36, v70, v66, s68
    v_perm_b32 v37, v78, v74, s68
    v_perm_b32 v38, v86, v82, s68
    v_perm_b32 v39, v94, v90, s68
    v_mfma_f32_16x16x32_bf16 a[0:3], v[32:35], v[28:31], a[0:3]
    v_perm_b32 v32, v69, v65, s67
    v_perm_b32 v33, v77, v73, s67
    v_perm_b32 v34, v85, v81, s67
    v_perm_b32 v35, v93, v89, s67
    v_mfma_f32_16x16x32_bf16 a[4:7], v[36:39], v[28:31], a[4:7]
    v_perm_b32 v36, v71, v67, s67
    v_perm_b32 v37, v79, v75, s67
    v_perm_b32 v38, v87, v83, s67
    v_perm_b32 v39, v95, v91, s67
    v_mfma_f32_16x16x32_bf16 a[0:3], v[32:35], v[40:43], a[0:3]
    v_perm_b32 v32, v69, v65, s68
    v_perm_b32 v33, v77, v73, s68
    v_perm_b32 v34, v85, v81, s68
    v_perm_b32 v35, v93, v89, s68
    v_mfma_f32_16x16x32_bf16 a[4:7], v[36:39], v[40:43], a[4:7]
    v_perm_b32 v36, v71, v67, s68
    v_perm_b32 v37, v79, v75, s68
    v_perm_b32 v38, v87, v83, s68
    v_perm_b32 v39, v95, v91, s68
    v_mfma_f32_16x16x32_bf16 a[0:3], v[32:35], v[44:47], a[0:3]
    s_nop 0
    v_mfma_f32_16x16x32_bf16 a[4:7], v[36:39], v[44:47], a[4:7]
    v_mov_b32_dpp v24, v16 row_ror:12 row_mask:0xf bank_mask:0x1
    v_mov_b32_dpp v25, v17 row_ror:12 row_mask:0xf bank_mask:0x1
    v_mov_b32_dpp v26, v18 row_ror:12 row_mask:0xf bank_mask:0x1
    v_mov_b32_dpp v27, v19 row_ror:12 row_mask:0xf bank_mask:0x1
    v_mov_b32_dpp v28, v16 quad_perm:[0,1,2,3] row_mask:0xf bank_mask:0x2
    v_mov_b32_dpp v29, v17 quad_perm:[0,1,2,3] row_mask:0xf bank_mask:0x2
    v_mov_b32_dpp v30, v18 quad_perm:[0,1,2,3] row_mask:0xf bank_mask:0x2
    v_mov_b32_dpp v31, v19 quad_perm:[0,1,2,3] row_mask:0xf bank_mask:0x2
    v_mov_b32_dpp v40, v16 row_ror:4 row_mask:0xf bank_mask:0x4
    v_mov_b32_dpp v41, v17 row_ror:4 row_mask:0xf bank_mask:0x4
    v_mov_b32_dpp v42, v18 row_ror:4 row_mask:0xf bank_mask:0x4
    v_mov_b32_dpp v43, v19 row_ror:4 row_mask:0xf bank_mask:0x4
    v_mov_b32_dpp v44, v16 row_ror:8 row_mask:0xf bank_mask:0x8
    v_mov_b32_dpp v45, v17 row_ror:8 row_mask:0xf bank_mask:0x8
    v_mov_b32_dpp v46, v18 row_ror:8 row_mask:0xf bank_mask:0x8
    v_mov_b32_dpp v47, v19 row_ror:8 row_mask:0xf bank_mask:0x8
    s_waitcnt vmcnt(37)
    buffer_load_dwordx4 v[64:67], v3, s[8:11], s60 offen offset:0 nt
    v_perm_b32 v32, v100, v96, s67
    v_perm_b32 v33, v108, v104, s67
    v_perm_b32 v34, v116, v112, s67
    v_perm_b32 v35, v124, v120, s67
    v_perm_b32 v36, v102, v98, s67
    buffer_load_dwordx4 v[68:71], v3, s[8:11], s60 offen offset:1024 nt
    v_perm_b32 v37, v110, v106, s67
    v_perm_b32 v38, v118, v114, s67
    v_perm_b32 v39, v126, v122, s67
    v_mfma_f32_16x16x32_bf16 a[0:3], v[32:35], v[24:27], a[0:3]
    v_perm_b32 v32, v100, v96, s68
    buffer_load_dwordx4 v[72:75], v3, s[8:11], s60 offen offset:2048 nt
    v_perm_b32 v33, v108, v104, s68
    v_perm_b32 v34, v116, v112, s68
    v_perm_b32 v35, v124, v120, s68
    v_mfma_f32_16x16x32_bf16 a[4:7], v[36:39], v[24:27], a[4:7]
    v_perm_b32 v36, v102, v98, s68
    buffer_load_dwordx4 v[76:79], v3, s[8:11], s60 offen offset:3072 nt
    v_perm_b32 v37, v110, v106, s68
    v_perm_b32 v38, v118, v114, s68
    v_perm_b32 v39, v126, v122, s68
    v_mfma_f32_16x16x32_bf16 a[0:3], v[32:35], v[28:31], a[0:3]
    v_perm_b32 v32, v101, v97, s67
    s_add_u32 s79, s60, 4096
    s_pack_lh_b32_b16 s60, s79, s60
    buffer_load_dwordx4 v[80:83], v3, s[8:11], s60 offen offset:0 nt
    v_perm_b32 v33, v109, v105, s67
    v_perm_b32 v34, v117, v113, s67
    v_perm_b32 v35, v125, v121, s67
    v_mfma_f32_16x16x32_bf16 a[4:7], v[36:39], v[28:31], a[4:7]
    v_perm_b32 v36, v103, v99, s67
    buffer_load_dwordx4 v[84:87], v3, s[8:11], s60 offen offset:1024 nt
    v_perm_b32 v37, v111, v107, s67
    v_perm_b32 v38, v119, v115, s67
    v_perm_b32 v39, v127, v123, s67
    v_mfma_f32_16x16x32_bf16 a[0:3], v[32:35], v[40:43], a[0:3]
    v_perm_b32 v32, v101, v97, s68
    buffer_load_dwordx4 v[88:91], v3, s[8:11], s60 offen offset:2048 nt
    v_perm_b32 v33, v109, v105, s68
    v_perm_b32 v34, v117, v113, s68
    v_perm_b32 v35, v125, v121, s68
    v_mfma_f32_16x16x32_bf16 a[4:7], v[36:39], v[40:43], a[4:7]
    v_perm_b32 v36, v103, v99, s68
    buffer_load_dwordx4 v[92:95], v3, s[8:11], s60 offen offset:3072 nt
    s_add_u32 s79, s60, 4096
    s_pack_lh_b32_b16 s60, s79, s60
    v_perm_b32 v37, v111, v107, s68
    v_perm_b32 v38, v119, v115, s68
    v_perm_b32 v39, v127, v123, s68
    v_mfma_f32_16x16x32_bf16 a[0:3], v[32:35], v[44:47], a[0:3]
    s_nop 0
    v_mfma_f32_16x16x32_bf16 a[4:7], v[36:39], v[44:47], a[4:7]
    v_mov_b32_dpp v24, v16 row_ror:8 row_mask:0xf bank_mask:0x1
    v_mov_b32_dpp v25, v17 row_ror:8 row_mask:0xf bank_mask:0x1
    v_mov_b32_dpp v26, v18 row_ror:8 row_mask:0xf bank_mask:0x1
    v_mov_b32_dpp v27, v19 row_ror:8 row_mask:0xf bank_mask:0x1
    v_mov_b32_dpp v28, v16 row_ror:12 row_mask:0xf bank_mask:0x2
    v_mov_b32_dpp v29, v17 row_ror:12 row_mask:0xf bank_mask:0x2
    v_mov_b32_dpp v30, v18 row_ror:12 row_mask:0xf bank_mask:0x2
    v_mov_b32_dpp v31, v19 row_ror:12 row_mask:0xf bank_mask:0x2
    v_mov_b32_dpp v40, v16 quad_perm:[0,1,2,3] row_mask:0xf bank_mask:0x4
    v_mov_b32_dpp v41, v17 quad_perm:[0,1,2,3] row_mask:0xf bank_mask:0x4
    v_mov_b32_dpp v42, v18 quad_perm:[0,1,2,3] row_mask:0xf bank_mask:0x4
    v_mov_b32_dpp v43, v19 quad_perm:[0,1,2,3] row_mask:0xf bank_mask:0x4
    v_mov_b32_dpp v44, v16 row_ror:4 row_mask:0xf bank_mask:0x8
    v_mov_b32_dpp v45, v17 row_ror:4 row_mask:0xf bank_mask:0x8
    v_mov_b32_dpp v46, v18 row_ror:4 row_mask:0xf bank_mask:0x8
    v_mov_b32_dpp v47, v19 row_ror:4 row_mask:0xf bank_mask:0x8
    s_waitcnt vmcnt(33)
    v_perm_b32 v32, v132, v128, s67
    v_perm_b32 v33, v140, v136, s67
    v_perm_b32 v34, v148, v144, s67
    v_perm_b32 v35, v156, v152, s67
    v_perm_b32 v36, v134, v130, s67
    v_perm_b32 v37, v142, v138, s67
    v_perm_b32 v38, v150, v146, s67
    v_perm_b32 v39, v158, v154, s67
    v_mfma_f32_16x16x32_bf16 a[0:3], v[32:35], v[24:27], a[0:3]
    v_perm_b32 v32, v132, v128, s68
    v_perm_b32 v33, v140, v136, s68
    v_perm_b32 v34, v148, v144, s68
    v_perm_b32 v35, v156, v152, s68
    v_mfma_f32_16x16x32_bf16 a[4:7], v[36:39], v[24:27], a[4:7]
    v_perm_b32 v36, v134, v130, s68
    v_perm_b32 v37, v142, v138, s68
    v_perm_b32 v38, v150, v146, s68
    v_perm_b32 v39, v158, v154, s68
    v_mfma_f32_16x16x32_bf16 a[0:3], v[32:35], v[28:31], a[0:3]
    v_perm_b32 v32, v133, v129, s67
    v_perm_b32 v33, v141, v137, s67
    v_perm_b32 v34, v149, v145, s67
    v_perm_b32 v35, v157, v153, s67
    v_mfma_f32_16x16x32_bf16 a[4:7], v[36:39], v[28:31], a[4:7]
    v_perm_b32 v36, v135, v131, s67
    v_perm_b32 v37, v143, v139, s67
    v_perm_b32 v38, v151, v147, s67
    v_perm_b32 v39, v159, v155, s67
    v_mfma_f32_16x16x32_bf16 a[0:3], v[32:35], v[40:43], a[0:3]
    v_perm_b32 v32, v133, v129, s68
    v_perm_b32 v33, v141, v137, s68
    v_perm_b32 v34, v149, v145, s68
    v_perm_b32 v35, v157, v153, s68
    v_mfma_f32_16x16x32_bf16 a[4:7], v[36:39], v[40:43], a[4:7]
    v_perm_b32 v36, v135, v131, s68
    v_perm_b32 v37, v143, v139, s68
    v_perm_b32 v38, v151, v147, s68
    v_perm_b32 v39, v159, v155, s68
    v_mfma_f32_16x16x32_bf16 a[0:3], v[32:35], v[44:47], a[0:3]
    s_nop 0
    v_mfma_f32_16x16x32_bf16 a[4:7], v[36:39], v[44:47], a[4:7]
    v_mov_b32_dpp v24, v16 row_ror:4 row_mask:0xf bank_mask:0x1
    v_mov_b32_dpp v25, v17 row_ror:4 row_mask:0xf bank_mask:0x1
    v_mov_b32_dpp v26, v18 row_ror:4 row_mask:0xf bank_mask:0x1
    v_mov_b32_dpp v27, v19 row_ror:4 row_mask:0xf bank_mask:0x1
    v_mov_b32_dpp v28, v16 row_ror:8 row_mask:0xf bank_mask:0x2
    v_mov_b32_dpp v29, v17 row_ror:8 row_mask:0xf bank_mask:0x2
    v_mov_b32_dpp v30, v18 row_ror:8 row_mask:0xf bank_mask:0x2
    v_mov_b32_dpp v31, v19 row_ror:8 row_mask:0xf bank_mask:0x2
    v_mov_b32_dpp v40, v16 row_ror:12 row_mask:0xf bank_mask:0x4
    v_mov_b32_dpp v41, v17 row_ror:12 row_mask:0xf bank_mask:0x4
    v_mov_b32_dpp v42, v18 row_ror:12 row_mask:0xf bank_mask:0x4
    v_mov_b32_dpp v43, v19 row_ror:12 row_mask:0xf bank_mask:0x4
    v_mov_b32_dpp v44, v16 quad_perm:[0,1,2,3] row_mask:0xf bank_mask:0x8
    v_mov_b32_dpp v45, v17 quad_perm:[0,1,2,3] row_mask:0xf bank_mask:0x8
    v_mov_b32_dpp v46, v18 quad_perm:[0,1,2,3] row_mask:0xf bank_mask:0x8
    v_mov_b32_dpp v47, v19 quad_perm:[0,1,2,3] row_mask:0xf bank_mask:0x8
    s_waitcnt vmcnt(25)
    s_mov_b32 s61, 0x20000
    buffer_load_dwordx4 v[48:51], v6, s[12:15], s61 offen offset:0 sc1
    v_perm_b32 v32, v228, v224, s67
    v_perm_b32 v33, v236, v232, s67
    v_perm_b32 v34, v244, v240, s67
    v_perm_b32 v35, v252, v248, s67
    s_mov_b32 s61, 0x20000
    buffer_load_dwordx4 v[52:55], v6, s[12:15], s61 offen offset:1024 sc1
    v_perm_b32 v36, v230, v226, s67
    v_perm_b32 v37, v238, v234, s67
    v_perm_b32 v38, v246, v242, s67
    v_perm_b32 v39, v254, v250, s67
    buffer_load_dwordx4 v[96:99], v3, s[8:11], s60 offen offset:0 nt
    v_mfma_f32_16x16x32_bf16 a[0:3], v[32:35], v[24:27], a[0:3]
    v_perm_b32 v32, v228, v224, s68
    v_perm_b32 v33, v236, v232, s68
    v_perm_b32 v34, v244, v240, s68
    buffer_load_dwordx4 v[100:103], v3, s[8:11], s60 offen offset:1024 nt
    v_perm_b32 v35, v252, v248, s68
    v_mfma_f32_16x16x32_bf16 a[4:7], v[36:39], v[24:27], a[4:7]
    v_perm_b32 v36, v230, v226, s68
    v_perm_b32 v37, v238, v234, s68
    buffer_load_dwordx4 v[104:107], v3, s[8:11], s60 offen offset:2048 nt
    v_perm_b32 v38, v246, v242, s68
    v_perm_b32 v39, v254, v250, s68
    v_mfma_f32_16x16x32_bf16 a[0:3], v[32:35], v[28:31], a[0:3]
    v_perm_b32 v32, v229, v225, s67
    buffer_load_dwordx4 v[108:111], v3, s[8:11], s60 offen offset:3072 nt
    v_perm_b32 v33, v237, v233, s67
    v_perm_b32 v34, v245, v241, s67
    v_perm_b32 v35, v253, v249, s67
    v_mfma_f32_16x16x32_bf16 a[4:7], v[36:39], v[28:31], a[4:7]
    s_add_u32 s79, s60, 4096
    s_pack_lh_b32_b16 s60, s79, s60
    buffer_load_dwordx4 v[112:115], v3, s[8:11], s60 offen offset:0 nt
    v_perm_b32 v36, v231, v227, s67
    v_perm_b32 v37, v239, v235, s67
    v_perm_b32 v38, v247, v243, s67
    v_perm_b32 v39, v255, v251, s67
    buffer_load_dwordx4 v[116:119], v3, s[8:11], s60 offen offset:1024 nt
    v_mfma_f32_16x16x32_bf16 a[0:3], v[32:35], v[40:43], a[0:3]
    v_perm_b32 v32, v229, v225, s68
    v_perm_b32 v33, v237, v233, s68
    v_perm_b32 v34, v245, v241, s68
    buffer_load_dwordx4 v[120:123], v3, s[8:11], s60 offen offset:2048 nt
    v_perm_b32 v35, v253, v249, s68
    v_mfma_f32_16x16x32_bf16 a[4:7], v[36:39], v[40:43], a[4:7]
    v_perm_b32 v36, v231, v227, s68
    v_perm_b32 v37, v239, v235, s68
    buffer_load_dwordx4 v[124:127], v3, s[8:11], s60 offen offset:3072 nt
    s_add_u32 s79, s60, 4096
    s_pack_lh_b32_b16 s60, s79, s60
    v_perm_b32 v38, v247, v243, s68
    v_perm_b32 v39, v255, v251, s68
    v_mfma_f32_16x16x32_bf16 a[0:3], v[32:35], v[44:47], a[0:3]
    s_nop 0
    v_mfma_f32_16x16x32_bf16 a[4:7], v[36:39], v[44:47], a[4:7]
    v_mov_b32_dpp v24, v20 quad_perm:[0,1,2,3] row_mask:0xf bank_mask:0x1
    v_mov_b32_dpp v25, v21 quad_perm:[0,1,2,3] row_mask:0xf bank_mask:0x1
    v_mov_b32_dpp v26, v22 quad_perm:[0,1,2,3] row_mask:0xf bank_mask:0x1
    v_mov_b32_dpp v27, v23 quad_perm:[0,1,2,3] row_mask:0xf bank_mask:0x1
    v_mov_b32_dpp v28, v20 row_ror:4 row_mask:0xf bank_mask:0x2
    v_mov_b32_dpp v29, v21 row_ror:4 row_mask:0xf bank_mask:0x2
    v_mov_b32_dpp v30, v22 row_ror:4 row_mask:0xf bank_mask:0x2
    v_mov_b32_dpp v31, v23 row_ror:4 row_mask:0xf bank_mask:0x2
    v_mov_b32_dpp v40, v20 row_ror:8 row_mask:0xf bank_mask:0x4
    v_mov_b32_dpp v41, v21 row_ror:8 row_mask:0xf bank_mask:0x4
    v_mov_b32_dpp v42, v22 row_ror:8 row_mask:0xf bank_mask:0x4
    v_mov_b32_dpp v43, v23 row_ror:8 row_mask:0xf bank_mask:0x4
    v_mov_b32_dpp v44, v20 row_ror:12 row_mask:0xf bank_mask:0x8
    v_mov_b32_dpp v45, v21 row_ror:12 row_mask:0xf bank_mask:0x8
    v_mov_b32_dpp v46, v22 row_ror:12 row_mask:0xf bank_mask:0x8
    v_mov_b32_dpp v47, v23 row_ror:12 row_mask:0xf bank_mask:0x8
    s_waitcnt vmcnt(27)
    v_perm_b32 v32, v164, v160, s67
    v_perm_b32 v33, v172, v168, s67
    v_perm_b32 v34, v180, v176, s67
    v_perm_b32 v35, v188, v184, s67
    v_perm_b32 v36, v166, v162, s67
    v_perm_b32 v37, v174, v170, s67
    v_perm_b32 v38, v182, v178, s67
    v_perm_b32 v39, v190, v186, s67
    v_mfma_f32_16x16x32_bf16 a[0:3], v[32:35], v[24:27], a[0:3]
    v_perm_b32 v32, v164, v160, s68
    v_perm_b32 v33, v172, v168, s68
    v_perm_b32 v34, v180, v176, s68
    v_perm_b32 v35, v188, v184, s68
    v_mfma_f32_16x16x32_bf16 a[4:7], v[36:39], v[24:27], a[4:7]
    v_perm_b32 v36, v166, v162, s68
    v_perm_b32 v37, v174, v170, s68
    v_perm_b32 v38, v182, v178, s68
    v_perm_b32 v39, v190, v186, s68
    v_mfma_f32_16x16x32_bf16 a[0:3], v[32:35], v[28:31], a[0:3]
    v_perm_b32 v32, v165, v161, s67
    v_perm_b32 v33, v173, v169, s67
    v_perm_b32 v34, v181, v177, s67
    v_perm_b32 v35, v189, v185, s67
    v_mfma_f32_16x16x32_bf16 a[4:7], v[36:39], v[28:31], a[4:7]
    v_perm_b32 v36, v167, v163, s67
    v_perm_b32 v37, v175, v171, s67
    v_perm_b32 v38, v183, v179, s67
    v_perm_b32 v39, v191, v187, s67
    v_mfma_f32_16x16x32_bf16 a[0:3], v[32:35], v[40:43], a[0:3]
    v_perm_b32 v32, v165, v161, s68
    v_perm_b32 v33, v173, v169, s68
    v_perm_b32 v34, v181, v177, s68
    v_perm_b32 v35, v189, v185, s68
    v_mfma_f32_16x16x32_bf16 a[4:7], v[36:39], v[40:43], a[4:7]
    v_perm_b32 v36, v167, v163, s68
    v_perm_b32 v37, v175, v171, s68
    v_perm_b32 v38, v183, v179, s68
    v_perm_b32 v39, v191, v187, s68
    v_mfma_f32_16x16x32_bf16 a[0:3], v[32:35], v[44:47], a[0:3]
    s_nop 0
    v_mfma_f32_16x16x32_bf16 a[4:7], v[36:39], v[44:47], a[4:7]
    v_mov_b32_dpp v24, v20 row_ror:12 row_mask:0xf bank_mask:0x1
    v_mov_b32_dpp v25, v21 row_ror:12 row_mask:0xf bank_mask:0x1
    v_mov_b32_dpp v26, v22 row_ror:12 row_mask:0xf bank_mask:0x1
    v_mov_b32_dpp v27, v23 row_ror:12 row_mask:0xf bank_mask:0x1
    v_mov_b32_dpp v28, v20 quad_perm:[0,1,2,3] row_mask:0xf bank_mask:0x2
    v_mov_b32_dpp v29, v21 quad_perm:[0,1,2,3] row_mask:0xf bank_mask:0x2
    v_mov_b32_dpp v30, v22 quad_perm:[0,1,2,3] row_mask:0xf bank_mask:0x2
    v_mov_b32_dpp v31, v23 quad_perm:[0,1,2,3] row_mask:0xf bank_mask:0x2
    v_mov_b32_dpp v40, v20 row_ror:4 row_mask:0xf bank_mask:0x4
    v_mov_b32_dpp v41, v21 row_ror:4 row_mask:0xf bank_mask:0x4
    v_mov_b32_dpp v42, v22 row_ror:4 row_mask:0xf bank_mask:0x4
    v_mov_b32_dpp v43, v23 row_ror:4 row_mask:0xf bank_mask:0x4
    v_mov_b32_dpp v44, v20 row_ror:8 row_mask:0xf bank_mask:0x8
    v_mov_b32_dpp v45, v21 row_ror:8 row_mask:0xf bank_mask:0x8
    v_mov_b32_dpp v46, v22 row_ror:8 row_mask:0xf bank_mask:0x8
    v_mov_b32_dpp v47, v23 row_ror:8 row_mask:0xf bank_mask:0x8
    s_waitcnt vmcnt(19)
    v_perm_b32 v32, v196, v192, s67
    v_perm_b32 v33, v204, v200, s67
    v_perm_b32 v34, v212, v208, s67
    v_perm_b32 v35, v220, v216, s67
    v_perm_b32 v36, v198, v194, s67
    v_perm_b32 v37, v206, v202, s67
    v_perm_b32 v38, v214, v210, s67
    v_perm_b32 v39, v222, v218, s67
    v_mfma_f32_16x16x32_bf16 a[0:3], v[32:35], v[24:27], a[0:3]
    v_perm_b32 v32, v196, v192, s68
    v_perm_b32 v33, v204, v200, s68
    v_perm_b32 v34, v212, v208, s68
    v_perm_b32 v35, v220, v216, s68
    v_mfma_f32_16x16x32_bf16 a[4:7], v[36:39], v[24:27], a[4:7]
    v_perm_b32 v36, v198, v194, s68
    v_perm_b32 v37, v206, v202, s68
    v_perm_b32 v38, v214, v210, s68
    v_perm_b32 v39, v222, v218, s68
    v_mfma_f32_16x16x32_bf16 a[0:3], v[32:35], v[28:31], a[0:3]
    v_perm_b32 v32, v197, v193, s67
    v_perm_b32 v33, v205, v201, s67
    v_perm_b32 v34, v213, v209, s67
    v_perm_b32 v35, v221, v217, s67
    v_mfma_f32_16x16x32_bf16 a[4:7], v[36:39], v[28:31], a[4:7]
    v_perm_b32 v36, v199, v195, s67
    v_perm_b32 v37, v207, v203, s67
    v_perm_b32 v38, v215, v211, s67
    v_perm_b32 v39, v223, v219, s67
    v_mfma_f32_16x16x32_bf16 a[0:3], v[32:35], v[40:43], a[0:3]
    v_perm_b32 v32, v197, v193, s68
    v_perm_b32 v33, v205, v201, s68
    v_perm_b32 v34, v213, v209, s68
    v_perm_b32 v35, v221, v217, s68
    v_mfma_f32_16x16x32_bf16 a[4:7], v[36:39], v[40:43], a[4:7]
    v_perm_b32 v36, v199, v195, s68
    v_perm_b32 v37, v207, v203, s68
    v_perm_b32 v38, v215, v211, s68
    v_perm_b32 v39, v223, v219, s68
    v_mfma_f32_16x16x32_bf16 a[0:3], v[32:35], v[44:47], a[0:3]
    s_nop 0
    v_mfma_f32_16x16x32_bf16 a[4:7], v[36:39], v[44:47], a[4:7]
    s_mov_b32 s61, 0x20000
    buffer_load_dwordx4 v[56:59], v6, s[12:15], s61 offen offset:0 sc1
    s_mov_b32 s61, 0x20000
    buffer_load_dwordx4 v[60:63], v6, s[12:15], s61 offen offset:1024 sc1
    v_mov_b32_dpp v24, v20 row_ror:8 row_mask:0xf bank_mask:0x1
    v_mov_b32_dpp v25, v21 row_ror:8 row_mask:0xf bank_mask:0x1
    v_mov_b32_dpp v26, v22 row_ror:8 row_mask:0xf bank_mask:0x1
    v_mov_b32_dpp v27, v23 row_ror:8 row_mask:0xf bank_mask:0x1
    v_mov_b32_dpp v28, v20 row_ror:12 row_mask:0xf bank_mask:0x2
    v_mov_b32_dpp v29, v21 row_ror:12 row_mask:0xf bank_mask:0x2
    v_mov_b32_dpp v30, v22 row_ror:12 row_mask:0xf bank_mask:0x2
    v_mov_b32_dpp v31, v23 row_ror:12 row_mask:0xf bank_mask:0x2
    v_mov_b32_dpp v40, v20 quad_perm:[0,1,2,3] row_mask:0xf bank_mask:0x4
    v_mov_b32_dpp v41, v21 quad_perm:[0,1,2,3] row_mask:0xf bank_mask:0x4
    v_mov_b32_dpp v42, v22 quad_perm:[0,1,2,3] row_mask:0xf bank_mask:0x4
    v_mov_b32_dpp v43, v23 quad_perm:[0,1,2,3] row_mask:0xf bank_mask:0x4
    v_mov_b32_dpp v44, v20 row_ror:4 row_mask:0xf bank_mask:0x8
    v_mov_b32_dpp v45, v21 row_ror:4 row_mask:0xf bank_mask:0x8
    v_mov_b32_dpp v46, v22 row_ror:4 row_mask:0xf bank_mask:0x8
    v_mov_b32_dpp v47, v23 row_ror:4 row_mask:0xf bank_mask:0x8
    s_waitcnt vmcnt(12)
    v_perm_b32 v32, v68, v64, s67
    v_perm_b32 v33, v76, v72, s67
    v_perm_b32 v34, v84, v80, s67
    v_perm_b32 v35, v92, v88, s67
    v_perm_b32 v36, v70, v66, s67
    v_perm_b32 v37, v78, v74, s67
    v_perm_b32 v38, v86, v82, s67
    v_perm_b32 v39, v94, v90, s67
    v_mfma_f32_16x16x32_bf16 a[0:3], v[32:35], v[24:27], a[0:3]
    v_perm_b32 v32, v68, v64, s68
    v_perm_b32 v33, v76, v72, s68
    v_perm_b32 v34, v84, v80, s68
    v_perm_b32 v35, v92, v88, s68
    v_mfma_f32_16x16x32_bf16 a[4:7], v[36:39], v[24:27], a[4:7]
    v_perm_b32 v36, v70, v66, s68
    v_perm_b32 v37, v78, v74, s68
    v_perm_b32 v38, v86, v82, s68
    v_perm_b32 v39, v94, v90, s68
    v_mfma_f32_16x16x32_bf16 a[0:3], v[32:35], v[28:31], a[0:3]
    v_perm_b32 v32, v69, v65, s67
    v_perm_b32 v33, v77, v73, s67
    v_perm_b32 v34, v85, v81, s67
    v_perm_b32 v35, v93, v89, s67
    v_mfma_f32_16x16x32_bf16 a[4:7], v[36:39], v[28:31], a[4:7]
    v_perm_b32 v36, v71, v67, s67
    v_perm_b32 v37, v79, v75, s67
    v_perm_b32 v38, v87, v83, s67
    v_perm_b32 v39, v95, v91, s67
    v_mfma_f32_16x16x32_bf16 a[0:3], v[32:35], v[40:43], a[0:3]
    v_perm_b32 v32, v69, v65, s68
    v_perm_b32 v33, v77, v73, s68
    v_perm_b32 v34, v85, v81, s68
    v_perm_b32 v35, v93, v89, s68
    v_mfma_f32_16x16x32_bf16 a[4:7], v[36:39], v[40:43], a[4:7]
    v_perm_b32 v36, v71, v67, s68
    v_perm_b32 v37, v79, v75, s68
    v_perm_b32 v38, v87, v83, s68
    v_perm_b32 v39, v95, v91, s68
    v_mfma_f32_16x16x32_bf16 a[0:3], v[32:35], v[44:47], a[0:3]
    s_nop 0
    v_mfma_f32_16x16x32_bf16 a[4:7], v[36:39], v[44:47], a[4:7]
    s_waitcnt vmcnt(10)
    v_xor_b32 v10, s58, v50
    v_bitop3_b32 v10, v51, s58, v10 bitop3:0xbe
    v_bitop3_b32 v10, v54, s58, v10 bitop3:0xbe
    v_bitop3_b32 v10, v55, s58, v10 bitop3:0xbe
    v_cmp_ne_u32 vcc, 0, v10
    s_mov_b32 s34, 1
    s_cbranch_vccnz MLS_F
    v_max_f32 v50, v48, v52
    s_nop 1
    v_max_f32_dpp v50, v50, v50 row_ror:4 row_mask:0xf bank_mask:0xf
    s_nop 1
    v_max_f32_dpp v50, v50, v50 row_ror:8 row_mask:0xf bank_mask:0xf
    v_mov_b32 v10, v50
    s_nop 1
    v_permlane16_swap_b32 v50, v10
    v_max_f32 v50, v50, v10
    v_mov_b32 v10, v50
    s_nop 1
    v_permlane32_swap_b32 v50, v10
    v_max_f32 v50, v50, v10
    v_sub_f32 v48, v48, v50
    v_sub_f32 v52, v52, v50
    v_sub_f32 v9, v9, v50
    v_mul_f32 v48, s69, v48
    v_mul_f32 v52, s69, v52
    v_mul_f32 v9, s69, v9
    v_exp_f32 v48, v48
    v_exp_f32 v52, v52
    v_exp_f32 v9, v9
    v_mul_f32 v49, v49, v48
    v_fmac_f32 v49, v53, v52
    s_nop 1
    v_add_f32_dpp v49, v49, v49 row_ror:4 row_mask:0xf bank_mask:0xf
    s_nop 1
    v_add_f32_dpp v49, v49, v49 row_ror:8 row_mask:0xf bank_mask:0xf
    v_mov_b32 v10, v49
    s_nop 1
    v_permlane16_swap_b32 v49, v10
    v_add_f32 v49, v49, v10
    v_mov_b32 v10, v49
    s_nop 1
    v_permlane32_swap_b32 v49, v10
    v_add_f32 v49, v49, v10
    v_rcp_f32 v49, v49
    s_nop 0
    v_mul_f32 v9, v9, v49
    v_lshlrev_b32 v10, 4, v1
    s_lshl_b32 s64, s3, 2
    v_add_u32 v10, s64, v10
    s_mov_b64 exec, 0xf
    ds_write_b32 v10, v9 offset:26880
    s_mov_b64 exec, -1
    s_mov_b32 s34, 0
MLS_F:
    v_mov_b32_dpp v24, v20 row_ror:4 row_mask:0xf bank_mask:0x1
    v_mov_b32_dpp v25, v21 row_ror:4 row_mask:0xf bank_mask:0x1
    v_mov_b32_dpp v26, v22 row_ror:4 row_mask:0xf bank_mask:0x1
    v_mov_b32_dpp v27, v23 row_ror:4 row_mask:0xf bank_mask:0x1
    v_mov_b32_dpp v28, v20 row_ror:8 row_mask:0xf bank_mask:0x2
    v_mov_b32_dpp v29, v21 row_ror:8 row_mask:0xf bank_mask:0x2
    v_mov_b32_dpp v30, v22 row_ror:8 row_mask:0xf bank_mask:0x2
    v_mov_b32_dpp v31, v23 row_ror:8 row_mask:0xf bank_mask:0x2
    v_mov_b32_dpp v40, v20 row_ror:12 row_mask:0xf bank_mask:0x4
    v_mov_b32_dpp v41, v21 row_ror:12 row_mask:0xf bank_mask:0x4
    v_mov_b32_dpp v42, v22 row_ror:12 row_mask:0xf bank_mask:0x4
    v_mov_b32_dpp v43, v23 row_ror:12 row_mask:0xf bank_mask:0x4
    v_mov_b32_dpp v44, v20 quad_perm:[0,1,2,3] row_mask:0xf bank_mask:0x8
    v_mov_b32_dpp v45, v21 quad_perm:[0,1,2,3] row_mask:0xf bank_mask:0x8
    v_mov_b32_dpp v46, v22 quad_perm:[0,1,2,3] row_mask:0xf bank_mask:0x8
    v_mov_b32_dpp v47, v23 quad_perm:[0,1,2,3] row_mask:0xf bank_mask:0x8
    s_waitcnt vmcnt(2)
    v_perm_b32 v32, v100, v96, s67
    v_perm_b32 v33, v108, v104, s67
    v_perm_b32 v34, v116, v112, s67
    v_perm_b32 v35, v124, v120, s67
    v_perm_b32 v36, v102, v98, s67
    v_perm_b32 v37, v110, v106, s67
    v_perm_b32 v38, v118, v114, s67
    v_perm_b32 v39, v126, v122, s67
    v_mfma_f32_16x16x32_bf16 a[0:3], v[32:35], v[24:27], a[0:3]
    v_perm_b32 v32, v100, v96, s68
    v_perm_b32 v33, v108, v104, s68
    v_perm_b32 v34, v116, v112, s68
    v_perm_b32 v35, v124, v120, s68
    v_mfma_f32_16x16x32_bf16 a[4:7], v[36:39], v[24:27], a[4:7]
    v_perm_b32 v36, v102, v98, s68
    v_perm_b32 v37, v110, v106, s68
    v_perm_b32 v38, v118, v114, s68
    v_perm_b32 v39, v126, v122, s68
    v_mfma_f32_16x16x32_bf16 a[0:3], v[32:35], v[28:31], a[0:3]
    v_perm_b32 v32, v101, v97, s67
    v_perm_b32 v33, v109, v105, s67
    v_perm_b32 v34, v117, v113, s67
    v_perm_b32 v35, v125, v121, s67
    v_mfma_f32_16x16x32_bf16 a[4:7], v[36:39], v[28:31], a[4:7]
    v_perm_b32 v36, v103, v99, s67
    v_perm_b32 v37, v111, v107, s67
    v_perm_b32 v38, v119, v115, s67
    v_perm_b32 v39, v127, v123, s67
    v_mfma_f32_16x16x32_bf16 a[0:3], v[32:35], v[40:43], a[0:3]
    v_perm_b32 v32, v101, v97, s68
    v_perm_b32 v33, v109, v105, s68
    v_perm_b32 v34, v117, v113, s68
    v_perm_b32 v35, v125, v121, s68
    v_mfma_f32_16x16x32_bf16 a[4:7], v[36:39], v[40:43], a[4:7]
    v_perm_b32 v36, v103, v99, s68
    v_perm_b32 v37, v111, v107, s68
    v_perm_b32 v38, v119, v115, s68
    v_perm_b32 v39, v127, v123, s68
    v_mfma_f32_16x16x32_bf16 a[0:3], v[32:35], v[44:47], a[0:3]
    s_nop 0
    v_mfma_f32_16x16x32_bf16 a[4:7], v[36:39], v[44:47], a[4:7]
    s_cmp_eq_u32 s34, 0
    s_cbranch_scc1 MLD_F
    s_mov_b32 s62, 0x40000
    s_waitcnt vmcnt(0)
MLR_F:
    v_xor_b32 v10, s58, v58
    v_bitop3_b32 v10, v59, s58, v10 bitop3:0xbe
    v_bitop3_b32 v10, v62, s58, v10 bitop3:0xbe
    v_bitop3_b32 v10, v63, s58, v10 bitop3:0xbe
    v_cmp_ne_u32 vcc, 0, v10
    s_cbranch_vccz MLF_F
    s_mov_b32 s61, 0x20000
    buffer_load_dwordx4 v[56:59], v6, s[12:15], s61 offen offset:0 sc1
    s_mov_b32 s61, 0x20000
    buffer_load_dwordx4 v[60:63], v6, s[12:15], s61 offen offset:1024 sc1
    s_waitcnt vmcnt(0)
    s_sub_u32 s62, s62, 1
    s_cbranch_scc0 MLR_F
MLF_F:
    v_max_f32 v58, v56, v60
    s_nop 1
    v_max_f32_dpp v58, v58, v58 row_ror:4 row_mask:0xf bank_mask:0xf
    s_nop 1
    v_max_f32_dpp v58, v58, v58 row_ror:8 row_mask:0xf bank_mask:0xf
    v_mov_b32 v10, v58
    s_nop 1
    v_permlane16_swap_b32 v58, v10
    v_max_f32 v58, v58, v10
    v_mov_b32 v10, v58
    s_nop 1
    v_permlane32_swap_b32 v58, v10
    v_max_f32 v58, v58, v10
    v_sub_f32 v56, v56, v58
    v_sub_f32 v60, v60, v58
    v_sub_f32 v9, v9, v58
    v_mul_f32 v56, s69, v56
    v_mul_f32 v60, s69, v60
    v_mul_f32 v9, s69, v9
    v_exp_f32 v56, v56
    v_exp_f32 v60, v60
    v_exp_f32 v9, v9
    v_mul_f32 v57, v57, v56
    v_fmac_f32 v57, v61, v60
    s_nop 1
    v_add_f32_dpp v57, v57, v57 row_ror:4 row_mask:0xf bank_mask:0xf
    s_nop 1
    v_add_f32_dpp v57, v57, v57 row_ror:8 row_mask:0xf bank_mask:0xf
    v_mov_b32 v10, v57
    s_nop 1
    v_permlane16_swap_b32 v57, v10
    v_add_f32 v57, v57, v10
    v_mov_b32 v10, v57
    s_nop 1
    v_permlane32_swap_b32 v57, v10
    v_add_f32 v57, v57, v10
    v_rcp_f32 v57, v57
    s_nop 0
    v_mul_f32 v9, v9, v57
    v_lshlrev_b32 v10, 4, v1
    s_lshl_b32 s64, s3, 2
    v_add_u32 v10, s64, v10
    s_mov_b64 exec, 0xf
    ds_write_b32 v10, v9 offset:26880
    s_mov_b64 exec, -1
MLD_F:
    s_nop 3
    ds_write_b128 v8, a[0:3] offset:18688
    s_nop 0
    ds_write_b128 v8, a[4:7] offset:19712
    s_waitcnt lgkmcnt(0)
    s_barrier
    s_cmp_ge_u32 s3, 2
    s_cbranch_scc1 SK2_F
    ds_read_b128 v[48:51], v15 offset:26880
    ds_read_b128 v[32:35], v2 offset:18688
    ds_read_b128 v[36:39], v2 offset:20736
    ds_read_b128 v[40:43], v2 offset:22784
    ds_read_b128 v[44:47], v2 offset:24832
    s_waitcnt lgkmcnt(2)
    v_pk_mul_f32 v[32:33], v[32:33], v[48:49] op_sel_hi:[1,0]
    v_pk_mul_f32 v[34:35], v[34:35], v[48:49] op_sel_hi:[1,0]
    v_pk_fma_f32 v[32:33], v[36:37], v[48:49], v[32:33] op_sel:[0,1,0] op_sel_hi:[1,1,1]
    v_pk_fma_f32 v[34:35], v[38:39], v[48:49], v[34:35] op_sel:[0,1,0] op_sel_hi:[1,1,1]
    s_waitcnt lgkmcnt(0)
    v_pk_fma_f32 v[32:33], v[40:41], v[50:51], v[32:33] op_sel_hi:[1,0,1]
    v_pk_fma_f32 v[34:35], v[42:43], v[50:51], v[34:35] op_sel_hi:[1,0,1]
    v_pk_fma_f32 v[32:33], v[44:45], v[50:51], v[32:33] op_sel:[0,1,0] op_sel_hi:[1,1,1]
    v_pk_fma_f32 v[34:35], v[46:47], v[50:51], v[34:35] op_sel:[0,1,0] op_sel_hi:[1,1,1]
    v_bfi_b32 v32, s65, v4, v32
    v_bfi_b32 v33, s65, v4, v33
    v_bfi_b32 v34, s65, v4, v34
    v_bfi_b32 v35, s65, v4, v35
    s_mov_b32 s61, 0x80000
    buffer_store_dwordx4 v[32:35], v14, s[12:15], s61 offen offset:0 sc1
SK2_F:
    s_barrier
    s_and_b32 s63, s2, 7
    s_mul_i32 s63, s63, 7
    s_sub_u32 s64, s2, 176
    s_lshr_b32 s64, s64, 3
    s_add_u32 s63, s63, s64
    s_lshl_b32 s64, s63, 6
    v_lshrrev_b32 v10, 4, v1
    v_lshlrev_b32 v10, 5, v10
    s_lshl_b32 s61, s3, 7
    v_add_u32 v10, s61, v10
    s_movk_i32 s61, 3584
    v_mul_lo_u32 v10, v10, s61
    v_and_b32 v11, 3, v1
    v_lshl_add_u32 v10, v11, 4, v10
    v_bfe_u32 v11, v1, 2, 1
    v_lshl_add_u32 v10, v11, 3, v10
    v_add_u32 v7, s64, v10
    s_mov_b32 s72, 0xff00ff00
    s_mov_b32 s73, 0xff00ff00
    v_mov_b32 v10, s44
    v_mov_b32 v11, s45
    v_mov_b32 v12, s46
    v_mov_b32 v13, s47
    v_cndmask_b32 v10, v10, v12, s[72:73]
    v_cndmask_b32 v11, v11, v13, s[72:73]
    v_mov_b32 v12, v7
    v_mov_b32 v13, 0
    v_lshl_add_u64 v[12:13], v[10:11], 0, v[12:13]
    s_movk_i32 s74, 7168
    s_mov_b32 s75, 0
    v_and_b32 v10, 3, v1
    v_mul_u32_u24 v10, 0x3000, v10
    v_add_u32 v3, v10, v5
    s_mov_b32 s61, 0x2000
    buffer_load_dwordx4 v[160:163], v3, s[12:15], s61 offen offset:0 sc1
    s_mov_b32 s61, 0x2000
    buffer_load_dwordx4 v[164:167], v3, s[12:15], s61 offen offset:256 sc1
    s_mov_b32 s61, 0x2000
    buffer_load_dwordx4 v[168:171], v3, s[12:15], s61 offen offset:2048 sc1
    s_mov_b32 s61, 0x2000
    buffer_load_dwordx4 v[172:175], v3, s[12:15], s61 offen offset:2304 sc1
    s_mov_b32 s61, 0x3000
    buffer_load_dwordx4 v[176:179], v3, s[12:15], s61 offen offset:0 sc1
    s_mov_b32 s61, 0x3000
    buffer_load_dwordx4 v[180:183], v3, s[12:15], s61 offen offset:256 sc1
    v_and_b32 v10, 3, v1
    v_lshlrev_b32 v10, 10, v10
    v_lshrrev_b32 v11, 4, v1
    v_lshl_add_u32 v10, v11, 6, v10
    v_bfe_u32 v11, v1, 2, 2
    v_lshl_add_u32 v10, v11, 2, v10
    s_lshl_b32 s61, s3, 8
    v_add_u32 v7, s61, v10
    buffer_load_dword v184, v7, s[24:27], 0 offen offset:0
    buffer_load_dword v185, v7, s[24:27], 0 offen offset:16
    buffer_load_dword v186, v7, s[24:27], 0 offen offset:32
    buffer_load_dword v187, v7, s[24:27], 0 offen offset:48
    global_load_dwordx2 v[128:129], v[12:13], off offset:0
    global_load_dwordx2 v[130:131], v[12:13], off offset:3584
    v_lshl_add_u64 v[12:13], v[12:13], 0, s[74:75]
    global_load_dwordx2 v[144:145], v[12:13], off offset:0
    global_load_dwordx2 v[146:147], v[12:13], off offset:3584
    v_lshl_add_u64 v[12:13], v[12:13], 0, s[74:75]
    global_load_dwordx2 v[224:225], v[12:13], off offset:0
    global_load_dwordx2 v[226:227], v[12:13], off offset:3584
    v_lshl_add_u64 v[12:13], v[12:13], 0, s[74:75]
    global_load_dwordx2 v[240:241], v[12:13], off offset:0
    global_load_dwordx2 v[242:243], v[12:13], off offset:3584
    v_lshl_add_u64 v[12:13], v[12:13], 0, s[74:75]
    global_load_dwordx2 v[132:133], v[12:13], off offset:0
    global_load_dwordx2 v[134:135], v[12:13], off offset:3584
    v_lshl_add_u64 v[12:13], v[12:13], 0, s[74:75]
    global_load_dwordx2 v[148:149], v[12:13], off offset:0
    global_load_dwordx2 v[150:151], v[12:13], off offset:3584
    v_lshl_add_u64 v[12:13], v[12:13], 0, s[74:75]
    global_load_dwordx2 v[228:229], v[12:13], off offset:0
    global_load_dwordx2 v[230:231], v[12:13], off offset:3584
    v_lshl_add_u64 v[12:13], v[12:13], 0, s[74:75]
    global_load_dwordx2 v[244:245], v[12:13], off offset:0
    global_load_dwordx2 v[246:247], v[12:13], off offset:3584
    v_lshl_add_u64 v[12:13], v[12:13], 0, s[74:75]
    global_load_dwordx2 v[136:137], v[12:13], off offset:0
    global_load_dwordx2 v[138:139], v[12:13], off offset:3584
    v_lshl_add_u64 v[12:13], v[12:13], 0, s[74:75]
    global_load_dwordx2 v[152:153], v[12:13], off offset:0
    global_load_dwordx2 v[154:155], v[12:13], off offset:3584
    v_lshl_add_u64 v[12:13], v[12:13], 0, s[74:75]
    global_load_dwordx2 v[232:233], v[12:13], off offset:0
    global_load_dwordx2 v[234:235], v[12:13], off offset:3584
    v_lshl_add_u64 v[12:13], v[12:13], 0, s[74:75]
    global_load_dwordx2 v[248:249], v[12:13], off offset:0
    global_load_dwordx2 v[250:251], v[12:13], off offset:3584
    v_lshl_add_u64 v[12:13], v[12:13], 0, s[74:75]
    global_load_dwordx2 v[140:141], v[12:13], off offset:0
    global_load_dwordx2 v[142:143], v[12:13], off offset:3584
    v_lshl_add_u64 v[12:13], v[12:13], 0, s[74:75]
    global_load_dwordx2 v[156:157], v[12:13], off offset:0
    global_load_dwordx2 v[158:159], v[12:13], off offset:3584
    v_lshl_add_u64 v[12:13], v[12:13], 0, s[74:75]
    global_load_dwordx2 v[236:237], v[12:13], off offset:0
    global_load_dwordx2 v[238:239], v[12:13], off offset:3584
    v_lshl_add_u64 v[12:13], v[12:13], 0, s[74:75]
    global_load_dwordx2 v[252:253], v[12:13], off offset:0
    global_load_dwordx2 v[254:255], v[12:13], off offset:3584
    s_mov_b32 s28, s48
    s_mov_b32 s29, s49
    s_mov_b32 s30, 0x1c0000
    s_mov_b32 s31, 0x20000
    v_lshrrev_b32 v10, 4, v1
    v_lshlrev_b32 v10, 11, v10
    v_and_b32 v11, 15, v1
    v_lshl_add_u32 v10, v11, 4, v10
    s_lshl_b32 s64, s63, 15
    s_lshl_b32 s61, s3, 8
    s_add_u32 s64, s64, s61
    v_add_u32 v7, s64, v10
    buffer_load_dwordx4 v[192:195], v7, s[28:31], 0 offen offset:0
    s_mov_b32 s61, 0x2000
    buffer_load_dwordx4 v[196:199], v7, s[28:31], s61 offen offset:0
    s_mov_b32 s61, 0x4000
    buffer_load_dwordx4 v[200:203], v7, s[28:31], s61 offen offset:0
    s_mov_b32 s61, 0x6000
    buffer_load_dwordx4 v[204:207], v7, s[28:31], s61 offen offset:0
    buffer_load_dwordx4 v[208:211], v7, s[28:31], 0 offen offset:1024
    s_mov_b32 s61, 0x2000
    buffer_load_dwordx4 v[212:215], v7, s[28:31], s61 offen offset:1024
    s_mov_b32 s61, 0x4000
    buffer_load_dwordx4 v[216:219], v7, s[28:31], s61 offen offset:1024
    s_mov_b32 s61, 0x6000
    buffer_load_dwordx4 v[220:223], v7, s[28:31], s61 offen offset:1024
    v_and_b32 v10, 3, v1
    v_mul_u32_u24 v10, 0x3000, v10
    v_add_u32 v3, v10, v5
    s_waitcnt vmcnt(40)
    s_mov_b32 s62, 0x40000
CF_md2:
    v_xor_b32 v10, s58, v160
    v_bitop3_b32 v10, v161, s58, v10 bitop3:0xbe
    v_bitop3_b32 v10, v162, s58, v10 bitop3:0xbe
    v_bitop3_b32 v10, v163, s58, v10 bitop3:0xbe
    v_bitop3_b32 v10, v164, s58, v10 bitop3:0xbe
    v_bitop3_b32 v10, v165, s58, v10 bitop3:0xbe
    v_bitop3_b32 v10, v166, s58, v10 bitop3:0xbe
    v_bitop3_b32 v10, v167, s58, v10 bitop3:0xbe
    v_bitop3_b32 v10, v168, s58, v10 bitop3:0xbe
    v_bitop3_b32 v10, v169, s58, v10 bitop3:0xbe
    v_bitop3_b32 v10, v170, s58, v10 bitop3:0xbe
    v_bitop3_b32 v10, v171, s58, v10 bitop3:0xbe
    v_bitop3_b32 v10, v172, s58, v10 bitop3:0xbe
    v_bitop3_b32 v10, v173, s58, v10 bitop3:0xbe
    v_bitop3_b32 v10, v174, s58, v10 bitop3:0xbe
    v_bitop3_b32 v10, v175, s58, v10 bitop3:0xbe
    v_bitop3_b32 v10, v176, s58, v10 bitop3:0xbe
    v_bitop3_b32 v10, v177, s58, v10 bitop3:0xbe
    v_bitop3_b32 v10, v178, s58, v10 bitop3:0xbe
    v_bitop3_b32 v10, v179, s58, v10 bitop3:0xbe
    v_bitop3_b32 v10, v180, s58, v10 bitop3:0xbe
    v_bitop3_b32 v10, v181, s58, v10 bitop3:0xbe
    v_bitop3_b32 v10, v182, s58, v10 bitop3:0xbe
    v_bitop3_b32 v10, v183, s58, v10 bitop3:0xbe
    v_and_b32 v10, 0xff, v10
    v_cmp_ne_u32 vcc, 0, v10
    s_cbranch_vccnz RF_md2
KF_md2:
    v_lshlrev_b32 v40, 16, v184
    v_and_b32 v44, s66, v184
    v_lshlrev_b32 v41, 16, v185
    v_and_b32 v45, s66, v185
    v_lshlrev_b32 v42, 16, v186
    v_and_b32 v46, s66, v186
    v_lshlrev_b32 v43, 16, v187
    v_and_b32 v47, s66, v187
    v_and_b32 v176, s66, v176
    v_and_b32 v177, s66, v177
    v_and_b32 v178, s66, v178
    v_and_b32 v179, s66, v179
    v_and_b32 v180, s66, v180
    v_and_b32 v181, s66, v181
    v_and_b32 v182, s66, v182
    v_and_b32 v183, s66, v183
    v_and_b32 v168, s66, v168
    v_and_b32 v169, s66, v169
    v_and_b32 v170, s66, v170
    v_and_b32 v171, s66, v171
    v_and_b32 v172, s66, v172
    v_and_b32 v173, s66, v173
    v_and_b32 v174, s66, v174
    v_and_b32 v175, s66, v175
    v_add_f32 v176, 1.0, v176
    v_add_f32 v177, 1.0, v177
    v_add_f32 v178, 1.0, v178
    v_add_f32 v179, 1.0, v179
    v_add_f32 v180, 1.0, v180
    v_add_f32 v181, 1.0, v181
    v_add_f32 v182, 1.0, v182
    v_add_f32 v183, 1.0, v183
    v_cvt_pk_bf16_f32 v24, v176, v177
    v_cvt_pk_bf16_f32 v25, v178, v179
    v_cvt_pk_bf16_f32 v26, v180, v181
    v_cvt_pk_bf16_f32 v27, v182, v183
    v_lshlrev_b32 v176, 16, v24
    v_and_b32 v177, s66, v24
    v_lshlrev_b32 v178, 16, v25
    v_and_b32 v179, s66, v25
    v_lshlrev_b32 v180, 16, v26
    v_and_b32 v181, s66, v26
    v_lshlrev_b32 v182, 16, v27
    v_and_b32 v183, s66, v27
    v_and_b32 v10, 3, v1
    v_lshl_add_u32 v6, v10, 11, v5
    s_waitcnt vmcnt(8)
    v_perm_b32 v64, v130, v128, s67
    v_perm_b32 v65, v134, v132, s67
    v_perm_b32 v66, v138, v136, s67
    v_perm_b32 v67, v142, v140, s67
    v_perm_b32 v68, v130, v128, s68
    v_perm_b32 v69, v134, v132, s68
    v_perm_b32 v70, v138, v136, s68
    v_perm_b32 v71, v142, v140, s68
    v_perm_b32 v72, v131, v129, s67
    v_perm_b32 v73, v135, v133, s67
    v_perm_b32 v74, v139, v137, s67
    v_perm_b32 v75, v143, v141, s67
    v_perm_b32 v76, v131, v129, s68
    v_perm_b32 v77, v135, v133, s68
    v_perm_b32 v78, v139, v137, s68
    v_perm_b32 v79, v143, v141, s68
    v_perm_b32 v80, v146, v144, s67
    v_perm_b32 v81, v150, v148, s67
    v_perm_b32 v82, v154, v152, s67
    v_perm_b32 v83, v158, v156, s67
    v_perm_b32 v84, v146, v144, s68
    v_perm_b32 v85, v150, v148, s68
    v_perm_b32 v86, v154, v152, s68
    v_perm_b32 v87, v158, v156, s68
    v_perm_b32 v88, v147, v145, s67
    v_perm_b32 v89, v151, v149, s67
    v_perm_b32 v90, v155, v153, s67
    v_perm_b32 v91, v159, v157, s67
    v_perm_b32 v92, v147, v145, s68
    v_perm_b32 v93, v151, v149, s68
    v_perm_b32 v94, v155, v153, s68
    v_perm_b32 v95, v159, v157, s68
    v_perm_b32 v96, v226, v224, s67
    v_perm_b32 v97, v230, v228, s67
    v_perm_b32 v98, v234, v232, s67
    v_perm_b32 v99, v238, v236, s67
    v_perm_b32 v100, v226, v224, s68
    v_perm_b32 v101, v230, v228, s68
    v_perm_b32 v102, v234, v232, s68
    v_perm_b32 v103, v238, v236, s68
    v_perm_b32 v104, v227, v225, s67
    v_perm_b32 v105, v231, v229, s67
    v_perm_b32 v106, v235, v233, s67
    v_perm_b32 v107, v239, v237, s67
    v_perm_b32 v108, v227, v225, s68
    v_perm_b32 v109, v231, v229, s68
    v_perm_b32 v110, v235, v233, s68
    v_perm_b32 v111, v239, v237, s68
    v_perm_b32 v112, v242, v240, s67
    v_perm_b32 v113, v246, v244, s67
    v_perm_b32 v114, v250, v248, s67
    v_perm_b32 v115, v254, v252, s67
    v_perm_b32 v116, v242, v240, s68
    v_perm_b32 v117, v246, v244, s68
    v_perm_b32 v118, v250, v248, s68
    v_perm_b32 v119, v254, v252, s68
    v_perm_b32 v120, v243, v241, s67
    v_perm_b32 v121, v247, v245, s67
    v_perm_b32 v122, v251, v249, s67
    v_perm_b32 v123, v255, v253, s67
    v_perm_b32 v124, v243, v241, s68
    v_perm_b32 v125, v247, v245, s68
    v_perm_b32 v126, v251, v249, s68
    v_perm_b32 v127, v255, v253, s68
    v_mov_b32 v48, 0
    v_mov_b32 v49, 0
    v_mov_b32 v50, 0
    v_mov_b32 v51, 0
    v_mov_b32 v52, 0
    v_mov_b32 v53, 0
    v_mov_b32 v54, 0
    v_mov_b32 v55, 0
    v_mov_b32 v56, 0
    v_mov_b32 v57, 0
    v_mov_b32 v58, 0
    v_mov_b32 v59, 0
    v_mov_b32 v60, 0
    v_mov_b32 v61, 0
    v_mov_b32 v62, 0
    v_mov_b32 v63, 0
    v_lshrrev_b32 v224, 16, v160
    v_and_b32 v228, s66, v164
    v_lshrrev_b32 v240, 16, v176
    v_mov_b32 v244, v180
    v_lshrrev_b32 v225, 16, v161
    v_and_b32 v229, s66, v165
    v_lshrrev_b32 v241, 16, v177
    v_mov_b32 v245, v181
    v_lshrrev_b32 v226, 16, v162
    v_and_b32 v230, s66, v166
    v_lshrrev_b32 v242, 16, v178
    v_mov_b32 v246, v182
    v_lshrrev_b32 v227, 16, v163
    v_and_b32 v231, s66, v167
    v_lshrrev_b32 v243, 16, v179
    v_mov_b32 v247, v183
    v_mov_b32 v232, v168
    v_mov_b32 v233, v169
    v_mov_b32 v234, v170
    v_mov_b32 v235, v171
    v_mov_b32 v236, v172
    v_mov_b32 v237, v173
    v_mov_b32 v238, v174
    v_mov_b32 v239, v175
    s_waitcnt vmcnt(0)
    v_perm_b32 v128, v196, v192, s67
    v_perm_b32 v129, v204, v200, s67
    v_perm_b32 v130, v212, v208, s67
    v_perm_b32 v131, v220, v216, s67
    v_perm_b32 v132, v196, v192, s68
    v_perm_b32 v133, v204, v200, s68
    v_perm_b32 v134, v212, v208, s68
    v_perm_b32 v135, v220, v216, s68
    v_perm_b32 v136, v197, v193, s67
    v_perm_b32 v137, v205, v201, s67
    v_perm_b32 v138, v213, v209, s67
    v_perm_b32 v139, v221, v217, s67
    v_perm_b32 v140, v197, v193, s68
    v_perm_b32 v141, v205, v201, s68
    v_perm_b32 v142, v213, v209, s68
    v_perm_b32 v143, v221, v217, s68
    v_perm_b32 v144, v198, v194, s67
    v_perm_b32 v145, v206, v202, s67
    v_perm_b32 v146, v214, v210, s67
    v_perm_b32 v147, v222, v218, s67
    v_perm_b32 v148, v198, v194, s68
    v_perm_b32 v149, v206, v202, s68
    v_perm_b32 v150, v214, v210, s68
    v_perm_b32 v151, v222, v218, s68
    v_perm_b32 v152, v199, v195, s67
    v_perm_b32 v153, v207, v203, s67
    v_perm_b32 v154, v215, v211, s67
    v_perm_b32 v155, v223, v219, s67
    v_perm_b32 v156, v199, v195, s68
    v_perm_b32 v157, v207, v203, s68
    v_perm_b32 v158, v215, v211, s68
    v_perm_b32 v159, v223, v219, s68
    v_mov_b32 v16, 0
    v_mov_b32 v17, 0
    v_mov_b32 v18, 0
    v_mov_b32 v19, 0
    v_mov_b32 v20, 0
    v_mov_b32 v21, 0
    v_mov_b32 v22, 0
    v_mov_b32 v23, 0
    v_mov_b32 v9, 0xffff
    v_mov_b32 v3, 0
    s_mov_b32 s74, 0xfffffeff
    s_mov_b32 s75, 0x200000
    s_mov_b32 s62, 0x40000
    s_and_b32 s64, s2, 0
    s_lshl_b32 s64, s64, 16
    s_add_u32 s75, s75, s64
    s_mov_b32 exec_lo, 0xcccccccc
    s_mov_b32 exec_hi, 0xcccccccc
    v_mov_b32 v9, 0
    s_mov_b32 exec_lo, 0x33333333
    s_mov_b32 exec_hi, 0x33333333
    buffer_load_dwordx4 v[160:163], v6, s[12:15], s75 offen offset:0 sc1
    buffer_load_dwordx4 v[164:167], v6, s[12:15], s75 offen offset:256 sc1
    s_add_u32 s61, s75, 0x2000
    buffer_load_dwordx4 v[168:171], v6, s[12:15], s61 offen offset:0 sc1
    buffer_load_dwordx4 v[172:175], v6, s[12:15], s61 offen offset:256 sc1
    s_add_u32 s61, s75, 0x4000
    buffer_load_dwordx4 v[176:179], v6, s[12:15], s61 offen offset:0 sc1
    buffer_load_dwordx4 v[180:183], v6, s[12:15], s61 offen offset:256 sc1
    s_add_u32 s61, s75, 0x6000
    buffer_load_dwordx4 v[184:187], v6, s[12:15], s61 offen offset:0 sc1
    buffer_load_dwordx4 v[188:191], v6, s[12:15], s61 offen offset:256 sc1
    s_add_u32 s61, s75, 0x8000
    buffer_load_dwordx4 v[192:195], v6, s[12:15], s61 offen offset:0 sc1
    buffer_load_dwordx4 v[196:199], v6, s[12:15], s61 offen offset:256 sc1
    s_add_u32 s61, s75, 0xa000
    buffer_load_dwordx4 v[200:203], v6, s[12:15], s61 offen offset:0 sc1
    buffer_load_dwordx4 v[204:207], v6, s[12:15], s61 offen offset:256 sc1
    s_add_u32 s61, s75, 0xc000
    buffer_load_dwordx4 v[208:211], v6, s[12:15], s61 offen offset:0 sc1
    buffer_load_dwordx4 v[212:215], v6, s[12:15], s61 offen offset:256 sc1
    s_add_u32 s61, s75, 0xe000
    buffer_load_dwordx4 v[216:219], v6, s[12:15], s61 offen offset:0 sc1
    buffer_load_dwordx4 v[220:223], v6, s[12:15], s61 offen offset:256 sc1
    s_mov_b64 exec, -1
    v_mov_b32 v248, 0x3e800000
    v_mov_b32 v249, 0x3b000000
    v_and_b32 v11, 3, v1
    v_lshlrev_b32 v2, 5, v11
    s_lshl_b32 s61, s3, 3
    v_add_u32 v7, s61, v2
    v_lshrrev_b32 v10, 4, v1
    v_add_u32 v10, v10, v1
    v_and_b32 v10, 3, v10
    v_and_b32 v11, 60, v1
    v_or_b32 v10, v10, v11
    v_lshlrev_b32 v10, 4, v10
    s_lshl_b32 s61, s3, 10
    v_add_u32 v8, s61, v10
    v_bfe_u32 v10, v1, 3, 1
    v_lshlrev_b32 v10, 3, v10
    v_lshrrev_b32 v12, 4, v1
    v_lshl_add_u32 v10, v12, 1, v10
    v_bfe_u32 v13, v1, 2, 1
    v_add_u32 v10, v10, v13
    v_lshrrev_b32 v13, 2, v10
    v_add_u32 v13, v13, v1
    v_and_b32 v13, 3, v13
    v_lshl_or_b32 v10, v10, 2, v13
    v_lshlrev_b32 v14, 4, v10
    v_bfe_u32 v10, v1, 2, 2
    v_lshl_add_u32 v10, v12, 3, v10
    v_mul_u32_u24 v10, 0xe00, v10
    v_and_b32 v11, 3, v1
    v_lshl_add_u32 v10, v11, 4, v10
    s_mul_i32 s64, s3, 114688
    s_lshl_b32 s61, s63, 6
    s_add_u32 s64, s64, s61
    v_add_u32 v15, s64, v10
    s_waitcnt vmcnt(14)
    v_xor_b32 v10, s58, v160
    v_bitop3_b32 v10, v161, s58, v10 bitop3:0xbe
    v_bitop3_b32 v10, v162, s58, v10 bitop3:0xbe
    v_bitop3_b32 v10, v163, s58, v10 bitop3:0xbe
    v_bitop3_b32 v10, v164, s58, v10 bitop3:0xbe
    v_bitop3_b32 v10, v165, s58, v10 bitop3:0xbe
    v_bitop3_b32 v10, v166, s58, v10 bitop3:0xbe
    v_bitop3_b32 v10, v167, s58, v10 bitop3:0xbe
    v_and_b32 v10, 0xff, v10
    v_cmp_eq_u32 vcc, 0, v10
    s_and_b32 exec_lo, vcc_lo, 0x33333333
    s_and_b32 exec_hi, vcc_hi, 0x33333333
    v_pk_add_f32 v[16:17], v[16:17], v[160:161]
    v_pk_add_f32 v[18:19], v[18:19], v[162:163]
    v_pk_add_f32 v[20:21], v[20:21], v[164:165]
    v_pk_add_f32 v[22:23], v[22:23], v[166:167]
    v_xor_b32 v9, 0x101, v9
    s_mov_b64 exec, -1
    s_waitcnt vmcnt(12)
    v_xor_b32 v10, s58, v168
    v_bitop3_b32 v10, v169, s58, v10 bitop3:0xbe
    v_bitop3_b32 v10, v170, s58, v10 bitop3:0xbe
    v_bitop3_b32 v10, v171, s58, v10 bitop3:0xbe
    v_bitop3_b32 v10, v172, s58, v10 bitop3:0xbe
    v_bitop3_b32 v10, v173, s58, v10 bitop3:0xbe
    v_bitop3_b32 v10, v174, s58, v10 bitop3:0xbe
    v_bitop3_b32 v10, v175, s58, v10 bitop3:0xbe
    v_and_b32 v10, 0xff, v10
    v_cmp_eq_u32 vcc, 0, v10
    s_and_b32 exec_lo, vcc_lo, 0x33333333
    s_and_b32 exec_hi, vcc_hi, 0x33333333
    v_pk_add_f32 v[16:17], v[16:17], v[168:169]
    v_pk_add_f32 v[18:19], v[18:19], v[170:171]
    v_pk_add_f32 v[20:21], v[20:21], v[172:173]
    v_pk_add_f32 v[22:23], v[22:23], v[174:175]
    v_xor_b32 v9, 0x202, v9
    s_mov_b64 exec, -1
    s_waitcnt vmcnt(10)
    v_xor_b32 v10, s58, v176
    v_bitop3_b32 v10, v177, s58, v10 bitop3:0xbe
    v_bitop3_b32 v10, v178, s58, v10 bitop3:0xbe
    v_bitop3_b32 v10, v179, s58, v10 bitop3:0xbe
    v_bitop3_b32 v10, v180, s58, v10 bitop3:0xbe
    v_bitop3_b32 v10, v181, s58, v10 bitop3:0xbe
    v_bitop3_b32 v10, v182, s58, v10 bitop3:0xbe
    v_bitop3_b32 v10, v183, s58, v10 bitop3:0xbe
    v_and_b32 v10, 0xff, v10
    v_cmp_eq_u32 vcc, 0, v10
    s_and_b32 exec_lo, vcc_lo, 0x33333333
    s_and_b32 exec_hi, vcc_hi, 0x33333333
    v_pk_add_f32 v[16:17], v[16:17], v[176:177]
    v_pk_add_f32 v[18:19], v[18:19], v[178:179]
    v_pk_add_f32 v[20:21], v[20:21], v[180:181]
    v_pk_add_f32 v[22:23], v[22:23], v[182:183]
    v_xor_b32 v9, 0x404, v9
    s_mov_b64 exec, -1
    s_waitcnt vmcnt(8)
    v_xor_b32 v10, s58, v184
    v_bitop3_b32 v10, v185, s58, v10 bitop3:0xbe
    v_bitop3_b32 v10, v186, s58, v10 bitop3:0xbe
    v_bitop3_b32 v10, v187, s58, v10 bitop3:0xbe
    v_bitop3_b32 v10, v188, s58, v10 bitop3:0xbe
    v_bitop3_b32 v10, v189, s58, v10 bitop3:0xbe
    v_bitop3_b32 v10, v190, s58, v10 bitop3:0xbe
    v_bitop3_b32 v10, v191, s58, v10 bitop3:0xbe
    v_and_b32 v10, 0xff, v10
    v_cmp_eq_u32 vcc, 0, v10
    s_and_b32 exec_lo, vcc_lo, 0x33333333
    s_and_b32 exec_hi, vcc_hi, 0x33333333
    v_pk_add_f32 v[16:17], v[16:17], v[184:185]
    v_pk_add_f32 v[18:19], v[18:19], v[186:187]
    v_pk_add_f32 v[20:21], v[20:21], v[188:189]
    v_pk_add_f32 v[22:23], v[22:23], v[190:191]
    v_xor_b32 v9, 0x808, v9
    s_mov_b64 exec, -1
    s_waitcnt vmcnt(6)
    v_xor_b32 v10, s58, v192
    v_bitop3_b32 v10, v193, s58, v10 bitop3:0xbe
    v_bitop3_b32 v10, v194, s58, v10 bitop3:0xbe
    v_bitop3_b32 v10, v195, s58, v10 bitop3:0xbe
    v_bitop3_b32 v10, v196, s58, v10 bitop3:0xbe
    v_bitop3_b32 v10, v197, s58, v10 bitop3:0xbe
    v_bitop3_b32 v10, v198, s58, v10 bitop3:0xbe
    v_bitop3_b32 v10, v199, s58, v10 bitop3:0xbe
    v_and_b32 v10, 0xff, v10
    v_cmp_eq_u32 vcc, 0, v10
    s_and_b32 exec_lo, vcc_lo, 0x33333333
    s_and_b32 exec_hi, vcc_hi, 0x33333333
    v_pk_add_f32 v[16:17], v[16:17], v[192:193]
    v_pk_add_f32 v[18:19], v[18:19], v[194:195]
    v_pk_add_f32 v[20:21], v[20:21], v[196:197]
    v_pk_add_f32 v[22:23], v[22:23], v[198:199]
    v_xor_b32 v9, 0x1010, v9
    s_mov_b64 exec, -1
    s_waitcnt vmcnt(4)
    v_xor_b32 v10, s58, v200
    v_bitop3_b32 v10, v201, s58, v10 bitop3:0xbe
    v_bitop3_b32 v10, v202, s58, v10 bitop3:0xbe
    v_bitop3_b32 v10, v203, s58, v10 bitop3:0xbe
    v_bitop3_b32 v10, v204, s58, v10 bitop3:0xbe
    v_bitop3_b32 v10, v205, s58, v10 bitop3:0xbe
    v_bitop3_b32 v10, v206, s58, v10 bitop3:0xbe
    v_bitop3_b32 v10, v207, s58, v10 bitop3:0xbe
    v_and_b32 v10, 0xff, v10
    v_cmp_eq_u32 vcc, 0, v10
    s_and_b32 exec_lo, vcc_lo, 0x33333333
    s_and_b32 exec_hi, vcc_hi, 0x33333333
    v_pk_add_f32 v[16:17], v[16:17], v[200:201]
    v_pk_add_f32 v[18:19], v[18:19], v[202:203]
    v_pk_add_f32 v[20:21], v[20:21], v[204:205]
    v_pk_add_f32 v[22:23], v[22:23], v[206:207]
    v_xor_b32 v9, 0x2020, v9
    s_mov_b64 exec, -1
    s_waitcnt vmcnt(2)
    v_xor_b32 v10, s58, v208
    v_bitop3_b32 v10, v209, s58, v10 bitop3:0xbe
    v_bitop3_b32 v10, v210, s58, v10 bitop3:0xbe
    v_bitop3_b32 v10, v211, s58, v10 bitop3:0xbe
    v_bitop3_b32 v10, v212, s58, v10 bitop3:0xbe
    v_bitop3_b32 v10, v213, s58, v10 bitop3:0xbe
    v_bitop3_b32 v10, v214, s58, v10 bitop3:0xbe
    v_bitop3_b32 v10, v215, s58, v10 bitop3:0xbe
    v_and_b32 v10, 0xff, v10
    v_cmp_eq_u32 vcc, 0, v10
    s_and_b32 exec_lo, vcc_lo, 0x33333333
    s_and_b32 exec_hi, vcc_hi, 0x33333333
    v_pk_add_f32 v[16:17], v[16:17], v[208:209]
    v_pk_add_f32 v[18:19], v[18:19], v[210:211]
    v_pk_add_f32 v[20:21], v[20:21], v[212:213]
    v_pk_add_f32 v[22:23], v[22:23], v[214:215]
    v_xor_b32 v9, 0x4040, v9
    s_mov_b64 exec, -1
    s_waitcnt vmcnt(0)
    v_xor_b32 v10, s58, v216
    v_bitop3_b32 v10, v217, s58, v10 bitop3:0xbe
    v_bitop3_b32 v10, v218, s58, v10 bitop3:0xbe
    v_bitop3_b32 v10, v219, s58, v10 bitop3:0xbe
    v_bitop3_b32 v10, v220, s58, v10 bitop3:0xbe
    v_bitop3_b32 v10, v221, s58, v10 bitop3:0xbe
    v_bitop3_b32 v10, v222, s58, v10 bitop3:0xbe
    v_bitop3_b32 v10, v223, s58, v10 bitop3:0xbe
    v_and_b32 v10, 0xff, v10
    v_cmp_eq_u32 vcc, 0, v10
    s_and_b32 exec_lo, vcc_lo, 0x33333333
    s_and_b32 exec_hi, vcc_hi, 0x33333333
    v_pk_add_f32 v[16:17], v[16:17], v[216:217]
    v_pk_add_f32 v[18:19], v[18:19], v[218:219]
    v_pk_add_f32 v[20:21], v[20:21], v[220:221]
    v_pk_add_f32 v[22:23], v[22:23], v[222:223]
    v_xor_b32 v9, 0x8080, v9
    s_mov_b64 exec, -1
    v_cmp_ne_u32 vcc, 0, v9
    s_mov_b64 exec, vcc
    s_cbranch_execz RD_Fm2
    v_lshrrev_b32 v11, v3, v9
    v_ffbl_b32 v11, v11
    v_add_u32 v11, v11, v3
    v_and_b32 v24, 7, v11
    v_add_u32 v3, 1, v24
    v_lshl_add_u32 v11, v24, 13, v6
    buffer_load_dwordx4 v[160:163], v11, s[12:15], s75 offen offset:0 sc1
    buffer_load_dwordx4 v[164:167], v11, s[12:15], s75 offen offset:256 sc1
    v_lshrrev_b32 v11, v3, v9
    v_ffbl_b32 v11, v11
    v_add_u32 v11, v11, v3
    v_and_b32 v25, 7, v11
    v_add_u32 v3, 1, v25
    v_lshl_add_u32 v11, v25, 13, v6
    buffer_load_dwordx4 v[168:171], v11, s[12:15], s75 offen offset:0 sc1
    buffer_load_dwordx4 v[172:175], v11, s[12:15], s75 offen offset:256 sc1
    v_lshrrev_b32 v11, v3, v9
    v_ffbl_b32 v11, v11
    v_add_u32 v11, v11, v3
    v_and_b32 v26, 7, v11
    v_add_u32 v3, 1, v26
    v_lshl_add_u32 v11, v26, 13, v6
    buffer_load_dwordx4 v[176:179], v11, s[12:15], s75 offen offset:0 sc1
    buffer_load_dwordx4 v[180:183], v11, s[12:15], s75 offen offset:256 sc1
RL_Fm2:
    v_lshrrev_b32 v11, v3, v9
    v_ffbl_b32 v11, v11
    v_add_u32 v11, v11, v3
    v_and_b32 v27, 7, v11
    v_add_u32 v3, 1, v27
    v_lshl_add_u32 v11, v27, 13, v6
    buffer_load_dwordx4 v[184:187], v11, s[12:15], s75 offen offset:0 sc1
    buffer_load_dwordx4 v[188:191], v11, s[12:15], s75 offen offset:256 sc1
    v_bfe_u32 v12, v9, v24, 1
    s_waitcnt vmcnt(6)
    v_xor_b32 v10, s58, v160
    v_bitop3_b32 v10, v161, s58, v10 bitop3:0xbe
    v_bitop3_b32 v10, v162, s58, v10 bitop3:0xbe
    v_bitop3_b32 v10, v163, s58, v10 bitop3:0xbe
    v_bitop3_b32 v10, v164, s58, v10 bitop3:0xbe
    v_bitop3_b32 v10, v165, s58, v10 bitop3:0xbe
    v_bitop3_b32 v10, v166, s58, v10 bitop3:0xbe
    v_bitop3_b32 v10, v167, s58, v10 bitop3:0xbe
    v_and_b32 v10, 0xff, v10
    v_cmp_lt_u32 vcc, v10, v12
    s_and_saveexec_b64 s[72:73], vcc
    v_pk_add_f32 v[16:17], v[16:17], v[160:161]
    v_pk_add_f32 v[18:19], v[18:19], v[162:163]
    v_pk_add_f32 v[20:21], v[20:21], v[164:165]
    v_pk_add_f32 v[22:23], v[22:23], v[166:167]
    v_lshl_add_u32 v9, s74, v24, v9
    s_mov_b64 exec, s[72:73]
    v_cmp_ne_u32 vcc, 0, v9
    s_mov_b64 exec, vcc
    s_cbranch_execz RD_Fm2
    v_lshrrev_b32 v11, v3, v9
    v_ffbl_b32 v11, v11
    v_add_u32 v11, v11, v3
    v_and_b32 v24, 7, v11
    v_add_u32 v3, 1, v24
    v_lshl_add_u32 v11, v24, 13, v6
    buffer_load_dwordx4 v[160:163], v11, s[12:15], s75 offen offset:0 sc1
    buffer_load_dwordx4 v[164:167], v11, s[12:15], s75 offen offset:256 sc1
    v_bfe_u32 v12, v9, v25, 1
    s_waitcnt vmcnt(6)
    v_xor_b32 v10, s58, v168
    v_bitop3_b32 v10, v169, s58, v10 bitop3:0xbe
    v_bitop3_b32 v10, v170, s58, v10 bitop3:0xbe
    v_bitop3_b32 v10, v171, s58, v10 bitop3:0xbe
    v_bitop3_b32 v10, v172, s58, v10 bitop3:0xbe
    v_bitop3_b32 v10, v173, s58, v10 bitop3:0xbe
    v_bitop3_b32 v10, v174, s58, v10 bitop3:0xbe
    v_bitop3_b32 v10, v175, s58, v10 bitop3:0xbe
    v_and_b32 v10, 0xff, v10
    v_cmp_lt_u32 vcc, v10, v12
    s_and_saveexec_b64 s[72:73], vcc
    v_pk_add_f32 v[16:17], v[16:17], v[168:169]
    v_pk_add_f32 v[18:19], v[18:19], v[170:171]
    v_pk_add_f32 v[20:21], v[20:21], v[172:173]
    v_pk_add_f32 v[22:23], v[22:23], v[174:175]
    v_lshl_add_u32 v9, s74, v25, v9
    s_mov_b64 exec, s[72:73]
    v_cmp_ne_u32 vcc, 0, v9
    s_mov_b64 exec, vcc
    s_cbranch_execz RD_Fm2
    v_lshrrev_b32 v11, v3, v9
    v_ffbl_b32 v11, v11
    v_add_u32 v11, v11, v3
    v_and_b32 v25, 7, v11
    v_add_u32 v3, 1, v25
    v_lshl_add_u32 v11, v25, 13, v6
    buffer_load_dwordx4 v[168:171], v11, s[12:15], s75 offen offset:0 sc1
    buffer_load_dwordx4 v[172:175], v11, s[12:15], s75 offen offset:256 sc1
    v_bfe_u32 v12, v9, v26, 1
    s_waitcnt vmcnt(6)
    v_xor_b32 v10, s58, v176
    v_bitop3_b32 v10, v177, s58, v10 bitop3:0xbe
    v_bitop3_b32 v10, v178, s58, v10 bitop3:0xbe
    v_bitop3_b32 v10, v179, s58, v10 bitop3:0xbe
    v_bitop3_b32 v10, v180, s58, v10 bitop3:0xbe
    v_bitop3_b32 v10, v181, s58, v10 bitop3:0xbe
    v_bitop3_b32 v10, v182, s58, v10 bitop3:0xbe
    v_bitop3_b32 v10, v183, s58, v10 bitop3:0xbe
    v_and_b32 v10, 0xff, v10
    v_cmp_lt_u32 vcc, v10, v12
    s_and_saveexec_b64 s[72:73], vcc
    v_pk_add_f32 v[16:17], v[16:17], v[176:177]
    v_pk_add_f32 v[18:19], v[18:19], v[178:179]
    v_pk_add_f32 v[20:21], v[20:21], v[180:181]
    v_pk_add_f32 v[22:23], v[22:23], v[182:183]
    v_lshl_add_u32 v9, s74, v26, v9
    s_mov_b64 exec, s[72:73]
    v_cmp_ne_u32 vcc, 0, v9
    s_mov_b64 exec, vcc
    s_cbranch_execz RD_Fm2
    v_lshrrev_b32 v11, v3, v9
    v_ffbl_b32 v11, v11
    v_add_u32 v11, v11, v3
    v_and_b32 v26, 7, v11
    v_add_u32 v3, 1, v26
    v_lshl_add_u32 v11, v26, 13, v6
    buffer_load_dwordx4 v[176:179], v11, s[12:15], s75 offen offset:0 sc1
    buffer_load_dwordx4 v[180:183], v11, s[12:15], s75 offen offset:256 sc1
    v_bfe_u32 v12, v9, v27, 1
    s_waitcnt vmcnt(6)
    v_xor_b32 v10, s58, v184
    v_bitop3_b32 v10, v185, s58, v10 bitop3:0xbe
    v_bitop3_b32 v10, v186, s58, v10 bitop3:0xbe
    v_bitop3_b32 v10, v187, s58, v10 bitop3:0xbe
    v_bitop3_b32 v10, v188, s58, v10 bitop3:0xbe
    v_bitop3_b32 v10, v189, s58, v10 bitop3:0xbe
    v_bitop3_b32 v10, v190, s58, v10 bitop3:0xbe
    v_bitop3_b32 v10, v191, s58, v10 bitop3:0xbe
    v_and_b32 v10, 0xff, v10
    v_cmp_lt_u32 vcc, v10, v12
    s_and_saveexec_b64 s[72:73], vcc
    v_pk_add_f32 v[16:17], v[16:17], v[184:185]
    v_pk_add_f32 v[18:19], v[18:19], v[186:187]
    v_pk_add_f32 v[20:21], v[20:21], v[188:189]
    v_pk_add_f32 v[22:23], v[22:23], v[190:191]
    v_lshl_add_u32 v9, s74, v27, v9
    s_mov_b64 exec, s[72:73]
    v_cmp_ne_u32 vcc, 0, v9
    s_mov_b64 exec, vcc
    s_cbranch_execz RD_Fm2
    s_sub_u32 s62, s62, 1
    s_cbranch_scc0 RL_Fm2
RD_Fm2:
    s_mov_b64 exec, -1
    v_cvt_pk_bf16_f32 v24, v16, v20
    v_cvt_pk_bf16_f32 v25, v17, v21
    v_cvt_pk_bf16_f32 v26, v18, v22
    v_cvt_pk_bf16_f32 v27, v19, v23
    v_dot2_f32_bf16 v16, v24, v224, 0
    v_dot2_f32_bf16 v17, v25, v225, 0
    v_dot2_f32_bf16 v18, v26, v226, 0
    v_dot2_f32_bf16 v19, v27, v227, 0
    v_dot2_f32_bf16 v20, v24, v228, 0
    v_dot2_f32_bf16 v21, v25, v229, 0
    v_dot2_f32_bf16 v22, v26, v230, 0
    v_dot2_f32_bf16 v23, v27, v231, 0
    v_cvt_pk_bf16_f32 v24, v16, v20
    v_cvt_pk_bf16_f32 v25, v17, v21
    v_cvt_pk_bf16_f32 v26, v18, v22
    v_cvt_pk_bf16_f32 v27, v19, v23
    v_dot2_f32_bf16 v16, v24, s76, v40
    v_dot2_f32_bf16 v17, v25, s76, v41
    v_dot2_f32_bf16 v18, v26, s76, v42
    v_dot2_f32_bf16 v19, v27, s76, v43
    v_dot2_f32_bf16 v20, v24, s77, v44
    v_dot2_f32_bf16 v21, v25, s77, v45
    v_dot2_f32_bf16 v22, v26, s77, v46
    v_dot2_f32_bf16 v23, v27, s77, v47
    v_cvt_pk_bf16_f32 v24, v16, v20
    v_cvt_pk_bf16_f32 v25, v17, v21
    v_cvt_pk_bf16_f32 v26, v18, v22
    v_cvt_pk_bf16_f32 v27, v19, v23
    v_dot2_f32_bf16 v28, v24, s78, 0
    v_dot2_f32_bf16 v28, v25, s78, v28
    v_dot2_f32_bf16 v28, v26, s78, v28
    v_dot2_f32_bf16 v28, v27, s78, v28
    s_nop 2
    v_add_f32_dpp v28, v28, v28 row_ror:4 row_mask:0xf bank_mask:0xf
    s_nop 1
    v_add_f32_dpp v28, v28, v28 row_ror:8 row_mask:0xf bank_mask:0xf
    v_mov_b32 v30, v28
    s_nop 1
    v_permlane16_swap_b32 v28, v30
    v_add_f32 v28, v28, v30
    v_mov_b32 v30, v28
    s_nop 1
    v_permlane32_swap_b32 v28, v30
    v_add_f32 v28, v28, v30
    v_mul_f32 v28, 0xbc000000, v28
    v_dot2_f32_bf16 v16, v24, s76, v28
    v_dot2_f32_bf16 v17, v25, s76, v28
    v_dot2_f32_bf16 v18, v26, s76, v28
    v_dot2_f32_bf16 v19, v27, s76, v28
    v_dot2_f32_bf16 v20, v24, s77, v28
    v_dot2_f32_bf16 v21, v25, s77, v28
    v_dot2_f32_bf16 v22, v26, s77, v28
    v_dot2_f32_bf16 v23, v27, s77, v28
    v_pk_mul_f32 v[30:31], v[16:17], v[16:17]
    v_pk_fma_f32 v[30:31], v[18:19], v[18:19], v[30:31]
    v_pk_fma_f32 v[30:31], v[20:21], v[20:21], v[30:31]
    v_pk_fma_f32 v[30:31], v[22:23], v[22:23], v[30:31]
    v_add_f32 v29, v30, v31
    s_nop 1
    v_add_f32_dpp v29, v29, v29 row_ror:4 row_mask:0xf bank_mask:0xf
    s_nop 1
    v_add_f32_dpp v29, v29, v29 row_ror:8 row_mask:0xf bank_mask:0xf
    v_mov_b32 v30, v29
    s_nop 1
    v_permlane16_swap_b32 v29, v30
    v_add_f32 v29, v29, v30
    v_mov_b32 v30, v29
    s_nop 1
    v_permlane32_swap_b32 v29, v30
    v_add_f32 v29, v29, v30
    s_mov_b64 exec, 0xf
    ds_write_b64 v7, v[28:29] offset:27072
    s_mov_b64 exec, -1
    s_waitcnt lgkmcnt(0)
    s_barrier
    ds_read_b128 v[32:35], v2 offset:27072
    ds_read_b128 v[36:39], v2 offset:27088
    s_waitcnt lgkmcnt(0)
    v_pk_add_f32 v[28:29], v[32:33], v[34:35]
    v_pk_add_f32 v[30:31], v[36:37], v[38:39]
    v_pk_add_f32 v[28:29], v[28:29], v[30:31]
    v_pk_mul_f32 v[28:29], v[28:29], v[248:249]
    v_mul_f32 v30, -0.5, v28
    v_fma_f32 v32, v32, 0.5, v30
    v_fma_f32 v34, v34, 0.5, v30
    v_fma_f32 v36, v36, 0.5, v30
    v_fma_f32 v38, v38, 0.5, v30
    v_fmac_f32 v29, v32, v32
    v_fmac_f32 v29, v34, v34
    v_fmac_f32 v29, v36, v36
    v_fmac_f32 v29, v38, v38
    v_cvt_pk_bf16_f32 v30, v28, v29
    v_and_b32 v29, s66, v30
    v_lshlrev_b32 v28, 16, v30
    v_add_f32 v29, s71, v29
    v_cvt_pk_bf16_f32 v29, v29, v29
    v_dot2_f32_bf16 v16, v24, s76, v28
    v_and_b32 v29, s66, v29
    v_dot2_f32_bf16 v17, v25, s76, v28
    v_sqrt_f32 v29, v29
    v_dot2_f32_bf16 v18, v26, s76, v28
    v_dot2_f32_bf16 v19, v27, s76, v28
    v_cvt_pk_bf16_f32 v29, v29, v29
    v_dot2_f32_bf16 v20, v24, s77, v28
    v_and_b32 v29, s66, v29
    v_dot2_f32_bf16 v21, v25, s77, v28
    v_rcp_f32 v30, v29
    v_dot2_f32_bf16 v22, v26, s77, v28
    v_dot2_f32_bf16 v23, v27, s77, v28
    v_cvt_pk_bf16_f32 v24, v16, v20
    v_cvt_pk_bf16_f32 v25, v17, v21
    v_cvt_pk_bf16_f32 v26, v18, v22
    v_cvt_pk_bf16_f32 v27, v19, v23
    v_lshlrev_b32 v16, 16, v24
    v_and_b32 v20, s66, v24
    v_lshlrev_b32 v17, 16, v25
    v_and_b32 v21, s66, v25
    v_lshlrev_b32 v18, 16, v26
    v_and_b32 v22, s66, v26
    v_lshlrev_b32 v19, 16, v27
    v_and_b32 v23, s66, v27
    v_pk_mul_f32 v[16:17], v[16:17], v[30:31] op_sel_hi:[1,0]
    v_pk_mul_f32 v[20:21], v[20:21], v[30:31] op_sel_hi:[1,0]
    v_pk_mul_f32 v[18:19], v[18:19], v[30:31] op_sel_hi:[1,0]
    v_pk_mul_f32 v[22:23], v[22:23], v[30:31] op_sel_hi:[1,0]
    v_cvt_pk_bf16_f32 v24, v16, v20
    v_cvt_pk_bf16_f32 v25, v17, v21
    v_cvt_pk_bf16_f32 v26, v18, v22
    v_cvt_pk_bf16_f32 v27, v19, v23
    v_dot2_f32_bf16 v16, v24, v240, 0
    v_dot2_f32_bf16 v17, v25, v241, 0
    v_dot2_f32_bf16 v18, v26, v242, 0
    v_dot2_f32_bf16 v19, v27, v243, 0
    v_dot2_f32_bf16 v20, v24, v244, 0
    v_dot2_f32_bf16 v21, v25, v245, 0
    v_dot2_f32_bf16 v22, v26, v246, 0
    v_dot2_f32_bf16 v23, v27, v247, 0
    v_cvt_pk_bf16_f32 v24, v16, v20
    v_cvt_pk_bf16_f32 v25, v17, v21
    v_cvt_pk_bf16_f32 v26, v18, v22
    v_cvt_pk_bf16_f32 v27, v19, v23
    v_dot2_f32_bf16 v16, v24, s76, v232
    v_dot2_f32_bf16 v17, v25, s76, v233
    v_dot2_f32_bf16 v18, v26, s76, v234
    v_dot2_f32_bf16 v19, v27, s76, v235
    v_dot2_f32_bf16 v20, v24, s77, v236
    v_dot2_f32_bf16 v21, v25, s77, v237
    v_dot2_f32_bf16 v22, v26, s77, v238
    v_dot2_f32_bf16 v23, v27, s77, v239
    v_cvt_pk_bf16_f32 v24, v16, v20
    v_cvt_pk_bf16_f32 v25, v17, v21
    v_cvt_pk_bf16_f32 v26, v18, v22
    v_cvt_pk_bf16_f32 v27, v19, v23
    v_mov_b32_dpp v48, v24 quad_perm:[0,1,2,3] row_mask:0xf bank_mask:0x1
    v_mov_b32_dpp v49, v25 quad_perm:[0,1,2,3] row_mask:0xf bank_mask:0x1
    v_mov_b32_dpp v50, v26 quad_perm:[0,1,2,3] row_mask:0xf bank_mask:0x1
    v_mov_b32_dpp v51, v27 quad_perm:[0,1,2,3] row_mask:0xf bank_mask:0x1
    s_nop 1
    v_mfma_f32_16x16x32_bf16 v[192:195], v[64:67], v[48:51], 0
    v_mov_b32_dpp v52, v24 quad_perm:[0,1,2,3] row_mask:0xf bank_mask:0x2
    v_mov_b32_dpp v53, v25 quad_perm:[0,1,2,3] row_mask:0xf bank_mask:0x2
    v_mfma_f32_16x16x32_bf16 v[196:199], v[68:71], v[48:51], 0
    v_mov_b32_dpp v54, v26 quad_perm:[0,1,2,3] row_mask:0xf bank_mask:0x2
    v_mov_b32_dpp v55, v27 quad_perm:[0,1,2,3] row_mask:0xf bank_mask:0x2
    s_nop 1
    v_mfma_f32_16x16x32_bf16 v[192:195], v[80:83], v[52:55], v[192:195]
    v_mov_b32_dpp v56, v24 quad_perm:[0,1,2,3] row_mask:0xf bank_mask:0x4
    v_mov_b32_dpp v57, v25 quad_perm:[0,1,2,3] row_mask:0xf bank_mask:0x4
    v_mfma_f32_16x16x32_bf16 v[196:199], v[84:87], v[52:55], v[196:199]
    v_mov_b32_dpp v58, v26 quad_perm:[0,1,2,3] row_mask:0xf bank_mask:0x4
    v_mov_b32_dpp v59, v27 quad_perm:[0,1,2,3] row_mask:0xf bank_mask:0x4
    s_nop 1
    v_mfma_f32_16x16x32_bf16 v[192:195], v[96:99], v[56:59], v[192:195]
    v_mov_b32_dpp v60, v24 quad_perm:[0,1,2,3] row_mask:0xf bank_mask:0x8
    v_mov_b32_dpp v61, v25 quad_perm:[0,1,2,3] row_mask:0xf bank_mask:0x8
    v_mfma_f32_16x16x32_bf16 v[196:199], v[100:103], v[56:59], v[196:199]
    v_mov_b32_dpp v62, v26 quad_perm:[0,1,2,3] row_mask:0xf bank_mask:0x8
    v_mov_b32_dpp v63, v27 quad_perm:[0,1,2,3] row_mask:0xf bank_mask:0x8
    s_nop 1
    v_mfma_f32_16x16x32_bf16 v[192:195], v[112:115], v[60:63], v[192:195]
    v_mfma_f32_16x16x32_bf16 v[196:199], v[116:119], v[60:63], v[196:199]
    v_mfma_f32_16x16x32_bf16 v[200:203], v[72:75], v[48:51], 0
    v_mfma_f32_16x16x32_bf16 v[204:207], v[76:79], v[48:51], 0
    v_mfma_f32_16x16x32_bf16 v[200:203], v[88:91], v[52:55], v[200:203]
    v_mfma_f32_16x16x32_bf16 v[204:207], v[92:95], v[52:55], v[204:207]
    s_nop 2
    v_add_f32_dpp v208, v192, v192 row_shl:4 row_mask:0xf bank_mask:0x5
    v_add_f32_dpp v210, v193, v193 row_shl:4 row_mask:0xf bank_mask:0x5
    v_mfma_f32_16x16x32_bf16 v[200:203], v[104:107], v[56:59], v[200:203]
    v_add_f32_dpp v212, v194, v194 row_shl:4 row_mask:0xf bank_mask:0x5
    v_add_f32_dpp v214, v195, v195 row_shl:4 row_mask:0xf bank_mask:0x5
    v_mfma_f32_16x16x32_bf16 v[204:207], v[108:111], v[56:59], v[204:207]
    v_add_f32_dpp v208, v196, v196 row_shr:4 row_mask:0xf bank_mask:0xa
    v_add_f32_dpp v210, v197, v197 row_shr:4 row_mask:0xf bank_mask:0xa
    v_mfma_f32_16x16x32_bf16 v[200:203], v[120:123], v[60:63], v[200:203]
    v_add_f32_dpp v212, v198, v198 row_shr:4 row_mask:0xf bank_mask:0xa
    v_add_f32_dpp v214, v199, v199 row_shr:4 row_mask:0xf bank_mask:0xa
    v_mfma_f32_16x16x32_bf16 v[204:207], v[124:127], v[60:63], v[204:207]
    s_nop 4
    v_add_f32_dpp v209, v200, v200 row_shl:4 row_mask:0xf bank_mask:0x5
    v_add_f32_dpp v211, v201, v201 row_shl:4 row_mask:0xf bank_mask:0x5
    v_add_f32_dpp v213, v202, v202 row_shl:4 row_mask:0xf bank_mask:0x5
    v_add_f32_dpp v215, v203, v203 row_shl:4 row_mask:0xf bank_mask:0x5
    v_add_f32_dpp v209, v204, v204 row_shr:4 row_mask:0xf bank_mask:0xa
    v_add_f32_dpp v211, v205, v205 row_shr:4 row_mask:0xf bank_mask:0xa
    v_add_f32_dpp v213, v206, v206 row_shr:4 row_mask:0xf bank_mask:0xa
    v_add_f32_dpp v215, v207, v207 row_shr:4 row_mask:0xf bank_mask:0xa
    v_add_f32_dpp v216, v208, v208 row_shl:8 row_mask:0xf bank_mask:0x3
    v_add_f32_dpp v217, v210, v210 row_shl:8 row_mask:0xf bank_mask:0x3
    v_add_f32_dpp v218, v212, v212 row_shl:8 row_mask:0xf bank_mask:0x3
    v_add_f32_dpp v219, v214, v214 row_shl:8 row_mask:0xf bank_mask:0x3
    v_add_f32_dpp v216, v209, v209 row_shr:8 row_mask:0xf bank_mask:0xc
    v_add_f32_dpp v217, v211, v211 row_shr:8 row_mask:0xf bank_mask:0xc
    v_add_f32_dpp v218, v213, v213 row_shr:8 row_mask:0xf bank_mask:0xc
    v_add_f32_dpp v219, v215, v215 row_shr:8 row_mask:0xf bank_mask:0xc
    ds_write_b128 v8, v[216:219] offset:0
    s_waitcnt lgkmcnt(0)
    s_barrier
    ds_read_b128 v[16:19], v14 offset:0
    ds_read_b128 v[20:23], v14 offset:1024
    ds_read_b128 v[24:27], v14 offset:2048
    ds_read_b128 v[28:31], v14 offset:3072
    s_waitcnt lgkmcnt(2)
    v_pk_add_f32 v[16:17], v[16:17], v[20:21]
    v_pk_add_f32 v[18:19], v[18:19], v[22:23]
    s_waitcnt lgkmcnt(0)
    v_pk_add_f32 v[24:25], v[24:25], v[28:29]
    v_pk_add_f32 v[26:27], v[26:27], v[30:31]
    v_pk_add_f32 v[16:17], v[16:17], v[24:25]
    v_pk_add_f32 v[18:19], v[18:19], v[26:27]
    v_cvt_pk_bf16_f32 v20, v16, v17
    v_cvt_pk_bf16_f32 v21, v18, v19
    v_lshlrev_b32 v16, 16, v20
    v_and_b32 v17, s66, v20
    v_lshlrev_b32 v18, 16, v21
    v_and_b32 v19, s66, v21
    v_mul_f32_dpp v20, v16, v16 row_ror:8 row_mask:0xf bank_mask:0xf
    v_mul_f32_dpp v21, v17, v17 row_ror:8 row_mask:0xf bank_mask:0xf
    v_mul_f32_dpp v22, v18, v18 row_ror:8 row_mask:0xf bank_mask:0xf
    v_mul_f32_dpp v23, v19, v19 row_ror:8 row_mask:0xf bank_mask:0xf
    v_cvt_pk_bf16_f32 v16, v20, v21
    v_cvt_pk_bf16_f32 v17, v22, v23
    s_nop 0
    v_mov_b32_dpp v48, v16 quad_perm:[0,1,2,3] row_mask:0xf bank_mask:0x1
    v_mov_b32_dpp v49, v17 quad_perm:[0,1,2,3] row_mask:0xf bank_mask:0x1
    v_mov_b32_dpp v50, v16 row_ror:4 row_mask:0xf bank_mask:0x1
    v_mov_b32_dpp v51, v17 row_ror:4 row_mask:0xf bank_mask:0x1
    s_nop 1
    v_mfma_f32_16x16x32_bf16 v[192:195], v[128:131], v[48:51], 0
    v_mov_b32_dpp v52, v16 row_ror:4 row_mask:0xf bank_mask:0x2
    v_mov_b32_dpp v53, v17 row_ror:4 row_mask:0xf bank_mask:0x2
    v_mfma_f32_16x16x32_bf16 v[196:199], v[144:147], v[48:51], 0
    v_mov_b32_dpp v54, v16 quad_perm:[0,1,2,3] row_mask:0xf bank_mask:0x2
    v_mov_b32_dpp v55, v17 quad_perm:[0,1,2,3] row_mask:0xf bank_mask:0x2
    s_nop 1
    v_mfma_f32_16x16x32_bf16 v[192:195], v[132:135], v[52:55], v[192:195]
    v_mov_b32_dpp v56, v16 quad_perm:[0,1,2,3] row_mask:0xf bank_mask:0x4
    v_mov_b32_dpp v57, v17 quad_perm:[0,1,2,3] row_mask:0xf bank_mask:0x4
    v_mfma_f32_16x16x32_bf16 v[196:199], v[148:151], v[52:55], v[196:199]
    v_mov_b32_dpp v58, v16 row_ror:4 row_mask:0xf bank_mask:0x4
    v_mov_b32_dpp v59, v17 row_ror:4 row_mask:0xf bank_mask:0x4
    s_nop 1
    v_mfma_f32_16x16x32_bf16 v[192:195], v[136:139], v[56:59], v[192:195]
    v_mov_b32_dpp v60, v16 row_ror:4 row_mask:0xf bank_mask:0x8
    v_mov_b32_dpp v61, v17 row_ror:4 row_mask:0xf bank_mask:0x8
    v_mfma_f32_16x16x32_bf16 v[196:199], v[152:155], v[56:59], v[196:199]
    v_mov_b32_dpp v62, v16 quad_perm:[0,1,2,3] row_mask:0xf bank_mask:0x8
    v_mov_b32_dpp v63, v17 quad_perm:[0,1,2,3] row_mask:0xf bank_mask:0x8
    s_nop 1
    v_mfma_f32_16x16x32_bf16 v[192:195], v[140:143], v[60:63], v[192:195]
    v_mfma_f32_16x16x32_bf16 v[196:199], v[156:159], v[60:63], v[196:199]
    s_mov_b32 s61, 0x100000
    s_mov_b32 s64, 0x103800
    s_mov_b32 exec_lo, 0x33333333
    s_mov_b32 exec_hi, 0x33333333
    s_nop 2
    v_bfi_b32 v192, s65, v4, v192
    v_bfi_b32 v193, s65, v4, v193
    v_bfi_b32 v194, s65, v4, v194
    v_bfi_b32 v195, s65, v4, v195
    buffer_store_dwordx4 v[192:195], v15, s[12:15], s61 offen sc1
    v_bfi_b32 v196, s65, v4, v196
    v_bfi_b32 v197, s65, v4, v197
    v_bfi_b32 v198, s65, v4, v198
    v_bfi_b32 v199, s65, v4, v199
    buffer_store_dwordx4 v[196:199], v15, s[12:15], s64 offen sc1
DONE_F:
    s_waitcnt vmcnt(0)
    s_endpgm
RF_md2:
    s_sub_u32 s62, s62, 1
    s_cbranch_scc1 KF_md2
    s_mov_b32 s61, 0x2000
    buffer_load_dwordx4 v[160:163], v3, s[12:15], s61 offen offset:0 sc1
    s_mov_b32 s61, 0x2000
    buffer_load_dwordx4 v[164:167], v3, s[12:15], s61 offen offset:256 sc1
    s_mov_b32 s61, 0x2000
    buffer_load_dwordx4 v[168:171], v3, s[12:15], s61 offen offset:2048 sc1
    s_mov_b32 s61, 0x2000
    buffer_load_dwordx4 v[172:175], v3, s[12:15], s61 offen offset:2304 sc1
    s_mov_b32 s61, 0x3000
    buffer_load_dwordx4 v[176:179], v3, s[12:15], s61 offen offset:0 sc1
    s_mov_b32 s61, 0x3000
    buffer_load_dwordx4 v[180:183], v3, s[12:15], s61 offen offset:256 sc1
    s_waitcnt vmcnt(0)
    s_branch CF_md2
.p2align 6
CLS_Y:
    s_sub_u32 s61, s2, 112
    s_lshr_b32 s61, s61, 3
    s_lshl_b32 s61, s61, 2
    s_add_u32 s61, s61, s3
    s_min_u32 s61, s61, 63
    s_lshl_b32 s61, s61, 3
    v_lshrrev_b32 v10, 3, v1
    v_add_u32 v10, s61, v10
    v_and_b32 v11, 7, v1
    s_and_b32 s64, s2, 7
    s_mul_i32 s61, s64, 768
    s_lshl_b32 s64, s64, 10
    v_min_u32 v12, 5, v11
    v_lshlrev_b32 v12, 7, v12
    v_add_u32 v12, s61, v12
    v_mul_u32_u24 v13, 0x1800, v10
    v_add_u32 v12, v12, v13
    global_load_dword v60, v12, s[52:53] nt
    v_lshlrev_b32 v10, 13, v10
    v_lshl_add_u32 v10, v11, 7, v10
    v_add_u32 v10, s64, v10
    global_load_dword v60, v10, s[38:39] nt
    buffer_load_dwordx4 a[0:3], v2, s[4:7], s59 offen offset:0 nt
    buffer_load_dwordx4 a[4:7], v2, s[4:7], s59 offen offset:128 nt
    buffer_load_dwordx4 a[8:11], v2, s[4:7], s59 offen offset:1024 nt
    buffer_load_dwordx4 a[12:15], v2, s[4:7], s59 offen offset:1152 nt
    buffer_load_dwordx4 a[16:19], v2, s[4:7], s59 offen offset:2048 nt
    buffer_load_dwordx4 a[20:23], v2, s[4:7], s59 offen offset:2176 nt
    buffer_load_dwordx4 a[24:27], v2, s[4:7], s59 offen offset:3072 nt
    buffer_load_dwordx4 a[28:31], v2, s[4:7], s59 offen offset:3200 nt
    s_add_u32 s79, s59, 4096
    s_pack_lh_b32_b16 s59, s79, s59
    s_waitcnt lgkmcnt(0)
    s_add_u32 s58, s58, 0x9e3779b9
    v_mov_b32 v4, s58
    buffer_load_dwordx4 a[32:35], v2, s[4:7], s59 offen offset:0 nt
    buffer_load_dwordx4 a[36:39], v2, s[4:7], s59 offen offset:128 nt
    buffer_load_dwordx4 a[40:43], v2, s[4:7], s59 offen offset:1024 nt
    buffer_load_dwordx4 a[44:47], v2, s[4:7], s59 offen offset:1152 nt
    buffer_load_dwordx4 a[48:51], v2, s[4:7], s59 offen offset:2048 nt
    buffer_load_dwordx4 a[52:55], v2, s[4:7], s59 offen offset:2176 nt
    buffer_load_dwordx4 a[56:59], v2, s[4:7], s59 offen offset:3072 nt
    buffer_load_dwordx4 a[60:63], v2, s[4:7], s59 offen offset:3200 nt
    s_add_u32 s79, s59, 12288
    s_pack_lh_b32_b16 s59, s79, s59
    buffer_load_dwordx4 a[64:67], v2, s[4:7], s59 offen offset:0 nt
    buffer_load_dwordx4 a[68:71], v2, s[4:7], s59 offen offset:128 nt
    buffer_load_dwordx4 a[72:75], v2, s[4:7], s59 offen offset:1024 nt
    buffer_load_dwordx4 a[76:79], v2, s[4:7], s59 offen offset:1152 nt
    buffer_load_dwordx4 a[80:83], v2, s[4:7], s59 offen offset:2048 nt
    buffer_load_dwordx4 a[84:87], v2, s[4:7], s59 offen offset:2176 nt
    buffer_load_dwordx4 a[88:91], v2, s[4:7], s59 offen offset:3072 nt
    buffer_load_dwordx4 a[92:95], v2, s[4:7], s59 offen offset:3200 nt
    s_add_u32 s79, s59, 4096
    s_pack_lh_b32_b16 s59, s79, s59
    buffer_load_dwordx4 a[96:99], v2, s[4:7], s59 offen offset:0 nt
    buffer_load_dwordx4 a[100:103], v2, s[4:7], s59 offen offset:128 nt
    buffer_load_dwordx4 a[104:107], v2, s[4:7], s59 offen offset:1024 nt
    buffer_load_dwordx4 a[108:111], v2, s[4:7], s59 offen offset:1152 nt
    buffer_load_dwordx4 a[112:115], v2, s[4:7], s59 offen offset:2048 nt
    buffer_load_dwordx4 a[116:119], v2, s[4:7], s59 offen offset:2176 nt
    buffer_load_dwordx4 a[120:123], v2, s[4:7], s59 offen offset:3072 nt
    buffer_load_dwordx4 a[124:127], v2, s[4:7], s59 offen offset:3200 nt
    s_add_u32 s79, s59, 12288
    s_pack_lh_b32_b16 s59, s79, s59
    buffer_load_dwordx4 a[128:131], v2, s[4:7], s59 offen offset:0 nt
    buffer_load_dwordx4 a[132:135], v2, s[4:7], s59 offen offset:128 nt
    buffer_load_dwordx4 a[136:139], v2, s[4:7], s59 offen offset:1024 nt
    buffer_load_dwordx4 a[140:143], v2, s[4:7], s59 offen offset:1152 nt
    buffer_load_dwordx4 a[144:147], v2, s[4:7], s59 offen offset:2048 nt
    buffer_load_dwordx4 a[148:151], v2, s[4:7], s59 offen offset:2176 nt
    buffer_load_dwordx4 a[152:155], v2, s[4:7], s59 offen offset:3072 nt
    buffer_load_dwordx4 a[156:159], v2, s[4:7], s59 offen offset:3200 nt
    s_add_u32 s79, s59, 4096
    s_pack_lh_b32_b16 s59, s79, s59
    buffer_load_dwordx4 a[160:163], v2, s[4:7], s59 offen offset:0 nt
    buffer_load_dwordx4 a[164:167], v2, s[4:7], s59 offen offset:128 nt
    buffer_load_dwordx4 a[168:171], v2, s[4:7], s59 offen offset:1024 nt
    buffer_load_dwordx4 a[172:175], v2, s[4:7], s59 offen offset:1152 nt
    buffer_load_dwordx4 a[176:179], v2, s[4:7], s59 offen offset:2048 nt
    buffer_load_dwordx4 a[180:183], v2, s[4:7], s59 offen offset:2176 nt
    buffer_load_dwordx4 a[184:187], v2, s[4:7], s59 offen offset:3072 nt
    buffer_load_dwordx4 a[188:191], v2, s[4:7], s59 offen offset:3200 nt
    s_add_u32 s79, s59, 12288
    s_pack_lh_b32_b16 s59, s79, s59
    buffer_load_dwordx4 a[192:195], v2, s[4:7], s59 offen offset:0 nt
    buffer_load_dwordx4 a[196:199], v2, s[4:7], s59 offen offset:128 nt
    buffer_load_dwordx4 a[200:203], v2, s[4:7], s59 offen offset:1024 nt
    buffer_load_dwordx4 a[204:207], v2, s[4:7], s59 offen offset:1152 nt
    buffer_load_dwordx4 a[208:211], v2, s[4:7], s59 offen offset:2048 nt
    buffer_load_dwordx4 a[212:215], v2, s[4:7], s59 offen offset:2176 nt
    buffer_load_dwordx4 a[216:219], v2, s[4:7], s59 offen offset:3072 nt
    buffer_load_dwordx4 a[220:223], v2, s[4:7], s59 offen offset:3200 nt
    s_add_u32 s79, s59, 4096
    s_pack_lh_b32_b16 s59, s79, s59
    buffer_load_dwordx4 a[224:227], v2, s[4:7], s59 offen offset:0 nt
    buffer_load_dwordx4 a[228:231], v2, s[4:7], s59 offen offset:128 nt
    buffer_load_dwordx4 a[232:235], v2, s[4:7], s59 offen offset:1024 nt
    buffer_load_dwordx4 a[236:239], v2, s[4:7], s59 offen offset:1152 nt
    buffer_load_dwordx4 a[240:243], v2, s[4:7], s59 offen offset:2048 nt
    buffer_load_dwordx4 a[244:247], v2, s[4:7], s59 offen offset:2176 nt
    buffer_load_dwordx4 a[248:251], v2, s[4:7], s59 offen offset:3072 nt
    buffer_load_dwordx4 a[252:255], v2, s[4:7], s59 offen offset:3200 nt
    s_add_u32 s79, s59, 12288
    s_pack_lh_b32_b16 s59, s79, s59
    v_and_b32 v10, 3, v1
    v_lshlrev_b32 v10, 9, v10
    v_lshrrev_b32 v11, 4, v1
    v_lshl_add_u32 v10, v11, 5, v10
    v_bfe_u32 v11, v1, 2, 1
    v_lshl_add_u32 v10, v11, 7, v10
    s_lshr_b32 s61, s2, 3
    s_lshl_b32 s61, s61, 11
    v_add_u32 v6, s61, v10
    s_mov_b32 s61, 0x10000
    buffer_load_dwordx4 v[224:227], v6, s[12:15], s61 offen offset:0 sc1
    s_mov_b32 s61, 0x10000
    buffer_load_dwordx4 v[228:231], v6, s[12:15], s61 offen offset:16 sc1
    s_mov_b32 s61, 0x10000
    buffer_load_dwordx4 v[232:235], v6, s[12:15], s61 offen offset:256 sc1
    s_mov_b32 s61, 0x10000
    buffer_load_dwordx4 v[236:239], v6, s[12:15], s61 offen offset:272 sc1
    buffer_load_dwordx4 v[64:67], v3, s[8:11], s60 offen offset:0 nt
    buffer_load_dwordx4 v[68:71], v3, s[8:11], s60 offen offset:1024 nt
    buffer_load_dwordx4 v[72:75], v3, s[8:11], s60 offen offset:2048 nt
    buffer_load_dwordx4 v[76:79], v3, s[8:11], s60 offen offset:3072 nt
    s_add_u32 s79, s60, 4096
    s_pack_lh_b32_b16 s60, s79, s60
    buffer_load_dwordx4 v[80:83], v3, s[8:11], s60 offen offset:0 nt
    buffer_load_dwordx4 v[84:87], v3, s[8:11], s60 offen offset:1024 nt
    buffer_load_dwordx4 v[88:91], v3, s[8:11], s60 offen offset:2048 nt
    buffer_load_dwordx4 v[92:95], v3, s[8:11], s60 offen offset:3072 nt
    s_add_u32 s79, s60, 4096
    s_pack_lh_b32_b16 s60, s79, s60
    s_mov_b32 s61, 0x10000
    buffer_load_dwordx4 v[224:227], v6, s[12:15], s61 offen offset:0 sc1
    s_mov_b32 s61, 0x10000
    buffer_load_dwordx4 v[228:231], v6, s[12:15], s61 offen offset:16 sc1
    s_mov_b32 s61, 0x10000
    buffer_load_dwordx4 v[232:235], v6, s[12:15], s61 offen offset:256 sc1
    s_mov_b32 s61, 0x10000
    buffer_load_dwordx4 v[236:239], v6, s[12:15], s61 offen offset:272 sc1
    buffer_load_dwordx4 v[96:99], v3, s[8:11], s60 offen offset:0 nt
    buffer_load_dwordx4 v[100:103], v3, s[8:11], s60 offen offset:1024 nt
    buffer_load_dwordx4 v[104:107], v3, s[8:11], s60 offen offset:2048 nt
    buffer_load_dwordx4 v[108:111], v3, s[8:11], s60 offen offset:3072 nt
    s_add_u32 s79, s60, 4096
    s_pack_lh_b32_b16 s60, s79, s60
    buffer_load_dwordx4 v[112:115], v3, s[8:11], s60 offen offset:0 nt
    buffer_load_dwordx4 v[116:119], v3, s[8:11], s60 offen offset:1024 nt
    buffer_load_dwordx4 v[120:123], v3, s[8:11], s60 offen offset:2048 nt
    buffer_load_dwordx4 v[124:127], v3, s[8:11], s60 offen offset:3072 nt
    s_add_u32 s79, s60, 4096
    s_pack_lh_b32_b16 s60, s79, s60
    s_mov_b32 s61, 0x10000
    buffer_load_dwordx4 v[224:227], v6, s[12:15], s61 offen offset:0 sc1
    s_mov_b32 s61, 0x10000
    buffer_load_dwordx4 v[228:231], v6, s[12:15], s61 offen offset:16 sc1
    s_mov_b32 s61, 0x10000
    buffer_load_dwordx4 v[232:235], v6, s[12:15], s61 offen offset:256 sc1
    s_mov_b32 s61, 0x10000
    buffer_load_dwordx4 v[236:239], v6, s[12:15], s61 offen offset:272 sc1
    buffer_load_dwordx4 v[128:131], v3, s[8:11], s60 offen offset:0 nt
    buffer_load_dwordx4 v[132:135], v3, s[8:11], s60 offen offset:1024 nt
    buffer_load_dwordx4 v[136:139], v3, s[8:11], s60 offen offset:2048 nt
    buffer_load_dwordx4 v[140:143], v3, s[8:11], s60 offen offset:3072 nt
    s_add_u32 s79, s60, 4096
    s_pack_lh_b32_b16 s60, s79, s60
    buffer_load_dwordx4 v[144:147], v3, s[8:11], s60 offen offset:0 nt
    buffer_load_dwordx4 v[148:151], v3, s[8:11], s60 offen offset:1024 nt
    buffer_load_dwordx4 v[152:155], v3, s[8:11], s60 offen offset:2048 nt
    buffer_load_dwordx4 v[156:159], v3, s[8:11], s60 offen offset:3072 nt
    s_add_u32 s79, s60, 4096
    s_pack_lh_b32_b16 s60, s79, s60
    s_waitcnt vmcnt(32)
    v_mov_b32 v48, v224
    v_mov_b32 v49, v225
    v_mov_b32 v50, v226
    v_mov_b32 v51, v227
    v_mov_b32 v52, v228
    v_mov_b32 v53, v229
    v_mov_b32 v54, v230
    v_mov_b32 v55, v231
    v_mov_b32 v56, v232
    v_mov_b32 v57, v233
    v_mov_b32 v58, v234
    v_mov_b32 v59, v235
    v_mov_b32 v60, v236
    v_mov_b32 v61, v237
    v_mov_b32 v62, v238
    v_mov_b32 v63, v239
    v_xor_b32 v10, s58, v48
    v_bitop3_b32 v10, v49, s58, v10 bitop3:0xbe
    v_bitop3_b32 v10, v50, s58, v10 bitop3:0xbe
    v_bitop3_b32 v10, v51, s58, v10 bitop3:0xbe
    v_bitop3_b32 v10, v52, s58, v10 bitop3:0xbe
    v_bitop3_b32 v10, v53, s58, v10 bitop3:0xbe
    v_bitop3_b32 v10, v54, s58, v10 bitop3:0xbe
    v_bitop3_b32 v10, v55, s58, v10 bitop3:0xbe
    v_bitop3_b32 v10, v56, s58, v10 bitop3:0xbe
    v_bitop3_b32 v10, v57, s58, v10 bitop3:0xbe
    v_bitop3_b32 v10, v58, s58, v10 bitop3:0xbe
    v_bitop3_b32 v10, v59, s58, v10 bitop3:0xbe
    v_bitop3_b32 v10, v60, s58, v10 bitop3:0xbe
    v_bitop3_b32 v10, v61, s58, v10 bitop3:0xbe
    v_bitop3_b32 v10, v62, s58, v10 bitop3:0xbe
    v_bitop3_b32 v10, v63, s58, v10 bitop3:0xbe
    v_and_b32 v10, 0xff, v10
    v_cmp_ne_u32 vcc, 0, v10
    s_cbranch_vccz QGO_Y
    s_waitcnt vmcnt(20)
    v_mov_b32 v48, v224
    v_mov_b32 v49, v225
    v_mov_b32 v50, v226
    v_mov_b32 v51, v227
    v_mov_b32 v52, v228
    v_mov_b32 v53, v229
    v_mov_b32 v54, v230
    v_mov_b32 v55, v231
    v_mov_b32 v56, v232
    v_mov_b32 v57, v233
    v_mov_b32 v58, v234
    v_mov_b32 v59, v235
    v_mov_b32 v60, v236
    v_mov_b32 v61, v237
    v_mov_b32 v62, v238
    v_mov_b32 v63, v239
    v_xor_b32 v10, s58, v48
    v_bitop3_b32 v10, v49, s58, v10 bitop3:0xbe
    v_bitop3_b32 v10, v50, s58, v10 bitop3:0xbe
    v_bitop3_b32 v10, v51, s58, v10 bitop3:0xbe
    v_bitop3_b32 v10, v52, s58, v10 bitop3:0xbe
    v_bitop3_b32 v10, v53, s58, v10 bitop3:0xbe
    v_bitop3_b32 v10, v54, s58, v10 bitop3:0xbe
    v_bitop3_b32 v10, v55, s58, v10 bitop3:0xbe
    v_bitop3_b32 v10, v56, s58, v10 bitop3:0xbe
    v_bitop3_b32 v10, v57, s58, v10 bitop3:0xbe
    v_bitop3_b32 v10, v58, s58, v10 bitop3:0xbe
    v_bitop3_b32 v10, v59, s58, v10 bitop3:0xbe
    v_bitop3_b32 v10, v60, s58, v10 bitop3:0xbe
    v_bitop3_b32 v10, v61, s58, v10 bitop3:0xbe
    v_bitop3_b32 v10, v62, s58, v10 bitop3:0xbe
    v_bitop3_b32 v10, v63, s58, v10 bitop3:0xbe
    v_and_b32 v10, 0xff, v10
    v_cmp_ne_u32 vcc, 0, v10
    s_cbranch_vccz QGO_Y
    s_waitcnt vmcnt(8)
    v_mov_b32 v48, v224
    v_mov_b32 v49, v225
    v_mov_b32 v50, v226
    v_mov_b32 v51, v227
    v_mov_b32 v52, v228
    v_mov_b32 v53, v229
    v_mov_b32 v54, v230
    v_mov_b32 v55, v231
    v_mov_b32 v56, v232
    v_mov_b32 v57, v233
    v_mov_b32 v58, v234
    v_mov_b32 v59, v235
    v_mov_b32 v60, v236
    v_mov_b32 v61, v237
    v_mov_b32 v62, v238
    v_mov_b32 v63, v239
    v_xor_b32 v10, s58, v48
    v_bitop3_b32 v10, v49, s58, v10 bitop3:0xbe
    v_bitop3_b32 v10, v50, s58, v10 bitop3:0xbe
    v_bitop3_b32 v10, v51, s58, v10 bitop3:0xbe
    v_bitop3_b32 v10, v52, s58, v10 bitop3:0xbe
    v_bitop3_b32 v10, v53, s58, v10 bitop3:0xbe
    v_bitop3_b32 v10, v54, s58, v10 bitop3:0xbe
    v_bitop3_b32 v10, v55, s58, v10 bitop3:0xbe
    v_bitop3_b32 v10, v56, s58, v10 bitop3:0xbe
    v_bitop3_b32 v10, v57, s58, v10 bitop3:0xbe
    v_bitop3_b32 v10, v58, s58, v10 bitop3:0xbe
    v_bitop3_b32 v10, v59, s58, v10 bitop3:0xbe
    v_bitop3_b32 v10, v60, s58, v10 bitop3:0xbe
    v_bitop3_b32 v10, v61, s58, v10 bitop3:0xbe
    v_bitop3_b32 v10, v62, s58, v10 bitop3:0xbe
    v_bitop3_b32 v10, v63, s58, v10 bitop3:0xbe
    v_and_b32 v10, 0xff, v10
    v_cmp_ne_u32 vcc, 0, v10
    s_cbranch_vccz QGO_Y
    s_mov_b32 s62, 0x40000
QRX_Y:
    s_mov_b32 s61, 0x10000
    buffer_load_dwordx4 v[224:227], v6, s[12:15], s61 offen offset:0 sc1
    s_mov_b32 s61, 0x10000
    buffer_load_dwordx4 v[228:231], v6, s[12:15], s61 offen offset:16 sc1
    s_mov_b32 s61, 0x10000
    buffer_load_dwordx4 v[232:235], v6, s[12:15], s61 offen offset:256 sc1
    s_mov_b32 s61, 0x10000
    buffer_load_dwordx4 v[236:239], v6, s[12:15], s61 offen offset:272 sc1
    s_waitcnt vmcnt(0)
    v_mov_b32 v48, v224
    v_mov_b32 v49, v225
    v_mov_b32 v50, v226
    v_mov_b32 v51, v227
    v_mov_b32 v52, v228
    v_mov_b32 v53, v229
    v_mov_b32 v54, v230
    v_mov_b32 v55, v231
    v_mov_b32 v56, v232
    v_mov_b32 v57, v233
    v_mov_b32 v58, v234
    v_mov_b32 v59, v235
    v_mov_b32 v60, v236
    v_mov_b32 v61, v237
    v_mov_b32 v62, v238
    v_mov_b32 v63, v239
    v_xor_b32 v10, s58, v48
    v_bitop3_b32 v10, v49, s58, v10 bitop3:0xbe
    v_bitop3_b32 v10, v50, s58, v10 bitop3:0xbe
    v_bitop3_b32 v10, v51, s58, v10 bitop3:0xbe
    v_bitop3_b32 v10, v52, s58, v10 bitop3:0xbe
    v_bitop3_b32 v10, v53, s58, v10 bitop3:0xbe
    v_bitop3_b32 v10, v54, s58, v10 bitop3:0xbe
    v_bitop3_b32 v10, v55, s58, v10 bitop3:0xbe
    v_bitop3_b32 v10, v56, s58, v10 bitop3:0xbe
    v_bitop3_b32 v10, v57, s58, v10 bitop3:0xbe
    v_bitop3_b32 v10, v58, s58, v10 bitop3:0xbe
    v_bitop3_b32 v10, v59, s58, v10 bitop3:0xbe
    v_bitop3_b32 v10, v60, s58, v10 bitop3:0xbe
    v_bitop3_b32 v10, v61, s58, v10 bitop3:0xbe
    v_bitop3_b32 v10, v62, s58, v10 bitop3:0xbe
    v_bitop3_b32 v10, v63, s58, v10 bitop3:0xbe
    v_and_b32 v10, 0xff, v10
    v_cmp_ne_u32 vcc, 0, v10
    s_cbranch_vccz QGO_Y
    s_sub_u32 s62, s62, 1
    s_cbranch_scc0 QRX_Y
QGO_Y:
    buffer_load_dwordx4 v[224:227], v3, s[8:11], s60 offen offset:0 nt
    v_perm_b32 v16, v49, v48, s68
    v_perm_b32 v17, v51, v50, s68
    v_perm_b32 v18, v53, v52, s68
    v_perm_b32 v19, v55, v54, s68
    v_perm_b32 v20, v57, v56, s68
    v_perm_b32 v21, v59, v58, s68
    v_perm_b32 v22, v61, v60, s68
    buffer_load_dwordx4 v[228:231], v3, s[8:11], s60 offen offset:1024 nt
    v_perm_b32 v23, v63, v62, s68
    v_cndmask_b32 v32, 0, v16, s[72:73]
    v_cndmask_b32 v33, 0, v17, s[72:73]
    v_cndmask_b32 v34, 0, v18, s[72:73]
    v_cndmask_b32 v35, 0, v19, s[72:73]
    v_cndmask_b32 v36, 0, v20, s[72:73]
    v_cndmask_b32 v37, 0, v21, s[72:73]
    v_cndmask_b32 v38, 0, v22, s[72:73]
    buffer_load_dwordx4 v[232:235], v3, s[8:11], s60 offen offset:2048 nt
    v_cndmask_b32 v39, 0, v23, s[72:73]
    v_cndmask_b32 v40, 0, v16, s[74:75]
    v_cndmask_b32 v41, 0, v17, s[74:75]
    v_cndmask_b32 v42, 0, v18, s[74:75]
    v_cndmask_b32 v43, 0, v19, s[74:75]
    v_cndmask_b32 v44, 0, v20, s[74:75]
    v_cndmask_b32 v45, 0, v21, s[74:75]
    buffer_load_dwordx4 v[236:239], v3, s[8:11], s60 offen offset:3072 nt
    v_cndmask_b32 v46, 0, v22, s[74:75]
    v_cndmask_b32 v47, 0, v23, s[74:75]
    v_mfma_f32_16x16x32_bf16 v[160:163], a[0:3], v[32:35], 0
    v_mfma_f32_16x16x32_bf16 v[164:167], a[8:11], v[32:35], 0
    v_mfma_f32_16x16x32_bf16 v[168:171], a[16:19], v[32:35], 0
    v_mfma_f32_16x16x32_bf16 v[172:175], a[24:27], v[32:35], 0
    v_mfma_f32_16x16x32_bf16 v[176:179], a[32:35], v[32:35], 0
    v_mfma_f32_16x16x32_bf16 v[180:183], a[40:43], v[32:35], 0
    s_add_u32 s79, s60, 4096
    s_pack_lh_b32_b16 s60, s79, s60
    buffer_load_dwordx4 v[240:243], v3, s[8:11], s60 offen offset:0 nt
    v_mfma_f32_16x16x32_bf16 v[184:187], a[48:51], v[32:35], 0
    v_mfma_f32_16x16x32_bf16 v[188:191], a[56:59], v[32:35], 0
    v_mfma_f32_16x16x32_bf16 v[160:163], a[4:7], v[36:39], v[160:163]
    v_mfma_f32_16x16x32_bf16 v[164:167], a[12:15], v[36:39], v[164:167]
    v_mfma_f32_16x16x32_bf16 v[168:171], a[20:23], v[36:39], v[168:171]
    v_mfma_f32_16x16x32_bf16 v[172:175], a[28:31], v[36:39], v[172:175]
    v_mfma_f32_16x16x32_bf16 v[176:179], a[36:39], v[36:39], v[176:179]
    buffer_load_dwordx4 v[244:247], v3, s[8:11], s60 offen offset:1024 nt
    v_mfma_f32_16x16x32_bf16 v[180:183], a[44:47], v[36:39], v[180:183]
    v_mfma_f32_16x16x32_bf16 v[184:187], a[52:55], v[36:39], v[184:187]
    v_mfma_f32_16x16x32_bf16 v[188:191], a[60:63], v[36:39], v[188:191]
    v_mfma_f32_16x16x32_bf16 v[160:163], a[64:67], v[40:43], v[160:163]
    v_mfma_f32_16x16x32_bf16 v[164:167], a[72:75], v[40:43], v[164:167]
    v_mfma_f32_16x16x32_bf16 v[168:171], a[80:83], v[40:43], v[168:171]
    v_mfma_f32_16x16x32_bf16 v[172:175], a[88:91], v[40:43], v[172:175]
    v_mfma_f32_16x16x32_bf16 v[176:179], a[96:99], v[40:43], v[176:179]
    buffer_load_dwordx4 v[248:251], v3, s[8:11], s60 offen offset:2048 nt
    v_mfma_f32_16x16x32_bf16 v[180:183], a[104:107], v[40:43], v[180:183]
    v_mfma_f32_16x16x32_bf16 v[184:187], a[112:115], v[40:43], v[184:187]
    v_mfma_f32_16x16x32_bf16 v[188:191], a[120:123], v[40:43], v[188:191]
    v_mfma_f32_16x16x32_bf16 v[160:163], a[68:71], v[44:47], v[160:163]
    v_mfma_f32_16x16x32_bf16 v[164:167], a[76:79], v[44:47], v[164:167]
    v_mfma_f32_16x16x32_bf16 v[168:171], a[84:87], v[44:47], v[168:171]
    v_mfma_f32_16x16x32_bf16 v[172:175], a[92:95], v[44:47], v[172:175]
    buffer_load_dwordx4 v[252:255], v3, s[8:11], s60 offen offset:3072 nt
    s_add_u32 s79, s60, 4096
    s_pack_lh_b32_b16 s60, s79, s60
    v_mfma_f32_16x16x32_bf16 v[176:179], a[100:103], v[44:47], v[176:179]
    v_mfma_f32_16x16x32_bf16 v[180:183], a[108:111], v[44:47], v[180:183]
    v_mfma_f32_16x16x32_bf16 v[184:187], a[116:119], v[44:47], v[184:187]
    v_mfma_f32_16x16x32_bf16 v[188:191], a[124:127], v[44:47], v[188:191]
    v_mfma_f32_16x16x32_bf16 v[192:195], a[128:131], v[32:35], 0
    v_mfma_f32_16x16x32_bf16 v[196:199], a[136:139], v[32:35], 0
    v_mfma_f32_16x16x32_bf16 v[200:203], a[144:147], v[32:35], 0
    v_mfma_f32_16x16x32_bf16 v[204:207], a[152:155], v[32:35], 0
    v_mfma_f32_16x16x32_bf16 v[208:211], a[160:163], v[32:35], 0
    v_mfma_f32_16x16x32_bf16 v[212:215], a[168:171], v[32:35], 0
    v_mfma_f32_16x16x32_bf16 v[216:219], a[176:179], v[32:35], 0
    v_mfma_f32_16x16x32_bf16 v[220:223], a[184:187], v[32:35], 0
    v_mfma_f32_16x16x32_bf16 v[192:195], a[132:135], v[36:39], v[192:195]
    v_mfma_f32_16x16x32_bf16 v[196:199], a[140:143], v[36:39], v[196:199]
    v_mfma_f32_16x16x32_bf16 v[200:203], a[148:151], v[36:39], v[200:203]
    v_mfma_f32_16x16x32_bf16 v[204:207], a[156:159], v[36:39], v[204:207]
    v_mfma_f32_16x16x32_bf16 v[208:211], a[164:167], v[36:39], v[208:211]
    v_mfma_f32_16x16x32_bf16 v[212:215], a[172:175], v[36:39], v[212:215]
    v_mfma_f32_16x16x32_bf16 v[216:219], a[180:183], v[36:39], v[216:219]
    v_mfma_f32_16x16x32_bf16 v[220:223], a[188:191], v[36:39], v[220:223]
    v_mfma_f32_16x16x32_bf16 v[192:195], a[192:195], v[40:43], v[192:195]
    v_mfma_f32_16x16x32_bf16 v[196:199], a[200:203], v[40:43], v[196:199]
    v_mfma_f32_16x16x32_bf16 v[200:203], a[208:211], v[40:43], v[200:203]
    v_mfma_f32_16x16x32_bf16 v[204:207], a[216:219], v[40:43], v[204:207]
    v_mfma_f32_16x16x32_bf16 v[208:211], a[224:227], v[40:43], v[208:211]
    v_mfma_f32_16x16x32_bf16 v[212:215], a[232:235], v[40:43], v[212:215]
    v_mfma_f32_16x16x32_bf16 v[216:219], a[240:243], v[40:43], v[216:219]
    v_mfma_f32_16x16x32_bf16 v[220:223], a[248:251], v[40:43], v[220:223]
    v_mfma_f32_16x16x32_bf16 v[192:195], a[196:199], v[44:47], v[192:195]
    v_mfma_f32_16x16x32_bf16 v[196:199], a[204:207], v[44:47], v[196:199]
    v_mfma_f32_16x16x32_bf16 v[200:203], a[212:215], v[44:47], v[200:203]
    v_mfma_f32_16x16x32_bf16 v[204:207], a[220:223], v[44:47], v[204:207]
    v_mfma_f32_16x16x32_bf16 v[208:211], a[228:231], v[44:47], v[208:211]
    v_mfma_f32_16x16x32_bf16 v[212:215], a[236:239], v[44:47], v[212:215]
    v_mfma_f32_16x16x32_bf16 v[216:219], a[244:247], v[44:47], v[216:219]
    v_mfma_f32_16x16x32_bf16 v[220:223], a[252:255], v[44:47], v[220:223]
    v_add_f32_dpp v48, v161, v160 row_shl:4 row_mask:0xf bank_mask:0x5
    v_add_f32_dpp v49, v165, v164 row_shl:4 row_mask:0xf bank_mask:0x5
    v_add_f32_dpp v50, v169, v168 row_shl:4 row_mask:0xf bank_mask:0x5
    v_add_f32_dpp v51, v173, v172 row_shl:4 row_mask:0xf bank_mask:0x5
    v_add_f32_dpp v52, v177, v176 row_shl:4 row_mask:0xf bank_mask:0x5
    v_add_f32_dpp v53, v181, v180 row_shl:4 row_mask:0xf bank_mask:0x5
    v_add_f32_dpp v54, v185, v184 row_shl:4 row_mask:0xf bank_mask:0x5
    v_add_f32_dpp v55, v189, v188 row_shl:4 row_mask:0xf bank_mask:0x5
    v_add_f32_dpp v56, v193, v192 row_shl:4 row_mask:0xf bank_mask:0x5
    v_add_f32_dpp v57, v197, v196 row_shl:4 row_mask:0xf bank_mask:0x5
    v_add_f32_dpp v58, v201, v200 row_shl:4 row_mask:0xf bank_mask:0x5
    v_add_f32_dpp v59, v205, v204 row_shl:4 row_mask:0xf bank_mask:0x5
    v_add_f32_dpp v60, v209, v208 row_shl:4 row_mask:0xf bank_mask:0x5
    v_add_f32_dpp v61, v213, v212 row_shl:4 row_mask:0xf bank_mask:0x5
    v_add_f32_dpp v62, v217, v216 row_shl:4 row_mask:0xf bank_mask:0x5
    v_add_f32_dpp v63, v221, v220 row_shl:4 row_mask:0xf bank_mask:0x5
    v_add_f32_dpp v48, v162, v163 row_shr:4 row_mask:0xf bank_mask:0xa
    v_add_f32_dpp v49, v166, v167 row_shr:4 row_mask:0xf bank_mask:0xa
    v_add_f32_dpp v50, v170, v171 row_shr:4 row_mask:0xf bank_mask:0xa
    v_add_f32_dpp v51, v174, v175 row_shr:4 row_mask:0xf bank_mask:0xa
    v_add_f32_dpp v52, v178, v179 row_shr:4 row_mask:0xf bank_mask:0xa
    v_add_f32_dpp v53, v182, v183 row_shr:4 row_mask:0xf bank_mask:0xa
    v_add_f32_dpp v54, v186, v187 row_shr:4 row_mask:0xf bank_mask:0xa
    v_add_f32_dpp v55, v190, v191 row_shr:4 row_mask:0xf bank_mask:0xa
    v_add_f32_dpp v56, v194, v195 row_shr:4 row_mask:0xf bank_mask:0xa
    v_add_f32_dpp v57, v198, v199 row_shr:4 row_mask:0xf bank_mask:0xa
    v_add_f32_dpp v58, v202, v203 row_shr:4 row_mask:0xf bank_mask:0xa
    v_add_f32_dpp v59, v206, v207 row_shr:4 row_mask:0xf bank_mask:0xa
    v_add_f32_dpp v60, v210, v211 row_shr:4 row_mask:0xf bank_mask:0xa
    v_add_f32_dpp v61, v214, v215 row_shr:4 row_mask:0xf bank_mask:0xa
    v_add_f32_dpp v62, v218, v219 row_shr:4 row_mask:0xf bank_mask:0xa
    v_add_f32_dpp v63, v222, v223 row_shr:4 row_mask:0xf bank_mask:0xa
    buffer_load_dwordx4 v[160:163], v3, s[8:11], s60 offen offset:0 nt
    v_cvt_pk_bf16_f32 v32, v48, v49
    v_cvt_pk_bf16_f32 v33, v50, v51
    v_cvt_pk_bf16_f32 v34, v52, v53
    v_cvt_pk_bf16_f32 v35, v54, v55
    v_cvt_pk_bf16_f32 v36, v56, v57
    v_cvt_pk_bf16_f32 v37, v58, v59
    v_cvt_pk_bf16_f32 v38, v60, v61
    v_cvt_pk_bf16_f32 v39, v62, v63
    v_lshlrev_b32 v48, 16, v32
    buffer_load_dwordx4 v[164:167], v3, s[8:11], s60 offen offset:1024 nt
    v_and_b32 v49, s66, v32
    v_lshlrev_b32 v50, 16, v33
    v_and_b32 v51, s66, v33
    v_lshlrev_b32 v52, 16, v34
    v_and_b32 v53, s66, v34
    v_lshlrev_b32 v54, 16, v35
    v_and_b32 v55, s66, v35
    v_lshlrev_b32 v56, 16, v36
    v_and_b32 v57, s66, v36
    v_lshlrev_b32 v58, 16, v37
    buffer_load_dwordx4 v[168:171], v3, s[8:11], s60 offen offset:2048 nt
    v_and_b32 v59, s66, v37
    v_lshlrev_b32 v60, 16, v38
    v_and_b32 v61, s66, v38
    v_lshlrev_b32 v62, 16, v39
    v_and_b32 v63, s66, v39
    v_mul_f32 v48, s70, v48
    v_mul_f32 v49, s70, v49
    v_mul_f32 v50, s70, v50
    v_mul_f32 v51, s70, v51
    buffer_load_dwordx4 v[172:175], v3, s[8:11], s60 offen offset:3072 nt
    v_mul_f32 v52, s70, v52
    v_mul_f32 v53, s70, v53
    v_mul_f32 v54, s70, v54
    v_mul_f32 v55, s70, v55
    v_mul_f32 v56, s70, v56
    v_mul_f32 v57, s70, v57
    v_mul_f32 v58, s70, v58
    v_mul_f32 v59, s70, v59
    v_mul_f32 v60, s70, v60
    v_mul_f32 v61, s70, v61
    s_add_u32 s79, s60, 4096
    s_pack_lh_b32_b16 s60, s79, s60
    buffer_load_dwordx4 v[176:179], v3, s[8:11], s60 offen offset:0 nt
    v_mul_f32 v62, s70, v62
    v_mul_f32 v63, s70, v63
    v_cvt_pk_bf16_f32 v32, v48, v49
    v_cvt_pk_bf16_f32 v33, v50, v51
    v_cvt_pk_bf16_f32 v34, v52, v53
    v_cvt_pk_bf16_f32 v35, v54, v55
    v_cvt_pk_bf16_f32 v36, v56, v57
    v_cvt_pk_bf16_f32 v37, v58, v59
    v_cvt_pk_bf16_f32 v38, v60, v61
    buffer_load_dwordx4 v[180:183], v3, s[8:11], s60 offen offset:1024 nt
    v_cvt_pk_bf16_f32 v39, v62, v63
    v_lshlrev_b32 v48, 16, v32
    v_and_b32 v49, s66, v32
    v_lshlrev_b32 v50, 16, v33
    v_and_b32 v51, s66, v33
    v_lshlrev_b32 v52, 16, v34
    v_and_b32 v53, s66, v34
    v_lshlrev_b32 v54, 16, v35
    v_and_b32 v55, s66, v35
    v_lshlrev_b32 v56, 16, v36
    buffer_load_dwordx4 v[184:187], v3, s[8:11], s60 offen offset:2048 nt
    v_and_b32 v57, s66, v36
    v_lshlrev_b32 v58, 16, v37
    v_and_b32 v59, s66, v37
    v_lshlrev_b32 v60, 16, v38
    v_and_b32 v61, s66, v38
    v_lshlrev_b32 v62, 16, v39
    v_and_b32 v63, s66, v39
    v_max3_f32 v9, v48, v49, v50
    v_max3_f32 v9, v9, v51, v52
    buffer_load_dwordx4 v[188:191], v3, s[8:11], s60 offen offset:3072 nt
    v_max3_f32 v9, v9, v53, v54
    v_max3_f32 v9, v9, v55, v56
    v_max3_f32 v9, v9, v57, v58
    v_max3_f32 v9, v9, v59, v60
    v_max3_f32 v9, v9, v61, v62
    v_max_f32 v9, v9, v63
    s_nop 1
    v_max_f32_dpp v9, v9, v9 row_ror:4 row_mask:0xf bank_mask:0xf
    s_nop 1
    v_max_f32_dpp v9, v9, v9 row_ror:8 row_mask:0xf bank_mask:0xf
    v_mov_b32 v10, v9
    s_nop 1
    v_permlane16_swap_b32 v9, v10
    s_add_u32 s79, s60, 4096
    s_pack_lh_b32_b16 s60, s79, s60
    buffer_load_dwordx4 v[192:195], v3, s[8:11], s60 offen offset:0 nt
    v_max_f32 v9, v9, v10
    v_mov_b32 v10, v9
    s_nop 1
    v_permlane32_swap_b32 v9, v10
    v_max_f32 v9, v9, v10
    v_mul_f32 v11, s69, v9
    v_fma_f32 v48, v48, s69, -v11
    v_fma_f32 v49, v49, s69, -v11
    v_fma_f32 v50, v50, s69, -v11
    v_fma_f32 v51, v51, s69, -v11
    buffer_load_dwordx4 v[196:199], v3, s[8:11], s60 offen offset:1024 nt
    v_fma_f32 v52, v52, s69, -v11
    v_fma_f32 v53, v53, s69, -v11
    v_fma_f32 v54, v54, s69, -v11
    v_fma_f32 v55, v55, s69, -v11
    v_fma_f32 v56, v56, s69, -v11
    v_fma_f32 v57, v57, s69, -v11
    v_fma_f32 v58, v58, s69, -v11
    v_fma_f32 v59, v59, s69, -v11
    v_fma_f32 v60, v60, s69, -v11
    v_fma_f32 v61, v61, s69, -v11
    buffer_load_dwordx4 v[200:203], v3, s[8:11], s60 offen offset:2048 nt
    v_fma_f32 v62, v62, s69, -v11
    v_fma_f32 v63, v63, s69, -v11
    v_exp_f32 v48, v48
    v_exp_f32 v49, v49
    v_exp_f32 v50, v50
    v_exp_f32 v51, v51
    v_exp_f32 v52, v52
    v_exp_f32 v53, v53
    v_exp_f32 v54, v54
    buffer_load_dwordx4 v[204:207], v3, s[8:11], s60 offen offset:3072 nt
    v_exp_f32 v55, v55
    v_exp_f32 v56, v56
    v_exp_f32 v57, v57
    v_exp_f32 v58, v58
    v_exp_f32 v59, v59
    v_exp_f32 v60, v60
    v_exp_f32 v61, v61
    v_exp_f32 v62, v62
    v_exp_f32 v63, v63
    v_add_f32 v13, v48, v49
    s_add_u32 s79, s60, 4096
    s_pack_lh_b32_b16 s60, s79, s60
    buffer_load_dwordx4 v[208:211], v3, s[8:11], s60 offen offset:0 nt
    v_add_f32 v13, v13, v50
    v_add_f32 v13, v13, v51
    v_add_f32 v13, v13, v52
    v_add_f32 v13, v13, v53
    v_add_f32 v13, v13, v54
    v_add_f32 v13, v13, v55
    v_add_f32 v13, v13, v56
    v_add_f32 v13, v13, v57
    v_add_f32 v13, v13, v58
    buffer_load_dwordx4 v[212:215], v3, s[8:11], s60 offen offset:1024 nt
    v_add_f32 v13, v13, v59
    v_add_f32 v13, v13, v60
    v_add_f32 v13, v13, v61
    v_add_f32 v13, v13, v62
    v_add_f32 v13, v13, v63
    v_cvt_pk_bf16_f32 v16, v48, v49
    v_cvt_pk_bf16_f32 v17, v50, v51
    v_cvt_pk_bf16_f32 v18, v52, v53
    v_cvt_pk_bf16_f32 v19, v54, v55
    v_cvt_pk_bf16_f32 v20, v56, v57
    buffer_load_dwordx4 v[216:219], v3, s[8:11], s60 offen offset:2048 nt
    v_cvt_pk_bf16_f32 v21, v58, v59
    v_cvt_pk_bf16_f32 v22, v60, v61
    v_cvt_pk_bf16_f32 v23, v62, v63
    v_add_f32_dpp v13, v13, v13 row_ror:4 row_mask:0xf bank_mask:0xf
    s_nop 1
    v_add_f32_dpp v13, v13, v13 row_ror:8 row_mask:0xf bank_mask:0xf
    v_mov_b32 v10, v13
    s_nop 1
    v_permlane16_swap_b32 v13, v10
    v_add_f32 v13, v13, v10
    v_mov_b32 v10, v13
    buffer_load_dwordx4 v[220:223], v3, s[8:11], s60 offen offset:3072 nt
    s_add_u32 s79, s60, 4096
    s_pack_lh_b32_b16 s60, s79, s60
    v_permlane32_swap_b32 v13, v10
    v_add_f32 v13, v13, v10
    v_mov_b32 v12, v9
    v_mov_b32 v14, s58
    v_mov_b32 v15, s58
    s_lshl_b32 s64, s2, 8
    s_lshl_b32 s61, s3, 6
    s_add_u32 s64, s64, s61
    v_lshlrev_b32 v10, 4, v1
    v_add_u32 v6, s64, v10
    s_mov_b64 exec, 0xf
    s_mov_b32 s61, 0x20000
    buffer_store_dwordx4 v[12:15], v6, s[12:15], s61 offen offset:0 sc1
    s_mov_b64 exec, -1
    v_mov_b32 v24, 0
    v_mov_b32 v25, 0
    v_mov_b32 v26, 0
    v_mov_b32 v27, 0
    v_mov_b32 v28, 0
    v_mov_b32 v29, 0
    v_mov_b32 v30, 0
    v_mov_b32 v31, 0
    v_mov_b32 v40, 0
    v_mov_b32 v41, 0
    v_mov_b32 v42, 0
    v_mov_b32 v43, 0
    v_mov_b32 v44, 0
    v_mov_b32 v45, 0
    v_mov_b32 v46, 0
    v_mov_b32 v47, 0
    s_lshr_b32 s61, s2, 3
    s_lshl_b32 s61, s61, 11
    v_lshlrev_b32 v10, 4, v1
    v_add_u32 v6, s61, v10
    s_mov_b32 s20, s40
    s_mov_b32 s21, s41
    s_mov_b32 s22, 0x400000
    s_mov_b32 s23, 0x20000
    s_and_b32 s63, s2, 7
    s_lshr_b32 s37, s2, 3
    s_sub_u32 s37, s37, 23
    s_lshl_b32 s64, s37, 7
    s_lshl_b32 s62, s63, 19
    s_add_u32 s64, s64, s62
    v_lshrrev_b32 v10, 4, v1
    v_lshlrev_b32 v10, 5, v10
    s_lshl_b32 s61, s3, 7
    v_add_u32 v10, s61, v10
    s_movk_i32 s61, 1024
    v_mul_lo_u32 v10, v10, s61
    v_and_b32 v11, 3, v1
    v_lshl_add_u32 v10, v11, 4, v10
    v_bfe_u32 v11, v1, 2, 1
    v_lshl_add_u32 v10, v11, 3, v10
    v_bfe_u32 v11, v1, 3, 1
    v_lshl_add_u32 v10, v11, 6, v10
    v_add_u32 v7, s64, v10
    v_lshrrev_b32 v10, 4, v1
    v_add_u32 v10, v10, v1
    v_and_b32 v10, 3, v10
    v_and_b32 v11, 60, v1
    v_or_b32 v10, v10, v11
    v_lshlrev_b32 v10, 4, v10
    s_lshl_b32 s61, s3, 11
    v_add_u32 v8, s61, v10
    v_bfe_u32 v11, v0, 5, 2
    v_lshlrev_b32 v15, 4, v11
    v_bfe_u32 v10, v0, 3, 2
    v_add_u32 v11, v11, v10
    v_and_b32 v11, 3, v11
    v_lshlrev_b32 v11, 4, v11
    v_lshl_add_u32 v11, v10, 8, v11
    v_and_b32 v10, 3, v0
    v_lshl_add_u32 v11, v10, 6, v11
    v_bfe_u32 v10, v0, 2, 1
    v_lshl_add_u32 v2, v10, 10, v11
    v_and_b32 v10, 0x60, v0
    v_bfe_u32 v11, v0, 1, 4
    v_or_b32 v10, v10, v11
    v_and_b32 v11, 1, v0
    v_lshl_or_b32 v10, v11, 4, v10
    v_lshlrev_b32 v10, 4, v10
    s_lshl_b32 s64, s2, 11
    v_add_u32 v14, s64, v10
    v_mov_b32_dpp v24, v16 quad_perm:[0,1,2,3] row_mask:0xf bank_mask:0x1
    v_mov_b32_dpp v25, v17 quad_perm:[0,1,2,3] row_mask:0xf bank_mask:0x1
    v_mov_b32_dpp v26, v18 quad_perm:[0,1,2,3] row_mask:0xf bank_mask:0x1
    v_mov_b32_dpp v27, v19 quad_perm:[0,1,2,3] row_mask:0xf bank_mask:0x1
    v_mov_b32_dpp v28, v16 row_ror:4 row_mask:0xf bank_mask:0x2
    v_mov_b32_dpp v29, v17 row_ror:4 row_mask:0xf bank_mask:0x2
    v_mov_b32_dpp v30, v18 row_ror:4 row_mask:0xf bank_mask:0x2
    v_mov_b32_dpp v31, v19 row_ror:4 row_mask:0xf bank_mask:0x2
    v_mov_b32_dpp v40, v16 row_ror:8 row_mask:0xf bank_mask:0x4
    v_mov_b32_dpp v41, v17 row_ror:8 row_mask:0xf bank_mask:0x4
    v_mov_b32_dpp v42, v18 row_ror:8 row_mask:0xf bank_mask:0x4
    v_mov_b32_dpp v43, v19 row_ror:8 row_mask:0xf bank_mask:0x4
    v_mov_b32_dpp v44, v16 row_ror:12 row_mask:0xf bank_mask:0x8
    v_mov_b32_dpp v45, v17 row_ror:12 row_mask:0xf bank_mask:0x8
    v_mov_b32_dpp v46, v18 row_ror:12 row_mask:0xf bank_mask:0x8
    v_mov_b32_dpp v47, v19 row_ror:12 row_mask:0xf bank_mask:0x8
    s_waitcnt vmcnt(49)
    v_perm_b32 v32, v68, v64, s67
    v_perm_b32 v33, v76, v72, s67
    v_perm_b32 v34, v84, v80, s67
    v_perm_b32 v35, v92, v88, s67
    v_perm_b32 v36, v70, v66, s67
    v_perm_b32 v37, v78, v74, s67
    v_perm_b32 v38, v86, v82, s67
    v_perm_b32 v39, v94, v90, s67
    v_mfma_f32_16x16x32_bf16 a[0:3], v[32:35], v[24:27], 0
    v_perm_b32 v32, v68, v64, s68
    v_perm_b32 v33, v76, v72, s68
    v_perm_b32 v34, v84, v80, s68
    v_perm_b32 v35, v92, v88, s68
    v_mfma_f32_16x16x32_bf16 a[4:7], v[36:39], v[24:27], 0
    v_perm_b32 v36, v70, v66, s68
    v_perm_b32 v37, v78, v74, s68
    v_perm_b32 v38, v86, v82, s68
    v_perm_b32 v39, v94, v90, s68
    v_mfma_f32_16x16x32_bf16 a[0:3], v[32:35], v[28:31], a[0:3]
    v_perm_b32 v32, v69, v65, s67
    v_perm_b32 v33, v77, v73, s67
    v_perm_b32 v34, v85, v81, s67
    v_perm_b32 v35, v93, v89, s67
    v_mfma_f32_16x16x32_bf16 a[4:7], v[36:39], v[28:31], a[4:7]
    v_perm_b32 v36, v71, v67, s67
    v_perm_b32 v37, v79, v75, s67
    v_perm_b32 v38, v87, v83, s67
    v_perm_b32 v39, v95, v91, s67
    v_mfma_f32_16x16x32_bf16 a[0:3], v[32:35], v[40:43], a[0:3]
    v_perm_b32 v32, v69, v65, s68
    v_perm_b32 v33, v77, v73, s68
    v_perm_b32 v34, v85, v81, s68
    v_perm_b32 v35, v93, v89, s68
    v_mfma_f32_16x16x32_bf16 a[4:7], v[36:39], v[40:43], a[4:7]
    v_perm_b32 v36, v71, v67, s68
    v_perm_b32 v37, v79, v75, s68
    v_perm_b32 v38, v87, v83, s68
    v_perm_b32 v39, v95, v91, s68
    v_mfma_f32_16x16x32_bf16 a[0:3], v[32:35], v[44:47], a[0:3]
    s_nop 0
    v_mfma_f32_16x16x32_bf16 a[4:7], v[36:39], v[44:47], a[4:7]
    v_mov_b32_dpp v24, v16 row_ror:12 row_mask:0xf bank_mask:0x1
    v_mov_b32_dpp v25, v17 row_ror:12 row_mask:0xf bank_mask:0x1
    v_mov_b32_dpp v26, v18 row_ror:12 row_mask:0xf bank_mask:0x1
    v_mov_b32_dpp v27, v19 row_ror:12 row_mask:0xf bank_mask:0x1
    v_mov_b32_dpp v28, v16 quad_perm:[0,1,2,3] row_mask:0xf bank_mask:0x2
    v_mov_b32_dpp v29, v17 quad_perm:[0,1,2,3] row_mask:0xf bank_mask:0x2
    v_mov_b32_dpp v30, v18 quad_perm:[0,1,2,3] row_mask:0xf bank_mask:0x2
    v_mov_b32_dpp v31, v19 quad_perm:[0,1,2,3] row_mask:0xf bank_mask:0x2
    v_mov_b32_dpp v40, v16 row_ror:4 row_mask:0xf bank_mask:0x4
    v_mov_b32_dpp v41, v17 row_ror:4 row_mask:0xf bank_mask:0x4
    v_mov_b32_dpp v42, v18 row_ror:4 row_mask:0xf bank_mask:0x4
    v_mov_b32_dpp v43, v19 row_ror:4 row_mask:0xf bank_mask:0x4
    v_mov_b32_dpp v44, v16 row_ror:8 row_mask:0xf bank_mask:0x8
    v_mov_b32_dpp v45, v17 row_ror:8 row_mask:0xf bank_mask:0x8
    v_mov_b32_dpp v46, v18 row_ror:8 row_mask:0xf bank_mask:0x8
    v_mov_b32_dpp v47, v19 row_ror:8 row_mask:0xf bank_mask:0x8
    s_waitcnt vmcnt(37)
    buffer_load_dwordx4 v[64:67], v3, s[8:11], s60 offen offset:0 nt
    v_perm_b32 v32, v100, v96, s67
    v_perm_b32 v33, v108, v104, s67
    v_perm_b32 v34, v116, v112, s67
    v_perm_b32 v35, v124, v120, s67
    v_perm_b32 v36, v102, v98, s67
    buffer_load_dwordx4 v[68:71], v3, s[8:11], s60 offen offset:1024 nt
    v_perm_b32 v37, v110, v106, s67
    v_perm_b32 v38, v118, v114, s67
    v_perm_b32 v39, v126, v122, s67
    v_mfma_f32_16x16x32_bf16 a[0:3], v[32:35], v[24:27], a[0:3]
    v_perm_b32 v32, v100, v96, s68
    buffer_load_dwordx4 v[72:75], v3, s[8:11], s60 offen offset:2048 nt
    v_perm_b32 v33, v108, v104, s68
    v_perm_b32 v34, v116, v112, s68
    v_perm_b32 v35, v124, v120, s68
    v_mfma_f32_16x16x32_bf16 a[4:7], v[36:39], v[24:27], a[4:7]
    v_perm_b32 v36, v102, v98, s68
    buffer_load_dwordx4 v[76:79], v3, s[8:11], s60 offen offset:3072 nt
    v_perm_b32 v37, v110, v106, s68
    v_perm_b32 v38, v118, v114, s68
    v_perm_b32 v39, v126, v122, s68
    v_mfma_f32_16x16x32_bf16 a[0:3], v[32:35], v[28:31], a[0:3]
    v_perm_b32 v32, v101, v97, s67
    s_add_u32 s79, s60, 4096
    s_pack_lh_b32_b16 s60, s79, s60
    buffer_load_dwordx4 v[80:83], v3, s[8:11], s60 offen offset:0 nt
    v_perm_b32 v33, v109, v105, s67
    v_perm_b32 v34, v117, v113, s67
    v_perm_b32 v35, v125, v121, s67
    v_mfma_f32_16x16x32_bf16 a[4:7], v[36:39], v[28:31], a[4:7]
    v_perm_b32 v36, v103, v99, s67
    buffer_load_dwordx4 v[84:87], v3, s[8:11], s60 offen offset:1024 nt
    v_perm_b32 v37, v111, v107, s67
    v_perm_b32 v38, v119, v115, s67
    v_perm_b32 v39, v127, v123, s67
    v_mfma_f32_16x16x32_bf16 a[0:3], v[32:35], v[40:43], a[0:3]
    v_perm_b32 v32, v101, v97, s68
    buffer_load_dwordx4 v[88:91], v3, s[8:11], s60 offen offset:2048 nt
    v_perm_b32 v33, v109, v105, s68
    v_perm_b32 v34, v117, v113, s68
    v_perm_b32 v35, v125, v121, s68
    v_mfma_f32_16x16x32_bf16 a[4:7], v[36:39], v[40:43], a[4:7]
    v_perm_b32 v36, v103, v99, s68
    buffer_load_dwordx4 v[92:95], v3, s[8:11], s60 offen offset:3072 nt
    s_add_u32 s79, s60, 4096
    s_pack_lh_b32_b16 s60, s79, s60
    v_perm_b32 v37, v111, v107, s68
    v_perm_b32 v38, v119, v115, s68
    v_perm_b32 v39, v127, v123, s68
    v_mfma_f32_16x16x32_bf16 a[0:3], v[32:35], v[44:47], a[0:3]
    s_nop 0
    v_mfma_f32_16x16x32_bf16 a[4:7], v[36:39], v[44:47], a[4:7]
    v_mov_b32_dpp v24, v16 row_ror:8 row_mask:0xf bank_mask:0x1
    v_mov_b32_dpp v25, v17 row_ror:8 row_mask:0xf bank_mask:0x1
    v_mov_b32_dpp v26, v18 row_ror:8 row_mask:0xf bank_mask:0x1
    v_mov_b32_dpp v27, v19 row_ror:8 row_mask:0xf bank_mask:0x1
    v_mov_b32_dpp v28, v16 row_ror:12 row_mask:0xf bank_mask:0x2
    v_mov_b32_dpp v29, v17 row_ror:12 row_mask:0xf bank_mask:0x2
    v_mov_b32_dpp v30, v18 row_ror:12 row_mask:0xf bank_mask:0x2
    v_mov_b32_dpp v31, v19 row_ror:12 row_mask:0xf bank_mask:0x2
    v_mov_b32_dpp v40, v16 quad_perm:[0,1,2,3] row_mask:0xf bank_mask:0x4
    v_mov_b32_dpp v41, v17 quad_perm:[0,1,2,3] row_mask:0xf bank_mask:0x4
    v_mov_b32_dpp v42, v18 quad_perm:[0,1,2,3] row_mask:0xf bank_mask:0x4
    v_mov_b32_dpp v43, v19 quad_perm:[0,1,2,3] row_mask:0xf bank_mask:0x4
    v_mov_b32_dpp v44, v16 row_ror:4 row_mask:0xf bank_mask:0x8
    v_mov_b32_dpp v45, v17 row_ror:4 row_mask:0xf bank_mask:0x8
    v_mov_b32_dpp v46, v18 row_ror:4 row_mask:0xf bank_mask:0x8
    v_mov_b32_dpp v47, v19 row_ror:4 row_mask:0xf bank_mask:0x8
    s_waitcnt vmcnt(33)
    v_perm_b32 v32, v132, v128, s67
    v_perm_b32 v33, v140, v136, s67
    v_perm_b32 v34, v148, v144, s67
    v_perm_b32 v35, v156, v152, s67
    v_perm_b32 v36, v134, v130, s67
    v_perm_b32 v37, v142, v138, s67
    v_perm_b32 v38, v150, v146, s67
    v_perm_b32 v39, v158, v154, s67
    v_mfma_f32_16x16x32_bf16 a[0:3], v[32:35], v[24:27], a[0:3]
    v_perm_b32 v32, v132, v128, s68
    v_perm_b32 v33, v140, v136, s68
    v_perm_b32 v34, v148, v144, s68
    v_perm_b32 v35, v156, v152, s68
    v_mfma_f32_16x16x32_bf16 a[4:7], v[36:39], v[24:27], a[4:7]
    v_perm_b32 v36, v134, v130, s68
    v_perm_b32 v37, v142, v138, s68
    v_perm_b32 v38, v150, v146, s68
    v_perm_b32 v39, v158, v154, s68
    v_mfma_f32_16x16x32_bf16 a[0:3], v[32:35], v[28:31], a[0:3]
    v_perm_b32 v32, v133, v129, s67
    v_perm_b32 v33, v141, v137, s67
    v_perm_b32 v34, v149, v145, s67
    v_perm_b32 v35, v157, v153, s67
    v_mfma_f32_16x16x32_bf16 a[4:7], v[36:39], v[28:31], a[4:7]
    v_perm_b32 v36, v135, v131, s67
    v_perm_b32 v37, v143, v139, s67
    v_perm_b32 v38, v151, v147, s67
    v_perm_b32 v39, v159, v155, s67
    v_mfma_f32_16x16x32_bf16 a[0:3], v[32:35], v[40:43], a[0:3]
    v_perm_b32 v32, v133, v129, s68
    v_perm_b32 v33, v141, v137, s68
    v_perm_b32 v34, v149, v145, s68
    v_perm_b32 v35, v157, v153, s68
    v_mfma_f32_16x16x32_bf16 a[4:7], v[36:39], v[40:43], a[4:7]
    v_perm_b32 v36, v135, v131, s68
    v_perm_b32 v37, v143, v139, s68
    v_perm_b32 v38, v151, v147, s68
    v_perm_b32 v39, v159, v155, s68
    v_mfma_f32_16x16x32_bf16 a[0:3], v[32:35], v[44:47], a[0:3]
    s_nop 0
    v_mfma_f32_16x16x32_bf16 a[4:7], v[36:39], v[44:47], a[4:7]
    v_mov_b32_dpp v24, v16 row_ror:4 row_mask:0xf bank_mask:0x1
    v_mov_b32_dpp v25, v17 row_ror:4 row_mask:0xf bank_mask:0x1
    v_mov_b32_dpp v26, v18 row_ror:4 row_mask:0xf bank_mask:0x1
    v_mov_b32_dpp v27, v19 row_ror:4 row_mask:0xf bank_mask:0x1
    v_mov_b32_dpp v28, v16 row_ror:8 row_mask:0xf bank_mask:0x2
    v_mov_b32_dpp v29, v17 row_ror:8 row_mask:0xf bank_mask:0x2
    v_mov_b32_dpp v30, v18 row_ror:8 row_mask:0xf bank_mask:0x2
    v_mov_b32_dpp v31, v19 row_ror:8 row_mask:0xf bank_mask:0x2
    v_mov_b32_dpp v40, v16 row_ror:12 row_mask:0xf bank_mask:0x4
    v_mov_b32_dpp v41, v17 row_ror:12 row_mask:0xf bank_mask:0x4
    v_mov_b32_dpp v42, v18 row_ror:12 row_mask:0xf bank_mask:0x4
    v_mov_b32_dpp v43, v19 row_ror:12 row_mask:0xf bank_mask:0x4
    v_mov_b32_dpp v44, v16 quad_perm:[0,1,2,3] row_mask:0xf bank_mask:0x8
    v_mov_b32_dpp v45, v17 quad_perm:[0,1,2,3] row_mask:0xf bank_mask:0x8
    v_mov_b32_dpp v46, v18 quad_perm:[0,1,2,3] row_mask:0xf bank_mask:0x8
    v_mov_b32_dpp v47, v19 quad_perm:[0,1,2,3] row_mask:0xf bank_mask:0x8
    s_waitcnt vmcnt(25)
    s_mov_b32 s61, 0x20000
    buffer_load_dwordx4 v[48:51], v6, s[12:15], s61 offen offset:0 sc1
    v_perm_b32 v32, v228, v224, s67
    v_perm_b32 v33, v236, v232, s67
    v_perm_b32 v34, v244, v240, s67
    v_perm_b32 v35, v252, v248, s67
    s_mov_b32 s61, 0x20000
    buffer_load_dwordx4 v[52:55], v6, s[12:15], s61 offen offset:1024 sc1
    v_perm_b32 v36, v230, v226, s67
    v_perm_b32 v37, v238, v234, s67
    v_perm_b32 v38, v246, v242, s67
    v_perm_b32 v39, v254, v250, s67
    buffer_load_dwordx4 v[96:99], v3, s[8:11], s60 offen offset:0 nt
    v_mfma_f32_16x16x32_bf16 a[0:3], v[32:35], v[24:27], a[0:3]
    v_perm_b32 v32, v228, v224, s68
    v_perm_b32 v33, v236, v232, s68
    v_perm_b32 v34, v244, v240, s68
    buffer_load_dwordx4 v[100:103], v3, s[8:11], s60 offen offset:1024 nt
    v_perm_b32 v35, v252, v248, s68
    v_mfma_f32_16x16x32_bf16 a[4:7], v[36:39], v[24:27], a[4:7]
    v_perm_b32 v36, v230, v226, s68
    v_perm_b32 v37, v238, v234, s68
    buffer_load_dwordx4 v[104:107], v3, s[8:11], s60 offen offset:2048 nt
    v_perm_b32 v38, v246, v242, s68
    v_perm_b32 v39, v254, v250, s68
    v_mfma_f32_16x16x32_bf16 a[0:3], v[32:35], v[28:31], a[0:3]
    v_perm_b32 v32, v229, v225, s67
    buffer_load_dwordx4 v[108:111], v3, s[8:11], s60 offen offset:3072 nt
    v_perm_b32 v33, v237, v233, s67
    v_perm_b32 v34, v245, v241, s67
    v_perm_b32 v35, v253, v249, s67
    v_mfma_f32_16x16x32_bf16 a[4:7], v[36:39], v[28:31], a[4:7]
    s_add_u32 s79, s60, 4096
    s_pack_lh_b32_b16 s60, s79, s60
    buffer_load_dwordx4 v[112:115], v3, s[8:11], s60 offen offset:0 nt
    v_perm_b32 v36, v231, v227, s67
    v_perm_b32 v37, v239, v235, s67
    v_perm_b32 v38, v247, v243, s67
    v_perm_b32 v39, v255, v251, s67
    buffer_load_dwordx4 v[116:119], v3, s[8:11], s60 offen offset:1024 nt
    v_mfma_f32_16x16x32_bf16 a[0:3], v[32:35], v[40:43], a[0:3]
    v_perm_b32 v32, v229, v225, s68
    v_perm_b32 v33, v237, v233, s68
    v_perm_b32 v34, v245, v241, s68
    buffer_load_dwordx4 v[120:123], v3, s[8:11], s60 offen offset:2048 nt
    v_perm_b32 v35, v253, v249, s68
    v_mfma_f32_16x16x32_bf16 a[4:7], v[36:39], v[40:43], a[4:7]
    v_perm_b32 v36, v231, v227, s68
    v_perm_b32 v37, v239, v235, s68
    buffer_load_dwordx4 v[124:127], v3, s[8:11], s60 offen offset:3072 nt
    s_add_u32 s79, s60, 4096
    s_pack_lh_b32_b16 s60, s79, s60
    v_perm_b32 v38, v247, v243, s68
    v_perm_b32 v39, v255, v251, s68
    v_mfma_f32_16x16x32_bf16 a[0:3], v[32:35], v[44:47], a[0:3]
    s_nop 0
    v_mfma_f32_16x16x32_bf16 a[4:7], v[36:39], v[44:47], a[4:7]
    v_mov_b32_dpp v24, v20 quad_perm:[0,1,2,3] row_mask:0xf bank_mask:0x1
    v_mov_b32_dpp v25, v21 quad_perm:[0,1,2,3] row_mask:0xf bank_mask:0x1
    v_mov_b32_dpp v26, v22 quad_perm:[0,1,2,3] row_mask:0xf bank_mask:0x1
    v_mov_b32_dpp v27, v23 quad_perm:[0,1,2,3] row_mask:0xf bank_mask:0x1
    v_mov_b32_dpp v28, v20 row_ror:4 row_mask:0xf bank_mask:0x2
    v_mov_b32_dpp v29, v21 row_ror:4 row_mask:0xf bank_mask:0x2
    v_mov_b32_dpp v30, v22 row_ror:4 row_mask:0xf bank_mask:0x2
    v_mov_b32_dpp v31, v23 row_ror:4 row_mask:0xf bank_mask:0x2
    v_mov_b32_dpp v40, v20 row_ror:8 row_mask:0xf bank_mask:0x4
    v_mov_b32_dpp v41, v21 row_ror:8 row_mask:0xf bank_mask:0x4
    v_mov_b32_dpp v42, v22 row_ror:8 row_mask:0xf bank_mask:0x4
    v_mov_b32_dpp v43, v23 row_ror:8 row_mask:0xf bank_mask:0x4
    v_mov_b32_dpp v44, v20 row_ror:12 row_mask:0xf bank_mask:0x8
    v_mov_b32_dpp v45, v21 row_ror:12 row_mask:0xf bank_mask:0x8
    v_mov_b32_dpp v46, v22 row_ror:12 row_mask:0xf bank_mask:0x8
    v_mov_b32_dpp v47, v23 row_ror:12 row_mask:0xf bank_mask:0x8
    s_waitcnt vmcnt(27)
    v_perm_b32 v32, v164, v160, s67
    v_perm_b32 v33, v172, v168, s67
    v_perm_b32 v34, v180, v176, s67
    v_perm_b32 v35, v188, v184, s67
    v_perm_b32 v36, v166, v162, s67
    v_perm_b32 v37, v174, v170, s67
    v_perm_b32 v38, v182, v178, s67
    v_perm_b32 v39, v190, v186, s67
    v_mfma_f32_16x16x32_bf16 a[0:3], v[32:35], v[24:27], a[0:3]
    v_perm_b32 v32, v164, v160, s68
    v_perm_b32 v33, v172, v168, s68
    v_perm_b32 v34, v180, v176, s68
    v_perm_b32 v35, v188, v184, s68
    v_mfma_f32_16x16x32_bf16 a[4:7], v[36:39], v[24:27], a[4:7]
    v_perm_b32 v36, v166, v162, s68
    v_perm_b32 v37, v174, v170, s68
    v_perm_b32 v38, v182, v178, s68
    v_perm_b32 v39, v190, v186, s68
    v_mfma_f32_16x16x32_bf16 a[0:3], v[32:35], v[28:31], a[0:3]
    v_perm_b32 v32, v165, v161, s67
    v_perm_b32 v33, v173, v169, s67
    v_perm_b32 v34, v181, v177, s67
    v_perm_b32 v35, v189, v185, s67
    v_mfma_f32_16x16x32_bf16 a[4:7], v[36:39], v[28:31], a[4:7]
    v_perm_b32 v36, v167, v163, s67
    v_perm_b32 v37, v175, v171, s67
    v_perm_b32 v38, v183, v179, s67
    v_perm_b32 v39, v191, v187, s67
    v_mfma_f32_16x16x32_bf16 a[0:3], v[32:35], v[40:43], a[0:3]
    v_perm_b32 v32, v165, v161, s68
    v_perm_b32 v33, v173, v169, s68
    v_perm_b32 v34, v181, v177, s68
    v_perm_b32 v35, v189, v185, s68
    v_mfma_f32_16x16x32_bf16 a[4:7], v[36:39], v[40:43], a[4:7]
    v_perm_b32 v36, v167, v163, s68
    v_perm_b32 v37, v175, v171, s68
    v_perm_b32 v38, v183, v179, s68
    v_perm_b32 v39, v191, v187, s68
    v_mfma_f32_16x16x32_bf16 a[0:3], v[32:35], v[44:47], a[0:3]
    s_nop 0
    v_mfma_f32_16x16x32_bf16 a[4:7], v[36:39], v[44:47], a[4:7]
    v_mov_b32_dpp v24, v20 row_ror:12 row_mask:0xf bank_mask:0x1
    v_mov_b32_dpp v25, v21 row_ror:12 row_mask:0xf bank_mask:0x1
    v_mov_b32_dpp v26, v22 row_ror:12 row_mask:0xf bank_mask:0x1
    v_mov_b32_dpp v27, v23 row_ror:12 row_mask:0xf bank_mask:0x1
    v_mov_b32_dpp v28, v20 quad_perm:[0,1,2,3] row_mask:0xf bank_mask:0x2
    v_mov_b32_dpp v29, v21 quad_perm:[0,1,2,3] row_mask:0xf bank_mask:0x2
    v_mov_b32_dpp v30, v22 quad_perm:[0,1,2,3] row_mask:0xf bank_mask:0x2
    v_mov_b32_dpp v31, v23 quad_perm:[0,1,2,3] row_mask:0xf bank_mask:0x2
    v_mov_b32_dpp v40, v20 row_ror:4 row_mask:0xf bank_mask:0x4
    v_mov_b32_dpp v41, v21 row_ror:4 row_mask:0xf bank_mask:0x4
    v_mov_b32_dpp v42, v22 row_ror:4 row_mask:0xf bank_mask:0x4
    v_mov_b32_dpp v43, v23 row_ror:4 row_mask:0xf bank_mask:0x4
    v_mov_b32_dpp v44, v20 row_ror:8 row_mask:0xf bank_mask:0x8
    v_mov_b32_dpp v45, v21 row_ror:8 row_mask:0xf bank_mask:0x8
    v_mov_b32_dpp v46, v22 row_ror:8 row_mask:0xf bank_mask:0x8
    v_mov_b32_dpp v47, v23 row_ror:8 row_mask:0xf bank_mask:0x8
    s_waitcnt vmcnt(19)
    v_perm_b32 v32, v196, v192, s67
    v_perm_b32 v33, v204, v200, s67
    v_perm_b32 v34, v212, v208, s67
    v_perm_b32 v35, v220, v216, s67
    v_perm_b32 v36, v198, v194, s67
    v_perm_b32 v37, v206, v202, s67
    v_perm_b32 v38, v214, v210, s67
    v_perm_b32 v39, v222, v218, s67
    v_mfma_f32_16x16x32_bf16 a[0:3], v[32:35], v[24:27], a[0:3]
    v_perm_b32 v32, v196, v192, s68
    v_perm_b32 v33, v204, v200, s68
    v_perm_b32 v34, v212, v208, s68
    v_perm_b32 v35, v220, v216, s68
    v_mfma_f32_16x16x32_bf16 a[4:7], v[36:39], v[24:27], a[4:7]
    v_perm_b32 v36, v198, v194, s68
    v_perm_b32 v37, v206, v202, s68
    v_perm_b32 v38, v214, v210, s68
    v_perm_b32 v39, v222, v218, s68
    v_mfma_f32_16x16x32_bf16 a[0:3], v[32:35], v[28:31], a[0:3]
    v_perm_b32 v32, v197, v193, s67
    v_perm_b32 v33, v205, v201, s67
    v_perm_b32 v34, v213, v209, s67
    v_perm_b32 v35, v221, v217, s67
    v_mfma_f32_16x16x32_bf16 a[4:7], v[36:39], v[28:31], a[4:7]
    v_perm_b32 v36, v199, v195, s67
    v_perm_b32 v37, v207, v203, s67
    v_perm_b32 v38, v215, v211, s67
    v_perm_b32 v39, v223, v219, s67
    v_mfma_f32_16x16x32_bf16 a[0:3], v[32:35], v[40:43], a[0:3]
    v_perm_b32 v32, v197, v193, s68
    v_perm_b32 v33, v205, v201, s68
    v_perm_b32 v34, v213, v209, s68
    v_perm_b32 v35, v221, v217, s68
    v_mfma_f32_16x16x32_bf16 a[4:7], v[36:39], v[40:43], a[4:7]
    v_perm_b32 v36, v199, v195, s68
    v_perm_b32 v37, v207, v203, s68
    v_perm_b32 v38, v215, v211, s68
    v_perm_b32 v39, v223, v219, s68
    v_mfma_f32_16x16x32_bf16 a[0:3], v[32:35], v[44:47], a[0:3]
    s_nop 0
    v_mfma_f32_16x16x32_bf16 a[4:7], v[36:39], v[44:47], a[4:7]
    s_mov_b32 s61, 0x20000
    buffer_load_dwordx4 v[56:59], v6, s[12:15], s61 offen offset:0 sc1
    s_mov_b32 s61, 0x20000
    buffer_load_dwordx4 v[60:63], v6, s[12:15], s61 offen offset:1024 sc1
    v_mov_b32_dpp v24, v20 row_ror:8 row_mask:0xf bank_mask:0x1
    v_mov_b32_dpp v25, v21 row_ror:8 row_mask:0xf bank_mask:0x1
    v_mov_b32_dpp v26, v22 row_ror:8 row_mask:0xf bank_mask:0x1
    v_mov_b32_dpp v27, v23 row_ror:8 row_mask:0xf bank_mask:0x1
    v_mov_b32_dpp v28, v20 row_ror:12 row_mask:0xf bank_mask:0x2
    v_mov_b32_dpp v29, v21 row_ror:12 row_mask:0xf bank_mask:0x2
    v_mov_b32_dpp v30, v22 row_ror:12 row_mask:0xf bank_mask:0x2
    v_mov_b32_dpp v31, v23 row_ror:12 row_mask:0xf bank_mask:0x2
    v_mov_b32_dpp v40, v20 quad_perm:[0,1,2,3] row_mask:0xf bank_mask:0x4
    v_mov_b32_dpp v41, v21 quad_perm:[0,1,2,3] row_mask:0xf bank_mask:0x4
    v_mov_b32_dpp v42, v22 quad_perm:[0,1,2,3] row_mask:0xf bank_mask:0x4
    v_mov_b32_dpp v43, v23 quad_perm:[0,1,2,3] row_mask:0xf bank_mask:0x4
    v_mov_b32_dpp v44, v20 row_ror:4 row_mask:0xf bank_mask:0x8
    v_mov_b32_dpp v45, v21 row_ror:4 row_mask:0xf bank_mask:0x8
    v_mov_b32_dpp v46, v22 row_ror:4 row_mask:0xf bank_mask:0x8
    v_mov_b32_dpp v47, v23 row_ror:4 row_mask:0xf bank_mask:0x8
    s_waitcnt vmcnt(12)
    v_perm_b32 v32, v68, v64, s67
    v_perm_b32 v33, v76, v72, s67
    v_perm_b32 v34, v84, v80, s67
    v_perm_b32 v35, v92, v88, s67
    v_perm_b32 v36, v70, v66, s67
    v_perm_b32 v37, v78, v74, s67
    v_perm_b32 v38, v86, v82, s67
    v_perm_b32 v39, v94, v90, s67
    v_mfma_f32_16x16x32_bf16 a[0:3], v[32:35], v[24:27], a[0:3]
    v_perm_b32 v32, v68, v64, s68
    v_perm_b32 v33, v76, v72, s68
    v_perm_b32 v34, v84, v80, s68
    v_perm_b32 v35, v92, v88, s68
    v_mfma_f32_16x16x32_bf16 a[4:7], v[36:39], v[24:27], a[4:7]
    v_perm_b32 v36, v70, v66, s68
    v_perm_b32 v37, v78, v74, s68
    v_perm_b32 v38, v86, v82, s68
    v_perm_b32 v39, v94, v90, s68
    v_mfma_f32_16x16x32_bf16 a[0:3], v[32:35], v[28:31], a[0:3]
    v_perm_b32 v32, v69, v65, s67
    v_perm_b32 v33, v77, v73, s67
    v_perm_b32 v34, v85, v81, s67
    v_perm_b32 v35, v93, v89, s67
    v_mfma_f32_16x16x32_bf16 a[4:7], v[36:39], v[28:31], a[4:7]
    v_perm_b32 v36, v71, v67, s67
    v_perm_b32 v37, v79, v75, s67
    v_perm_b32 v38, v87, v83, s67
    v_perm_b32 v39, v95, v91, s67
    v_mfma_f32_16x16x32_bf16 a[0:3], v[32:35], v[40:43], a[0:3]
    v_perm_b32 v32, v69, v65, s68
    v_perm_b32 v33, v77, v73, s68
    v_perm_b32 v34, v85, v81, s68
    v_perm_b32 v35, v93, v89, s68
    v_mfma_f32_16x16x32_bf16 a[4:7], v[36:39], v[40:43], a[4:7]
    v_perm_b32 v36, v71, v67, s68
    v_perm_b32 v37, v79, v75, s68
    v_perm_b32 v38, v87, v83, s68
    v_perm_b32 v39, v95, v91, s68
    v_mfma_f32_16x16x32_bf16 a[0:3], v[32:35], v[44:47], a[0:3]
    s_nop 0
    v_mfma_f32_16x16x32_bf16 a[4:7], v[36:39], v[44:47], a[4:7]
    s_waitcnt vmcnt(10)
    v_xor_b32 v10, s58, v50
    v_bitop3_b32 v10, v51, s58, v10 bitop3:0xbe
    v_bitop3_b32 v10, v54, s58, v10 bitop3:0xbe
    v_bitop3_b32 v10, v55, s58, v10 bitop3:0xbe
    v_cmp_ne_u32 vcc, 0, v10
    s_mov_b32 s34, 1
    s_cbranch_vccnz MLS_Y
    v_max_f32 v50, v48, v52
    s_nop 1
    v_max_f32_dpp v50, v50, v50 row_ror:4 row_mask:0xf bank_mask:0xf
    s_nop 1
    v_max_f32_dpp v50, v50, v50 row_ror:8 row_mask:0xf bank_mask:0xf
    v_mov_b32 v10, v50
    s_nop 1
    v_permlane16_swap_b32 v50, v10
    v_max_f32 v50, v50, v10
    v_mov_b32 v10, v50
    s_nop 1
    v_permlane32_swap_b32 v50, v10
    v_max_f32 v50, v50, v10
    v_sub_f32 v48, v48, v50
    v_sub_f32 v52, v52, v50
    v_sub_f32 v9, v9, v50
    v_mul_f32 v48, s69, v48
    v_mul_f32 v52, s69, v52
    v_mul_f32 v9, s69, v9
    v_exp_f32 v48, v48
    v_exp_f32 v52, v52
    v_exp_f32 v9, v9
    v_mul_f32 v49, v49, v48
    v_fmac_f32 v49, v53, v52
    s_nop 1
    v_add_f32_dpp v49, v49, v49 row_ror:4 row_mask:0xf bank_mask:0xf
    s_nop 1
    v_add_f32_dpp v49, v49, v49 row_ror:8 row_mask:0xf bank_mask:0xf
    v_mov_b32 v10, v49
    s_nop 1
    v_permlane16_swap_b32 v49, v10
    v_add_f32 v49, v49, v10
    v_mov_b32 v10, v49
    s_nop 1
    v_permlane32_swap_b32 v49, v10
    v_add_f32 v49, v49, v10
    v_rcp_f32 v49, v49
    s_nop 0
    v_mul_f32 v9, v9, v49
    v_lshlrev_b32 v10, 4, v1
    s_lshl_b32 s64, s3, 2
    v_add_u32 v10, s64, v10
    s_mov_b64 exec, 0xf
    ds_write_b32 v10, v9 offset:26880
    s_mov_b64 exec, -1
    s_mov_b32 s34, 0
MLS_Y:
    v_mov_b32_dpp v24, v20 row_ror:4 row_mask:0xf bank_mask:0x1
    v_mov_b32_dpp v25, v21 row_ror:4 row_mask:0xf bank_mask:0x1
    v_mov_b32_dpp v26, v22 row_ror:4 row_mask:0xf bank_mask:0x1
    v_mov_b32_dpp v27, v23 row_ror:4 row_mask:0xf bank_mask:0x1
    v_mov_b32_dpp v28, v20 row_ror:8 row_mask:0xf bank_mask:0x2
    v_mov_b32_dpp v29, v21 row_ror:8 row_mask:0xf bank_mask:0x2
    v_mov_b32_dpp v30, v22 row_ror:8 row_mask:0xf bank_mask:0x2
    v_mov_b32_dpp v31, v23 row_ror:8 row_mask:0xf bank_mask:0x2
    v_mov_b32_dpp v40, v20 row_ror:12 row_mask:0xf bank_mask:0x4
    v_mov_b32_dpp v41, v21 row_ror:12 row_mask:0xf bank_mask:0x4
    v_mov_b32_dpp v42, v22 row_ror:12 row_mask:0xf bank_mask:0x4
    v_mov_b32_dpp v43, v23 row_ror:12 row_mask:0xf bank_mask:0x4
    v_mov_b32_dpp v44, v20 quad_perm:[0,1,2,3] row_mask:0xf bank_mask:0x8
    v_mov_b32_dpp v45, v21 quad_perm:[0,1,2,3] row_mask:0xf bank_mask:0x8
    v_mov_b32_dpp v46, v22 quad_perm:[0,1,2,3] row_mask:0xf bank_mask:0x8
    v_mov_b32_dpp v47, v23 quad_perm:[0,1,2,3] row_mask:0xf bank_mask:0x8
    s_waitcnt vmcnt(2)
    buffer_load_dwordx2 v[128:129], v7, s[20:23], 0 offen offset:0
    v_perm_b32 v32, v100, v96, s67
    buffer_load_dwordx2 v[130:131], v7, s[20:23], 0 offen offset:1024
    v_perm_b32 v33, v108, v104, s67
    buffer_load_dwordx2 v[144:145], v7, s[20:23], 0 offen offset:2048
    v_perm_b32 v34, v116, v112, s67
    buffer_load_dwordx2 v[146:147], v7, s[20:23], 0 offen offset:3072
    v_perm_b32 v35, v124, v120, s67
    v_perm_b32 v36, v102, v98, s67
    s_mov_b32 s61, 0x1000
    buffer_load_dwordx2 v[224:225], v7, s[20:23], s61 offen offset:0
    v_perm_b32 v37, v110, v106, s67
    s_mov_b32 s61, 0x1000
    buffer_load_dwordx2 v[226:227], v7, s[20:23], s61 offen offset:1024
    v_perm_b32 v38, v118, v114, s67
    s_mov_b32 s61, 0x1000
    buffer_load_dwordx2 v[240:241], v7, s[20:23], s61 offen offset:2048
    v_perm_b32 v39, v126, v122, s67
    s_mov_b32 s61, 0x1000
    buffer_load_dwordx2 v[242:243], v7, s[20:23], s61 offen offset:3072
    v_mfma_f32_16x16x32_bf16 a[0:3], v[32:35], v[24:27], a[0:3]
    v_perm_b32 v32, v100, v96, s68
    s_mov_b32 s61, 0x2000
    buffer_load_dwordx2 v[132:133], v7, s[20:23], s61 offen offset:0
    v_perm_b32 v33, v108, v104, s68
    s_mov_b32 s61, 0x2000
    buffer_load_dwordx2 v[134:135], v7, s[20:23], s61 offen offset:1024
    v_perm_b32 v34, v116, v112, s68
    s_mov_b32 s61, 0x2000
    buffer_load_dwordx2 v[148:149], v7, s[20:23], s61 offen offset:2048
    v_perm_b32 v35, v124, v120, s68
    s_mov_b32 s61, 0x2000
    buffer_load_dwordx2 v[150:151], v7, s[20:23], s61 offen offset:3072
    v_mfma_f32_16x16x32_bf16 a[4:7], v[36:39], v[24:27], a[4:7]
    v_perm_b32 v36, v102, v98, s68
    s_mov_b32 s61, 0x3000
    buffer_load_dwordx2 v[228:229], v7, s[20:23], s61 offen offset:0
    v_perm_b32 v37, v110, v106, s68
    s_mov_b32 s61, 0x3000
    buffer_load_dwordx2 v[230:231], v7, s[20:23], s61 offen offset:1024
    v_perm_b32 v38, v118, v114, s68
    s_mov_b32 s61, 0x3000
    buffer_load_dwordx2 v[244:245], v7, s[20:23], s61 offen offset:2048
    v_perm_b32 v39, v126, v122, s68
    s_mov_b32 s61, 0x3000
    buffer_load_dwordx2 v[246:247], v7, s[20:23], s61 offen offset:3072
    v_mfma_f32_16x16x32_bf16 a[0:3], v[32:35], v[28:31], a[0:3]
    v_perm_b32 v32, v101, v97, s67
    s_mov_b32 s61, 0x4000
    buffer_load_dwordx2 v[136:137], v7, s[20:23], s61 offen offset:0
    v_perm_b32 v33, v109, v105, s67
    s_mov_b32 s61, 0x4000
    buffer_load_dwordx2 v[138:139], v7, s[20:23], s61 offen offset:1024
    v_perm_b32 v34, v117, v113, s67
    s_mov_b32 s61, 0x4000
    buffer_load_dwordx2 v[152:153], v7, s[20:23], s61 offen offset:2048
    v_perm_b32 v35, v125, v121, s67
    s_mov_b32 s61, 0x4000
    buffer_load_dwordx2 v[154:155], v7, s[20:23], s61 offen offset:3072
    v_mfma_f32_16x16x32_bf16 a[4:7], v[36:39], v[28:31], a[4:7]
    v_perm_b32 v36, v103, v99, s67
    s_mov_b32 s61, 0x5000
    buffer_load_dwordx2 v[232:233], v7, s[20:23], s61 offen offset:0
    v_perm_b32 v37, v111, v107, s67
    s_mov_b32 s61, 0x5000
    buffer_load_dwordx2 v[234:235], v7, s[20:23], s61 offen offset:1024
    v_perm_b32 v38, v119, v115, s67
    s_mov_b32 s61, 0x5000
    buffer_load_dwordx2 v[248:249], v7, s[20:23], s61 offen offset:2048
    v_perm_b32 v39, v127, v123, s67
    s_mov_b32 s61, 0x5000
    buffer_load_dwordx2 v[250:251], v7, s[20:23], s61 offen offset:3072
    v_mfma_f32_16x16x32_bf16 a[0:3], v[32:35], v[40:43], a[0:3]
    v_perm_b32 v32, v101, v97, s68
    s_mov_b32 s61, 0x6000
    buffer_load_dwordx2 v[140:141], v7, s[20:23], s61 offen offset:0
    v_perm_b32 v33, v109, v105, s68
    s_mov_b32 s61, 0x6000
    buffer_load_dwordx2 v[142:143], v7, s[20:23], s61 offen offset:1024
    v_perm_b32 v34, v117, v113, s68
    s_mov_b32 s61, 0x6000
    buffer_load_dwordx2 v[156:157], v7, s[20:23], s61 offen offset:2048
    v_perm_b32 v35, v125, v121, s68
    s_mov_b32 s61, 0x6000
    buffer_load_dwordx2 v[158:159], v7, s[20:23], s61 offen offset:3072
    v_mfma_f32_16x16x32_bf16 a[4:7], v[36:39], v[40:43], a[4:7]
    v_perm_b32 v36, v103, v99, s68
    s_mov_b32 s61, 0x7000
    buffer_load_dwordx2 v[236:237], v7, s[20:23], s61 offen offset:0
    v_perm_b32 v37, v111, v107, s68
    s_mov_b32 s61, 0x7000
    buffer_load_dwordx2 v[238:239], v7, s[20:23], s61 offen offset:1024
    v_perm_b32 v38, v119, v115, s68
    s_mov_b32 s61, 0x7000
    buffer_load_dwordx2 v[252:253], v7, s[20:23], s61 offen offset:2048
    v_perm_b32 v39, v127, v123, s68
    s_mov_b32 s61, 0x7000
    buffer_load_dwordx2 v[254:255], v7, s[20:23], s61 offen offset:3072
    v_mfma_f32_16x16x32_bf16 a[0:3], v[32:35], v[44:47], a[0:3]
    v_mfma_f32_16x16x32_bf16 a[4:7], v[36:39], v[44:47], a[4:7]
    s_cmp_eq_u32 s34, 0
    s_cbranch_scc1 MLD_Y
    s_mov_b32 s62, 0x40000
    s_waitcnt vmcnt(32)
MLR_Y:
    v_xor_b32 v10, s58, v58
    v_bitop3_b32 v10, v59, s58, v10 bitop3:0xbe
    v_bitop3_b32 v10, v62, s58, v10 bitop3:0xbe
    v_bitop3_b32 v10, v63, s58, v10 bitop3:0xbe
    v_cmp_ne_u32 vcc, 0, v10
    s_cbranch_vccz MLF_Y
    s_mov_b32 s61, 0x20000
    buffer_load_dwordx4 v[56:59], v6, s[12:15], s61 offen offset:0 sc1
    s_mov_b32 s61, 0x20000
    buffer_load_dwordx4 v[60:63], v6, s[12:15], s61 offen offset:1024 sc1
    s_waitcnt vmcnt(0)
    s_sub_u32 s62, s62, 1
    s_cbranch_scc0 MLR_Y
MLF_Y:
    v_max_f32 v58, v56, v60
    s_nop 1
    v_max_f32_dpp v58, v58, v58 row_ror:4 row_mask:0xf bank_mask:0xf
    s_nop 1
    v_max_f32_dpp v58, v58, v58 row_ror:8 row_mask:0xf bank_mask:0xf
    v_mov_b32 v10, v58
    s_nop 1
    v_permlane16_swap_b32 v58, v10
    v_max_f32 v58, v58, v10
    v_mov_b32 v10, v58
    s_nop 1
    v_permlane32_swap_b32 v58, v10
    v_max_f32 v58, v58, v10
    v_sub_f32 v56, v56, v58
    v_sub_f32 v60, v60, v58
    v_sub_f32 v9, v9, v58
    v_mul_f32 v56, s69, v56
    v_mul_f32 v60, s69, v60
    v_mul_f32 v9, s69, v9
    v_exp_f32 v56, v56
    v_exp_f32 v60, v60
    v_exp_f32 v9, v9
    v_mul_f32 v57, v57, v56
    v_fmac_f32 v57, v61, v60
    s_nop 1
    v_add_f32_dpp v57, v57, v57 row_ror:4 row_mask:0xf bank_mask:0xf
    s_nop 1
    v_add_f32_dpp v57, v57, v57 row_ror:8 row_mask:0xf bank_mask:0xf
    v_mov_b32 v10, v57
    s_nop 1
    v_permlane16_swap_b32 v57, v10
    v_add_f32 v57, v57, v10
    v_mov_b32 v10, v57
    s_nop 1
    v_permlane32_swap_b32 v57, v10
    v_add_f32 v57, v57, v10
    v_rcp_f32 v57, v57
    s_nop 0
    v_mul_f32 v9, v9, v57
    v_lshlrev_b32 v10, 4, v1
    s_lshl_b32 s64, s3, 2
    v_add_u32 v10, s64, v10
    s_mov_b64 exec, 0xf
    ds_write_b32 v10, v9 offset:26880
    s_mov_b64 exec, -1
MLD_Y:
    s_nop 4
    ds_write_b128 v8, a[0:3] offset:18688
    ds_write_b128 v8, a[4:7] offset:19712
    s_waitcnt lgkmcnt(0)
    s_barrier
    s_cmp_ge_u32 s3, 2
    s_cbranch_scc1 SK2_Y
    ds_read_b128 v[48:51], v15 offset:26880
    ds_read_b128 v[32:35], v2 offset:18688
    ds_read_b128 v[36:39], v2 offset:20736
    ds_read_b128 v[40:43], v2 offset:22784
    ds_read_b128 v[44:47], v2 offset:24832
    s_waitcnt lgkmcnt(2)
    v_pk_mul_f32 v[32:33], v[32:33], v[48:49] op_sel_hi:[1,0]
    v_pk_mul_f32 v[34:35], v[34:35], v[48:49] op_sel_hi:[1,0]
    v_pk_fma_f32 v[32:33], v[36:37], v[48:49], v[32:33] op_sel:[0,1,0] op_sel_hi:[1,1,1]
    v_pk_fma_f32 v[34:35], v[38:39], v[48:49], v[34:35] op_sel:[0,1,0] op_sel_hi:[1,1,1]
    s_waitcnt lgkmcnt(0)
    v_pk_fma_f32 v[32:33], v[40:41], v[50:51], v[32:33] op_sel_hi:[1,0,1]
    v_pk_fma_f32 v[34:35], v[42:43], v[50:51], v[34:35] op_sel_hi:[1,0,1]
    v_pk_fma_f32 v[32:33], v[44:45], v[50:51], v[32:33] op_sel:[0,1,0] op_sel_hi:[1,1,1]
    v_pk_fma_f32 v[34:35], v[46:47], v[50:51], v[34:35] op_sel:[0,1,0] op_sel_hi:[1,1,1]
    v_bfi_b32 v32, s65, v4, v32
    v_bfi_b32 v33, s65, v4, v33
    v_bfi_b32 v34, s65, v4, v34
    v_bfi_b32 v35, s65, v4, v35
    s_mov_b32 s61, 0x80000
    buffer_store_dwordx4 v[32:35], v14, s[12:15], s61 offen offset:0 sc1
SK2_Y:
    s_barrier
    v_and_b32 v10, 3, v1
    v_lshlrev_b32 v10, 17, v10
    v_add_u32 v10, v10, v5
    s_lshl_b32 s64, s63, 14
    v_add_u32 v6, s64, v10
    v_mov_b32 v16, 0
    v_mov_b32 v17, 0
    v_mov_b32 v18, 0
    v_mov_b32 v19, 0
    v_mov_b32 v20, 0
    v_mov_b32 v21, 0
    v_mov_b32 v22, 0
    v_mov_b32 v23, 0
    v_mov_b32 v9, 0xffff
    v_mov_b32 v3, 0
    s_mov_b32 s74, 0xfffffeff
    s_mov_b32 s75, 0x80000
    s_mov_b32 s62, 0x40000
    s_mov_b32 exec_lo, 0x33333333
    s_mov_b32 exec_hi, 0x33333333
    v_mov_b32 v9, 0
    s_mov_b32 exec_lo, 0xcccccccc
    s_mov_b32 exec_hi, 0xcccccccc
    buffer_load_dwordx4 v[160:163], v6, s[12:15], s75 offen offset:0 sc1
    buffer_load_dwordx4 v[164:167], v6, s[12:15], s75 offen offset:256 sc1
    buffer_load_dwordx4 v[168:171], v6, s[12:15], s75 offen offset:2048 sc1
    buffer_load_dwordx4 v[172:175], v6, s[12:15], s75 offen offset:2304 sc1
    s_add_u32 s61, s75, 0x1000
    buffer_load_dwordx4 v[176:179], v6, s[12:15], s61 offen offset:0 sc1
    buffer_load_dwordx4 v[180:183], v6, s[12:15], s61 offen offset:256 sc1
    s_add_u32 s61, s75, 0x1000
    buffer_load_dwordx4 v[184:187], v6, s[12:15], s61 offen offset:2048 sc1
    buffer_load_dwordx4 v[188:191], v6, s[12:15], s61 offen offset:2304 sc1
    s_add_u32 s61, s75, 0x2000
    buffer_load_dwordx4 v[192:195], v6, s[12:15], s61 offen offset:0 sc1
    buffer_load_dwordx4 v[196:199], v6, s[12:15], s61 offen offset:256 sc1
    s_add_u32 s61, s75, 0x2000
    buffer_load_dwordx4 v[200:203], v6, s[12:15], s61 offen offset:2048 sc1
    buffer_load_dwordx4 v[204:207], v6, s[12:15], s61 offen offset:2304 sc1
    s_add_u32 s61, s75, 0x3000
    buffer_load_dwordx4 v[208:211], v6, s[12:15], s61 offen offset:0 sc1
    buffer_load_dwordx4 v[212:215], v6, s[12:15], s61 offen offset:256 sc1
    s_add_u32 s61, s75, 0x3000
    buffer_load_dwordx4 v[216:219], v6, s[12:15], s61 offen offset:2048 sc1
    buffer_load_dwordx4 v[220:223], v6, s[12:15], s61 offen offset:2304 sc1
    s_mov_b64 exec, -1
    v_lshrrev_b32 v10, 4, v1
    v_add_u32 v10, v10, v1
    v_and_b32 v10, 3, v10
    v_and_b32 v11, 60, v1
    v_or_b32 v10, v10, v11
    v_lshlrev_b32 v10, 4, v10
    s_lshl_b32 s61, s3, 10
    v_add_u32 v8, s61, v10
    v_lshrrev_b32 v10, 4, v1
    v_bfe_u32 v11, v1, 2, 2
    v_add_u32 v10, v10, v11
    v_and_b32 v10, 3, v10
    v_and_b32 v11, 15, v1
    v_lshl_or_b32 v10, v11, 2, v10
    v_lshlrev_b32 v14, 4, v10
    s_lshl_b32 s64, s63, 13
    s_lshr_b32 s61, s37, 1
    s_lshl_b32 s61, s61, 9
    s_add_u32 s64, s64, s61
    s_and_b32 s61, s37, 1
    s_lshl_b32 s61, s61, 7
    s_add_u32 s64, s64, s61
    v_lshrrev_b32 v10, 4, v1
    v_mul_u32_u24 v10, 0x800, v10
    v_and_b32 v11, 1, v1
    v_lshl_add_u32 v10, v11, 8, v10
    v_bfe_u32 v11, v1, 1, 3
    v_lshl_add_u32 v10, v11, 4, v10
    v_add_u32 v15, s64, v10
    s_mul_i32 s36, s3, 0x0
    s_add_u32 s36, s36, 0x200000
    s_waitcnt vmcnt(16)
    v_perm_b32 v64, v130, v128, s67
    v_perm_b32 v65, v134, v132, s67
    v_perm_b32 v66, v138, v136, s67
    v_perm_b32 v67, v142, v140, s67
    v_perm_b32 v68, v130, v128, s68
    v_perm_b32 v69, v134, v132, s68
    v_perm_b32 v70, v138, v136, s68
    v_perm_b32 v71, v142, v140, s68
    v_perm_b32 v72, v131, v129, s67
    v_perm_b32 v73, v135, v133, s67
    v_perm_b32 v74, v139, v137, s67
    v_perm_b32 v75, v143, v141, s67
    v_perm_b32 v76, v131, v129, s68
    v_perm_b32 v77, v135, v133, s68
    v_perm_b32 v78, v139, v137, s68
    v_perm_b32 v79, v143, v141, s68
    v_perm_b32 v80, v146, v144, s67
    v_perm_b32 v81, v150, v148, s67
    v_perm_b32 v82, v154, v152, s67
    v_perm_b32 v83, v158, v156, s67
    v_perm_b32 v84, v146, v144, s68
    v_perm_b32 v85, v150, v148, s68
    v_perm_b32 v86, v154, v152, s68
    v_perm_b32 v87, v158, v156, s68
    v_perm_b32 v88, v147, v145, s67
    v_perm_b32 v89, v151, v149, s67
    v_perm_b32 v90, v155, v153, s67
    v_perm_b32 v91, v159, v157, s67
    v_perm_b32 v92, v147, v145, s68
    v_perm_b32 v93, v151, v149, s68
    v_perm_b32 v94, v155, v153, s68
    v_perm_b32 v95, v159, v157, s68
    v_perm_b32 v96, v226, v224, s67
    v_perm_b32 v97, v230, v228, s67
    v_perm_b32 v98, v234, v232, s67
    v_perm_b32 v99, v238, v236, s67
    v_perm_b32 v100, v226, v224, s68
    v_perm_b32 v101, v230, v228, s68
    v_perm_b32 v102, v234, v232, s68
    v_perm_b32 v103, v238, v236, s68
    v_perm_b32 v104, v227, v225, s67
    v_perm_b32 v105, v231, v229, s67
    v_perm_b32 v106, v235, v233, s67
    v_perm_b32 v107, v239, v237, s67
    v_perm_b32 v108, v227, v225, s68
    v_perm_b32 v109, v231, v229, s68
    v_perm_b32 v110, v235, v233, s68
    v_perm_b32 v111, v239, v237, s68
    v_perm_b32 v112, v242, v240, s67
    v_perm_b32 v113, v246, v244, s67
    v_perm_b32 v114, v250, v248, s67
    v_perm_b32 v115, v254, v252, s67
    v_perm_b32 v116, v242, v240, s68
    v_perm_b32 v117, v246, v244, s68
    v_perm_b32 v118, v250, v248, s68
    v_perm_b32 v119, v254, v252, s68
    v_perm_b32 v120, v243, v241, s67
    v_perm_b32 v121, v247, v245, s67
    v_perm_b32 v122, v251, v249, s67
    v_perm_b32 v123, v255, v253, s67
    v_perm_b32 v124, v243, v241, s68
    v_perm_b32 v125, v247, v245, s68
    v_perm_b32 v126, v251, v249, s68
    v_perm_b32 v127, v255, v253, s68
    v_mov_b32 v48, 0
    v_mov_b32 v49, 0
    v_mov_b32 v50, 0
    v_mov_b32 v51, 0
    v_mov_b32 v52, 0
    v_mov_b32 v53, 0
    v_mov_b32 v54, 0
    v_mov_b32 v55, 0
    v_mov_b32 v56, 0
    v_mov_b32 v57, 0
    v_mov_b32 v58, 0
    v_mov_b32 v59, 0
    v_mov_b32 v60, 0
    v_mov_b32 v61, 0
    v_mov_b32 v62, 0
    v_mov_b32 v63, 0
    s_waitcnt vmcnt(14)
    v_xor_b32 v10, s58, v160
    v_bitop3_b32 v10, v161, s58, v10 bitop3:0xbe
    v_bitop3_b32 v10, v162, s58, v10 bitop3:0xbe
    v_bitop3_b32 v10, v163, s58, v10 bitop3:0xbe
    v_bitop3_b32 v10, v164, s58, v10 bitop3:0xbe
    v_bitop3_b32 v10, v165, s58, v10 bitop3:0xbe
    v_bitop3_b32 v10, v166, s58, v10 bitop3:0xbe
    v_bitop3_b32 v10, v167, s58, v10 bitop3:0xbe
    v_and_b32 v10, 0xff, v10
    v_cmp_eq_u32 vcc, 0, v10
    s_and_b32 exec_lo, vcc_lo, 0xcccccccc
    s_and_b32 exec_hi, vcc_hi, 0xcccccccc
    v_pk_add_f32 v[16:17], v[16:17], v[160:161]
    v_pk_add_f32 v[18:19], v[18:19], v[162:163]
    v_pk_add_f32 v[20:21], v[20:21], v[164:165]
    v_pk_add_f32 v[22:23], v[22:23], v[166:167]
    v_xor_b32 v9, 0x101, v9
    s_mov_b64 exec, -1
    s_waitcnt vmcnt(12)
    v_xor_b32 v10, s58, v168
    v_bitop3_b32 v10, v169, s58, v10 bitop3:0xbe
    v_bitop3_b32 v10, v170, s58, v10 bitop3:0xbe
    v_bitop3_b32 v10, v171, s58, v10 bitop3:0xbe
    v_bitop3_b32 v10, v172, s58, v10 bitop3:0xbe
    v_bitop3_b32 v10, v173, s58, v10 bitop3:0xbe
    v_bitop3_b32 v10, v174, s58, v10 bitop3:0xbe
    v_bitop3_b32 v10, v175, s58, v10 bitop3:0xbe
    v_and_b32 v10, 0xff, v10
    v_cmp_eq_u32 vcc, 0, v10
    s_and_b32 exec_lo, vcc_lo, 0xcccccccc
    s_and_b32 exec_hi, vcc_hi, 0xcccccccc
    v_pk_add_f32 v[16:17], v[16:17], v[168:169]
    v_pk_add_f32 v[18:19], v[18:19], v[170:171]
    v_pk_add_f32 v[20:21], v[20:21], v[172:173]
    v_pk_add_f32 v[22:23], v[22:23], v[174:175]
    v_xor_b32 v9, 0x202, v9
    s_mov_b64 exec, -1
    s_waitcnt vmcnt(10)
    v_xor_b32 v10, s58, v176
    v_bitop3_b32 v10, v177, s58, v10 bitop3:0xbe
    v_bitop3_b32 v10, v178, s58, v10 bitop3:0xbe
    v_bitop3_b32 v10, v179, s58, v10 bitop3:0xbe
    v_bitop3_b32 v10, v180, s58, v10 bitop3:0xbe
    v_bitop3_b32 v10, v181, s58, v10 bitop3:0xbe
    v_bitop3_b32 v10, v182, s58, v10 bitop3:0xbe
    v_bitop3_b32 v10, v183, s58, v10 bitop3:0xbe
    v_and_b32 v10, 0xff, v10
    v_cmp_eq_u32 vcc, 0, v10
    s_and_b32 exec_lo, vcc_lo, 0xcccccccc
    s_and_b32 exec_hi, vcc_hi, 0xcccccccc
    v_pk_add_f32 v[16:17], v[16:17], v[176:177]
    v_pk_add_f32 v[18:19], v[18:19], v[178:179]
    v_pk_add_f32 v[20:21], v[20:21], v[180:181]
    v_pk_add_f32 v[22:23], v[22:23], v[182:183]
    v_xor_b32 v9, 0x404, v9
    s_mov_b64 exec, -1
    s_waitcnt vmcnt(8)
    v_xor_b32 v10, s58, v184
    v_bitop3_b32 v10, v185, s58, v10 bitop3:0xbe
    v_bitop3_b32 v10, v186, s58, v10 bitop3:0xbe
    v_bitop3_b32 v10, v187, s58, v10 bitop3:0xbe
    v_bitop3_b32 v10, v188, s58, v10 bitop3:0xbe
    v_bitop3_b32 v10, v189, s58, v10 bitop3:0xbe
    v_bitop3_b32 v10, v190, s58, v10 bitop3:0xbe
    v_bitop3_b32 v10, v191, s58, v10 bitop3:0xbe
    v_and_b32 v10, 0xff, v10
    v_cmp_eq_u32 vcc, 0, v10
    s_and_b32 exec_lo, vcc_lo, 0xcccccccc
    s_and_b32 exec_hi, vcc_hi, 0xcccccccc
    v_pk_add_f32 v[16:17], v[16:17], v[184:185]
    v_pk_add_f32 v[18:19], v[18:19], v[186:187]
    v_pk_add_f32 v[20:21], v[20:21], v[188:189]
    v_pk_add_f32 v[22:23], v[22:23], v[190:191]
    v_xor_b32 v9, 0x808, v9
    s_mov_b64 exec, -1
    s_waitcnt vmcnt(6)
    v_xor_b32 v10, s58, v192
    v_bitop3_b32 v10, v193, s58, v10 bitop3:0xbe
    v_bitop3_b32 v10, v194, s58, v10 bitop3:0xbe
    v_bitop3_b32 v10, v195, s58, v10 bitop3:0xbe
    v_bitop3_b32 v10, v196, s58, v10 bitop3:0xbe
    v_bitop3_b32 v10, v197, s58, v10 bitop3:0xbe
    v_bitop3_b32 v10, v198, s58, v10 bitop3:0xbe
    v_bitop3_b32 v10, v199, s58, v10 bitop3:0xbe
    v_and_b32 v10, 0xff, v10
    v_cmp_eq_u32 vcc, 0, v10
    s_and_b32 exec_lo, vcc_lo, 0xcccccccc
    s_and_b32 exec_hi, vcc_hi, 0xcccccccc
    v_pk_add_f32 v[16:17], v[16:17], v[192:193]
    v_pk_add_f32 v[18:19], v[18:19], v[194:195]
    v_pk_add_f32 v[20:21], v[20:21], v[196:197]
    v_pk_add_f32 v[22:23], v[22:23], v[198:199]
    v_xor_b32 v9, 0x1010, v9
    s_mov_b64 exec, -1
    s_waitcnt vmcnt(4)
    v_xor_b32 v10, s58, v200
    v_bitop3_b32 v10, v201, s58, v10 bitop3:0xbe
    v_bitop3_b32 v10, v202, s58, v10 bitop3:0xbe
    v_bitop3_b32 v10, v203, s58, v10 bitop3:0xbe
    v_bitop3_b32 v10, v204, s58, v10 bitop3:0xbe
    v_bitop3_b32 v10, v205, s58, v10 bitop3:0xbe
    v_bitop3_b32 v10, v206, s58, v10 bitop3:0xbe
    v_bitop3_b32 v10, v207, s58, v10 bitop3:0xbe
    v_and_b32 v10, 0xff, v10
    v_cmp_eq_u32 vcc, 0, v10
    s_and_b32 exec_lo, vcc_lo, 0xcccccccc
    s_and_b32 exec_hi, vcc_hi, 0xcccccccc
    v_pk_add_f32 v[16:17], v[16:17], v[200:201]
    v_pk_add_f32 v[18:19], v[18:19], v[202:203]
    v_pk_add_f32 v[20:21], v[20:21], v[204:205]
    v_pk_add_f32 v[22:23], v[22:23], v[206:207]
    v_xor_b32 v9, 0x2020, v9
    s_mov_b64 exec, -1
    s_waitcnt vmcnt(2)
    v_xor_b32 v10, s58, v208
    v_bitop3_b32 v10, v209, s58, v10 bitop3:0xbe
    v_bitop3_b32 v10, v210, s58, v10 bitop3:0xbe
    v_bitop3_b32 v10, v211, s58, v10 bitop3:0xbe
    v_bitop3_b32 v10, v212, s58, v10 bitop3:0xbe
    v_bitop3_b32 v10, v213, s58, v10 bitop3:0xbe
    v_bitop3_b32 v10, v214, s58, v10 bitop3:0xbe
    v_bitop3_b32 v10, v215, s58, v10 bitop3:0xbe
    v_and_b32 v10, 0xff, v10
    v_cmp_eq_u32 vcc, 0, v10
    s_and_b32 exec_lo, vcc_lo, 0xcccccccc
    s_and_b32 exec_hi, vcc_hi, 0xcccccccc
    v_pk_add_f32 v[16:17], v[16:17], v[208:209]
    v_pk_add_f32 v[18:19], v[18:19], v[210:211]
    v_pk_add_f32 v[20:21], v[20:21], v[212:213]
    v_pk_add_f32 v[22:23], v[22:23], v[214:215]
    v_xor_b32 v9, 0x4040, v9
    s_mov_b64 exec, -1
    s_waitcnt vmcnt(0)
    v_xor_b32 v10, s58, v216
    v_bitop3_b32 v10, v217, s58, v10 bitop3:0xbe
    v_bitop3_b32 v10, v218, s58, v10 bitop3:0xbe
    v_bitop3_b32 v10, v219, s58, v10 bitop3:0xbe
    v_bitop3_b32 v10, v220, s58, v10 bitop3:0xbe
    v_bitop3_b32 v10, v221, s58, v10 bitop3:0xbe
    v_bitop3_b32 v10, v222, s58, v10 bitop3:0xbe
    v_bitop3_b32 v10, v223, s58, v10 bitop3:0xbe
    v_and_b32 v10, 0xff, v10
    v_cmp_eq_u32 vcc, 0, v10
    s_and_b32 exec_lo, vcc_lo, 0xcccccccc
    s_and_b32 exec_hi, vcc_hi, 0xcccccccc
    v_pk_add_f32 v[16:17], v[16:17], v[216:217]
    v_pk_add_f32 v[18:19], v[18:19], v[218:219]
    v_pk_add_f32 v[20:21], v[20:21], v[220:221]
    v_pk_add_f32 v[22:23], v[22:23], v[222:223]
    v_xor_b32 v9, 0x8080, v9
    s_mov_b64 exec, -1
    v_cmp_ne_u32 vcc, 0, v9
    s_mov_b64 exec, vcc
    s_cbranch_execz RD_Ym1
    v_lshrrev_b32 v11, v3, v9
    v_ffbl_b32 v11, v11
    v_add_u32 v11, v11, v3
    v_and_b32 v24, 7, v11
    v_add_u32 v3, 1, v24
    v_lshl_add_u32 v11, v24, 11, v6
    buffer_load_dwordx4 v[160:163], v11, s[12:15], s75 offen offset:0 sc1
    buffer_load_dwordx4 v[164:167], v11, s[12:15], s75 offen offset:256 sc1
    v_lshrrev_b32 v11, v3, v9
    v_ffbl_b32 v11, v11
    v_add_u32 v11, v11, v3
    v_and_b32 v25, 7, v11
    v_add_u32 v3, 1, v25
    v_lshl_add_u32 v11, v25, 11, v6
    buffer_load_dwordx4 v[168:171], v11, s[12:15], s75 offen offset:0 sc1
    buffer_load_dwordx4 v[172:175], v11, s[12:15], s75 offen offset:256 sc1
    v_lshrrev_b32 v11, v3, v9
    v_ffbl_b32 v11, v11
    v_add_u32 v11, v11, v3
    v_and_b32 v26, 7, v11
    v_add_u32 v3, 1, v26
    v_lshl_add_u32 v11, v26, 11, v6
    buffer_load_dwordx4 v[176:179], v11, s[12:15], s75 offen offset:0 sc1
    buffer_load_dwordx4 v[180:183], v11, s[12:15], s75 offen offset:256 sc1
RL_Ym1:
    v_lshrrev_b32 v11, v3, v9
    v_ffbl_b32 v11, v11
    v_add_u32 v11, v11, v3
    v_and_b32 v27, 7, v11
    v_add_u32 v3, 1, v27
    v_lshl_add_u32 v11, v27, 11, v6
    buffer_load_dwordx4 v[184:187], v11, s[12:15], s75 offen offset:0 sc1
    buffer_load_dwordx4 v[188:191], v11, s[12:15], s75 offen offset:256 sc1
    v_bfe_u32 v12, v9, v24, 1
    s_waitcnt vmcnt(6)
    v_xor_b32 v10, s58, v160
    v_bitop3_b32 v10, v161, s58, v10 bitop3:0xbe
    v_bitop3_b32 v10, v162, s58, v10 bitop3:0xbe
    v_bitop3_b32 v10, v163, s58, v10 bitop3:0xbe
    v_bitop3_b32 v10, v164, s58, v10 bitop3:0xbe
    v_bitop3_b32 v10, v165, s58, v10 bitop3:0xbe
    v_bitop3_b32 v10, v166, s58, v10 bitop3:0xbe
    v_bitop3_b32 v10, v167, s58, v10 bitop3:0xbe
    v_and_b32 v10, 0xff, v10
    v_cmp_lt_u32 vcc, v10, v12
    s_and_saveexec_b64 s[72:73], vcc
    v_pk_add_f32 v[16:17], v[16:17], v[160:161]
    v_pk_add_f32 v[18:19], v[18:19], v[162:163]
    v_pk_add_f32 v[20:21], v[20:21], v[164:165]
    v_pk_add_f32 v[22:23], v[22:23], v[166:167]
    v_lshl_add_u32 v9, s74, v24, v9
    s_mov_b64 exec, s[72:73]
    v_cmp_ne_u32 vcc, 0, v9
    s_mov_b64 exec, vcc
    s_cbranch_execz RD_Ym1
    v_lshrrev_b32 v11, v3, v9
    v_ffbl_b32 v11, v11
    v_add_u32 v11, v11, v3
    v_and_b32 v24, 7, v11
    v_add_u32 v3, 1, v24
    v_lshl_add_u32 v11, v24, 11, v6
    buffer_load_dwordx4 v[160:163], v11, s[12:15], s75 offen offset:0 sc1
    buffer_load_dwordx4 v[164:167], v11, s[12:15], s75 offen offset:256 sc1
    v_bfe_u32 v12, v9, v25, 1
    s_waitcnt vmcnt(6)
    v_xor_b32 v10, s58, v168
    v_bitop3_b32 v10, v169, s58, v10 bitop3:0xbe
    v_bitop3_b32 v10, v170, s58, v10 bitop3:0xbe
    v_bitop3_b32 v10, v171, s58, v10 bitop3:0xbe
    v_bitop3_b32 v10, v172, s58, v10 bitop3:0xbe
    v_bitop3_b32 v10, v173, s58, v10 bitop3:0xbe
    v_bitop3_b32 v10, v174, s58, v10 bitop3:0xbe
    v_bitop3_b32 v10, v175, s58, v10 bitop3:0xbe
    v_and_b32 v10, 0xff, v10
    v_cmp_lt_u32 vcc, v10, v12
    s_and_saveexec_b64 s[72:73], vcc
    v_pk_add_f32 v[16:17], v[16:17], v[168:169]
    v_pk_add_f32 v[18:19], v[18:19], v[170:171]
    v_pk_add_f32 v[20:21], v[20:21], v[172:173]
    v_pk_add_f32 v[22:23], v[22:23], v[174:175]
    v_lshl_add_u32 v9, s74, v25, v9
    s_mov_b64 exec, s[72:73]
    v_cmp_ne_u32 vcc, 0, v9
    s_mov_b64 exec, vcc
    s_cbranch_execz RD_Ym1
    v_lshrrev_b32 v11, v3, v9
    v_ffbl_b32 v11, v11
    v_add_u32 v11, v11, v3
    v_and_b32 v25, 7, v11
    v_add_u32 v3, 1, v25
    v_lshl_add_u32 v11, v25, 11, v6
    buffer_load_dwordx4 v[168:171], v11, s[12:15], s75 offen offset:0 sc1
    buffer_load_dwordx4 v[172:175], v11, s[12:15], s75 offen offset:256 sc1
    v_bfe_u32 v12, v9, v26, 1
    s_waitcnt vmcnt(6)
    v_xor_b32 v10, s58, v176
    v_bitop3_b32 v10, v177, s58, v10 bitop3:0xbe
    v_bitop3_b32 v10, v178, s58, v10 bitop3:0xbe
    v_bitop3_b32 v10, v179, s58, v10 bitop3:0xbe
    v_bitop3_b32 v10, v180, s58, v10 bitop3:0xbe
    v_bitop3_b32 v10, v181, s58, v10 bitop3:0xbe
    v_bitop3_b32 v10, v182, s58, v10 bitop3:0xbe
    v_bitop3_b32 v10, v183, s58, v10 bitop3:0xbe
    v_and_b32 v10, 0xff, v10
    v_cmp_lt_u32 vcc, v10, v12
    s_and_saveexec_b64 s[72:73], vcc
    v_pk_add_f32 v[16:17], v[16:17], v[176:177]
    v_pk_add_f32 v[18:19], v[18:19], v[178:179]
    v_pk_add_f32 v[20:21], v[20:21], v[180:181]
    v_pk_add_f32 v[22:23], v[22:23], v[182:183]
    v_lshl_add_u32 v9, s74, v26, v9
    s_mov_b64 exec, s[72:73]
    v_cmp_ne_u32 vcc, 0, v9
    s_mov_b64 exec, vcc
    s_cbranch_execz RD_Ym1
    v_lshrrev_b32 v11, v3, v9
    v_ffbl_b32 v11, v11
    v_add_u32 v11, v11, v3
    v_and_b32 v26, 7, v11
    v_add_u32 v3, 1, v26
    v_lshl_add_u32 v11, v26, 11, v6
    buffer_load_dwordx4 v[176:179], v11, s[12:15], s75 offen offset:0 sc1
    buffer_load_dwordx4 v[180:183], v11, s[12:15], s75 offen offset:256 sc1
    v_bfe_u32 v12, v9, v27, 1
    s_waitcnt vmcnt(6)
    v_xor_b32 v10, s58, v184
    v_bitop3_b32 v10, v185, s58, v10 bitop3:0xbe
    v_bitop3_b32 v10, v186, s58, v10 bitop3:0xbe
    v_bitop3_b32 v10, v187, s58, v10 bitop3:0xbe
    v_bitop3_b32 v10, v188, s58, v10 bitop3:0xbe
    v_bitop3_b32 v10, v189, s58, v10 bitop3:0xbe
    v_bitop3_b32 v10, v190, s58, v10 bitop3:0xbe
    v_bitop3_b32 v10, v191, s58, v10 bitop3:0xbe
    v_and_b32 v10, 0xff, v10
    v_cmp_lt_u32 vcc, v10, v12
    s_and_saveexec_b64 s[72:73], vcc
    v_pk_add_f32 v[16:17], v[16:17], v[184:185]
    v_pk_add_f32 v[18:19], v[18:19], v[186:187]
    v_pk_add_f32 v[20:21], v[20:21], v[188:189]
    v_pk_add_f32 v[22:23], v[22:23], v[190:191]
    v_lshl_add_u32 v9, s74, v27, v9
    s_mov_b64 exec, s[72:73]
    v_cmp_ne_u32 vcc, 0, v9
    s_mov_b64 exec, vcc
    s_cbranch_execz RD_Ym1
    s_sub_u32 s62, s62, 1
    s_cbranch_scc0 RL_Ym1
RD_Ym1:
    s_mov_b64 exec, -1
    v_cvt_pk_bf16_f32 v24, v16, v20
    v_cvt_pk_bf16_f32 v25, v17, v21
    v_cvt_pk_bf16_f32 v26, v18, v22
    v_cvt_pk_bf16_f32 v27, v19, v23
    v_mov_b32_dpp v48, v24 quad_perm:[0,1,2,3] row_mask:0xf bank_mask:0x1
    v_mov_b32_dpp v49, v25 quad_perm:[0,1,2,3] row_mask:0xf bank_mask:0x1
    v_mov_b32_dpp v50, v26 quad_perm:[0,1,2,3] row_mask:0xf bank_mask:0x1
    v_mov_b32_dpp v51, v27 quad_perm:[0,1,2,3] row_mask:0xf bank_mask:0x1
    s_nop 1
    v_mfma_f32_16x16x32_bf16 v[128:131], v[64:67], v[48:51], 0
    v_mov_b32_dpp v52, v24 quad_perm:[0,1,2,3] row_mask:0xf bank_mask:0x2
    v_mov_b32_dpp v53, v25 quad_perm:[0,1,2,3] row_mask:0xf bank_mask:0x2
    v_mfma_f32_16x16x32_bf16 v[132:135], v[68:71], v[48:51], 0
    v_mov_b32_dpp v54, v26 quad_perm:[0,1,2,3] row_mask:0xf bank_mask:0x2
    v_mov_b32_dpp v55, v27 quad_perm:[0,1,2,3] row_mask:0xf bank_mask:0x2
    s_nop 1
    v_mfma_f32_16x16x32_bf16 v[128:131], v[80:83], v[52:55], v[128:131]
    v_mov_b32_dpp v56, v24 quad_perm:[0,1,2,3] row_mask:0xf bank_mask:0x4
    v_mov_b32_dpp v57, v25 quad_perm:[0,1,2,3] row_mask:0xf bank_mask:0x4
    v_mfma_f32_16x16x32_bf16 v[132:135], v[84:87], v[52:55], v[132:135]
    v_mov_b32_dpp v58, v26 quad_perm:[0,1,2,3] row_mask:0xf bank_mask:0x4
    v_mov_b32_dpp v59, v27 quad_perm:[0,1,2,3] row_mask:0xf bank_mask:0x4
    s_nop 1
    v_mfma_f32_16x16x32_bf16 v[128:131], v[96:99], v[56:59], v[128:131]
    v_mov_b32_dpp v60, v24 quad_perm:[0,1,2,3] row_mask:0xf bank_mask:0x8
    v_mov_b32_dpp v61, v25 quad_perm:[0,1,2,3] row_mask:0xf bank_mask:0x8
    v_mfma_f32_16x16x32_bf16 v[132:135], v[100:103], v[56:59], v[132:135]
    v_mov_b32_dpp v62, v26 quad_perm:[0,1,2,3] row_mask:0xf bank_mask:0x8
    v_mov_b32_dpp v63, v27 quad_perm:[0,1,2,3] row_mask:0xf bank_mask:0x8
    s_nop 1
    v_mfma_f32_16x16x32_bf16 v[128:131], v[112:115], v[60:63], v[128:131]
    v_mfma_f32_16x16x32_bf16 v[132:135], v[116:119], v[60:63], v[132:135]
    v_mfma_f32_16x16x32_bf16 v[136:139], v[72:75], v[48:51], 0
    v_mfma_f32_16x16x32_bf16 v[140:143], v[76:79], v[48:51], 0
    v_mfma_f32_16x16x32_bf16 v[136:139], v[88:91], v[52:55], v[136:139]
    v_mfma_f32_16x16x32_bf16 v[140:143], v[92:95], v[52:55], v[140:143]
    s_nop 2
    v_add_f32_dpp v144, v128, v128 row_shl:4 row_mask:0xf bank_mask:0x5
    v_add_f32_dpp v146, v129, v129 row_shl:4 row_mask:0xf bank_mask:0x5
    v_mfma_f32_16x16x32_bf16 v[136:139], v[104:107], v[56:59], v[136:139]
    v_add_f32_dpp v148, v130, v130 row_shl:4 row_mask:0xf bank_mask:0x5
    v_add_f32_dpp v150, v131, v131 row_shl:4 row_mask:0xf bank_mask:0x5
    v_mfma_f32_16x16x32_bf16 v[140:143], v[108:111], v[56:59], v[140:143]
    v_add_f32_dpp v144, v132, v132 row_shr:4 row_mask:0xf bank_mask:0xa
    v_add_f32_dpp v146, v133, v133 row_shr:4 row_mask:0xf bank_mask:0xa
    v_mfma_f32_16x16x32_bf16 v[136:139], v[120:123], v[60:63], v[136:139]
    v_add_f32_dpp v148, v134, v134 row_shr:4 row_mask:0xf bank_mask:0xa
    v_add_f32_dpp v150, v135, v135 row_shr:4 row_mask:0xf bank_mask:0xa
    v_mfma_f32_16x16x32_bf16 v[140:143], v[124:127], v[60:63], v[140:143]
    s_nop 4
    v_add_f32_dpp v145, v136, v136 row_shl:4 row_mask:0xf bank_mask:0x5
    v_add_f32_dpp v147, v137, v137 row_shl:4 row_mask:0xf bank_mask:0x5
    v_add_f32_dpp v149, v138, v138 row_shl:4 row_mask:0xf bank_mask:0x5
    v_add_f32_dpp v151, v139, v139 row_shl:4 row_mask:0xf bank_mask:0x5
    v_add_f32_dpp v145, v140, v140 row_shr:4 row_mask:0xf bank_mask:0xa
    v_add_f32_dpp v147, v141, v141 row_shr:4 row_mask:0xf bank_mask:0xa
    v_add_f32_dpp v149, v142, v142 row_shr:4 row_mask:0xf bank_mask:0xa
    v_add_f32_dpp v151, v143, v143 row_shr:4 row_mask:0xf bank_mask:0xa
    v_add_f32_dpp v152, v144, v144 row_shl:8 row_mask:0xf bank_mask:0x3
    v_add_f32_dpp v153, v146, v146 row_shl:8 row_mask:0xf bank_mask:0x3
    v_add_f32_dpp v154, v148, v148 row_shl:8 row_mask:0xf bank_mask:0x3
    v_add_f32_dpp v155, v150, v150 row_shl:8 row_mask:0xf bank_mask:0x3
    v_add_f32_dpp v152, v145, v145 row_shr:8 row_mask:0xf bank_mask:0xc
    v_add_f32_dpp v153, v147, v147 row_shr:8 row_mask:0xf bank_mask:0xc
    v_add_f32_dpp v154, v149, v149 row_shr:8 row_mask:0xf bank_mask:0xc
    v_add_f32_dpp v155, v151, v151 row_shr:8 row_mask:0xf bank_mask:0xc
    ds_write_b128 v8, v[152:155] offset:0
    s_waitcnt lgkmcnt(0)
    s_barrier
    s_cmp_lg_u32 s3, 0
    s_cbranch_scc1 WS_Y
    ds_read_b128 v[16:19], v14 offset:0
    ds_read_b128 v[20:23], v14 offset:1024
    ds_read_b128 v[24:27], v14 offset:2048
    ds_read_b128 v[28:31], v14 offset:3072
    s_waitcnt lgkmcnt(2)
    v_pk_add_f32 v[16:17], v[16:17], v[20:21]
    v_pk_add_f32 v[18:19], v[18:19], v[22:23]
    s_waitcnt lgkmcnt(0)
    v_pk_add_f32 v[24:25], v[24:25], v[28:29]
    v_pk_add_f32 v[26:27], v[26:27], v[30:31]
    v_pk_add_f32 v[16:17], v[16:17], v[24:25]
    v_pk_add_f32 v[18:19], v[18:19], v[26:27]
    v_bfi_b32 v16, s65, v4, v16
    v_bfi_b32 v17, s65, v4, v17
    v_bfi_b32 v18, s65, v4, v18
    v_bfi_b32 v19, s65, v4, v19
    s_mov_b32 exec_lo, 0
    buffer_store_dwordx4 v[16:19], v15, s[12:15], s36 offen sc1
    s_mov_b64 exec, -1
WS_Y:
DONE_Y:
    s_waitcnt vmcnt(0)
    s_endpgm
.p2align 6
CLS_N:
    s_sub_u32 s61, s2, 112
    s_lshr_b32 s61, s61, 3
    s_lshl_b32 s61, s61, 2
    s_add_u32 s61, s61, s3
    s_min_u32 s61, s61, 63
    s_lshl_b32 s61, s61, 3
    v_lshrrev_b32 v10, 3, v1
    v_add_u32 v10, s61, v10
    v_and_b32 v11, 7, v1
    s_and_b32 s64, s2, 7
    s_mul_i32 s61, s64, 768
    s_lshl_b32 s64, s64, 10
    v_min_u32 v12, 5, v11
    v_lshlrev_b32 v12, 7, v12
    v_add_u32 v12, s61, v12
    v_mul_u32_u24 v13, 0x1800, v10
    v_add_u32 v12, v12, v13
    global_load_dword v60, v12, s[52:53] nt
    v_lshlrev_b32 v10, 13, v10
    v_lshl_add_u32 v10, v11, 7, v10
    v_add_u32 v10, s64, v10
    global_load_dword v60, v10, s[38:39] nt
    buffer_load_dwordx4 a[0:3], v2, s[4:7], s59 offen offset:0 nt
    buffer_load_dwordx4 a[4:7], v2, s[4:7], s59 offen offset:128 nt
    buffer_load_dwordx4 a[8:11], v2, s[4:7], s59 offen offset:1024 nt
    buffer_load_dwordx4 a[12:15], v2, s[4:7], s59 offen offset:1152 nt
    buffer_load_dwordx4 a[16:19], v2, s[4:7], s59 offen offset:2048 nt
    buffer_load_dwordx4 a[20:23], v2, s[4:7], s59 offen offset:2176 nt
    buffer_load_dwordx4 a[24:27], v2, s[4:7], s59 offen offset:3072 nt
    buffer_load_dwordx4 a[28:31], v2, s[4:7], s59 offen offset:3200 nt
    s_add_u32 s79, s59, 4096
    s_pack_lh_b32_b16 s59, s79, s59
    s_waitcnt lgkmcnt(0)
    s_add_u32 s58, s58, 0x9e3779b9
    v_mov_b32 v4, s58
    buffer_load_dwordx4 a[32:35], v2, s[4:7], s59 offen offset:0 nt
    buffer_load_dwordx4 a[36:39], v2, s[4:7], s59 offen offset:128 nt
    buffer_load_dwordx4 a[40:43], v2, s[4:7], s59 offen offset:1024 nt
    buffer_load_dwordx4 a[44:47], v2, s[4:7], s59 offen offset:1152 nt
    buffer_load_dwordx4 a[48:51], v2, s[4:7], s59 offen offset:2048 nt
    buffer_load_dwordx4 a[52:55], v2, s[4:7], s59 offen offset:2176 nt
    buffer_load_dwordx4 a[56:59], v2, s[4:7], s59 offen offset:3072 nt
    buffer_load_dwordx4 a[60:63], v2, s[4:7], s59 offen offset:3200 nt
    s_add_u32 s79, s59, 12288
    s_pack_lh_b32_b16 s59, s79, s59
    buffer_load_dwordx4 a[64:67], v2, s[4:7], s59 offen offset:0 nt
    buffer_load_dwordx4 a[68:71], v2, s[4:7], s59 offen offset:128 nt
    buffer_load_dwordx4 a[72:75], v2, s[4:7], s59 offen offset:1024 nt
    buffer_load_dwordx4 a[76:79], v2, s[4:7], s59 offen offset:1152 nt
    buffer_load_dwordx4 a[80:83], v2, s[4:7], s59 offen offset:2048 nt
    buffer_load_dwordx4 a[84:87], v2, s[4:7], s59 offen offset:2176 nt
    buffer_load_dwordx4 a[88:91], v2, s[4:7], s59 offen offset:3072 nt
    buffer_load_dwordx4 a[92:95], v2, s[4:7], s59 offen offset:3200 nt
    s_add_u32 s79, s59, 4096
    s_pack_lh_b32_b16 s59, s79, s59
    buffer_load_dwordx4 a[96:99], v2, s[4:7], s59 offen offset:0 nt
    buffer_load_dwordx4 a[100:103], v2, s[4:7], s59 offen offset:128 nt
    buffer_load_dwordx4 a[104:107], v2, s[4:7], s59 offen offset:1024 nt
    buffer_load_dwordx4 a[108:111], v2, s[4:7], s59 offen offset:1152 nt
    buffer_load_dwordx4 a[112:115], v2, s[4:7], s59 offen offset:2048 nt
    buffer_load_dwordx4 a[116:119], v2, s[4:7], s59 offen offset:2176 nt
    buffer_load_dwordx4 a[120:123], v2, s[4:7], s59 offen offset:3072 nt
    buffer_load_dwordx4 a[124:127], v2, s[4:7], s59 offen offset:3200 nt
    s_add_u32 s79, s59, 12288
    s_pack_lh_b32_b16 s59, s79, s59
    buffer_load_dwordx4 a[128:131], v2, s[4:7], s59 offen offset:0 nt
    buffer_load_dwordx4 a[132:135], v2, s[4:7], s59 offen offset:128 nt
    buffer_load_dwordx4 a[136:139], v2, s[4:7], s59 offen offset:1024 nt
    buffer_load_dwordx4 a[140:143], v2, s[4:7], s59 offen offset:1152 nt
    buffer_load_dwordx4 a[144:147], v2, s[4:7], s59 offen offset:2048 nt
    buffer_load_dwordx4 a[148:151], v2, s[4:7], s59 offen offset:2176 nt
    buffer_load_dwordx4 a[152:155], v2, s[4:7], s59 offen offset:3072 nt
    buffer_load_dwordx4 a[156:159], v2, s[4:7], s59 offen offset:3200 nt
    s_add_u32 s79, s59, 4096
    s_pack_lh_b32_b16 s59, s79, s59
    buffer_load_dwordx4 a[160:163], v2, s[4:7], s59 offen offset:0 nt
    buffer_load_dwordx4 a[164:167], v2, s[4:7], s59 offen offset:128 nt
    buffer_load_dwordx4 a[168:171], v2, s[4:7], s59 offen offset:1024 nt
    buffer_load_dwordx4 a[172:175], v2, s[4:7], s59 offen offset:1152 nt
    buffer_load_dwordx4 a[176:179], v2, s[4:7], s59 offen offset:2048 nt
    buffer_load_dwordx4 a[180:183], v2, s[4:7], s59 offen offset:2176 nt
    buffer_load_dwordx4 a[184:187], v2, s[4:7], s59 offen offset:3072 nt
    buffer_load_dwordx4 a[188:191], v2, s[4:7], s59 offen offset:3200 nt
    s_add_u32 s79, s59, 12288
    s_pack_lh_b32_b16 s59, s79, s59
    buffer_load_dwordx4 a[192:195], v2, s[4:7], s59 offen offset:0 nt
    buffer_load_dwordx4 a[196:199], v2, s[4:7], s59 offen offset:128 nt
    buffer_load_dwordx4 a[200:203], v2, s[4:7], s59 offen offset:1024 nt
    buffer_load_dwordx4 a[204:207], v2, s[4:7], s59 offen offset:1152 nt
    buffer_load_dwordx4 a[208:211], v2, s[4:7], s59 offen offset:2048 nt
    buffer_load_dwordx4 a[212:215], v2, s[4:7], s59 offen offset:2176 nt
    buffer_load_dwordx4 a[216:219], v2, s[4:7], s59 offen offset:3072 nt
    buffer_load_dwordx4 a[220:223], v2, s[4:7], s59 offen offset:3200 nt
    s_add_u32 s79, s59, 4096
    s_pack_lh_b32_b16 s59, s79, s59
    buffer_load_dwordx4 a[224:227], v2, s[4:7], s59 offen offset:0 nt
    buffer_load_dwordx4 a[228:231], v2, s[4:7], s59 offen offset:128 nt
    buffer_load_dwordx4 a[232:235], v2, s[4:7], s59 offen offset:1024 nt
    buffer_load_dwordx4 a[236:239], v2, s[4:7], s59 offen offset:1152 nt
    buffer_load_dwordx4 a[240:243], v2, s[4:7], s59 offen offset:2048 nt
    buffer_load_dwordx4 a[244:247], v2, s[4:7], s59 offen offset:2176 nt
    buffer_load_dwordx4 a[248:251], v2, s[4:7], s59 offen offset:3072 nt
    buffer_load_dwordx4 a[252:255], v2, s[4:7], s59 offen offset:3200 nt
    s_add_u32 s79, s59, 12288
    s_pack_lh_b32_b16 s59, s79, s59
    v_and_b32 v10, 3, v1
    v_lshlrev_b32 v10, 9, v10
    v_lshrrev_b32 v11, 4, v1
    v_lshl_add_u32 v10, v11, 5, v10
    v_bfe_u32 v11, v1, 2, 1
    v_lshl_add_u32 v10, v11, 7, v10
    s_lshr_b32 s61, s2, 3
    s_lshl_b32 s61, s61, 11
    v_add_u32 v6, s61, v10
    s_mov_b32 s61, 0x10000
    buffer_load_dwordx4 v[224:227], v6, s[12:15], s61 offen offset:0 sc1
    s_mov_b32 s61, 0x10000
    buffer_load_dwordx4 v[228:231], v6, s[12:15], s61 offen offset:16 sc1
    s_mov_b32 s61, 0x10000
    buffer_load_dwordx4 v[232:235], v6, s[12:15], s61 offen offset:256 sc1
    s_mov_b32 s61, 0x10000
    buffer_load_dwordx4 v[236:239], v6, s[12:15], s61 offen offset:272 sc1
    buffer_load_dwordx4 v[64:67], v3, s[8:11], s60 offen offset:0 nt
    buffer_load_dwordx4 v[68:71], v3, s[8:11], s60 offen offset:1024 nt
    buffer_load_dwordx4 v[72:75], v3, s[8:11], s60 offen offset:2048 nt
    buffer_load_dwordx4 v[76:79], v3, s[8:11], s60 offen offset:3072 nt
    s_add_u32 s79, s60, 4096
    s_pack_lh_b32_b16 s60, s79, s60
    buffer_load_dwordx4 v[80:83], v3, s[8:11], s60 offen offset:0 nt
    buffer_load_dwordx4 v[84:87], v3, s[8:11], s60 offen offset:1024 nt
    buffer_load_dwordx4 v[88:91], v3, s[8:11], s60 offen offset:2048 nt
    buffer_load_dwordx4 v[92:95], v3, s[8:11], s60 offen offset:3072 nt
    s_add_u32 s79, s60, 4096
    s_pack_lh_b32_b16 s60, s79, s60
    s_mov_b32 s61, 0x10000
    buffer_load_dwordx4 v[224:227], v6, s[12:15], s61 offen offset:0 sc1
    s_mov_b32 s61, 0x10000
    buffer_load_dwordx4 v[228:231], v6, s[12:15], s61 offen offset:16 sc1
    s_mov_b32 s61, 0x10000
    buffer_load_dwordx4 v[232:235], v6, s[12:15], s61 offen offset:256 sc1
    s_mov_b32 s61, 0x10000
    buffer_load_dwordx4 v[236:239], v6, s[12:15], s61 offen offset:272 sc1
    buffer_load_dwordx4 v[96:99], v3, s[8:11], s60 offen offset:0 nt
    buffer_load_dwordx4 v[100:103], v3, s[8:11], s60 offen offset:1024 nt
    buffer_load_dwordx4 v[104:107], v3, s[8:11], s60 offen offset:2048 nt
    buffer_load_dwordx4 v[108:111], v3, s[8:11], s60 offen offset:3072 nt
    s_add_u32 s79, s60, 4096
    s_pack_lh_b32_b16 s60, s79, s60
    buffer_load_dwordx4 v[112:115], v3, s[8:11], s60 offen offset:0 nt
    buffer_load_dwordx4 v[116:119], v3, s[8:11], s60 offen offset:1024 nt
    buffer_load_dwordx4 v[120:123], v3, s[8:11], s60 offen offset:2048 nt
    buffer_load_dwordx4 v[124:127], v3, s[8:11], s60 offen offset:3072 nt
    s_add_u32 s79, s60, 4096
    s_pack_lh_b32_b16 s60, s79, s60
    s_mov_b32 s61, 0x10000
    buffer_load_dwordx4 v[224:227], v6, s[12:15], s61 offen offset:0 sc1
    s_mov_b32 s61, 0x10000
    buffer_load_dwordx4 v[228:231], v6, s[12:15], s61 offen offset:16 sc1
    s_mov_b32 s61, 0x10000
    buffer_load_dwordx4 v[232:235], v6, s[12:15], s61 offen offset:256 sc1
    s_mov_b32 s61, 0x10000
    buffer_load_dwordx4 v[236:239], v6, s[12:15], s61 offen offset:272 sc1
    buffer_load_dwordx4 v[128:131], v3, s[8:11], s60 offen offset:0 nt
    buffer_load_dwordx4 v[132:135], v3, s[8:11], s60 offen offset:1024 nt
    buffer_load_dwordx4 v[136:139], v3, s[8:11], s60 offen offset:2048 nt
    buffer_load_dwordx4 v[140:143], v3, s[8:11], s60 offen offset:3072 nt
    s_add_u32 s79, s60, 4096
    s_pack_lh_b32_b16 s60, s79, s60
    buffer_load_dwordx4 v[144:147], v3, s[8:11], s60 offen offset:0 nt
    buffer_load_dwordx4 v[148:151], v3, s[8:11], s60 offen offset:1024 nt
    buffer_load_dwordx4 v[152:155], v3, s[8:11], s60 offen offset:2048 nt
    buffer_load_dwordx4 v[156:159], v3, s[8:11], s60 offen offset:3072 nt
    s_add_u32 s79, s60, 4096
    s_pack_lh_b32_b16 s60, s79, s60
    s_waitcnt vmcnt(32)
    v_mov_b32 v48, v224
    v_mov_b32 v49, v225
    v_mov_b32 v50, v226
    v_mov_b32 v51, v227
    v_mov_b32 v52, v228
    v_mov_b32 v53, v229
    v_mov_b32 v54, v230
    v_mov_b32 v55, v231
    v_mov_b32 v56, v232
    v_mov_b32 v57, v233
    v_mov_b32 v58, v234
    v_mov_b32 v59, v235
    v_mov_b32 v60, v236
    v_mov_b32 v61, v237
    v_mov_b32 v62, v238
    v_mov_b32 v63, v239
    v_xor_b32 v10, s58, v48
    v_bitop3_b32 v10, v49, s58, v10 bitop3:0xbe
    v_bitop3_b32 v10, v50, s58, v10 bitop3:0xbe
    v_bitop3_b32 v10, v51, s58, v10 bitop3:0xbe
    v_bitop3_b32 v10, v52, s58, v10 bitop3:0xbe
    v_bitop3_b32 v10, v53, s58, v10 bitop3:0xbe
    v_bitop3_b32 v10, v54, s58, v10 bitop3:0xbe
    v_bitop3_b32 v10, v55, s58, v10 bitop3:0xbe
    v_bitop3_b32 v10, v56, s58, v10 bitop3:0xbe
    v_bitop3_b32 v10, v57, s58, v10 bitop3:0xbe
    v_bitop3_b32 v10, v58, s58, v10 bitop3:0xbe
    v_bitop3_b32 v10, v59, s58, v10 bitop3:0xbe
    v_bitop3_b32 v10, v60, s58, v10 bitop3:0xbe
    v_bitop3_b32 v10, v61, s58, v10 bitop3:0xbe
    v_bitop3_b32 v10, v62, s58, v10 bitop3:0xbe
    v_bitop3_b32 v10, v63, s58, v10 bitop3:0xbe
    v_and_b32 v10, 0xff, v10
    v_cmp_ne_u32 vcc, 0, v10
    s_cbranch_vccz QGO_N
    s_waitcnt vmcnt(20)
    v_mov_b32 v48, v224
    v_mov_b32 v49, v225
    v_mov_b32 v50, v226
    v_mov_b32 v51, v227
    v_mov_b32 v52, v228
    v_mov_b32 v53, v229
    v_mov_b32 v54, v230
    v_mov_b32 v55, v231
    v_mov_b32 v56, v232
    v_mov_b32 v57, v233
    v_mov_b32 v58, v234
    v_mov_b32 v59, v235
    v_mov_b32 v60, v236
    v_mov_b32 v61, v237
    v_mov_b32 v62, v238
    v_mov_b32 v63, v239
    v_xor_b32 v10, s58, v48
    v_bitop3_b32 v10, v49, s58, v10 bitop3:0xbe
    v_bitop3_b32 v10, v50, s58, v10 bitop3:0xbe
    v_bitop3_b32 v10, v51, s58, v10 bitop3:0xbe
    v_bitop3_b32 v10, v52, s58, v10 bitop3:0xbe
    v_bitop3_b32 v10, v53, s58, v10 bitop3:0xbe
    v_bitop3_b32 v10, v54, s58, v10 bitop3:0xbe
    v_bitop3_b32 v10, v55, s58, v10 bitop3:0xbe
    v_bitop3_b32 v10, v56, s58, v10 bitop3:0xbe
    v_bitop3_b32 v10, v57, s58, v10 bitop3:0xbe
    v_bitop3_b32 v10, v58, s58, v10 bitop3:0xbe
    v_bitop3_b32 v10, v59, s58, v10 bitop3:0xbe
    v_bitop3_b32 v10, v60, s58, v10 bitop3:0xbe
    v_bitop3_b32 v10, v61, s58, v10 bitop3:0xbe
    v_bitop3_b32 v10, v62, s58, v10 bitop3:0xbe
    v_bitop3_b32 v10, v63, s58, v10 bitop3:0xbe
    v_and_b32 v10, 0xff, v10
    v_cmp_ne_u32 vcc, 0, v10
    s_cbranch_vccz QGO_N
    s_waitcnt vmcnt(8)
    v_mov_b32 v48, v224
    v_mov_b32 v49, v225
    v_mov_b32 v50, v226
    v_mov_b32 v51, v227
    v_mov_b32 v52, v228
    v_mov_b32 v53, v229
    v_mov_b32 v54, v230
    v_mov_b32 v55, v231
    v_mov_b32 v56, v232
    v_mov_b32 v57, v233
    v_mov_b32 v58, v234
    v_mov_b32 v59, v235
    v_mov_b32 v60, v236
    v_mov_b32 v61, v237
    v_mov_b32 v62, v238
    v_mov_b32 v63, v239
    v_xor_b32 v10, s58, v48
    v_bitop3_b32 v10, v49, s58, v10 bitop3:0xbe
    v_bitop3_b32 v10, v50, s58, v10 bitop3:0xbe
    v_bitop3_b32 v10, v51, s58, v10 bitop3:0xbe
    v_bitop3_b32 v10, v52, s58, v10 bitop3:0xbe
    v_bitop3_b32 v10, v53, s58, v10 bitop3:0xbe
    v_bitop3_b32 v10, v54, s58, v10 bitop3:0xbe
    v_bitop3_b32 v10, v55, s58, v10 bitop3:0xbe
    v_bitop3_b32 v10, v56, s58, v10 bitop3:0xbe
    v_bitop3_b32 v10, v57, s58, v10 bitop3:0xbe
    v_bitop3_b32 v10, v58, s58, v10 bitop3:0xbe
    v_bitop3_b32 v10, v59, s58, v10 bitop3:0xbe
    v_bitop3_b32 v10, v60, s58, v10 bitop3:0xbe
    v_bitop3_b32 v10, v61, s58, v10 bitop3:0xbe
    v_bitop3_b32 v10, v62, s58, v10 bitop3:0xbe
    v_bitop3_b32 v10, v63, s58, v10 bitop3:0xbe
    v_and_b32 v10, 0xff, v10
    v_cmp_ne_u32 vcc, 0, v10
    s_cbranch_vccz QGO_N
    s_mov_b32 s62, 0x40000
QRX_N:
    s_mov_b32 s61, 0x10000
    buffer_load_dwordx4 v[224:227], v6, s[12:15], s61 offen offset:0 sc1
    s_mov_b32 s61, 0x10000
    buffer_load_dwordx4 v[228:231], v6, s[12:15], s61 offen offset:16 sc1
    s_mov_b32 s61, 0x10000
    buffer_load_dwordx4 v[232:235], v6, s[12:15], s61 offen offset:256 sc1
    s_mov_b32 s61, 0x10000
    buffer_load_dwordx4 v[236:239], v6, s[12:15], s61 offen offset:272 sc1
    s_waitcnt vmcnt(0)
    v_mov_b32 v48, v224
    v_mov_b32 v49, v225
    v_mov_b32 v50, v226
    v_mov_b32 v51, v227
    v_mov_b32 v52, v228
    v_mov_b32 v53, v229
    v_mov_b32 v54, v230
    v_mov_b32 v55, v231
    v_mov_b32 v56, v232
    v_mov_b32 v57, v233
    v_mov_b32 v58, v234
    v_mov_b32 v59, v235
    v_mov_b32 v60, v236
    v_mov_b32 v61, v237
    v_mov_b32 v62, v238
    v_mov_b32 v63, v239
    v_xor_b32 v10, s58, v48
    v_bitop3_b32 v10, v49, s58, v10 bitop3:0xbe
    v_bitop3_b32 v10, v50, s58, v10 bitop3:0xbe
    v_bitop3_b32 v10, v51, s58, v10 bitop3:0xbe
    v_bitop3_b32 v10, v52, s58, v10 bitop3:0xbe
    v_bitop3_b32 v10, v53, s58, v10 bitop3:0xbe
    v_bitop3_b32 v10, v54, s58, v10 bitop3:0xbe
    v_bitop3_b32 v10, v55, s58, v10 bitop3:0xbe
    v_bitop3_b32 v10, v56, s58, v10 bitop3:0xbe
    v_bitop3_b32 v10, v57, s58, v10 bitop3:0xbe
    v_bitop3_b32 v10, v58, s58, v10 bitop3:0xbe
    v_bitop3_b32 v10, v59, s58, v10 bitop3:0xbe
    v_bitop3_b32 v10, v60, s58, v10 bitop3:0xbe
    v_bitop3_b32 v10, v61, s58, v10 bitop3:0xbe
    v_bitop3_b32 v10, v62, s58, v10 bitop3:0xbe
    v_bitop3_b32 v10, v63, s58, v10 bitop3:0xbe
    v_and_b32 v10, 0xff, v10
    v_cmp_ne_u32 vcc, 0, v10
    s_cbranch_vccz QGO_N
    s_sub_u32 s62, s62, 1
    s_cbranch_scc0 QRX_N
QGO_N:
    buffer_load_dwordx4 v[224:227], v3, s[8:11], s60 offen offset:0 nt
    v_perm_b32 v16, v49, v48, s68
    v_perm_b32 v17, v51, v50, s68
    v_perm_b32 v18, v53, v52, s68
    v_perm_b32 v19, v55, v54, s68
    v_perm_b32 v20, v57, v56, s68
    v_perm_b32 v21, v59, v58, s68
    v_perm_b32 v22, v61, v60, s68
    buffer_load_dwordx4 v[228:231], v3, s[8:11], s60 offen offset:1024 nt
    v_perm_b32 v23, v63, v62, s68
    v_cndmask_b32 v32, 0, v16, s[72:73]
    v_cndmask_b32 v33, 0, v17, s[72:73]
    v_cndmask_b32 v34, 0, v18, s[72:73]
    v_cndmask_b32 v35, 0, v19, s[72:73]
    v_cndmask_b32 v36, 0, v20, s[72:73]
    v_cndmask_b32 v37, 0, v21, s[72:73]
    v_cndmask_b32 v38, 0, v22, s[72:73]
    buffer_load_dwordx4 v[232:235], v3, s[8:11], s60 offen offset:2048 nt
    v_cndmask_b32 v39, 0, v23, s[72:73]
    v_cndmask_b32 v40, 0, v16, s[74:75]
    v_cndmask_b32 v41, 0, v17, s[74:75]
    v_cndmask_b32 v42, 0, v18, s[74:75]
    v_cndmask_b32 v43, 0, v19, s[74:75]
    v_cndmask_b32 v44, 0, v20, s[74:75]
    v_cndmask_b32 v45, 0, v21, s[74:75]
    buffer_load_dwordx4 v[236:239], v3, s[8:11], s60 offen offset:3072 nt
    v_cndmask_b32 v46, 0, v22, s[74:75]
    v_cndmask_b32 v47, 0, v23, s[74:75]
    v_mfma_f32_16x16x32_bf16 v[160:163], a[0:3], v[32:35], 0
    v_mfma_f32_16x16x32_bf16 v[164:167], a[8:11], v[32:35], 0
    v_mfma_f32_16x16x32_bf16 v[168:171], a[16:19], v[32:35], 0
    v_mfma_f32_16x16x32_bf16 v[172:175], a[24:27], v[32:35], 0
    v_mfma_f32_16x16x32_bf16 v[176:179], a[32:35], v[32:35], 0
    v_mfma_f32_16x16x32_bf16 v[180:183], a[40:43], v[32:35], 0
    s_add_u32 s79, s60, 4096
    s_pack_lh_b32_b16 s60, s79, s60
    buffer_load_dwordx4 v[240:243], v3, s[8:11], s60 offen offset:0 nt
    v_mfma_f32_16x16x32_bf16 v[184:187], a[48:51], v[32:35], 0
    v_mfma_f32_16x16x32_bf16 v[188:191], a[56:59], v[32:35], 0
    v_mfma_f32_16x16x32_bf16 v[160:163], a[4:7], v[36:39], v[160:163]
    v_mfma_f32_16x16x32_bf16 v[164:167], a[12:15], v[36:39], v[164:167]
    v_mfma_f32_16x16x32_bf16 v[168:171], a[20:23], v[36:39], v[168:171]
    v_mfma_f32_16x16x32_bf16 v[172:175], a[28:31], v[36:39], v[172:175]
    v_mfma_f32_16x16x32_bf16 v[176:179], a[36:39], v[36:39], v[176:179]
    buffer_load_dwordx4 v[244:247], v3, s[8:11], s60 offen offset:1024 nt
    v_mfma_f32_16x16x32_bf16 v[180:183], a[44:47], v[36:39], v[180:183]
    v_mfma_f32_16x16x32_bf16 v[184:187], a[52:55], v[36:39], v[184:187]
    v_mfma_f32_16x16x32_bf16 v[188:191], a[60:63], v[36:39], v[188:191]
    v_mfma_f32_16x16x32_bf16 v[160:163], a[64:67], v[40:43], v[160:163]
    v_mfma_f32_16x16x32_bf16 v[164:167], a[72:75], v[40:43], v[164:167]
    v_mfma_f32_16x16x32_bf16 v[168:171], a[80:83], v[40:43], v[168:171]
    v_mfma_f32_16x16x32_bf16 v[172:175], a[88:91], v[40:43], v[172:175]
    v_mfma_f32_16x16x32_bf16 v[176:179], a[96:99], v[40:43], v[176:179]
    buffer_load_dwordx4 v[248:251], v3, s[8:11], s60 offen offset:2048 nt
    v_mfma_f32_16x16x32_bf16 v[180:183], a[104:107], v[40:43], v[180:183]
    v_mfma_f32_16x16x32_bf16 v[184:187], a[112:115], v[40:43], v[184:187]
    v_mfma_f32_16x16x32_bf16 v[188:191], a[120:123], v[40:43], v[188:191]
    v_mfma_f32_16x16x32_bf16 v[160:163], a[68:71], v[44:47], v[160:163]
    v_mfma_f32_16x16x32_bf16 v[164:167], a[76:79], v[44:47], v[164:167]
    v_mfma_f32_16x16x32_bf16 v[168:171], a[84:87], v[44:47], v[168:171]
    v_mfma_f32_16x16x32_bf16 v[172:175], a[92:95], v[44:47], v[172:175]
    buffer_load_dwordx4 v[252:255], v3, s[8:11], s60 offen offset:3072 nt
    s_add_u32 s79, s60, 4096
    s_pack_lh_b32_b16 s60, s79, s60
    v_mfma_f32_16x16x32_bf16 v[176:179], a[100:103], v[44:47], v[176:179]
    v_mfma_f32_16x16x32_bf16 v[180:183], a[108:111], v[44:47], v[180:183]
    v_mfma_f32_16x16x32_bf16 v[184:187], a[116:119], v[44:47], v[184:187]
    v_mfma_f32_16x16x32_bf16 v[188:191], a[124:127], v[44:47], v[188:191]
    v_mfma_f32_16x16x32_bf16 v[192:195], a[128:131], v[32:35], 0
    v_mfma_f32_16x16x32_bf16 v[196:199], a[136:139], v[32:35], 0
    v_mfma_f32_16x16x32_bf16 v[200:203], a[144:147], v[32:35], 0
    v_mfma_f32_16x16x32_bf16 v[204:207], a[152:155], v[32:35], 0
    v_mfma_f32_16x16x32_bf16 v[208:211], a[160:163], v[32:35], 0
    v_mfma_f32_16x16x32_bf16 v[212:215], a[168:171], v[32:35], 0
    v_mfma_f32_16x16x32_bf16 v[216:219], a[176:179], v[32:35], 0
    v_mfma_f32_16x16x32_bf16 v[220:223], a[184:187], v[32:35], 0
    v_mfma_f32_16x16x32_bf16 v[192:195], a[132:135], v[36:39], v[192:195]
    v_mfma_f32_16x16x32_bf16 v[196:199], a[140:143], v[36:39], v[196:199]
    v_mfma_f32_16x16x32_bf16 v[200:203], a[148:151], v[36:39], v[200:203]
    v_mfma_f32_16x16x32_bf16 v[204:207], a[156:159], v[36:39], v[204:207]
    v_mfma_f32_16x16x32_bf16 v[208:211], a[164:167], v[36:39], v[208:211]
    v_mfma_f32_16x16x32_bf16 v[212:215], a[172:175], v[36:39], v[212:215]
    v_mfma_f32_16x16x32_bf16 v[216:219], a[180:183], v[36:39], v[216:219]
    v_mfma_f32_16x16x32_bf16 v[220:223], a[188:191], v[36:39], v[220:223]
    v_mfma_f32_16x16x32_bf16 v[192:195], a[192:195], v[40:43], v[192:195]
    v_mfma_f32_16x16x32_bf16 v[196:199], a[200:203], v[40:43], v[196:199]
    v_mfma_f32_16x16x32_bf16 v[200:203], a[208:211], v[40:43], v[200:203]
    v_mfma_f32_16x16x32_bf16 v[204:207], a[216:219], v[40:43], v[204:207]
    v_mfma_f32_16x16x32_bf16 v[208:211], a[224:227], v[40:43], v[208:211]
    v_mfma_f32_16x16x32_bf16 v[212:215], a[232:235], v[40:43], v[212:215]
    v_mfma_f32_16x16x32_bf16 v[216:219], a[240:243], v[40:43], v[216:219]
    v_mfma_f32_16x16x32_bf16 v[220:223], a[248:251], v[40:43], v[220:223]
    v_mfma_f32_16x16x32_bf16 v[192:195], a[196:199], v[44:47], v[192:195]
    v_mfma_f32_16x16x32_bf16 v[196:199], a[204:207], v[44:47], v[196:199]
    v_mfma_f32_16x16x32_bf16 v[200:203], a[212:215], v[44:47], v[200:203]
    v_mfma_f32_16x16x32_bf16 v[204:207], a[220:223], v[44:47], v[204:207]
    v_mfma_f32_16x16x32_bf16 v[208:211], a[228:231], v[44:47], v[208:211]
    v_mfma_f32_16x16x32_bf16 v[212:215], a[236:239], v[44:47], v[212:215]
    v_mfma_f32_16x16x32_bf16 v[216:219], a[244:247], v[44:47], v[216:219]
    v_mfma_f32_16x16x32_bf16 v[220:223], a[252:255], v[44:47], v[220:223]
    v_add_f32_dpp v48, v161, v160 row_shl:4 row_mask:0xf bank_mask:0x5
    v_add_f32_dpp v49, v165, v164 row_shl:4 row_mask:0xf bank_mask:0x5
    v_add_f32_dpp v50, v169, v168 row_shl:4 row_mask:0xf bank_mask:0x5
    v_add_f32_dpp v51, v173, v172 row_shl:4 row_mask:0xf bank_mask:0x5
    v_add_f32_dpp v52, v177, v176 row_shl:4 row_mask:0xf bank_mask:0x5
    v_add_f32_dpp v53, v181, v180 row_shl:4 row_mask:0xf bank_mask:0x5
    v_add_f32_dpp v54, v185, v184 row_shl:4 row_mask:0xf bank_mask:0x5
    v_add_f32_dpp v55, v189, v188 row_shl:4 row_mask:0xf bank_mask:0x5
    v_add_f32_dpp v56, v193, v192 row_shl:4 row_mask:0xf bank_mask:0x5
    v_add_f32_dpp v57, v197, v196 row_shl:4 row_mask:0xf bank_mask:0x5
    v_add_f32_dpp v58, v201, v200 row_shl:4 row_mask:0xf bank_mask:0x5
    v_add_f32_dpp v59, v205, v204 row_shl:4 row_mask:0xf bank_mask:0x5
    v_add_f32_dpp v60, v209, v208 row_shl:4 row_mask:0xf bank_mask:0x5
    v_add_f32_dpp v61, v213, v212 row_shl:4 row_mask:0xf bank_mask:0x5
    v_add_f32_dpp v62, v217, v216 row_shl:4 row_mask:0xf bank_mask:0x5
    v_add_f32_dpp v63, v221, v220 row_shl:4 row_mask:0xf bank_mask:0x5
    v_add_f32_dpp v48, v162, v163 row_shr:4 row_mask:0xf bank_mask:0xa
    v_add_f32_dpp v49, v166, v167 row_shr:4 row_mask:0xf bank_mask:0xa
    v_add_f32_dpp v50, v170, v171 row_shr:4 row_mask:0xf bank_mask:0xa
    v_add_f32_dpp v51, v174, v175 row_shr:4 row_mask:0xf bank_mask:0xa
    v_add_f32_dpp v52, v178, v179 row_shr:4 row_mask:0xf bank_mask:0xa
    v_add_f32_dpp v53, v182, v183 row_shr:4 row_mask:0xf bank_mask:0xa
    v_add_f32_dpp v54, v186, v187 row_shr:4 row_mask:0xf bank_mask:0xa
    v_add_f32_dpp v55, v190, v191 row_shr:4 row_mask:0xf bank_mask:0xa
    v_add_f32_dpp v56, v194, v195 row_shr:4 row_mask:0xf bank_mask:0xa
    v_add_f32_dpp v57, v198, v199 row_shr:4 row_mask:0xf bank_mask:0xa
    v_add_f32_dpp v58, v202, v203 row_shr:4 row_mask:0xf bank_mask:0xa
    v_add_f32_dpp v59, v206, v207 row_shr:4 row_mask:0xf bank_mask:0xa
    v_add_f32_dpp v60, v210, v211 row_shr:4 row_mask:0xf bank_mask:0xa
    v_add_f32_dpp v61, v214, v215 row_shr:4 row_mask:0xf bank_mask:0xa
    v_add_f32_dpp v62, v218, v219 row_shr:4 row_mask:0xf bank_mask:0xa
    v_add_f32_dpp v63, v222, v223 row_shr:4 row_mask:0xf bank_mask:0xa
    buffer_load_dwordx4 v[160:163], v3, s[8:11], s60 offen offset:0 nt
    v_cvt_pk_bf16_f32 v32, v48, v49
    v_cvt_pk_bf16_f32 v33, v50, v51
    v_cvt_pk_bf16_f32 v34, v52, v53
    v_cvt_pk_bf16_f32 v35, v54, v55
    v_cvt_pk_bf16_f32 v36, v56, v57
    v_cvt_pk_bf16_f32 v37, v58, v59
    v_cvt_pk_bf16_f32 v38, v60, v61
    v_cvt_pk_bf16_f32 v39, v62, v63
    v_lshlrev_b32 v48, 16, v32
    buffer_load_dwordx4 v[164:167], v3, s[8:11], s60 offen offset:1024 nt
    v_and_b32 v49, s66, v32
    v_lshlrev_b32 v50, 16, v33
    v_and_b32 v51, s66, v33
    v_lshlrev_b32 v52, 16, v34
    v_and_b32 v53, s66, v34
    v_lshlrev_b32 v54, 16, v35
    v_and_b32 v55, s66, v35
    v_lshlrev_b32 v56, 16, v36
    v_and_b32 v57, s66, v36
    v_lshlrev_b32 v58, 16, v37
    buffer_load_dwordx4 v[168:171], v3, s[8:11], s60 offen offset:2048 nt
    v_and_b32 v59, s66, v37
    v_lshlrev_b32 v60, 16, v38
    v_and_b32 v61, s66, v38
    v_lshlrev_b32 v62, 16, v39
    v_and_b32 v63, s66, v39
    v_mul_f32 v48, s70, v48
    v_mul_f32 v49, s70, v49
    v_mul_f32 v50, s70, v50
    v_mul_f32 v51, s70, v51
    buffer_load_dwordx4 v[172:175], v3, s[8:11], s60 offen offset:3072 nt
    v_mul_f32 v52, s70, v52
    v_mul_f32 v53, s70, v53
    v_mul_f32 v54, s70, v54
    v_mul_f32 v55, s70, v55
    v_mul_f32 v56, s70, v56
    v_mul_f32 v57, s70, v57
    v_mul_f32 v58, s70, v58
    v_mul_f32 v59, s70, v59
    v_mul_f32 v60, s70, v60
    v_mul_f32 v61, s70, v61
    s_add_u32 s79, s60, 4096
    s_pack_lh_b32_b16 s60, s79, s60
    buffer_load_dwordx4 v[176:179], v3, s[8:11], s60 offen offset:0 nt
    v_mul_f32 v62, s70, v62
    v_mul_f32 v63, s70, v63
    v_cvt_pk_bf16_f32 v32, v48, v49
    v_cvt_pk_bf16_f32 v33, v50, v51
    v_cvt_pk_bf16_f32 v34, v52, v53
    v_cvt_pk_bf16_f32 v35, v54, v55
    v_cvt_pk_bf16_f32 v36, v56, v57
    v_cvt_pk_bf16_f32 v37, v58, v59
    v_cvt_pk_bf16_f32 v38, v60, v61
    buffer_load_dwordx4 v[180:183], v3, s[8:11], s60 offen offset:1024 nt
    v_cvt_pk_bf16_f32 v39, v62, v63
    v_lshlrev_b32 v48, 16, v32
    v_and_b32 v49, s66, v32
    v_lshlrev_b32 v50, 16, v33
    v_and_b32 v51, s66, v33
    v_lshlrev_b32 v52, 16, v34
    v_and_b32 v53, s66, v34
    v_lshlrev_b32 v54, 16, v35
    v_and_b32 v55, s66, v35
    v_lshlrev_b32 v56, 16, v36
    buffer_load_dwordx4 v[184:187], v3, s[8:11], s60 offen offset:2048 nt
    v_and_b32 v57, s66, v36
    v_lshlrev_b32 v58, 16, v37
    v_and_b32 v59, s66, v37
    v_lshlrev_b32 v60, 16, v38
    v_and_b32 v61, s66, v38
    v_lshlrev_b32 v62, 16, v39
    v_and_b32 v63, s66, v39
    v_max3_f32 v9, v48, v49, v50
    v_max3_f32 v9, v9, v51, v52
    buffer_load_dwordx4 v[188:191], v3, s[8:11], s60 offen offset:3072 nt
    v_max3_f32 v9, v9, v53, v54
    v_max3_f32 v9, v9, v55, v56
    v_max3_f32 v9, v9, v57, v58
    v_max3_f32 v9, v9, v59, v60
    v_max3_f32 v9, v9, v61, v62
    v_max_f32 v9, v9, v63
    s_nop 1
    v_max_f32_dpp v9, v9, v9 row_ror:4 row_mask:0xf bank_mask:0xf
    s_nop 1
    v_max_f32_dpp v9, v9, v9 row_ror:8 row_mask:0xf bank_mask:0xf
    v_mov_b32 v10, v9
    s_nop 1
    v_permlane16_swap_b32 v9, v10
    s_add_u32 s79, s60, 4096
    s_pack_lh_b32_b16 s60, s79, s60
    buffer_load_dwordx4 v[192:195], v3, s[8:11], s60 offen offset:0 nt
    v_max_f32 v9, v9, v10
    v_mov_b32 v10, v9
    s_nop 1
    v_permlane32_swap_b32 v9, v10
    v_max_f32 v9, v9, v10
    v_mul_f32 v11, s69, v9
    v_fma_f32 v48, v48, s69, -v11
    v_fma_f32 v49, v49, s69, -v11
    v_fma_f32 v50, v50, s69, -v11
    v_fma_f32 v51, v51, s69, -v11
    buffer_load_dwordx4 v[196:199], v3, s[8:11], s60 offen offset:1024 nt
    v_fma_f32 v52, v52, s69, -v11
    v_fma_f32 v53, v53, s69, -v11
    v_fma_f32 v54, v54, s69, -v11
    v_fma_f32 v55, v55, s69, -v11
    v_fma_f32 v56, v56, s69, -v11
    v_fma_f32 v57, v57, s69, -v11
    v_fma_f32 v58, v58, s69, -v11
    v_fma_f32 v59, v59, s69, -v11
    v_fma_f32 v60, v60, s69, -v11
    v_fma_f32 v61, v61, s69, -v11
    buffer_load_dwordx4 v[200:203], v3, s[8:11], s60 offen offset:2048 nt
    v_fma_f32 v62, v62, s69, -v11
    v_fma_f32 v63, v63, s69, -v11
    v_exp_f32 v48, v48
    v_exp_f32 v49, v49
    v_exp_f32 v50, v50
    v_exp_f32 v51, v51
    v_exp_f32 v52, v52
    v_exp_f32 v53, v53
    v_exp_f32 v54, v54
    buffer_load_dwordx4 v[204:207], v3, s[8:11], s60 offen offset:3072 nt
    v_exp_f32 v55, v55
    v_exp_f32 v56, v56
    v_exp_f32 v57, v57
    v_exp_f32 v58, v58
    v_exp_f32 v59, v59
    v_exp_f32 v60, v60
    v_exp_f32 v61, v61
    v_exp_f32 v62, v62
    v_exp_f32 v63, v63
    v_add_f32 v13, v48, v49
    s_add_u32 s79, s60, 4096
    s_pack_lh_b32_b16 s60, s79, s60
    buffer_load_dwordx4 v[208:211], v3, s[8:11], s60 offen offset:0 nt
    v_add_f32 v13, v13, v50
    v_add_f32 v13, v13, v51
    v_add_f32 v13, v13, v52
    v_add_f32 v13, v13, v53
    v_add_f32 v13, v13, v54
    v_add_f32 v13, v13, v55
    v_add_f32 v13, v13, v56
    v_add_f32 v13, v13, v57
    v_add_f32 v13, v13, v58
    buffer_load_dwordx4 v[212:215], v3, s[8:11], s60 offen offset:1024 nt
    v_add_f32 v13, v13, v59
    v_add_f32 v13, v13, v60
    v_add_f32 v13, v13, v61
    v_add_f32 v13, v13, v62
    v_add_f32 v13, v13, v63
    v_cvt_pk_bf16_f32 v16, v48, v49
    v_cvt_pk_bf16_f32 v17, v50, v51
    v_cvt_pk_bf16_f32 v18, v52, v53
    v_cvt_pk_bf16_f32 v19, v54, v55
    v_cvt_pk_bf16_f32 v20, v56, v57
    buffer_load_dwordx4 v[216:219], v3, s[8:11], s60 offen offset:2048 nt
    v_cvt_pk_bf16_f32 v21, v58, v59
    v_cvt_pk_bf16_f32 v22, v60, v61
    v_cvt_pk_bf16_f32 v23, v62, v63
    v_add_f32_dpp v13, v13, v13 row_ror:4 row_mask:0xf bank_mask:0xf
    s_nop 1
    v_add_f32_dpp v13, v13, v13 row_ror:8 row_mask:0xf bank_mask:0xf
    v_mov_b32 v10, v13
    s_nop 1
    v_permlane16_swap_b32 v13, v10
    v_add_f32 v13, v13, v10
    v_mov_b32 v10, v13
    buffer_load_dwordx4 v[220:223], v3, s[8:11], s60 offen offset:3072 nt
    s_add_u32 s79, s60, 4096
    s_pack_lh_b32_b16 s60, s79, s60
    v_permlane32_swap_b32 v13, v10
    v_add_f32 v13, v13, v10
    v_mov_b32 v12, v9
    v_mov_b32 v14, s58
    v_mov_b32 v15, s58
    s_lshl_b32 s64, s2, 8
    s_lshl_b32 s61, s3, 6
    s_add_u32 s64, s64, s61
    v_lshlrev_b32 v10, 4, v1
    v_add_u32 v6, s64, v10
    s_mov_b64 exec, 0xf
    s_mov_b32 s61, 0x20000
    buffer_store_dwordx4 v[12:15], v6, s[12:15], s61 offen offset:0 sc1
    s_mov_b64 exec, -1
    v_mov_b32 v24, 0
    v_mov_b32 v25, 0
    v_mov_b32 v26, 0
    v_mov_b32 v27, 0
    v_mov_b32 v28, 0
    v_mov_b32 v29, 0
    v_mov_b32 v30, 0
    v_mov_b32 v31, 0
    v_mov_b32 v40, 0
    v_mov_b32 v41, 0
    v_mov_b32 v42, 0
    v_mov_b32 v43, 0
    v_mov_b32 v44, 0
    v_mov_b32 v45, 0
    v_mov_b32 v46, 0
    v_mov_b32 v47, 0
    s_lshr_b32 s61, s2, 3
    s_lshl_b32 s61, s61, 11
    v_lshlrev_b32 v10, 4, v1
    v_add_u32 v6, s61, v10
    v_lshrrev_b32 v10, 4, v1
    v_add_u32 v10, v10, v1
    v_and_b32 v10, 3, v10
    v_and_b32 v11, 60, v1
    v_or_b32 v10, v10, v11
    v_lshlrev_b32 v10, 4, v10
    s_lshl_b32 s61, s3, 11
    v_add_u32 v8, s61, v10
    v_bfe_u32 v11, v0, 5, 2
    v_lshlrev_b32 v15, 4, v11
    v_bfe_u32 v10, v0, 3, 2
    v_add_u32 v11, v11, v10
    v_and_b32 v11, 3, v11
    v_lshlrev_b32 v11, 4, v11
    v_lshl_add_u32 v11, v10, 8, v11
    v_and_b32 v10, 3, v0
    v_lshl_add_u32 v11, v10, 6, v11
    v_bfe_u32 v10, v0, 2, 1
    v_lshl_add_u32 v2, v10, 10, v11
    v_and_b32 v10, 0x60, v0
    v_bfe_u32 v11, v0, 1, 4
    v_or_b32 v10, v10, v11
    v_and_b32 v11, 1, v0
    v_lshl_or_b32 v10, v11, 4, v10
    v_lshlrev_b32 v10, 4, v10
    s_lshl_b32 s64, s2, 11
    v_add_u32 v14, s64, v10
    v_mov_b32_dpp v24, v16 quad_perm:[0,1,2,3] row_mask:0xf bank_mask:0x1
    v_mov_b32_dpp v25, v17 quad_perm:[0,1,2,3] row_mask:0xf bank_mask:0x1
    v_mov_b32_dpp v26, v18 quad_perm:[0,1,2,3] row_mask:0xf bank_mask:0x1
    v_mov_b32_dpp v27, v19 quad_perm:[0,1,2,3] row_mask:0xf bank_mask:0x1
    v_mov_b32_dpp v28, v16 row_ror:4 row_mask:0xf bank_mask:0x2
    v_mov_b32_dpp v29, v17 row_ror:4 row_mask:0xf bank_mask:0x2
    v_mov_b32_dpp v30, v18 row_ror:4 row_mask:0xf bank_mask:0x2
    v_mov_b32_dpp v31, v19 row_ror:4 row_mask:0xf bank_mask:0x2
    v_mov_b32_dpp v40, v16 row_ror:8 row_mask:0xf bank_mask:0x4
    v_mov_b32_dpp v41, v17 row_ror:8 row_mask:0xf bank_mask:0x4
    v_mov_b32_dpp v42, v18 row_ror:8 row_mask:0xf bank_mask:0x4
    v_mov_b32_dpp v43, v19 row_ror:8 row_mask:0xf bank_mask:0x4
    v_mov_b32_dpp v44, v16 row_ror:12 row_mask:0xf bank_mask:0x8
    v_mov_b32_dpp v45, v17 row_ror:12 row_mask:0xf bank_mask:0x8
    v_mov_b32_dpp v46, v18 row_ror:12 row_mask:0xf bank_mask:0x8
    v_mov_b32_dpp v47, v19 row_ror:12 row_mask:0xf bank_mask:0x8
    s_waitcnt vmcnt(49)
    v_perm_b32 v32, v68, v64, s67
    v_perm_b32 v33, v76, v72, s67
    v_perm_b32 v34, v84, v80, s67
    v_perm_b32 v35, v92, v88, s67
    v_perm_b32 v36, v70, v66, s67
    v_perm_b32 v37, v78, v74, s67
    v_perm_b32 v38, v86, v82, s67
    v_perm_b32 v39, v94, v90, s67
    v_mfma_f32_16x16x32_bf16 a[0:3], v[32:35], v[24:27], 0
    v_perm_b32 v32, v68, v64, s68
    v_perm_b32 v33, v76, v72, s68
    v_perm_b32 v34, v84, v80, s68
    v_perm_b32 v35, v92, v88, s68
    v_mfma_f32_16x16x32_bf16 a[4:7], v[36:39], v[24:27], 0
    v_perm_b32 v36, v70, v66, s68
    v_perm_b32 v37, v78, v74, s68
    v_perm_b32 v38, v86, v82, s68
    v_perm_b32 v39, v94, v90, s68
    v_mfma_f32_16x16x32_bf16 a[0:3], v[32:35], v[28:31], a[0:3]
    v_perm_b32 v32, v69, v65, s67
    v_perm_b32 v33, v77, v73, s67
    v_perm_b32 v34, v85, v81, s67
    v_perm_b32 v35, v93, v89, s67
    v_mfma_f32_16x16x32_bf16 a[4:7], v[36:39], v[28:31], a[4:7]
    v_perm_b32 v36, v71, v67, s67
    v_perm_b32 v37, v79, v75, s67
    v_perm_b32 v38, v87, v83, s67
    v_perm_b32 v39, v95, v91, s67
    v_mfma_f32_16x16x32_bf16 a[0:3], v[32:35], v[40:43], a[0:3]
    v_perm_b32 v32, v69, v65, s68
    v_perm_b32 v33, v77, v73, s68
    v_perm_b32 v34, v85, v81, s68
    v_perm_b32 v35, v93, v89, s68
    v_mfma_f32_16x16x32_bf16 a[4:7], v[36:39], v[40:43], a[4:7]
    v_perm_b32 v36, v71, v67, s68
    v_perm_b32 v37, v79, v75, s68
    v_perm_b32 v38, v87, v83, s68
    v_perm_b32 v39, v95, v91, s68
    v_mfma_f32_16x16x32_bf16 a[0:3], v[32:35], v[44:47], a[0:3]
    s_nop 0
    v_mfma_f32_16x16x32_bf16 a[4:7], v[36:39], v[44:47], a[4:7]
    v_mov_b32_dpp v24, v16 row_ror:12 row_mask:0xf bank_mask:0x1
    v_mov_b32_dpp v25, v17 row_ror:12 row_mask:0xf bank_mask:0x1
    v_mov_b32_dpp v26, v18 row_ror:12 row_mask:0xf bank_mask:0x1
    v_mov_b32_dpp v27, v19 row_ror:12 row_mask:0xf bank_mask:0x1
    v_mov_b32_dpp v28, v16 quad_perm:[0,1,2,3] row_mask:0xf bank_mask:0x2
    v_mov_b32_dpp v29, v17 quad_perm:[0,1,2,3] row_mask:0xf bank_mask:0x2
    v_mov_b32_dpp v30, v18 quad_perm:[0,1,2,3] row_mask:0xf bank_mask:0x2
    v_mov_b32_dpp v31, v19 quad_perm:[0,1,2,3] row_mask:0xf bank_mask:0x2
    v_mov_b32_dpp v40, v16 row_ror:4 row_mask:0xf bank_mask:0x4
    v_mov_b32_dpp v41, v17 row_ror:4 row_mask:0xf bank_mask:0x4
    v_mov_b32_dpp v42, v18 row_ror:4 row_mask:0xf bank_mask:0x4
    v_mov_b32_dpp v43, v19 row_ror:4 row_mask:0xf bank_mask:0x4
    v_mov_b32_dpp v44, v16 row_ror:8 row_mask:0xf bank_mask:0x8
    v_mov_b32_dpp v45, v17 row_ror:8 row_mask:0xf bank_mask:0x8
    v_mov_b32_dpp v46, v18 row_ror:8 row_mask:0xf bank_mask:0x8
    v_mov_b32_dpp v47, v19 row_ror:8 row_mask:0xf bank_mask:0x8
    s_waitcnt vmcnt(37)
    buffer_load_dwordx4 v[64:67], v3, s[8:11], s60 offen offset:0 nt
    v_perm_b32 v32, v100, v96, s67
    v_perm_b32 v33, v108, v104, s67
    v_perm_b32 v34, v116, v112, s67
    v_perm_b32 v35, v124, v120, s67
    v_perm_b32 v36, v102, v98, s67
    buffer_load_dwordx4 v[68:71], v3, s[8:11], s60 offen offset:1024 nt
    v_perm_b32 v37, v110, v106, s67
    v_perm_b32 v38, v118, v114, s67
    v_perm_b32 v39, v126, v122, s67
    v_mfma_f32_16x16x32_bf16 a[0:3], v[32:35], v[24:27], a[0:3]
    v_perm_b32 v32, v100, v96, s68
    buffer_load_dwordx4 v[72:75], v3, s[8:11], s60 offen offset:2048 nt
    v_perm_b32 v33, v108, v104, s68
    v_perm_b32 v34, v116, v112, s68
    v_perm_b32 v35, v124, v120, s68
    v_mfma_f32_16x16x32_bf16 a[4:7], v[36:39], v[24:27], a[4:7]
    v_perm_b32 v36, v102, v98, s68
    buffer_load_dwordx4 v[76:79], v3, s[8:11], s60 offen offset:3072 nt
    v_perm_b32 v37, v110, v106, s68
    v_perm_b32 v38, v118, v114, s68
    v_perm_b32 v39, v126, v122, s68
    v_mfma_f32_16x16x32_bf16 a[0:3], v[32:35], v[28:31], a[0:3]
    v_perm_b32 v32, v101, v97, s67
    s_add_u32 s79, s60, 4096
    s_pack_lh_b32_b16 s60, s79, s60
    buffer_load_dwordx4 v[80:83], v3, s[8:11], s60 offen offset:0 nt
    v_perm_b32 v33, v109, v105, s67
    v_perm_b32 v34, v117, v113, s67
    v_perm_b32 v35, v125, v121, s67
    v_mfma_f32_16x16x32_bf16 a[4:7], v[36:39], v[28:31], a[4:7]
    v_perm_b32 v36, v103, v99, s67
    buffer_load_dwordx4 v[84:87], v3, s[8:11], s60 offen offset:1024 nt
    v_perm_b32 v37, v111, v107, s67
    v_perm_b32 v38, v119, v115, s67
    v_perm_b32 v39, v127, v123, s67
    v_mfma_f32_16x16x32_bf16 a[0:3], v[32:35], v[40:43], a[0:3]
    v_perm_b32 v32, v101, v97, s68
    buffer_load_dwordx4 v[88:91], v3, s[8:11], s60 offen offset:2048 nt
    v_perm_b32 v33, v109, v105, s68
    v_perm_b32 v34, v117, v113, s68
    v_perm_b32 v35, v125, v121, s68
    v_mfma_f32_16x16x32_bf16 a[4:7], v[36:39], v[40:43], a[4:7]
    v_perm_b32 v36, v103, v99, s68
    buffer_load_dwordx4 v[92:95], v3, s[8:11], s60 offen offset:3072 nt
    s_add_u32 s79, s60, 4096
    s_pack_lh_b32_b16 s60, s79, s60
    v_perm_b32 v37, v111, v107, s68
    v_perm_b32 v38, v119, v115, s68
    v_perm_b32 v39, v127, v123, s68
    v_mfma_f32_16x16x32_bf16 a[0:3], v[32:35], v[44:47], a[0:3]
    s_nop 0
    v_mfma_f32_16x16x32_bf16 a[4:7], v[36:39], v[44:47], a[4:7]
    v_mov_b32_dpp v24, v16 row_ror:8 row_mask:0xf bank_mask:0x1
    v_mov_b32_dpp v25, v17 row_ror:8 row_mask:0xf bank_mask:0x1
    v_mov_b32_dpp v26, v18 row_ror:8 row_mask:0xf bank_mask:0x1
    v_mov_b32_dpp v27, v19 row_ror:8 row_mask:0xf bank_mask:0x1
    v_mov_b32_dpp v28, v16 row_ror:12 row_mask:0xf bank_mask:0x2
    v_mov_b32_dpp v29, v17 row_ror:12 row_mask:0xf bank_mask:0x2
    v_mov_b32_dpp v30, v18 row_ror:12 row_mask:0xf bank_mask:0x2
    v_mov_b32_dpp v31, v19 row_ror:12 row_mask:0xf bank_mask:0x2
    v_mov_b32_dpp v40, v16 quad_perm:[0,1,2,3] row_mask:0xf bank_mask:0x4
    v_mov_b32_dpp v41, v17 quad_perm:[0,1,2,3] row_mask:0xf bank_mask:0x4
    v_mov_b32_dpp v42, v18 quad_perm:[0,1,2,3] row_mask:0xf bank_mask:0x4
    v_mov_b32_dpp v43, v19 quad_perm:[0,1,2,3] row_mask:0xf bank_mask:0x4
    v_mov_b32_dpp v44, v16 row_ror:4 row_mask:0xf bank_mask:0x8
    v_mov_b32_dpp v45, v17 row_ror:4 row_mask:0xf bank_mask:0x8
    v_mov_b32_dpp v46, v18 row_ror:4 row_mask:0xf bank_mask:0x8
    v_mov_b32_dpp v47, v19 row_ror:4 row_mask:0xf bank_mask:0x8
    s_waitcnt vmcnt(33)
    v_perm_b32 v32, v132, v128, s67
    v_perm_b32 v33, v140, v136, s67
    v_perm_b32 v34, v148, v144, s67
    v_perm_b32 v35, v156, v152, s67
    v_perm_b32 v36, v134, v130, s67
    v_perm_b32 v37, v142, v138, s67
    v_perm_b32 v38, v150, v146, s67
    v_perm_b32 v39, v158, v154, s67
    v_mfma_f32_16x16x32_bf16 a[0:3], v[32:35], v[24:27], a[0:3]
    v_perm_b32 v32, v132, v128, s68
    v_perm_b32 v33, v140, v136, s68
    v_perm_b32 v34, v148, v144, s68
    v_perm_b32 v35, v156, v152, s68
    v_mfma_f32_16x16x32_bf16 a[4:7], v[36:39], v[24:27], a[4:7]
    v_perm_b32 v36, v134, v130, s68
    v_perm_b32 v37, v142, v138, s68
    v_perm_b32 v38, v150, v146, s68
    v_perm_b32 v39, v158, v154, s68
    v_mfma_f32_16x16x32_bf16 a[0:3], v[32:35], v[28:31], a[0:3]
    v_perm_b32 v32, v133, v129, s67
    v_perm_b32 v33, v141, v137, s67
    v_perm_b32 v34, v149, v145, s67
    v_perm_b32 v35, v157, v153, s67
    v_mfma_f32_16x16x32_bf16 a[4:7], v[36:39], v[28:31], a[4:7]
    v_perm_b32 v36, v135, v131, s67
    v_perm_b32 v37, v143, v139, s67
    v_perm_b32 v38, v151, v147, s67
    v_perm_b32 v39, v159, v155, s67
    v_mfma_f32_16x16x32_bf16 a[0:3], v[32:35], v[40:43], a[0:3]
    v_perm_b32 v32, v133, v129, s68
    v_perm_b32 v33, v141, v137, s68
    v_perm_b32 v34, v149, v145, s68
    v_perm_b32 v35, v157, v153, s68
    v_mfma_f32_16x16x32_bf16 a[4:7], v[36:39], v[40:43], a[4:7]
    v_perm_b32 v36, v135, v131, s68
    v_perm_b32 v37, v143, v139, s68
    v_perm_b32 v38, v151, v147, s68
    v_perm_b32 v39, v159, v155, s68
    v_mfma_f32_16x16x32_bf16 a[0:3], v[32:35], v[44:47], a[0:3]
    s_nop 0
    v_mfma_f32_16x16x32_bf16 a[4:7], v[36:39], v[44:47], a[4:7]
    v_mov_b32_dpp v24, v16 row_ror:4 row_mask:0xf bank_mask:0x1
    v_mov_b32_dpp v25, v17 row_ror:4 row_mask:0xf bank_mask:0x1
    v_mov_b32_dpp v26, v18 row_ror:4 row_mask:0xf bank_mask:0x1
    v_mov_b32_dpp v27, v19 row_ror:4 row_mask:0xf bank_mask:0x1
    v_mov_b32_dpp v28, v16 row_ror:8 row_mask:0xf bank_mask:0x2
    v_mov_b32_dpp v29, v17 row_ror:8 row_mask:0xf bank_mask:0x2
    v_mov_b32_dpp v30, v18 row_ror:8 row_mask:0xf bank_mask:0x2
    v_mov_b32_dpp v31, v19 row_ror:8 row_mask:0xf bank_mask:0x2
    v_mov_b32_dpp v40, v16 row_ror:12 row_mask:0xf bank_mask:0x4
    v_mov_b32_dpp v41, v17 row_ror:12 row_mask:0xf bank_mask:0x4
    v_mov_b32_dpp v42, v18 row_ror:12 row_mask:0xf bank_mask:0x4
    v_mov_b32_dpp v43, v19 row_ror:12 row_mask:0xf bank_mask:0x4
    v_mov_b32_dpp v44, v16 quad_perm:[0,1,2,3] row_mask:0xf bank_mask:0x8
    v_mov_b32_dpp v45, v17 quad_perm:[0,1,2,3] row_mask:0xf bank_mask:0x8
    v_mov_b32_dpp v46, v18 quad_perm:[0,1,2,3] row_mask:0xf bank_mask:0x8
    v_mov_b32_dpp v47, v19 quad_perm:[0,1,2,3] row_mask:0xf bank_mask:0x8
    s_waitcnt vmcnt(25)
    s_mov_b32 s61, 0x20000
    buffer_load_dwordx4 v[48:51], v6, s[12:15], s61 offen offset:0 sc1
    v_perm_b32 v32, v228, v224, s67
    v_perm_b32 v33, v236, v232, s67
    v_perm_b32 v34, v244, v240, s67
    v_perm_b32 v35, v252, v248, s67
    s_mov_b32 s61, 0x20000
    buffer_load_dwordx4 v[52:55], v6, s[12:15], s61 offen offset:1024 sc1
    v_perm_b32 v36, v230, v226, s67
    v_perm_b32 v37, v238, v234, s67
    v_perm_b32 v38, v246, v242, s67
    v_perm_b32 v39, v254, v250, s67
    buffer_load_dwordx4 v[96:99], v3, s[8:11], s60 offen offset:0 nt
    v_mfma_f32_16x16x32_bf16 a[0:3], v[32:35], v[24:27], a[0:3]
    v_perm_b32 v32, v228, v224, s68
    v_perm_b32 v33, v236, v232, s68
    v_perm_b32 v34, v244, v240, s68
    buffer_load_dwordx4 v[100:103], v3, s[8:11], s60 offen offset:1024 nt
    v_perm_b32 v35, v252, v248, s68
    v_mfma_f32_16x16x32_bf16 a[4:7], v[36:39], v[24:27], a[4:7]
    v_perm_b32 v36, v230, v226, s68
    v_perm_b32 v37, v238, v234, s68
    buffer_load_dwordx4 v[104:107], v3, s[8:11], s60 offen offset:2048 nt
    v_perm_b32 v38, v246, v242, s68
    v_perm_b32 v39, v254, v250, s68
    v_mfma_f32_16x16x32_bf16 a[0:3], v[32:35], v[28:31], a[0:3]
    v_perm_b32 v32, v229, v225, s67
    buffer_load_dwordx4 v[108:111], v3, s[8:11], s60 offen offset:3072 nt
    v_perm_b32 v33, v237, v233, s67
    v_perm_b32 v34, v245, v241, s67
    v_perm_b32 v35, v253, v249, s67
    v_mfma_f32_16x16x32_bf16 a[4:7], v[36:39], v[28:31], a[4:7]
    s_add_u32 s79, s60, 4096
    s_pack_lh_b32_b16 s60, s79, s60
    buffer_load_dwordx4 v[112:115], v3, s[8:11], s60 offen offset:0 nt
    v_perm_b32 v36, v231, v227, s67
    v_perm_b32 v37, v239, v235, s67
    v_perm_b32 v38, v247, v243, s67
    v_perm_b32 v39, v255, v251, s67
    buffer_load_dwordx4 v[116:119], v3, s[8:11], s60 offen offset:1024 nt
    v_mfma_f32_16x16x32_bf16 a[0:3], v[32:35], v[40:43], a[0:3]
    v_perm_b32 v32, v229, v225, s68
    v_perm_b32 v33, v237, v233, s68
    v_perm_b32 v34, v245, v241, s68
    buffer_load_dwordx4 v[120:123], v3, s[8:11], s60 offen offset:2048 nt
    v_perm_b32 v35, v253, v249, s68
    v_mfma_f32_16x16x32_bf16 a[4:7], v[36:39], v[40:43], a[4:7]
    v_perm_b32 v36, v231, v227, s68
    v_perm_b32 v37, v239, v235, s68
    buffer_load_dwordx4 v[124:127], v3, s[8:11], s60 offen offset:3072 nt
    s_add_u32 s79, s60, 4096
    s_pack_lh_b32_b16 s60, s79, s60
    v_perm_b32 v38, v247, v243, s68
    v_perm_b32 v39, v255, v251, s68
    v_mfma_f32_16x16x32_bf16 a[0:3], v[32:35], v[44:47], a[0:3]
    s_nop 0
    v_mfma_f32_16x16x32_bf16 a[4:7], v[36:39], v[44:47], a[4:7]
    v_mov_b32_dpp v24, v20 quad_perm:[0,1,2,3] row_mask:0xf bank_mask:0x1
    v_mov_b32_dpp v25, v21 quad_perm:[0,1,2,3] row_mask:0xf bank_mask:0x1
    v_mov_b32_dpp v26, v22 quad_perm:[0,1,2,3] row_mask:0xf bank_mask:0x1
    v_mov_b32_dpp v27, v23 quad_perm:[0,1,2,3] row_mask:0xf bank_mask:0x1
    v_mov_b32_dpp v28, v20 row_ror:4 row_mask:0xf bank_mask:0x2
    v_mov_b32_dpp v29, v21 row_ror:4 row_mask:0xf bank_mask:0x2
    v_mov_b32_dpp v30, v22 row_ror:4 row_mask:0xf bank_mask:0x2
    v_mov_b32_dpp v31, v23 row_ror:4 row_mask:0xf bank_mask:0x2
    v_mov_b32_dpp v40, v20 row_ror:8 row_mask:0xf bank_mask:0x4
    v_mov_b32_dpp v41, v21 row_ror:8 row_mask:0xf bank_mask:0x4
    v_mov_b32_dpp v42, v22 row_ror:8 row_mask:0xf bank_mask:0x4
    v_mov_b32_dpp v43, v23 row_ror:8 row_mask:0xf bank_mask:0x4
    v_mov_b32_dpp v44, v20 row_ror:12 row_mask:0xf bank_mask:0x8
    v_mov_b32_dpp v45, v21 row_ror:12 row_mask:0xf bank_mask:0x8
    v_mov_b32_dpp v46, v22 row_ror:12 row_mask:0xf bank_mask:0x8
    v_mov_b32_dpp v47, v23 row_ror:12 row_mask:0xf bank_mask:0x8
    s_waitcnt vmcnt(27)
    v_perm_b32 v32, v164, v160, s67
    v_perm_b32 v33, v172, v168, s67
    v_perm_b32 v34, v180, v176, s67
    v_perm_b32 v35, v188, v184, s67
    v_perm_b32 v36, v166, v162, s67
    v_perm_b32 v37, v174, v170, s67
    v_perm_b32 v38, v182, v178, s67
    v_perm_b32 v39, v190, v186, s67
    v_mfma_f32_16x16x32_bf16 a[0:3], v[32:35], v[24:27], a[0:3]
    v_perm_b32 v32, v164, v160, s68
    v_perm_b32 v33, v172, v168, s68
    v_perm_b32 v34, v180, v176, s68
    v_perm_b32 v35, v188, v184, s68
    v_mfma_f32_16x16x32_bf16 a[4:7], v[36:39], v[24:27], a[4:7]
    v_perm_b32 v36, v166, v162, s68
    v_perm_b32 v37, v174, v170, s68
    v_perm_b32 v38, v182, v178, s68
    v_perm_b32 v39, v190, v186, s68
    v_mfma_f32_16x16x32_bf16 a[0:3], v[32:35], v[28:31], a[0:3]
    v_perm_b32 v32, v165, v161, s67
    v_perm_b32 v33, v173, v169, s67
    v_perm_b32 v34, v181, v177, s67
    v_perm_b32 v35, v189, v185, s67
    v_mfma_f32_16x16x32_bf16 a[4:7], v[36:39], v[28:31], a[4:7]
    v_perm_b32 v36, v167, v163, s67
    v_perm_b32 v37, v175, v171, s67
    v_perm_b32 v38, v183, v179, s67
    v_perm_b32 v39, v191, v187, s67
    v_mfma_f32_16x16x32_bf16 a[0:3], v[32:35], v[40:43], a[0:3]
    v_perm_b32 v32, v165, v161, s68
    v_perm_b32 v33, v173, v169, s68
    v_perm_b32 v34, v181, v177, s68
    v_perm_b32 v35, v189, v185, s68
    v_mfma_f32_16x16x32_bf16 a[4:7], v[36:39], v[40:43], a[4:7]
    v_perm_b32 v36, v167, v163, s68
    v_perm_b32 v37, v175, v171, s68
    v_perm_b32 v38, v183, v179, s68
    v_perm_b32 v39, v191, v187, s68
    v_mfma_f32_16x16x32_bf16 a[0:3], v[32:35], v[44:47], a[0:3]
    s_nop 0
    v_mfma_f32_16x16x32_bf16 a[4:7], v[36:39], v[44:47], a[4:7]
    v_mov_b32_dpp v24, v20 row_ror:12 row_mask:0xf bank_mask:0x1
    v_mov_b32_dpp v25, v21 row_ror:12 row_mask:0xf bank_mask:0x1
    v_mov_b32_dpp v26, v22 row_ror:12 row_mask:0xf bank_mask:0x1
    v_mov_b32_dpp v27, v23 row_ror:12 row_mask:0xf bank_mask:0x1
    v_mov_b32_dpp v28, v20 quad_perm:[0,1,2,3] row_mask:0xf bank_mask:0x2
    v_mov_b32_dpp v29, v21 quad_perm:[0,1,2,3] row_mask:0xf bank_mask:0x2
    v_mov_b32_dpp v30, v22 quad_perm:[0,1,2,3] row_mask:0xf bank_mask:0x2
    v_mov_b32_dpp v31, v23 quad_perm:[0,1,2,3] row_mask:0xf bank_mask:0x2
    v_mov_b32_dpp v40, v20 row_ror:4 row_mask:0xf bank_mask:0x4
    v_mov_b32_dpp v41, v21 row_ror:4 row_mask:0xf bank_mask:0x4
    v_mov_b32_dpp v42, v22 row_ror:4 row_mask:0xf bank_mask:0x4
    v_mov_b32_dpp v43, v23 row_ror:4 row_mask:0xf bank_mask:0x4
    v_mov_b32_dpp v44, v20 row_ror:8 row_mask:0xf bank_mask:0x8
    v_mov_b32_dpp v45, v21 row_ror:8 row_mask:0xf bank_mask:0x8
    v_mov_b32_dpp v46, v22 row_ror:8 row_mask:0xf bank_mask:0x8
    v_mov_b32_dpp v47, v23 row_ror:8 row_mask:0xf bank_mask:0x8
    s_waitcnt vmcnt(19)
    v_perm_b32 v32, v196, v192, s67
    v_perm_b32 v33, v204, v200, s67
    v_perm_b32 v34, v212, v208, s67
    v_perm_b32 v35, v220, v216, s67
    v_perm_b32 v36, v198, v194, s67
    v_perm_b32 v37, v206, v202, s67
    v_perm_b32 v38, v214, v210, s67
    v_perm_b32 v39, v222, v218, s67
    v_mfma_f32_16x16x32_bf16 a[0:3], v[32:35], v[24:27], a[0:3]
    v_perm_b32 v32, v196, v192, s68
    v_perm_b32 v33, v204, v200, s68
    v_perm_b32 v34, v212, v208, s68
    v_perm_b32 v35, v220, v216, s68
    v_mfma_f32_16x16x32_bf16 a[4:7], v[36:39], v[24:27], a[4:7]
    v_perm_b32 v36, v198, v194, s68
    v_perm_b32 v37, v206, v202, s68
    v_perm_b32 v38, v214, v210, s68
    v_perm_b32 v39, v222, v218, s68
    v_mfma_f32_16x16x32_bf16 a[0:3], v[32:35], v[28:31], a[0:3]
    v_perm_b32 v32, v197, v193, s67
    v_perm_b32 v33, v205, v201, s67
    v_perm_b32 v34, v213, v209, s67
    v_perm_b32 v35, v221, v217, s67
    v_mfma_f32_16x16x32_bf16 a[4:7], v[36:39], v[28:31], a[4:7]
    v_perm_b32 v36, v199, v195, s67
    v_perm_b32 v37, v207, v203, s67
    v_perm_b32 v38, v215, v211, s67
    v_perm_b32 v39, v223, v219, s67
    v_mfma_f32_16x16x32_bf16 a[0:3], v[32:35], v[40:43], a[0:3]
    v_perm_b32 v32, v197, v193, s68
    v_perm_b32 v33, v205, v201, s68
    v_perm_b32 v34, v213, v209, s68
    v_perm_b32 v35, v221, v217, s68
    v_mfma_f32_16x16x32_bf16 a[4:7], v[36:39], v[40:43], a[4:7]
    v_perm_b32 v36, v199, v195, s68
    v_perm_b32 v37, v207, v203, s68
    v_perm_b32 v38, v215, v211, s68
    v_perm_b32 v39, v223, v219, s68
    v_mfma_f32_16x16x32_bf16 a[0:3], v[32:35], v[44:47], a[0:3]
    s_nop 0
    v_mfma_f32_16x16x32_bf16 a[4:7], v[36:39], v[44:47], a[4:7]
    s_mov_b32 s61, 0x20000
    buffer_load_dwordx4 v[56:59], v6, s[12:15], s61 offen offset:0 sc1
    s_mov_b32 s61, 0x20000
    buffer_load_dwordx4 v[60:63], v6, s[12:15], s61 offen offset:1024 sc1
    v_mov_b32_dpp v24, v20 row_ror:8 row_mask:0xf bank_mask:0x1
    v_mov_b32_dpp v25, v21 row_ror:8 row_mask:0xf bank_mask:0x1
    v_mov_b32_dpp v26, v22 row_ror:8 row_mask:0xf bank_mask:0x1
    v_mov_b32_dpp v27, v23 row_ror:8 row_mask:0xf bank_mask:0x1
    v_mov_b32_dpp v28, v20 row_ror:12 row_mask:0xf bank_mask:0x2
    v_mov_b32_dpp v29, v21 row_ror:12 row_mask:0xf bank_mask:0x2
    v_mov_b32_dpp v30, v22 row_ror:12 row_mask:0xf bank_mask:0x2
    v_mov_b32_dpp v31, v23 row_ror:12 row_mask:0xf bank_mask:0x2
    v_mov_b32_dpp v40, v20 quad_perm:[0,1,2,3] row_mask:0xf bank_mask:0x4
    v_mov_b32_dpp v41, v21 quad_perm:[0,1,2,3] row_mask:0xf bank_mask:0x4
    v_mov_b32_dpp v42, v22 quad_perm:[0,1,2,3] row_mask:0xf bank_mask:0x4
    v_mov_b32_dpp v43, v23 quad_perm:[0,1,2,3] row_mask:0xf bank_mask:0x4
    v_mov_b32_dpp v44, v20 row_ror:4 row_mask:0xf bank_mask:0x8
    v_mov_b32_dpp v45, v21 row_ror:4 row_mask:0xf bank_mask:0x8
    v_mov_b32_dpp v46, v22 row_ror:4 row_mask:0xf bank_mask:0x8
    v_mov_b32_dpp v47, v23 row_ror:4 row_mask:0xf bank_mask:0x8
    s_waitcnt vmcnt(12)
    v_perm_b32 v32, v68, v64, s67
    v_perm_b32 v33, v76, v72, s67
    v_perm_b32 v34, v84, v80, s67
    v_perm_b32 v35, v92, v88, s67
    v_perm_b32 v36, v70, v66, s67
    v_perm_b32 v37, v78, v74, s67
    v_perm_b32 v38, v86, v82, s67
    v_perm_b32 v39, v94, v90, s67
    v_mfma_f32_16x16x32_bf16 a[0:3], v[32:35], v[24:27], a[0:3]
    v_perm_b32 v32, v68, v64, s68
    v_perm_b32 v33, v76, v72, s68
    v_perm_b32 v34, v84, v80, s68
    v_perm_b32 v35, v92, v88, s68
    v_mfma_f32_16x16x32_bf16 a[4:7], v[36:39], v[24:27], a[4:7]
    v_perm_b32 v36, v70, v66, s68
    v_perm_b32 v37, v78, v74, s68
    v_perm_b32 v38, v86, v82, s68
    v_perm_b32 v39, v94, v90, s68
    v_mfma_f32_16x16x32_bf16 a[0:3], v[32:35], v[28:31], a[0:3]
    v_perm_b32 v32, v69, v65, s67
    v_perm_b32 v33, v77, v73, s67
    v_perm_b32 v34, v85, v81, s67
    v_perm_b32 v35, v93, v89, s67
    v_mfma_f32_16x16x32_bf16 a[4:7], v[36:39], v[28:31], a[4:7]
    v_perm_b32 v36, v71, v67, s67
    v_perm_b32 v37, v79, v75, s67
    v_perm_b32 v38, v87, v83, s67
    v_perm_b32 v39, v95, v91, s67
    v_mfma_f32_16x16x32_bf16 a[0:3], v[32:35], v[40:43], a[0:3]
    v_perm_b32 v32, v69, v65, s68
    v_perm_b32 v33, v77, v73, s68
    v_perm_b32 v34, v85, v81, s68
    v_perm_b32 v35, v93, v89, s68
    v_mfma_f32_16x16x32_bf16 a[4:7], v[36:39], v[40:43], a[4:7]
    v_perm_b32 v36, v71, v67, s68
    v_perm_b32 v37, v79, v75, s68
    v_perm_b32 v38, v87, v83, s68
    v_perm_b32 v39, v95, v91, s68
    v_mfma_f32_16x16x32_bf16 a[0:3], v[32:35], v[44:47], a[0:3]
    s_nop 0
    v_mfma_f32_16x16x32_bf16 a[4:7], v[36:39], v[44:47], a[4:7]
    s_waitcnt vmcnt(10)
    v_xor_b32 v10, s58, v50
    v_bitop3_b32 v10, v51, s58, v10 bitop3:0xbe
    v_bitop3_b32 v10, v54, s58, v10 bitop3:0xbe
    v_bitop3_b32 v10, v55, s58, v10 bitop3:0xbe
    v_cmp_ne_u32 vcc, 0, v10
    s_mov_b32 s34, 1
    s_cbranch_vccnz MLS_N
    v_max_f32 v50, v48, v52
    s_nop 1
    v_max_f32_dpp v50, v50, v50 row_ror:4 row_mask:0xf bank_mask:0xf
    s_nop 1
    v_max_f32_dpp v50, v50, v50 row_ror:8 row_mask:0xf bank_mask:0xf
    v_mov_b32 v10, v50
    s_nop 1
    v_permlane16_swap_b32 v50, v10
    v_max_f32 v50, v50, v10
    v_mov_b32 v10, v50
    s_nop 1
    v_permlane32_swap_b32 v50, v10
    v_max_f32 v50, v50, v10
    v_sub_f32 v48, v48, v50
    v_sub_f32 v52, v52, v50
    v_sub_f32 v9, v9, v50
    v_mul_f32 v48, s69, v48
    v_mul_f32 v52, s69, v52
    v_mul_f32 v9, s69, v9
    v_exp_f32 v48, v48
    v_exp_f32 v52, v52
    v_exp_f32 v9, v9
    v_mul_f32 v49, v49, v48
    v_fmac_f32 v49, v53, v52
    s_nop 1
    v_add_f32_dpp v49, v49, v49 row_ror:4 row_mask:0xf bank_mask:0xf
    s_nop 1
    v_add_f32_dpp v49, v49, v49 row_ror:8 row_mask:0xf bank_mask:0xf
    v_mov_b32 v10, v49
    s_nop 1
    v_permlane16_swap_b32 v49, v10
    v_add_f32 v49, v49, v10
    v_mov_b32 v10, v49
    s_nop 1
    v_permlane32_swap_b32 v49, v10
    v_add_f32 v49, v49, v10
    v_rcp_f32 v49, v49
    s_nop 0
    v_mul_f32 v9, v9, v49
    v_lshlrev_b32 v10, 4, v1
    s_lshl_b32 s64, s3, 2
    v_add_u32 v10, s64, v10
    s_mov_b64 exec, 0xf
    ds_write_b32 v10, v9 offset:26880
    s_mov_b64 exec, -1
    s_mov_b32 s34, 0
MLS_N:
    v_mov_b32_dpp v24, v20 row_ror:4 row_mask:0xf bank_mask:0x1
    v_mov_b32_dpp v25, v21 row_ror:4 row_mask:0xf bank_mask:0x1
    v_mov_b32_dpp v26, v22 row_ror:4 row_mask:0xf bank_mask:0x1
    v_mov_b32_dpp v27, v23 row_ror:4 row_mask:0xf bank_mask:0x1
    v_mov_b32_dpp v28, v20 row_ror:8 row_mask:0xf bank_mask:0x2
    v_mov_b32_dpp v29, v21 row_ror:8 row_mask:0xf bank_mask:0x2
    v_mov_b32_dpp v30, v22 row_ror:8 row_mask:0xf bank_mask:0x2
    v_mov_b32_dpp v31, v23 row_ror:8 row_mask:0xf bank_mask:0x2
    v_mov_b32_dpp v40, v20 row_ror:12 row_mask:0xf bank_mask:0x4
    v_mov_b32_dpp v41, v21 row_ror:12 row_mask:0xf bank_mask:0x4
    v_mov_b32_dpp v42, v22 row_ror:12 row_mask:0xf bank_mask:0x4
    v_mov_b32_dpp v43, v23 row_ror:12 row_mask:0xf bank_mask:0x4
    v_mov_b32_dpp v44, v20 quad_perm:[0,1,2,3] row_mask:0xf bank_mask:0x8
    v_mov_b32_dpp v45, v21 quad_perm:[0,1,2,3] row_mask:0xf bank_mask:0x8
    v_mov_b32_dpp v46, v22 quad_perm:[0,1,2,3] row_mask:0xf bank_mask:0x8
    v_mov_b32_dpp v47, v23 quad_perm:[0,1,2,3] row_mask:0xf bank_mask:0x8
    s_waitcnt vmcnt(2)
    v_perm_b32 v32, v100, v96, s67
    v_perm_b32 v33, v108, v104, s67
    v_perm_b32 v34, v116, v112, s67
    v_perm_b32 v35, v124, v120, s67
    v_perm_b32 v36, v102, v98, s67
    v_perm_b32 v37, v110, v106, s67
    v_perm_b32 v38, v118, v114, s67
    v_perm_b32 v39, v126, v122, s67
    v_mfma_f32_16x16x32_bf16 a[0:3], v[32:35], v[24:27], a[0:3]
    v_perm_b32 v32, v100, v96, s68
    v_perm_b32 v33, v108, v104, s68
    v_perm_b32 v34, v116, v112, s68
    v_perm_b32 v35, v124, v120, s68
    v_mfma_f32_16x16x32_bf16 a[4:7], v[36:39], v[24:27], a[4:7]
    v_perm_b32 v36, v102, v98, s68
    v_perm_b32 v37, v110, v106, s68
    v_perm_b32 v38, v118, v114, s68
    v_perm_b32 v39, v126, v122, s68
    v_mfma_f32_16x16x32_bf16 a[0:3], v[32:35], v[28:31], a[0:3]
    v_perm_b32 v32, v101, v97, s67
    v_perm_b32 v33, v109, v105, s67
    v_perm_b32 v34, v117, v113, s67
    v_perm_b32 v35, v125, v121, s67
    v_mfma_f32_16x16x32_bf16 a[4:7], v[36:39], v[28:31], a[4:7]
    v_perm_b32 v36, v103, v99, s67
    v_perm_b32 v37, v111, v107, s67
    v_perm_b32 v38, v119, v115, s67
    v_perm_b32 v39, v127, v123, s67
    v_mfma_f32_16x16x32_bf16 a[0:3], v[32:35], v[40:43], a[0:3]
    v_perm_b32 v32, v101, v97, s68
    v_perm_b32 v33, v109, v105, s68
    v_perm_b32 v34, v117, v113, s68
    v_perm_b32 v35, v125, v121, s68
    v_mfma_f32_16x16x32_bf16 a[4:7], v[36:39], v[40:43], a[4:7]
    v_perm_b32 v36, v103, v99, s68
    v_perm_b32 v37, v111, v107, s68
    v_perm_b32 v38, v119, v115, s68
    v_perm_b32 v39, v127, v123, s68
    v_mfma_f32_16x16x32_bf16 a[0:3], v[32:35], v[44:47], a[0:3]
    s_nop 0
    v_mfma_f32_16x16x32_bf16 a[4:7], v[36:39], v[44:47], a[4:7]
    s_cmp_eq_u32 s34, 0
    s_cbranch_scc1 MLD_N
    s_mov_b32 s62, 0x40000
    s_waitcnt vmcnt(0)
MLR_N:
    v_xor_b32 v10, s58, v58
    v_bitop3_b32 v10, v59, s58, v10 bitop3:0xbe
    v_bitop3_b32 v10, v62, s58, v10 bitop3:0xbe
    v_bitop3_b32 v10, v63, s58, v10 bitop3:0xbe
    v_cmp_ne_u32 vcc, 0, v10
    s_cbranch_vccz MLF_N
    s_mov_b32 s61, 0x20000
    buffer_load_dwordx4 v[56:59], v6, s[12:15], s61 offen offset:0 sc1
    s_mov_b32 s61, 0x20000
    buffer_load_dwordx4 v[60:63], v6, s[12:15], s61 offen offset:1024 sc1
    s_waitcnt vmcnt(0)
    s_sub_u32 s62, s62, 1
    s_cbranch_scc0 MLR_N
MLF_N:
    v_max_f32 v58, v56, v60
    s_nop 1
    v_max_f32_dpp v58, v58, v58 row_ror:4 row_mask:0xf bank_mask:0xf
    s_nop 1
    v_max_f32_dpp v58, v58, v58 row_ror:8 row_mask:0xf bank_mask:0xf
    v_mov_b32 v10, v58
    s_nop 1
    v_permlane16_swap_b32 v58, v10
    v_max_f32 v58, v58, v10
    v_mov_b32 v10, v58
    s_nop 1
    v_permlane32_swap_b32 v58, v10
    v_max_f32 v58, v58, v10
    v_sub_f32 v56, v56, v58
    v_sub_f32 v60, v60, v58
    v_sub_f32 v9, v9, v58
    v_mul_f32 v56, s69, v56
    v_mul_f32 v60, s69, v60
    v_mul_f32 v9, s69, v9
    v_exp_f32 v56, v56
    v_exp_f32 v60, v60
    v_exp_f32 v9, v9
    v_mul_f32 v57, v57, v56
    v_fmac_f32 v57, v61, v60
    s_nop 1
    v_add_f32_dpp v57, v57, v57 row_ror:4 row_mask:0xf bank_mask:0xf
    s_nop 1
    v_add_f32_dpp v57, v57, v57 row_ror:8 row_mask:0xf bank_mask:0xf
    v_mov_b32 v10, v57
    s_nop 1
    v_permlane16_swap_b32 v57, v10
    v_add_f32 v57, v57, v10
    v_mov_b32 v10, v57
    s_nop 1
    v_permlane32_swap_b32 v57, v10
    v_add_f32 v57, v57, v10
    v_rcp_f32 v57, v57
    s_nop 0
    v_mul_f32 v9, v9, v57
    v_lshlrev_b32 v10, 4, v1
    s_lshl_b32 s64, s3, 2
    v_add_u32 v10, s64, v10
    s_mov_b64 exec, 0xf
    ds_write_b32 v10, v9 offset:26880
    s_mov_b64 exec, -1
MLD_N:
    s_nop 3
    ds_write_b128 v8, a[0:3] offset:18688
    s_nop 0
    ds_write_b128 v8, a[4:7] offset:19712
    s_waitcnt lgkmcnt(0)
    s_barrier
    s_cmp_ge_u32 s3, 2
    s_cbranch_scc1 SK2_N
    ds_read_b128 v[48:51], v15 offset:26880
    ds_read_b128 v[32:35], v2 offset:18688
    ds_read_b128 v[36:39], v2 offset:20736
    ds_read_b128 v[40:43], v2 offset:22784
    ds_read_b128 v[44:47], v2 offset:24832
    s_waitcnt lgkmcnt(2)
    v_pk_mul_f32 v[32:33], v[32:33], v[48:49] op_sel_hi:[1,0]
    v_pk_mul_f32 v[34:35], v[34:35], v[48:49] op_sel_hi:[1,0]
    v_pk_fma_f32 v[32:33], v[36:37], v[48:49], v[32:33] op_sel:[0,1,0] op_sel_hi:[1,1,1]
    v_pk_fma_f32 v[34:35], v[38:39], v[48:49], v[34:35] op_sel:[0,1,0] op_sel_hi:[1,1,1]
    s_waitcnt lgkmcnt(0)
    v_pk_fma_f32 v[32:33], v[40:41], v[50:51], v[32:33] op_sel_hi:[1,0,1]
    v_pk_fma_f32 v[34:35], v[42:43], v[50:51], v[34:35] op_sel_hi:[1,0,1]
    v_pk_fma_f32 v[32:33], v[44:45], v[50:51], v[32:33] op_sel:[0,1,0] op_sel_hi:[1,1,1]
    v_pk_fma_f32 v[34:35], v[46:47], v[50:51], v[34:35] op_sel:[0,1,0] op_sel_hi:[1,1,1]
    v_bfi_b32 v32, s65, v4, v32
    v_bfi_b32 v33, s65, v4, v33
    v_bfi_b32 v34, s65, v4, v34
    v_bfi_b32 v35, s65, v4, v35
    s_mov_b32 s61, 0x80000
    buffer_store_dwordx4 v[32:35], v14, s[12:15], s61 offen offset:0 sc1
SK2_N:
DONE_N:
    s_waitcnt vmcnt(0)
    s_endpgm
.section .rodata,"a"
.p2align 6
.amdhsa_kernel adaLN_cond__gqa_block_cached__glu_gated_bilinear__decode_kernel
  .amdhsa_next_free_vgpr 512
  .amdhsa_next_free_sgpr 102
  .amdhsa_accum_offset 256
  .amdhsa_group_segment_fixed_size 0
  .amdhsa_kernarg_size 112
  .amdhsa_user_sgpr_count 2
  .amdhsa_user_sgpr_kernarg_segment_ptr 1
  .amdhsa_system_sgpr_workgroup_id_x 1
.end_amdhsa_kernel
```
